```python
import torch

def _softmax(x, axis=-1):
    return torch.softmax(x, dim=axis)

def _gelu(x):
    return torch.nn.functional.gelu(x, approximate='tanh')

def _silu(x):
    return torch.nn.functional.silu(x)

def _sigmoid(x):
    return torch.sigmoid(x)

def _layernorm(x, axis=-1, eps=1e-05):
    m = x.mean(dim=axis, keepdim=True)
    v = x.var(dim=axis, keepdim=True, unbiased=False)
    return (x - m) / torch.sqrt(v + eps)

def _scatter_add(tgt, idx, src, axis=0):
    return tgt.clone().index_add_(axis, idx, src)

def _segment_sum(src, seg, n):
    out = torch.zeros((n,) + src.shape[1:], dtype=src.dtype)
    return out.index_add_(0, seg, src)

def _pad(x, pw):
    flat = tuple((v for pair in reversed(pw) for v in pair))
    return torch.nn.functional.pad(x, flat)
kernel_name = 'gated_mix__memory_aug_recurrent_mem_tr__dense_activation_gelu__prompt'

def setup_inputs():

    _w = lambda a: (lambda t: t.to(torch.bfloat16) if t.is_floating_point() else t)(torch.as_tensor(a))

    def _A_setup():
        B, S, Dm = (1, 2048, 512)
        H, Dh = (32, 128)
        M, seg = (8, 32)
        seg = min(seg, S)
        S = S // seg * seg
        return {'x': _w((lambda *s: torch.randn(*s, dtype=torch.bfloat16) * 0.05)(B, S, Dm)), 'mem0': _w((lambda *s: torch.randn(*s, dtype=torch.bfloat16) * 0.4)(B, M, Dm)), 'Wq': _w((lambda *s: torch.randn(*s, dtype=torch.bfloat16) * 6.4)(Dm, H, Dh) * Dm ** (-0.5)), 'Wk': _w((lambda *s: torch.randn(*s, dtype=torch.bfloat16) * 6.4)(Dm, H, Dh) * Dm ** (-0.5)), 'Wv': _w((lambda *s: torch.randn(*s, dtype=torch.bfloat16) * 0.4)(Dm, H, Dh) * Dm ** (-0.5)), 'Wo': _w((lambda *s: torch.randn(*s, dtype=torch.bfloat16) * 0.4)(H, Dh, Dm) * (H * Dh) ** (-0.5)), 'seg_len': seg}
    _A_in = _A_setup()

    def _B_setup():
        B, S, D, F = (1, 2048, 512, 1376)
        return {'x': _w((lambda *s: torch.randn(*s, dtype=torch.bfloat16) * 0.05)(B, S, D)), 'w1': _w((lambda *s: torch.randn(*s, dtype=torch.bfloat16) * 3.2)(D, F) * D ** (-0.5)), 'b1': _w((lambda *s: torch.randn(*s, dtype=torch.bfloat16) * 3.2)(F) * 0.01), 'w2': _w((lambda *s: torch.randn(*s, dtype=torch.bfloat16) * 0.2)(F, D) * F ** (-0.5)), 'b2': _w((lambda *s: torch.randn(*s, dtype=torch.bfloat16) * 0.4)(D) * 0.01)}
    _B_in = _B_setup()
    return {'A_x': _A_in['x'], 'A_mem0': _A_in['mem0'], 'A_Wq': _A_in['Wq'], 'A_Wk': _A_in['Wk'], 'A_Wv': _A_in['Wv'], 'A_Wo': _A_in['Wo'], 'A_seg_len': _A_in['seg_len'], 'B_x': _B_in['x'], 'B_w1': _B_in['w1'], 'B_b1': _B_in['b1'], 'B_w2': _B_in['w2'], 'B_b2': _B_in['b2'], 'gate_w': _w((lambda *s: torch.randn(*s, dtype=torch.bfloat16) * 0.05)(512) * 16.0)}

def reference(A_x, A_mem0, A_Wq, A_Wk, A_Wv, A_Wo, A_seg_len, B_x, B_w1, B_b1, B_w2, B_b2, gate_w):

    def _A_ref(x, mem0, Wq, Wk, Wv, Wo, seg_len):
        B, S, Dm = x.shape
        H, Dh = (Wq.shape[1], Wq.shape[2])
        M = mem0.shape[1]
        scale = Dh ** (-0.5)
        n_seg = S // seg_len
        L = M + seg_len
        idx = torch.arange(L)
        mask = (idx[:, None] < M) | (idx[:, None] >= idx[None, :])
        mem = mem0
        outs = []
        for s in range(n_seg):
            xs = x[:, s * seg_len:(s + 1) * seg_len, :].clone()
            h = torch.concatenate([mem, xs], axis=1)
            q = torch.einsum('btd,dhe->bhte', h, Wq)
            k = torch.einsum('btd,dhe->bhte', h, Wk)
            v = torch.einsum('btd,dhe->bhte', h, Wv)
            scores = torch.einsum('bhqe,bhke->bhqk', q, k) * scale
            scores = torch.where(mask[None, None], scores, -1000000000.0)
            p = _softmax(scores, axis=-1)
            o = torch.einsum('bhqk,bhke->bhqe', p, v)
            o = torch.einsum('bhte,hed->btd', o, Wo)
            mem = o[:, :M, :].clone()
            outs.append(o[:, M:, :])
        return torch.concatenate(outs, axis=1)

    def _B_ref(x, w1, b1, w2, b2):
        h = torch.einsum('bsd,df->bsf', x, w1) + b1
        h = _gelu(h)
        return torch.einsum('bsf,fd->bsd', h, w2) + b2
    x = A_x
    g = _sigmoid((x * gate_w).sum(-1, keepdims=True))
    a = _A_ref(x, A_mem0, A_Wq, A_Wk, A_Wv, A_Wo, A_seg_len)
    b = _B_ref(x, B_w1, B_b1, B_w2, B_b2)
    return g * a + (1 - g) * b
```

```asm
; @launch grid=(256,1,1) block=(256,1,1) lds=163840
.amdgcn_target "amdgcn-amd-amdhsa--gfx950"
.text
.globl gated_mix__memory_aug_recurrent_mem_tr__dense_activation_gelu__prompt_kernel
.p2align 8
.type gated_mix__memory_aug_recurrent_mem_tr__dense_activation_gelu__prompt_kernel,@function
gated_mix__memory_aug_recurrent_mem_tr__dense_activation_gelu__prompt_kernel:
    s_cmp_ge_u32 s2, 256
    s_cbranch_scc1 KEND
    s_load_dwordx2 s[8:9], s[0:1], 120
    s_getreg_b32 s64, hwreg(HW_REG_XCC_ID)
    s_and_b32 s64, s64, 7
    s_mov_b32 s91, 0
    s_mov_b32 s88, 0
    s_mov_b32 s90, 0
    v_lshrrev_b32 v1, 6, v0
    v_mov_b32 v2, 0
    v_readfirstlane_b32 s12, v1
    s_lshr_b32 s65, s2, 3
    s_cmp_lg_u32 s12, 0
    s_cbranch_scc1 ROLEF
    v_lshlrev_b32 v3, 2, v0
    s_lshl_b32 s13, s2, 7
    s_waitcnt lgkmcnt(0)
    s_and_b32 s9, s9, 0xffff
    s_mov_b32 s10, 0x10000000
    s_mov_b32 s11, 0x20000
    s_mov_b32 exec_hi, 0
    buffer_store_dword v2, v3, s[8:11], s13 offen sc1
    s_mov_b64 exec, -1
    s_branch ROLEF
KABORT:
    s_endpgm
KTICK:
    s_waitcnt vmcnt(0) lgkmcnt(0)
    s_barrier
    s_load_dwordx2 s[4:5], s[0:1], 112
    v_lshrrev_b32 v1, 6, v0
    v_mov_b32 v2, 0
    v_mov_b32 v6, 1
    v_readfirstlane_b32 s12, v1
    s_and_b32 s15, s64, 3
    s_lshl_b32 s15, s15, 6
    s_and_b32 s14, s64, 4
    s_add_u32 s15, s15, s14
    s_waitcnt lgkmcnt(0)
    s_and_b32 s5, s5, 0xffff
    s_mov_b32 s6, 0x100
    s_mov_b32 s7, 0x20000
    s_cmp_lg_u32 s12, 0
    s_cbranch_scc1 KTW
    s_mov_b64 exec, 1
    buffer_atomic_add v6, v2, s[4:7], s15 offen offset:16 sc0
    s_waitcnt vmcnt(0)
    ds_write_b32 v2, v6
    s_mov_b64 exec, -1
    s_waitcnt lgkmcnt(0)
KTW:
    s_barrier
    ds_read_b32 v6, v2
    s_waitcnt lgkmcnt(0)
    v_readfirstlane_b32 s65, v6
    s_nop 0
    s_and_b32 s65, s65, 31
    s_mov_b32 s91, 1
    s_barrier
    s_branch ROLEF
KSAFE:
    s_waitcnt vmcnt(0) lgkmcnt(0)
    s_barrier
    s_mov_b32 s91, 1
    s_mov_b32 s90, 1
    s_and_b32 s64, s2, 7
    s_lshr_b32 s65, s2, 3
    s_cmp_eq_u32 s64, 0
    s_cbranch_scc1 CHAINS
    s_branch WORK
ROLEF:
    s_waitcnt lgkmcnt(0)
    s_cmp_eq_u32 s64, 0
    s_cbranch_scc0 WORK
    s_load_dwordx2 s[4:5], s[0:1], 16
    s_load_dwordx2 s[8:9], s[0:1], 24
    s_load_dwordx2 s[12:13], s[0:1], 32
    s_load_dwordx2 s[16:17], s[0:1], 40
    s_load_dwordx2 s[20:21], s[0:1], 120
    s_load_dwordx2 s[24:25], s[0:1], 8
    s_load_dwordx2 s[28:29], s[0:1], 112
    s_xor_b32 s32, s65, 0
    v_lshrrev_b32 v121, 6, v0
    v_and_b32 v112, 63, v0
    v_readfirstlane_b32 s33, v121
    v_and_b32 v113, 15, v112
    v_lshrrev_b32 v114, 4, v112
    s_mov_b32 s35, 0x5040100
    s_mov_b32 s36, 0x7060302
    s_waitcnt lgkmcnt(0)
    s_and_b32 s5, s5, 0xffff
    s_mov_b32 s6, 0x400000
    s_mov_b32 s7, 0x20000
    s_and_b32 s9, s9, 0xffff
    s_mov_b32 s10, 0x400000
    s_mov_b32 s11, 0x20000
    s_and_b32 s13, s13, 0xffff
    s_mov_b32 s14, 0x400000
    s_mov_b32 s15, 0x20000
    s_and_b32 s17, s17, 0xffff
    s_mov_b32 s18, 0x400000
    s_mov_b32 s19, 0x20000
    s_and_b32 s21, s21, 0xffff
    s_mov_b32 s22, 0x10000000
    s_mov_b32 s23, 0x20000
    s_and_b32 s25, s25, 0xffff
    s_mov_b32 s26, 0x2000
    s_mov_b32 s27, 0x20000
    s_and_b32 s29, s29, 0xffff
    s_mov_b32 s30, 0x100
    s_mov_b32 s31, 0x20000
    v_lshrrev_b32 v115, 1, v114
    v_and_b32 v116, 1, v114
    v_lshlrev_b32 v117, 2, v116
    v_lshl_add_u32 v117, v115, 4, v117
    s_lshl_b32 s37, s32, 8
    s_lshl_b32 s38, s33, 6
    s_add_u32 s37, s37, s38
    v_lshl_add_u32 v121, v113, 2, s37
    v_lshl_add_u32 v118, v117, 13, v121
    v_add_u32 v119, 8192, v118
    s_lshl_b32 s37, s32, 17
    s_lshl_b32 s38, s33, 8
    s_add_u32 s37, s37, s38
    v_lshl_add_u32 v121, v113, 2, s37
    v_lshlrev_b32 v122, 2, v114
    v_lshl_add_u32 v120, v122, 10, v121
    s_lshl_b32 s37, s33, 15
    s_xor_b32 s37, s37, 0x0
    buffer_load_dword v32, v120, s[16:19], s37 offen offset:0
    buffer_load_dword v33, v120, s[16:19], s37 offen offset:1024
    s_lshl_b32 s37, s33, 15
    s_xor_b32 s37, s37, 0x800
    buffer_load_dword v34, v120, s[16:19], s37 offen offset:0
    buffer_load_dword v35, v120, s[16:19], s37 offen offset:1024
    s_waitcnt vmcnt(50)
    s_lshl_b32 s37, s33, 15
    s_xor_b32 s37, s37, 0x4000
    buffer_load_dword v36, v120, s[16:19], s37 offen offset:0
    buffer_load_dword v37, v120, s[16:19], s37 offen offset:1024
    s_lshl_b32 s37, s33, 15
    s_xor_b32 s37, s37, 0x4800
    buffer_load_dword v38, v120, s[16:19], s37 offen offset:0
    buffer_load_dword v39, v120, s[16:19], s37 offen offset:1024
    s_lshl_b32 s37, s33, 15
    s_xor_b32 s37, s37, 0x8000
    buffer_load_dword v40, v120, s[16:19], s37 offen offset:0
    buffer_load_dword v41, v120, s[16:19], s37 offen offset:1024
    s_lshl_b32 s37, s33, 15
    s_xor_b32 s37, s37, 0x8800
    buffer_load_dword v42, v120, s[16:19], s37 offen offset:0
    buffer_load_dword v43, v120, s[16:19], s37 offen offset:1024
    s_lshl_b32 s37, s33, 15
    s_xor_b32 s37, s37, 0xc000
    buffer_load_dword v44, v120, s[16:19], s37 offen offset:0
    buffer_load_dword v45, v120, s[16:19], s37 offen offset:1024
    s_lshl_b32 s37, s33, 15
    s_xor_b32 s37, s37, 0xc800
    buffer_load_dword v46, v120, s[16:19], s37 offen offset:0
    buffer_load_dword v47, v120, s[16:19], s37 offen offset:1024
    s_lshl_b32 s37, s33, 15
    s_xor_b32 s37, s37, 0x10000
    buffer_load_dword v48, v120, s[16:19], s37 offen offset:0
    buffer_load_dword v49, v120, s[16:19], s37 offen offset:1024
    s_lshl_b32 s37, s33, 15
    s_xor_b32 s37, s37, 0x10800
    buffer_load_dword v50, v120, s[16:19], s37 offen offset:0
    buffer_load_dword v51, v120, s[16:19], s37 offen offset:1024
    s_waitcnt vmcnt(50)
    s_lshl_b32 s37, s33, 15
    s_xor_b32 s37, s37, 0x14000
    buffer_load_dword v52, v120, s[16:19], s37 offen offset:0
    buffer_load_dword v53, v120, s[16:19], s37 offen offset:1024
    s_lshl_b32 s37, s33, 15
    s_xor_b32 s37, s37, 0x14800
    buffer_load_dword v54, v120, s[16:19], s37 offen offset:0
    buffer_load_dword v55, v120, s[16:19], s37 offen offset:1024
    s_lshl_b32 s37, s33, 15
    s_xor_b32 s37, s37, 0x18000
    buffer_load_dword v56, v120, s[16:19], s37 offen offset:0
    buffer_load_dword v57, v120, s[16:19], s37 offen offset:1024
    s_lshl_b32 s37, s33, 15
    s_xor_b32 s37, s37, 0x18800
    buffer_load_dword v58, v120, s[16:19], s37 offen offset:0
    buffer_load_dword v59, v120, s[16:19], s37 offen offset:1024
    s_lshl_b32 s37, s33, 15
    s_xor_b32 s37, s37, 0x1c000
    buffer_load_dword v60, v120, s[16:19], s37 offen offset:0
    buffer_load_dword v61, v120, s[16:19], s37 offen offset:1024
    s_lshl_b32 s37, s33, 15
    s_xor_b32 s37, s37, 0x1c800
    buffer_load_dword v62, v120, s[16:19], s37 offen offset:0
    buffer_load_dword v63, v120, s[16:19], s37 offen offset:1024
    s_lshl_b32 s37, s33, 15
    s_xor_b32 s37, s37, 0x0
    buffer_load_dword v64, v120, s[16:19], s37 offen offset:64
    buffer_load_dword v65, v120, s[16:19], s37 offen offset:1088
    s_lshl_b32 s37, s33, 15
    s_xor_b32 s37, s37, 0x800
    buffer_load_dword v66, v120, s[16:19], s37 offen offset:64
    buffer_load_dword v67, v120, s[16:19], s37 offen offset:1088
    s_waitcnt vmcnt(50)
    s_lshl_b32 s37, s33, 15
    s_xor_b32 s37, s37, 0x4000
    buffer_load_dword v68, v120, s[16:19], s37 offen offset:64
    buffer_load_dword v69, v120, s[16:19], s37 offen offset:1088
    s_lshl_b32 s37, s33, 15
    s_xor_b32 s37, s37, 0x4800
    buffer_load_dword v70, v120, s[16:19], s37 offen offset:64
    buffer_load_dword v71, v120, s[16:19], s37 offen offset:1088
    s_lshl_b32 s37, s33, 15
    s_xor_b32 s37, s37, 0x8000
    buffer_load_dword v72, v120, s[16:19], s37 offen offset:64
    buffer_load_dword v73, v120, s[16:19], s37 offen offset:1088
    s_lshl_b32 s37, s33, 15
    s_xor_b32 s37, s37, 0x8800
    buffer_load_dword v74, v120, s[16:19], s37 offen offset:64
    buffer_load_dword v75, v120, s[16:19], s37 offen offset:1088
    s_lshl_b32 s37, s33, 15
    s_xor_b32 s37, s37, 0xc000
    buffer_load_dword v76, v120, s[16:19], s37 offen offset:64
    buffer_load_dword v77, v120, s[16:19], s37 offen offset:1088
    s_lshl_b32 s37, s33, 15
    s_xor_b32 s37, s37, 0xc800
    buffer_load_dword v78, v120, s[16:19], s37 offen offset:64
    buffer_load_dword v79, v120, s[16:19], s37 offen offset:1088
    v_and_b32 v121, 2, v113
    v_cmp_eq_u32 vcc, 0, v121
    v_mov_b32 v121, 0xeeee
    v_mov_b32 v122, 0x4444
    v_cndmask_b32 v1, v121, v122, vcc
    v_lshlrev_b32 v124, 4, v112
    v_add_u32 v2, 0x20000, v124
    s_lshl_b32 s37, s33, 11
    s_add_u32 s49, s37, 0x0
    v_add_u32 v3, s37, v2
    s_lshl_b32 s38, s33, 15
    v_add_u32 v4, s38, v124
    s_lshl_b32 s38, s32, 13
    s_add_u32 s57, s38, s37
    s_add_u32 s60, s37, 0x20000
    s_add_u32 s61, s37, 0x22000
    s_lshr_b32 s56, s57, 1
    v_mul_u32_u24 v121, 576, v114
    v_lshl_add_u32 v121, v113, 2, v121
    s_lshl_b32 s62, s33, 6
    s_add_u32 s38, s62, 0x26000
    v_add_u32 v5, s38, v121
    v_lshrrev_b32 v121, 2, v113
    v_and_b32 v122, 1, v113
    v_lshl_add_u32 v121, v121, 1, v122
    v_mul_u32_u24 v121, 288, v121
    v_lshl_add_u32 v121, v114, 4, v121
    v_add_u32 v8, 0x26000, v121
    v_and_b32 v122, 2, v113
    v_lshl_add_u32 v121, v122, 2, v8
    v_add_u32 v6, s62, v121
    s_xor_b32 s38, s62, 64
    v_add_u32 v7, s38, v8
    s_xor_b32 s38, s62, 128
    v_add_u32 v9, s38, v8
    s_xor_b32 s42, s62, 192
    s_mov_b32 s66, 0xcccccccc
    s_mov_b32 s67, 0xcccccccc
    v_lshrrev_b32 v121, 2, v113
    v_lshl_add_u32 v121, v121, 2, v114
    v_lshlrev_b32 v121, 11, v121
    v_and_b32 v122, 3, v113
    v_lshl_add_u32 v121, v122, 4, v121
    s_lshl_b32 s38, s33, 16
    s_lshl_b32 s39, s32, 6
    s_add_u32 s38, s38, s39
    s_add_u32 s38, s38, 0x40000
    v_add_u32 v10, s38, v121
    s_lshr_b32 s72, s32, 3
    s_bfe_u32 s86, s32, 0x10002
    s_and_b32 s73, s32, 3
    s_mov_b32 s74, s33
    s_lshl_b32 s38, s72, 1
    s_add_u32 s38, s38, s86
    s_lshl_b32 s39, s38, 2
    s_add_u32 s39, s39, s73
    s_lshl_b32 s39, s39, 2
    s_add_u32 s39, s39, s74
    s_lshl_b32 s39, s39, 11
    s_add_u32 s45, s39, 0x20000
    s_lshl_b32 s38, s38, 10
    s_and_b32 s39, s73, 2
    s_lshl_b32 s39, s39, 7
    s_add_u32 s38, s38, s39
    s_and_b32 s39, s73, 1
    s_lshl_b32 s39, s39, 5
    s_add_u32 s38, s38, s39
    s_lshl_b32 s39, s74, 6
    s_add_u32 s38, s38, s39
    s_add_u32 s38, s38, 0x20000
    v_lshlrev_b32 v121, 9, v115
    v_lshl_add_u32 v121, v116, 4, v121
    v_lshl_add_u32 v121, v113, 2, v121
    v_add_u32 v121, s38, v121
    v_cmp_gt_u32 vcc, 4, v113
    v_mov_b32 v122, 0x40000000
    s_nop 0
    v_cndmask_b32 v11, v122, v121, vcc
    v_and_b32 v121, 1, v113
    v_lshlrev_b32 v121, 4, v121
    v_mov_b32 v122, 0x3f80
    v_lshlrev_b32 v121, v121, v122
    v_and_b32 v122, 14, v113
    v_cmp_eq_u32 vcc, 0, v122
    s_nop 1
    v_cndmask_b32 v20, 0, v121, vcc
    v_cmp_eq_u32 vcc, 4, v122
    s_nop 1
    v_cndmask_b32 v21, 0, v121, vcc
    v_cmp_eq_u32 vcc, 8, v122
    s_nop 1
    v_cndmask_b32 v22, 0, v121, vcc
    v_cmp_eq_u32 vcc, 12, v122
    s_nop 1
    v_cndmask_b32 v23, 0, v121, vcc
    ds_write_b128 v2, v[20:23] offset:31488
    s_waitcnt lgkmcnt(0)
    s_mov_b32 s58, 0x3e0293ee
    s_mov_b32 s59, 0xfffffffe
    s_mov_b32 s63, 0x5f800000
    v_mov_b32 v16, 0x3f803f80
    v_mov_b32 v17, 0x3f803f80
    v_mov_b32 v18, 0x3f803f80
    v_mov_b32 v19, 0x3f803f80
    v_mov_b32 v20, 0
    v_mov_b32 v21, 0
    v_mov_b32 v22, 0
    v_mov_b32 v23, 0
    v_mov_b32 v24, 0
    v_mov_b32 v25, 0
    v_mov_b32 v26, 0
    v_mov_b32 v27, 0
    v_mov_b32 v12, 0
    v_mov_b32 v13, 0
    v_mov_b32 v14, 0
    v_mov_b32 v15, 0
    s_waitcnt vmcnt(48)
    s_or_b32 s92, s91, s33
    s_or_b32 s92, s92, s88
    s_cbranch_scc1 REP_1
    s_and_b32 s92, s64, 3
    s_lshl_b32 s92, s92, 6
    s_and_b32 s93, s64, 4
    s_lshl_b32 s93, s93, 1
    s_add_u32 s92, s92, s93
    v_mov_b32 v121, s92
    s_lshr_b32 s93, s2, 3
    s_lshl_b32 s93, 1, s93
    v_mov_b32 v126, 1
    v_mov_b32 v127, s93
    s_mov_b64 exec, 1
    buffer_atomic_add_x2 v[126:127], v121, s[28:31], 0 offen
    s_mov_b64 exec, -1
REP_1:
    s_lshl_b32 s37, s33, 15
    s_xor_b32 s37, s37, 0x10000
    buffer_load_dword v80, v120, s[16:19], s37 offen offset:64
    buffer_load_dword v81, v120, s[16:19], s37 offen offset:1088
    s_lshl_b32 s37, s33, 15
    s_xor_b32 s37, s37, 0x10800
    buffer_load_dword v82, v120, s[16:19], s37 offen offset:64
    buffer_load_dword v83, v120, s[16:19], s37 offen offset:1088
    s_waitcnt vmcnt(50)
    s_lshl_b32 s37, s33, 15
    s_xor_b32 s37, s37, 0x14000
    buffer_load_dword v84, v120, s[16:19], s37 offen offset:64
    buffer_load_dword v85, v120, s[16:19], s37 offen offset:1088
    s_lshl_b32 s37, s33, 15
    s_xor_b32 s37, s37, 0x14800
    buffer_load_dword v86, v120, s[16:19], s37 offen offset:64
    buffer_load_dword v87, v120, s[16:19], s37 offen offset:1088
    s_lshl_b32 s37, s33, 15
    s_xor_b32 s37, s37, 0x18000
    buffer_load_dword v88, v120, s[16:19], s37 offen offset:64
    buffer_load_dword v89, v120, s[16:19], s37 offen offset:1088
    s_lshl_b32 s37, s33, 15
    s_xor_b32 s37, s37, 0x18800
    buffer_load_dword v90, v120, s[16:19], s37 offen offset:64
    buffer_load_dword v91, v120, s[16:19], s37 offen offset:1088
    s_lshl_b32 s37, s33, 15
    s_xor_b32 s37, s37, 0x1c000
    buffer_load_dword v92, v120, s[16:19], s37 offen offset:64
    buffer_load_dword v93, v120, s[16:19], s37 offen offset:1088
    s_lshl_b32 s37, s33, 15
    s_xor_b32 s37, s37, 0x1c800
    buffer_load_dword v94, v120, s[16:19], s37 offen offset:64
    buffer_load_dword v95, v120, s[16:19], s37 offen offset:1088
    s_waitcnt vmcnt(48)
    v_perm_b32 v96, v33, v32, s35
    v_perm_b32 v97, v33, v32, s36
    v_perm_b32 v98, v35, v34, s35
    v_perm_b32 v99, v35, v34, s36
    v_perm_b32 v100, v37, v36, s35
    v_perm_b32 v101, v37, v36, s36
    v_perm_b32 v102, v39, v38, s35
    v_perm_b32 v103, v39, v38, s36
    ds_write_b128 v4, v[96:99] offset:0
    ds_write_b128 v4, v[100:103] offset:1024
    v_perm_b32 v104, v41, v40, s35
    v_perm_b32 v105, v41, v40, s36
    v_perm_b32 v106, v43, v42, s35
    v_perm_b32 v107, v43, v42, s36
    v_perm_b32 v108, v45, v44, s35
    v_perm_b32 v109, v45, v44, s36
    v_perm_b32 v110, v47, v46, s35
    v_perm_b32 v111, v47, v46, s36
    v_accvgpr_write_b32 a24, v104
    v_accvgpr_write_b32 a25, v105
    v_accvgpr_write_b32 a26, v106
    v_accvgpr_write_b32 a27, v107
    v_accvgpr_write_b32 a28, v108
    v_accvgpr_write_b32 a29, v109
    v_accvgpr_write_b32 a30, v110
    v_accvgpr_write_b32 a31, v111
    s_waitcnt lgkmcnt(0)
    s_lshl_b32 s37, s33, 15
    s_xor_b32 s37, s37, 0x0
    buffer_load_dword v32, v120, s[16:19], s37 offen offset:128
    buffer_load_dword v33, v120, s[16:19], s37 offen offset:1152
    s_lshl_b32 s37, s33, 15
    s_xor_b32 s37, s37, 0x800
    buffer_load_dword v34, v120, s[16:19], s37 offen offset:128
    buffer_load_dword v35, v120, s[16:19], s37 offen offset:1152
    s_waitcnt vmcnt(50)
    s_lshl_b32 s37, s33, 15
    s_xor_b32 s37, s37, 0x4000
    buffer_load_dword v36, v120, s[16:19], s37 offen offset:128
    buffer_load_dword v37, v120, s[16:19], s37 offen offset:1152
    s_lshl_b32 s37, s33, 15
    s_xor_b32 s37, s37, 0x4800
    buffer_load_dword v38, v120, s[16:19], s37 offen offset:128
    buffer_load_dword v39, v120, s[16:19], s37 offen offset:1152
    s_lshl_b32 s37, s33, 15
    s_xor_b32 s37, s37, 0x8000
    buffer_load_dword v40, v120, s[16:19], s37 offen offset:128
    buffer_load_dword v41, v120, s[16:19], s37 offen offset:1152
    s_lshl_b32 s37, s33, 15
    s_xor_b32 s37, s37, 0x8800
    buffer_load_dword v42, v120, s[16:19], s37 offen offset:128
    buffer_load_dword v43, v120, s[16:19], s37 offen offset:1152
    s_lshl_b32 s37, s33, 15
    s_xor_b32 s37, s37, 0xc000
    buffer_load_dword v44, v120, s[16:19], s37 offen offset:128
    buffer_load_dword v45, v120, s[16:19], s37 offen offset:1152
    s_lshl_b32 s37, s33, 15
    s_xor_b32 s37, s37, 0xc800
    buffer_load_dword v46, v120, s[16:19], s37 offen offset:128
    buffer_load_dword v47, v120, s[16:19], s37 offen offset:1152
    s_waitcnt vmcnt(48)
    v_perm_b32 v136, v49, v48, s35
    v_perm_b32 v137, v49, v48, s36
    v_perm_b32 v138, v51, v50, s35
    v_perm_b32 v139, v51, v50, s36
    v_perm_b32 v140, v53, v52, s35
    v_perm_b32 v141, v53, v52, s36
    v_perm_b32 v142, v55, v54, s35
    v_perm_b32 v143, v55, v54, s36
    v_perm_b32 v104, v57, v56, s35
    v_perm_b32 v105, v57, v56, s36
    v_perm_b32 v106, v59, v58, s35
    v_perm_b32 v107, v59, v58, s36
    v_perm_b32 v108, v61, v60, s35
    v_perm_b32 v109, v61, v60, s36
    v_perm_b32 v110, v63, v62, s35
    v_perm_b32 v111, v63, v62, s36
    v_accvgpr_write_b32 a96, v104
    v_accvgpr_write_b32 a97, v105
    v_accvgpr_write_b32 a98, v106
    v_accvgpr_write_b32 a99, v107
    v_accvgpr_write_b32 a100, v108
    v_accvgpr_write_b32 a101, v109
    v_accvgpr_write_b32 a102, v110
    v_accvgpr_write_b32 a103, v111
    s_lshl_b32 s37, s33, 15
    s_xor_b32 s37, s37, 0x10000
    buffer_load_dword v48, v120, s[16:19], s37 offen offset:128
    buffer_load_dword v49, v120, s[16:19], s37 offen offset:1152
    s_lshl_b32 s37, s33, 15
    s_xor_b32 s37, s37, 0x10800
    buffer_load_dword v50, v120, s[16:19], s37 offen offset:128
    buffer_load_dword v51, v120, s[16:19], s37 offen offset:1152
    s_waitcnt vmcnt(50)
    s_lshl_b32 s37, s33, 15
    s_xor_b32 s37, s37, 0x14000
    buffer_load_dword v52, v120, s[16:19], s37 offen offset:128
    buffer_load_dword v53, v120, s[16:19], s37 offen offset:1152
    s_lshl_b32 s37, s33, 15
    s_xor_b32 s37, s37, 0x14800
    buffer_load_dword v54, v120, s[16:19], s37 offen offset:128
    buffer_load_dword v55, v120, s[16:19], s37 offen offset:1152
    s_lshl_b32 s37, s33, 15
    s_xor_b32 s37, s37, 0x18000
    buffer_load_dword v56, v120, s[16:19], s37 offen offset:128
    buffer_load_dword v57, v120, s[16:19], s37 offen offset:1152
    s_lshl_b32 s37, s33, 15
    s_xor_b32 s37, s37, 0x18800
    buffer_load_dword v58, v120, s[16:19], s37 offen offset:128
    buffer_load_dword v59, v120, s[16:19], s37 offen offset:1152
    s_lshl_b32 s37, s33, 15
    s_xor_b32 s37, s37, 0x1c000
    buffer_load_dword v60, v120, s[16:19], s37 offen offset:128
    buffer_load_dword v61, v120, s[16:19], s37 offen offset:1152
    s_lshl_b32 s37, s33, 15
    s_xor_b32 s37, s37, 0x1c800
    buffer_load_dword v62, v120, s[16:19], s37 offen offset:128
    buffer_load_dword v63, v120, s[16:19], s37 offen offset:1152
    s_waitcnt vmcnt(48)
    v_perm_b32 v96, v65, v64, s35
    v_perm_b32 v97, v65, v64, s36
    v_perm_b32 v98, v67, v66, s35
    v_perm_b32 v99, v67, v66, s36
    v_perm_b32 v100, v69, v68, s35
    v_perm_b32 v101, v69, v68, s36
    v_perm_b32 v102, v71, v70, s35
    v_perm_b32 v103, v71, v70, s36
    ds_write_b128 v4, v[96:99] offset:8192
    ds_write_b128 v4, v[100:103] offset:9216
    v_perm_b32 v104, v73, v72, s35
    v_perm_b32 v105, v73, v72, s36
    v_perm_b32 v106, v75, v74, s35
    v_perm_b32 v107, v75, v74, s36
    v_perm_b32 v108, v77, v76, s35
    v_perm_b32 v109, v77, v76, s36
    v_perm_b32 v110, v79, v78, s35
    v_perm_b32 v111, v79, v78, s36
    v_accvgpr_write_b32 a104, v104
    v_accvgpr_write_b32 a105, v105
    v_accvgpr_write_b32 a106, v106
    v_accvgpr_write_b32 a107, v107
    v_accvgpr_write_b32 a108, v108
    v_accvgpr_write_b32 a109, v109
    v_accvgpr_write_b32 a110, v110
    v_accvgpr_write_b32 a111, v111
    s_waitcnt lgkmcnt(0)
    s_lshl_b32 s37, s33, 15
    s_xor_b32 s37, s37, 0x0
    buffer_load_dword v64, v120, s[16:19], s37 offen offset:192
    buffer_load_dword v65, v120, s[16:19], s37 offen offset:1216
    s_lshl_b32 s37, s33, 15
    s_xor_b32 s37, s37, 0x800
    buffer_load_dword v66, v120, s[16:19], s37 offen offset:192
    buffer_load_dword v67, v120, s[16:19], s37 offen offset:1216
    s_waitcnt vmcnt(50)
    s_lshl_b32 s37, s33, 15
    s_xor_b32 s37, s37, 0x4000
    buffer_load_dword v68, v120, s[16:19], s37 offen offset:192
    buffer_load_dword v69, v120, s[16:19], s37 offen offset:1216
    s_lshl_b32 s37, s33, 15
    s_xor_b32 s37, s37, 0x4800
    buffer_load_dword v70, v120, s[16:19], s37 offen offset:192
    buffer_load_dword v71, v120, s[16:19], s37 offen offset:1216
    s_lshl_b32 s37, s33, 15
    s_xor_b32 s37, s37, 0x8000
    buffer_load_dword v72, v120, s[16:19], s37 offen offset:192
    buffer_load_dword v73, v120, s[16:19], s37 offen offset:1216
    s_lshl_b32 s37, s33, 15
    s_xor_b32 s37, s37, 0x8800
    buffer_load_dword v74, v120, s[16:19], s37 offen offset:192
    buffer_load_dword v75, v120, s[16:19], s37 offen offset:1216
    s_lshl_b32 s37, s33, 15
    s_xor_b32 s37, s37, 0xc000
    buffer_load_dword v76, v120, s[16:19], s37 offen offset:192
    buffer_load_dword v77, v120, s[16:19], s37 offen offset:1216
    s_lshl_b32 s37, s33, 15
    s_xor_b32 s37, s37, 0xc800
    buffer_load_dword v78, v120, s[16:19], s37 offen offset:192
    buffer_load_dword v79, v120, s[16:19], s37 offen offset:1216
    s_waitcnt vmcnt(48)
    v_perm_b32 v96, v81, v80, s35
    v_perm_b32 v97, v81, v80, s36
    v_perm_b32 v98, v83, v82, s35
    v_perm_b32 v99, v83, v82, s36
    v_perm_b32 v100, v85, v84, s35
    v_perm_b32 v101, v85, v84, s36
    v_perm_b32 v102, v87, v86, s35
    v_perm_b32 v103, v87, v86, s36
    v_accvgpr_write_b32 a112, v96
    v_accvgpr_write_b32 a113, v97
    v_accvgpr_write_b32 a114, v98
    v_accvgpr_write_b32 a115, v99
    v_accvgpr_write_b32 a116, v100
    v_accvgpr_write_b32 a117, v101
    v_accvgpr_write_b32 a118, v102
    v_accvgpr_write_b32 a119, v103
    v_perm_b32 v104, v89, v88, s35
    v_perm_b32 v105, v89, v88, s36
    v_perm_b32 v106, v91, v90, s35
    v_perm_b32 v107, v91, v90, s36
    v_perm_b32 v108, v93, v92, s35
    v_perm_b32 v109, v93, v92, s36
    v_perm_b32 v110, v95, v94, s35
    v_perm_b32 v111, v95, v94, s36
    v_accvgpr_write_b32 a120, v104
    v_accvgpr_write_b32 a121, v105
    v_accvgpr_write_b32 a122, v106
    v_accvgpr_write_b32 a123, v107
    v_accvgpr_write_b32 a124, v108
    v_accvgpr_write_b32 a125, v109
    v_accvgpr_write_b32 a126, v110
    v_accvgpr_write_b32 a127, v111
    s_lshl_b32 s37, s33, 15
    s_xor_b32 s37, s37, 0x10000
    buffer_load_dword v80, v120, s[16:19], s37 offen offset:192
    buffer_load_dword v81, v120, s[16:19], s37 offen offset:1216
    s_lshl_b32 s37, s33, 15
    s_xor_b32 s37, s37, 0x10800
    buffer_load_dword v82, v120, s[16:19], s37 offen offset:192
    buffer_load_dword v83, v120, s[16:19], s37 offen offset:1216
    s_waitcnt vmcnt(50)
    s_lshl_b32 s37, s33, 15
    s_xor_b32 s37, s37, 0x14000
    buffer_load_dword v84, v120, s[16:19], s37 offen offset:192
    buffer_load_dword v85, v120, s[16:19], s37 offen offset:1216
    s_lshl_b32 s37, s33, 15
    s_xor_b32 s37, s37, 0x14800
    buffer_load_dword v86, v120, s[16:19], s37 offen offset:192
    buffer_load_dword v87, v120, s[16:19], s37 offen offset:1216
    s_lshl_b32 s37, s33, 15
    s_xor_b32 s37, s37, 0x18000
    buffer_load_dword v88, v120, s[16:19], s37 offen offset:192
    buffer_load_dword v89, v120, s[16:19], s37 offen offset:1216
    s_lshl_b32 s37, s33, 15
    s_xor_b32 s37, s37, 0x18800
    buffer_load_dword v90, v120, s[16:19], s37 offen offset:192
    buffer_load_dword v91, v120, s[16:19], s37 offen offset:1216
    s_lshl_b32 s37, s33, 15
    s_xor_b32 s37, s37, 0x1c000
    buffer_load_dword v92, v120, s[16:19], s37 offen offset:192
    buffer_load_dword v93, v120, s[16:19], s37 offen offset:1216
    s_lshl_b32 s37, s33, 15
    s_xor_b32 s37, s37, 0x1c800
    buffer_load_dword v94, v120, s[16:19], s37 offen offset:192
    buffer_load_dword v95, v120, s[16:19], s37 offen offset:1216
    s_waitcnt vmcnt(48)
    v_perm_b32 v96, v33, v32, s35
    v_perm_b32 v97, v33, v32, s36
    v_perm_b32 v98, v35, v34, s35
    v_perm_b32 v99, v35, v34, s36
    v_perm_b32 v100, v37, v36, s35
    v_perm_b32 v101, v37, v36, s36
    v_perm_b32 v102, v39, v38, s35
    v_perm_b32 v103, v39, v38, s36
    ds_write_b128 v4, v[96:99] offset:16384
    ds_write_b128 v4, v[100:103] offset:17408
    v_perm_b32 v104, v41, v40, s35
    v_perm_b32 v105, v41, v40, s36
    v_perm_b32 v106, v43, v42, s35
    v_perm_b32 v107, v43, v42, s36
    v_perm_b32 v108, v45, v44, s35
    v_perm_b32 v109, v45, v44, s36
    v_perm_b32 v110, v47, v46, s35
    v_perm_b32 v111, v47, v46, s36
    ds_write_b128 v4, v[104:107] offset:18432
    ds_write_b128 v4, v[108:111] offset:19456
    s_waitcnt lgkmcnt(0)
    s_xor_b32 s38, s33, 0
    s_lshl_b32 s38, s38, 20
    s_add_u32 s37, s38, 0x0
    buffer_load_dword v32, v118, s[8:11], s37 offen
    buffer_load_dword v33, v119, s[8:11], s37 offen
    s_add_u32 s37, s38, 0x10000
    buffer_load_dword v34, v118, s[8:11], s37 offen
    buffer_load_dword v35, v119, s[8:11], s37 offen
    s_waitcnt vmcnt(50)
    s_add_u32 s37, s38, 0x4000
    buffer_load_dword v36, v118, s[8:11], s37 offen
    buffer_load_dword v37, v119, s[8:11], s37 offen
    s_add_u32 s37, s38, 0x14000
    buffer_load_dword v38, v118, s[8:11], s37 offen
    buffer_load_dword v39, v119, s[8:11], s37 offen
    s_add_u32 s37, s38, 0x40000
    buffer_load_dword v40, v118, s[8:11], s37 offen
    buffer_load_dword v41, v119, s[8:11], s37 offen
    s_add_u32 s37, s38, 0x50000
    buffer_load_dword v42, v118, s[8:11], s37 offen
    buffer_load_dword v43, v119, s[8:11], s37 offen
    s_add_u32 s37, s38, 0x44000
    buffer_load_dword v44, v118, s[8:11], s37 offen
    buffer_load_dword v45, v119, s[8:11], s37 offen
    s_add_u32 s37, s38, 0x54000
    buffer_load_dword v46, v118, s[8:11], s37 offen
    buffer_load_dword v47, v119, s[8:11], s37 offen
    s_waitcnt vmcnt(48)
    v_perm_b32 v96, v49, v48, s35
    v_perm_b32 v97, v49, v48, s36
    v_perm_b32 v98, v51, v50, s35
    v_perm_b32 v99, v51, v50, s36
    v_perm_b32 v100, v53, v52, s35
    v_perm_b32 v101, v53, v52, s36
    v_perm_b32 v102, v55, v54, s35
    v_perm_b32 v103, v55, v54, s36
    ds_write_b128 v4, v[96:99] offset:20480
    ds_write_b128 v4, v[100:103] offset:21504
    v_perm_b32 v104, v57, v56, s35
    v_perm_b32 v105, v57, v56, s36
    v_perm_b32 v106, v59, v58, s35
    v_perm_b32 v107, v59, v58, s36
    v_perm_b32 v108, v61, v60, s35
    v_perm_b32 v109, v61, v60, s36
    v_perm_b32 v110, v63, v62, s35
    v_perm_b32 v111, v63, v62, s36
    ds_write_b128 v4, v[104:107] offset:22528
    ds_write_b128 v4, v[108:111] offset:23552
    s_waitcnt lgkmcnt(0)
    s_xor_b32 s38, s33, 0
    s_lshl_b32 s38, s38, 20
    s_add_u32 s37, s38, 0x80000
    buffer_load_dword v48, v118, s[8:11], s37 offen
    buffer_load_dword v49, v119, s[8:11], s37 offen
    s_add_u32 s37, s38, 0x90000
    buffer_load_dword v50, v118, s[8:11], s37 offen
    buffer_load_dword v51, v119, s[8:11], s37 offen
    s_waitcnt vmcnt(50)
    s_add_u32 s37, s38, 0x84000
    buffer_load_dword v52, v118, s[8:11], s37 offen
    buffer_load_dword v53, v119, s[8:11], s37 offen
    s_add_u32 s37, s38, 0x94000
    buffer_load_dword v54, v118, s[8:11], s37 offen
    buffer_load_dword v55, v119, s[8:11], s37 offen
    s_add_u32 s37, s38, 0xc0000
    buffer_load_dword v56, v118, s[8:11], s37 offen
    buffer_load_dword v57, v119, s[8:11], s37 offen
    s_add_u32 s37, s38, 0xd0000
    buffer_load_dword v58, v118, s[8:11], s37 offen
    buffer_load_dword v59, v119, s[8:11], s37 offen
    s_add_u32 s37, s38, 0xc4000
    buffer_load_dword v60, v118, s[8:11], s37 offen
    buffer_load_dword v61, v119, s[8:11], s37 offen
    s_add_u32 s37, s38, 0xd4000
    buffer_load_dword v62, v118, s[8:11], s37 offen
    buffer_load_dword v63, v119, s[8:11], s37 offen
    s_waitcnt vmcnt(48)
    v_perm_b32 v96, v65, v64, s35
    v_perm_b32 v97, v65, v64, s36
    v_perm_b32 v98, v67, v66, s35
    v_perm_b32 v99, v67, v66, s36
    v_perm_b32 v100, v69, v68, s35
    v_perm_b32 v101, v69, v68, s36
    v_perm_b32 v102, v71, v70, s35
    v_perm_b32 v103, v71, v70, s36
    v_accvgpr_write_b32 a8, v96
    v_accvgpr_write_b32 a9, v97
    v_accvgpr_write_b32 a10, v98
    v_accvgpr_write_b32 a11, v99
    v_accvgpr_write_b32 a12, v100
    v_accvgpr_write_b32 a13, v101
    v_accvgpr_write_b32 a14, v102
    v_accvgpr_write_b32 a15, v103
    v_perm_b32 v104, v73, v72, s35
    v_perm_b32 v105, v73, v72, s36
    v_perm_b32 v106, v75, v74, s35
    v_perm_b32 v107, v75, v74, s36
    v_perm_b32 v108, v77, v76, s35
    v_perm_b32 v109, v77, v76, s36
    v_perm_b32 v110, v79, v78, s35
    v_perm_b32 v111, v79, v78, s36
    ds_write_b128 v4, v[104:107] offset:26624
    ds_write_b128 v4, v[108:111] offset:27648
    s_waitcnt lgkmcnt(0)
    s_xor_b32 s38, s33, 1
    s_lshl_b32 s38, s38, 20
    s_add_u32 s37, s38, 0x0
    buffer_load_dword v64, v118, s[8:11], s37 offen
    buffer_load_dword v65, v119, s[8:11], s37 offen
    s_add_u32 s37, s38, 0x10000
    buffer_load_dword v66, v118, s[8:11], s37 offen
    buffer_load_dword v67, v119, s[8:11], s37 offen
    s_waitcnt vmcnt(50)
    s_add_u32 s37, s38, 0x4000
    buffer_load_dword v68, v118, s[8:11], s37 offen
    buffer_load_dword v69, v119, s[8:11], s37 offen
    s_add_u32 s37, s38, 0x14000
    buffer_load_dword v70, v118, s[8:11], s37 offen
    buffer_load_dword v71, v119, s[8:11], s37 offen
    s_add_u32 s37, s38, 0x40000
    buffer_load_dword v72, v118, s[8:11], s37 offen
    buffer_load_dword v73, v119, s[8:11], s37 offen
    s_add_u32 s37, s38, 0x50000
    buffer_load_dword v74, v118, s[8:11], s37 offen
    buffer_load_dword v75, v119, s[8:11], s37 offen
    s_add_u32 s37, s38, 0x44000
    buffer_load_dword v76, v118, s[8:11], s37 offen
    buffer_load_dword v77, v119, s[8:11], s37 offen
    s_add_u32 s37, s38, 0x54000
    buffer_load_dword v78, v118, s[8:11], s37 offen
    buffer_load_dword v79, v119, s[8:11], s37 offen
    s_waitcnt vmcnt(48)
    v_perm_b32 v96, v81, v80, s35
    v_perm_b32 v97, v81, v80, s36
    v_perm_b32 v98, v83, v82, s35
    v_perm_b32 v99, v83, v82, s36
    v_perm_b32 v100, v85, v84, s35
    v_perm_b32 v101, v85, v84, s36
    v_perm_b32 v102, v87, v86, s35
    v_perm_b32 v103, v87, v86, s36
    ds_write_b128 v4, v[96:99] offset:28672
    ds_write_b128 v4, v[100:103] offset:29696
    v_perm_b32 v104, v89, v88, s35
    v_perm_b32 v105, v89, v88, s36
    v_perm_b32 v106, v91, v90, s35
    v_perm_b32 v107, v91, v90, s36
    v_perm_b32 v108, v93, v92, s35
    v_perm_b32 v109, v93, v92, s36
    v_perm_b32 v110, v95, v94, s35
    v_perm_b32 v111, v95, v94, s36
    ds_write_b128 v4, v[104:107] offset:30720
    ds_write_b128 v4, v[108:111] offset:31744
    s_waitcnt lgkmcnt(0)
    v_lshlrev_b32 v121, 2, v112
    buffer_load_dword v122, v121, s[28:31], 0 offen sc1
    s_xor_b32 s38, s33, 1
    s_lshl_b32 s38, s38, 20
    s_add_u32 s37, s38, 0x80000
    buffer_load_dword v80, v118, s[8:11], s37 offen
    buffer_load_dword v81, v119, s[8:11], s37 offen
    s_add_u32 s37, s38, 0x90000
    buffer_load_dword v82, v118, s[8:11], s37 offen
    buffer_load_dword v83, v119, s[8:11], s37 offen
    s_waitcnt vmcnt(50)
    s_add_u32 s37, s38, 0x84000
    buffer_load_dword v84, v118, s[8:11], s37 offen
    buffer_load_dword v85, v119, s[8:11], s37 offen
    s_add_u32 s37, s38, 0x94000
    buffer_load_dword v86, v118, s[8:11], s37 offen
    buffer_load_dword v87, v119, s[8:11], s37 offen
    s_add_u32 s37, s38, 0xc0000
    buffer_load_dword v88, v118, s[8:11], s37 offen
    buffer_load_dword v89, v119, s[8:11], s37 offen
    s_add_u32 s37, s38, 0xd0000
    buffer_load_dword v90, v118, s[8:11], s37 offen
    buffer_load_dword v91, v119, s[8:11], s37 offen
    s_add_u32 s37, s38, 0xc4000
    buffer_load_dword v92, v118, s[8:11], s37 offen
    buffer_load_dword v93, v119, s[8:11], s37 offen
    s_add_u32 s37, s38, 0xd4000
    buffer_load_dword v94, v118, s[8:11], s37 offen
    buffer_load_dword v95, v119, s[8:11], s37 offen
    s_waitcnt vmcnt(49)
    v_perm_b32 v96, v33, v32, s35
    v_perm_b32 v97, v35, v34, s35
    v_perm_b32 v98, v37, v36, s35
    v_perm_b32 v99, v39, v38, s35
    v_perm_b32 v100, v41, v40, s35
    v_perm_b32 v101, v43, v42, s35
    v_perm_b32 v102, v45, v44, s35
    v_perm_b32 v103, v47, v46, s35
    v_accvgpr_write_b32 a128, v96
    v_accvgpr_write_b32 a129, v97
    v_accvgpr_write_b32 a130, v98
    v_accvgpr_write_b32 a131, v99
    v_accvgpr_write_b32 a132, v100
    v_accvgpr_write_b32 a133, v101
    v_accvgpr_write_b32 a134, v102
    v_accvgpr_write_b32 a135, v103
    v_perm_b32 v104, v33, v32, s36
    v_perm_b32 v105, v35, v34, s36
    v_perm_b32 v106, v37, v36, s36
    v_perm_b32 v107, v39, v38, s36
    v_perm_b32 v108, v41, v40, s36
    v_perm_b32 v109, v43, v42, s36
    v_perm_b32 v110, v45, v44, s36
    v_perm_b32 v111, v47, v46, s36
    v_accvgpr_write_b32 a136, v104
    v_accvgpr_write_b32 a137, v105
    v_accvgpr_write_b32 a138, v106
    v_accvgpr_write_b32 a139, v107
    v_accvgpr_write_b32 a140, v108
    v_accvgpr_write_b32 a141, v109
    v_accvgpr_write_b32 a142, v110
    v_accvgpr_write_b32 a143, v111
    s_xor_b32 s38, s33, 2
    s_lshl_b32 s38, s38, 20
    s_add_u32 s37, s38, 0x0
    buffer_load_dword v32, v118, s[8:11], s37 offen
    buffer_load_dword v33, v119, s[8:11], s37 offen
    s_add_u32 s37, s38, 0x10000
    buffer_load_dword v34, v118, s[8:11], s37 offen
    buffer_load_dword v35, v119, s[8:11], s37 offen
    s_waitcnt vmcnt(50)
    s_add_u32 s37, s38, 0x4000
    buffer_load_dword v36, v118, s[8:11], s37 offen
    buffer_load_dword v37, v119, s[8:11], s37 offen
    s_add_u32 s37, s38, 0x14000
    buffer_load_dword v38, v118, s[8:11], s37 offen
    buffer_load_dword v39, v119, s[8:11], s37 offen
    s_add_u32 s37, s38, 0x40000
    buffer_load_dword v40, v118, s[8:11], s37 offen
    buffer_load_dword v41, v119, s[8:11], s37 offen
    s_add_u32 s37, s38, 0x50000
    buffer_load_dword v42, v118, s[8:11], s37 offen
    buffer_load_dword v43, v119, s[8:11], s37 offen
    s_add_u32 s37, s38, 0x44000
    buffer_load_dword v44, v118, s[8:11], s37 offen
    buffer_load_dword v45, v119, s[8:11], s37 offen
    s_add_u32 s37, s38, 0x54000
    buffer_load_dword v46, v118, s[8:11], s37 offen
    buffer_load_dword v47, v119, s[8:11], s37 offen
    s_waitcnt vmcnt(49)
    v_perm_b32 v96, v49, v48, s35
    v_perm_b32 v97, v51, v50, s35
    v_perm_b32 v98, v53, v52, s35
    v_perm_b32 v99, v55, v54, s35
    v_perm_b32 v100, v57, v56, s35
    v_perm_b32 v101, v59, v58, s35
    v_perm_b32 v102, v61, v60, s35
    v_perm_b32 v103, v63, v62, s35
    v_accvgpr_write_b32 a144, v96
    v_accvgpr_write_b32 a145, v97
    v_accvgpr_write_b32 a146, v98
    v_accvgpr_write_b32 a147, v99
    v_accvgpr_write_b32 a148, v100
    v_accvgpr_write_b32 a149, v101
    v_accvgpr_write_b32 a150, v102
    v_accvgpr_write_b32 a151, v103
    v_perm_b32 v104, v49, v48, s36
    v_perm_b32 v105, v51, v50, s36
    v_perm_b32 v106, v53, v52, s36
    v_perm_b32 v107, v55, v54, s36
    v_perm_b32 v108, v57, v56, s36
    v_perm_b32 v109, v59, v58, s36
    v_perm_b32 v110, v61, v60, s36
    v_perm_b32 v111, v63, v62, s36
    v_accvgpr_write_b32 a152, v104
    v_accvgpr_write_b32 a153, v105
    v_accvgpr_write_b32 a154, v106
    v_accvgpr_write_b32 a155, v107
    v_accvgpr_write_b32 a156, v108
    v_accvgpr_write_b32 a157, v109
    v_accvgpr_write_b32 a158, v110
    v_accvgpr_write_b32 a159, v111
    s_xor_b32 s38, s33, 2
    s_lshl_b32 s38, s38, 20
    s_add_u32 s37, s38, 0x80000
    buffer_load_dword v48, v118, s[8:11], s37 offen
    buffer_load_dword v49, v119, s[8:11], s37 offen
    s_add_u32 s37, s38, 0x90000
    buffer_load_dword v50, v118, s[8:11], s37 offen
    buffer_load_dword v51, v119, s[8:11], s37 offen
    s_waitcnt vmcnt(50)
    s_add_u32 s37, s38, 0x84000
    buffer_load_dword v52, v118, s[8:11], s37 offen
    buffer_load_dword v53, v119, s[8:11], s37 offen
    s_add_u32 s37, s38, 0x94000
    buffer_load_dword v54, v118, s[8:11], s37 offen
    buffer_load_dword v55, v119, s[8:11], s37 offen
    s_add_u32 s37, s38, 0xc0000
    buffer_load_dword v56, v118, s[8:11], s37 offen
    buffer_load_dword v57, v119, s[8:11], s37 offen
    s_add_u32 s37, s38, 0xd0000
    buffer_load_dword v58, v118, s[8:11], s37 offen
    buffer_load_dword v59, v119, s[8:11], s37 offen
    s_add_u32 s37, s38, 0xc4000
    buffer_load_dword v60, v118, s[8:11], s37 offen
    buffer_load_dword v61, v119, s[8:11], s37 offen
    s_add_u32 s37, s38, 0xd4000
    buffer_load_dword v62, v118, s[8:11], s37 offen
    buffer_load_dword v63, v119, s[8:11], s37 offen
    s_waitcnt vmcnt(49)
    v_perm_b32 v96, v65, v64, s35
    v_perm_b32 v97, v67, v66, s35
    v_perm_b32 v98, v69, v68, s35
    v_perm_b32 v99, v71, v70, s35
    v_perm_b32 v100, v73, v72, s35
    v_perm_b32 v101, v75, v74, s35
    v_perm_b32 v102, v77, v76, s35
    v_perm_b32 v103, v79, v78, s35
    v_accvgpr_write_b32 a160, v96
    v_accvgpr_write_b32 a161, v97
    v_accvgpr_write_b32 a162, v98
    v_accvgpr_write_b32 a163, v99
    v_accvgpr_write_b32 a164, v100
    v_accvgpr_write_b32 a165, v101
    v_accvgpr_write_b32 a166, v102
    v_accvgpr_write_b32 a167, v103
    v_perm_b32 v104, v65, v64, s36
    v_perm_b32 v105, v67, v66, s36
    v_perm_b32 v106, v69, v68, s36
    v_perm_b32 v107, v71, v70, s36
    v_perm_b32 v108, v73, v72, s36
    v_perm_b32 v109, v75, v74, s36
    v_perm_b32 v110, v77, v76, s36
    v_perm_b32 v111, v79, v78, s36
    v_accvgpr_write_b32 a168, v104
    v_accvgpr_write_b32 a169, v105
    v_accvgpr_write_b32 a170, v106
    v_accvgpr_write_b32 a171, v107
    v_accvgpr_write_b32 a172, v108
    v_accvgpr_write_b32 a173, v109
    v_accvgpr_write_b32 a174, v110
    v_accvgpr_write_b32 a175, v111
    s_xor_b32 s38, s33, 3
    s_lshl_b32 s38, s38, 20
    s_add_u32 s37, s38, 0x0
    buffer_load_dword v64, v118, s[8:11], s37 offen
    buffer_load_dword v65, v119, s[8:11], s37 offen
    s_add_u32 s37, s38, 0x10000
    buffer_load_dword v66, v118, s[8:11], s37 offen
    buffer_load_dword v67, v119, s[8:11], s37 offen
    s_waitcnt vmcnt(50)
    s_add_u32 s37, s38, 0x4000
    buffer_load_dword v68, v118, s[8:11], s37 offen
    buffer_load_dword v69, v119, s[8:11], s37 offen
    s_add_u32 s37, s38, 0x14000
    buffer_load_dword v70, v118, s[8:11], s37 offen
    buffer_load_dword v71, v119, s[8:11], s37 offen
    s_add_u32 s37, s38, 0x40000
    buffer_load_dword v72, v118, s[8:11], s37 offen
    buffer_load_dword v73, v119, s[8:11], s37 offen
    s_add_u32 s37, s38, 0x50000
    buffer_load_dword v74, v118, s[8:11], s37 offen
    buffer_load_dword v75, v119, s[8:11], s37 offen
    s_add_u32 s37, s38, 0x44000
    buffer_load_dword v76, v118, s[8:11], s37 offen
    buffer_load_dword v77, v119, s[8:11], s37 offen
    s_add_u32 s37, s38, 0x54000
    buffer_load_dword v78, v118, s[8:11], s37 offen
    buffer_load_dword v79, v119, s[8:11], s37 offen
    s_waitcnt vmcnt(48)
    s_cmp_lg_u32 s91, 0
    s_cbranch_scc1 CVD_4
    s_mov_b32 s40, 0
    s_branch CVE_3
CVR_2:
    buffer_load_dword v122, v121, s[28:31], 0 offen sc1
    s_add_u32 s40, s40, 1
    s_cmp_gt_u32 s40, 0x40000
    s_cbranch_scc1 KABORT
    s_waitcnt vmcnt(0)
CVE_3:
    v_readlane_b32 s37, v122, 0
    v_readlane_b32 s38, v122, 2
    s_nop 0
    s_add_u32 s37, s37, s38
    v_readlane_b32 s38, v122, 16
    s_nop 0
    s_add_u32 s37, s37, s38
    v_readlane_b32 s38, v122, 18
    s_nop 0
    s_add_u32 s37, s37, s38
    v_readlane_b32 s38, v122, 32
    s_nop 0
    s_add_u32 s37, s37, s38
    v_readlane_b32 s38, v122, 34
    s_nop 0
    s_add_u32 s37, s37, s38
    v_readlane_b32 s38, v122, 48
    s_nop 0
    s_add_u32 s37, s37, s38
    v_readlane_b32 s38, v122, 50
    s_nop 0
    s_add_u32 s37, s37, s38
    s_cmp_lt_u32 s37, 256
    s_cbranch_scc1 CVR_2
    v_cmp_eq_u32 vcc, 32, v122
    s_nop 0
    s_and_b32 s37, vcc_lo, vcc_hi
    s_and_b32 s37, s37, 0x50005
    s_cmp_lg_u32 s37, 0x50005
    s_cbranch_scc1 KSAFE
    v_cmp_eq_u32 vcc, -1, v122
    s_nop 0
    s_and_b32 s37, vcc_lo, vcc_hi
    s_and_b32 s37, s37, 0xa000a
    s_cmp_lg_u32 s37, 0xa000a
    s_cbranch_scc1 KTICK
    s_mov_b32 s91, 1
CVD_4:
    v_mov_b32 v123, -1
    buffer_store_dwordx4 v[20:23], v2, s[20:23], s45 offen offset:0
    buffer_store_dwordx4 v[20:23], v2, s[20:23], s45 offen offset:1024
    s_mov_b32 s37, 0
    buffer_store_dword v123, v11, s[20:23], s37 offen
    s_mov_b32 s37, 8192
    buffer_store_dword v123, v11, s[20:23], s37 offen
    s_mov_b32 s37, 16384
    buffer_store_dword v123, v11, s[20:23], s37 offen
    s_mov_b32 s37, 24576
    buffer_store_dword v123, v11, s[20:23], s37 offen
    v_perm_b32 v96, v81, v80, s35
    v_perm_b32 v97, v83, v82, s35
    v_perm_b32 v98, v85, v84, s35
    v_perm_b32 v99, v87, v86, s35
    v_perm_b32 v100, v89, v88, s35
    v_perm_b32 v101, v91, v90, s35
    v_perm_b32 v102, v93, v92, s35
    v_perm_b32 v103, v95, v94, s35
    v_accvgpr_write_b32 a176, v96
    v_accvgpr_write_b32 a177, v97
    v_accvgpr_write_b32 a178, v98
    v_accvgpr_write_b32 a179, v99
    v_accvgpr_write_b32 a180, v100
    v_accvgpr_write_b32 a181, v101
    v_accvgpr_write_b32 a182, v102
    v_accvgpr_write_b32 a183, v103
    v_perm_b32 v104, v81, v80, s36
    v_perm_b32 v105, v83, v82, s36
    v_perm_b32 v106, v85, v84, s36
    v_perm_b32 v107, v87, v86, s36
    v_perm_b32 v108, v89, v88, s36
    v_perm_b32 v109, v91, v90, s36
    v_perm_b32 v110, v93, v92, s36
    v_perm_b32 v111, v95, v94, s36
    v_accvgpr_write_b32 a184, v104
    v_accvgpr_write_b32 a185, v105
    v_accvgpr_write_b32 a186, v106
    v_accvgpr_write_b32 a187, v107
    v_accvgpr_write_b32 a188, v108
    v_accvgpr_write_b32 a189, v109
    v_accvgpr_write_b32 a190, v110
    v_accvgpr_write_b32 a191, v111
    s_xor_b32 s38, s33, 3
    s_lshl_b32 s38, s38, 20
    s_add_u32 s37, s38, 0x80000
    buffer_load_dword v80, v118, s[8:11], s37 offen
    buffer_load_dword v81, v119, s[8:11], s37 offen
    s_add_u32 s37, s38, 0x90000
    buffer_load_dword v82, v118, s[8:11], s37 offen
    buffer_load_dword v83, v119, s[8:11], s37 offen
    s_waitcnt vmcnt(50)
    s_add_u32 s37, s38, 0x84000
    buffer_load_dword v84, v118, s[8:11], s37 offen
    buffer_load_dword v85, v119, s[8:11], s37 offen
    s_add_u32 s37, s38, 0x94000
    buffer_load_dword v86, v118, s[8:11], s37 offen
    buffer_load_dword v87, v119, s[8:11], s37 offen
    s_add_u32 s37, s38, 0xc0000
    buffer_load_dword v88, v118, s[8:11], s37 offen
    buffer_load_dword v89, v119, s[8:11], s37 offen
    s_add_u32 s37, s38, 0xd0000
    buffer_load_dword v90, v118, s[8:11], s37 offen
    buffer_load_dword v91, v119, s[8:11], s37 offen
    s_add_u32 s37, s38, 0xc4000
    buffer_load_dword v92, v118, s[8:11], s37 offen
    buffer_load_dword v93, v119, s[8:11], s37 offen
    s_add_u32 s37, s38, 0xd4000
    buffer_load_dword v94, v118, s[8:11], s37 offen
    buffer_load_dword v95, v119, s[8:11], s37 offen
    s_waitcnt vmcnt(54)
    v_perm_b32 v96, v33, v32, s35
    v_perm_b32 v97, v35, v34, s35
    v_perm_b32 v98, v37, v36, s35
    v_perm_b32 v99, v39, v38, s35
    v_perm_b32 v100, v41, v40, s35
    v_perm_b32 v101, v43, v42, s35
    v_perm_b32 v102, v45, v44, s35
    v_perm_b32 v103, v47, v46, s35
    v_accvgpr_write_b32 a192, v96
    v_accvgpr_write_b32 a193, v97
    v_accvgpr_write_b32 a194, v98
    v_accvgpr_write_b32 a195, v99
    v_accvgpr_write_b32 a196, v100
    v_accvgpr_write_b32 a197, v101
    v_accvgpr_write_b32 a198, v102
    v_accvgpr_write_b32 a199, v103
    v_perm_b32 v104, v33, v32, s36
    v_perm_b32 v105, v35, v34, s36
    v_perm_b32 v106, v37, v36, s36
    v_perm_b32 v107, v39, v38, s36
    v_perm_b32 v108, v41, v40, s36
    v_perm_b32 v109, v43, v42, s36
    v_perm_b32 v110, v45, v44, s36
    v_perm_b32 v111, v47, v46, s36
    v_accvgpr_write_b32 a200, v104
    v_accvgpr_write_b32 a201, v105
    v_accvgpr_write_b32 a202, v106
    v_accvgpr_write_b32 a203, v107
    v_accvgpr_write_b32 a204, v108
    v_accvgpr_write_b32 a205, v109
    v_accvgpr_write_b32 a206, v110
    v_accvgpr_write_b32 a207, v111
    s_xor_b32 s38, s33, 0
    s_lshl_b32 s38, s38, 20
    s_add_u32 s37, s38, 0x0
    buffer_load_dword v32, v118, s[12:15], s37 offen
    buffer_load_dword v33, v119, s[12:15], s37 offen
    s_add_u32 s37, s38, 0x10000
    buffer_load_dword v34, v118, s[12:15], s37 offen
    buffer_load_dword v35, v119, s[12:15], s37 offen
    s_waitcnt vmcnt(50)
    s_add_u32 s37, s38, 0x4000
    buffer_load_dword v36, v118, s[12:15], s37 offen
    buffer_load_dword v37, v119, s[12:15], s37 offen
    s_add_u32 s37, s38, 0x14000
    buffer_load_dword v38, v118, s[12:15], s37 offen
    buffer_load_dword v39, v119, s[12:15], s37 offen
    s_add_u32 s37, s38, 0x40000
    buffer_load_dword v40, v118, s[12:15], s37 offen
    buffer_load_dword v41, v119, s[12:15], s37 offen
    s_add_u32 s37, s38, 0x50000
    buffer_load_dword v42, v118, s[12:15], s37 offen
    buffer_load_dword v43, v119, s[12:15], s37 offen
    s_add_u32 s37, s38, 0x44000
    buffer_load_dword v44, v118, s[12:15], s37 offen
    buffer_load_dword v45, v119, s[12:15], s37 offen
    s_add_u32 s37, s38, 0x54000
    buffer_load_dword v46, v118, s[12:15], s37 offen
    buffer_load_dword v47, v119, s[12:15], s37 offen
    s_waitcnt vmcnt(54)
    v_perm_b32 v96, v49, v48, s35
    v_perm_b32 v97, v51, v50, s35
    v_perm_b32 v98, v53, v52, s35
    v_perm_b32 v99, v55, v54, s35
    v_perm_b32 v100, v57, v56, s35
    v_perm_b32 v101, v59, v58, s35
    v_perm_b32 v102, v61, v60, s35
    v_perm_b32 v103, v63, v62, s35
    v_accvgpr_write_b32 a208, v96
    v_accvgpr_write_b32 a209, v97
    v_accvgpr_write_b32 a210, v98
    v_accvgpr_write_b32 a211, v99
    v_accvgpr_write_b32 a212, v100
    v_accvgpr_write_b32 a213, v101
    v_accvgpr_write_b32 a214, v102
    v_accvgpr_write_b32 a215, v103
    v_perm_b32 v104, v49, v48, s36
    v_perm_b32 v105, v51, v50, s36
    v_perm_b32 v106, v53, v52, s36
    v_perm_b32 v107, v55, v54, s36
    v_perm_b32 v108, v57, v56, s36
    v_perm_b32 v109, v59, v58, s36
    v_perm_b32 v110, v61, v60, s36
    v_perm_b32 v111, v63, v62, s36
    v_accvgpr_write_b32 a216, v104
    v_accvgpr_write_b32 a217, v105
    v_accvgpr_write_b32 a218, v106
    v_accvgpr_write_b32 a219, v107
    v_accvgpr_write_b32 a220, v108
    v_accvgpr_write_b32 a221, v109
    v_accvgpr_write_b32 a222, v110
    v_accvgpr_write_b32 a223, v111
    s_xor_b32 s38, s33, 0
    s_lshl_b32 s38, s38, 20
    s_add_u32 s37, s38, 0x80000
    buffer_load_dword v48, v118, s[12:15], s37 offen
    buffer_load_dword v49, v119, s[12:15], s37 offen
    s_add_u32 s37, s38, 0x90000
    buffer_load_dword v50, v118, s[12:15], s37 offen
    buffer_load_dword v51, v119, s[12:15], s37 offen
    s_waitcnt vmcnt(50)
    s_add_u32 s37, s38, 0x84000
    buffer_load_dword v52, v118, s[12:15], s37 offen
    buffer_load_dword v53, v119, s[12:15], s37 offen
    s_add_u32 s37, s38, 0x94000
    buffer_load_dword v54, v118, s[12:15], s37 offen
    buffer_load_dword v55, v119, s[12:15], s37 offen
    s_add_u32 s37, s38, 0xc0000
    buffer_load_dword v56, v118, s[12:15], s37 offen
    buffer_load_dword v57, v119, s[12:15], s37 offen
    s_add_u32 s37, s38, 0xd0000
    buffer_load_dword v58, v118, s[12:15], s37 offen
    buffer_load_dword v59, v119, s[12:15], s37 offen
    s_add_u32 s37, s38, 0xc4000
    buffer_load_dword v60, v118, s[12:15], s37 offen
    buffer_load_dword v61, v119, s[12:15], s37 offen
    s_add_u32 s37, s38, 0xd4000
    buffer_load_dword v62, v118, s[12:15], s37 offen
    buffer_load_dword v63, v119, s[12:15], s37 offen
    s_waitcnt vmcnt(54)
    v_perm_b32 v96, v65, v64, s35
    v_perm_b32 v97, v67, v66, s35
    v_perm_b32 v98, v69, v68, s35
    v_perm_b32 v99, v71, v70, s35
    v_perm_b32 v100, v73, v72, s35
    v_perm_b32 v101, v75, v74, s35
    v_perm_b32 v102, v77, v76, s35
    v_perm_b32 v103, v79, v78, s35
    v_accvgpr_write_b32 a224, v96
    v_accvgpr_write_b32 a225, v97
    v_accvgpr_write_b32 a226, v98
    v_accvgpr_write_b32 a227, v99
    v_accvgpr_write_b32 a228, v100
    v_accvgpr_write_b32 a229, v101
    v_accvgpr_write_b32 a230, v102
    v_accvgpr_write_b32 a231, v103
    v_perm_b32 v104, v65, v64, s36
    v_perm_b32 v105, v67, v66, s36
    v_perm_b32 v106, v69, v68, s36
    v_perm_b32 v107, v71, v70, s36
    v_perm_b32 v108, v73, v72, s36
    v_perm_b32 v109, v75, v74, s36
    v_perm_b32 v110, v77, v76, s36
    v_perm_b32 v111, v79, v78, s36
    v_accvgpr_write_b32 a232, v104
    v_accvgpr_write_b32 a233, v105
    v_accvgpr_write_b32 a234, v106
    v_accvgpr_write_b32 a235, v107
    v_accvgpr_write_b32 a236, v108
    v_accvgpr_write_b32 a237, v109
    v_accvgpr_write_b32 a238, v110
    v_accvgpr_write_b32 a239, v111
    s_xor_b32 s38, s33, 1
    s_lshl_b32 s38, s38, 20
    s_add_u32 s37, s38, 0x0
    buffer_load_dword v64, v118, s[12:15], s37 offen
    buffer_load_dword v65, v119, s[12:15], s37 offen
    s_add_u32 s37, s38, 0x10000
    buffer_load_dword v66, v118, s[12:15], s37 offen
    buffer_load_dword v67, v119, s[12:15], s37 offen
    s_waitcnt vmcnt(50)
    s_add_u32 s37, s38, 0x4000
    buffer_load_dword v68, v118, s[12:15], s37 offen
    buffer_load_dword v69, v119, s[12:15], s37 offen
    s_add_u32 s37, s38, 0x14000
    buffer_load_dword v70, v118, s[12:15], s37 offen
    buffer_load_dword v71, v119, s[12:15], s37 offen
    s_add_u32 s37, s38, 0x40000
    buffer_load_dword v72, v118, s[12:15], s37 offen
    buffer_load_dword v73, v119, s[12:15], s37 offen
    s_add_u32 s37, s38, 0x50000
    buffer_load_dword v74, v118, s[12:15], s37 offen
    buffer_load_dword v75, v119, s[12:15], s37 offen
    s_add_u32 s37, s38, 0x44000
    buffer_load_dword v76, v118, s[12:15], s37 offen
    buffer_load_dword v77, v119, s[12:15], s37 offen
    s_add_u32 s37, s38, 0x54000
    buffer_load_dword v78, v118, s[12:15], s37 offen
    buffer_load_dword v79, v119, s[12:15], s37 offen
    s_waitcnt vmcnt(48)
    s_barrier
    s_cmp_lg_u32 s33, 0
    s_cbranch_scc1 CARR_5
    v_mov_b32 v121, 1
    v_mov_b32 v122, 0x40000000
    v_cmp_eq_u32 vcc, 0, v112
    v_mov_b32 v123, 32
    s_nop 0
    v_cndmask_b32 v122, v122, v123, vcc
    buffer_atomic_add v121, v122, s[28:31], 0 offen
CARR_5:
    v_perm_b32 v96, v81, v80, s35
    v_perm_b32 v97, v83, v82, s35
    v_perm_b32 v98, v85, v84, s35
    v_perm_b32 v99, v87, v86, s35
    v_perm_b32 v100, v89, v88, s35
    v_perm_b32 v101, v91, v90, s35
    v_perm_b32 v102, v93, v92, s35
    v_perm_b32 v103, v95, v94, s35
    v_accvgpr_write_b32 a240, v96
    v_accvgpr_write_b32 a241, v97
    v_accvgpr_write_b32 a242, v98
    v_accvgpr_write_b32 a243, v99
    v_accvgpr_write_b32 a244, v100
    v_accvgpr_write_b32 a245, v101
    v_accvgpr_write_b32 a246, v102
    v_accvgpr_write_b32 a247, v103
    v_perm_b32 v104, v81, v80, s36
    v_perm_b32 v105, v83, v82, s36
    v_perm_b32 v106, v85, v84, s36
    v_perm_b32 v107, v87, v86, s36
    v_perm_b32 v108, v89, v88, s36
    v_perm_b32 v109, v91, v90, s36
    v_perm_b32 v110, v93, v92, s36
    v_perm_b32 v111, v95, v94, s36
    v_accvgpr_write_b32 a248, v104
    v_accvgpr_write_b32 a249, v105
    v_accvgpr_write_b32 a250, v106
    v_accvgpr_write_b32 a251, v107
    v_accvgpr_write_b32 a252, v108
    v_accvgpr_write_b32 a253, v109
    v_accvgpr_write_b32 a254, v110
    v_accvgpr_write_b32 a255, v111
    s_xor_b32 s38, s33, 1
    s_lshl_b32 s38, s38, 20
    s_add_u32 s37, s38, 0x80000
    buffer_load_dword v80, v118, s[12:15], s37 offen
    buffer_load_dword v81, v119, s[12:15], s37 offen
    s_add_u32 s37, s38, 0x90000
    buffer_load_dword v82, v118, s[12:15], s37 offen
    buffer_load_dword v83, v119, s[12:15], s37 offen
    s_waitcnt vmcnt(50)
    s_add_u32 s37, s38, 0x84000
    buffer_load_dword v84, v118, s[12:15], s37 offen
    buffer_load_dword v85, v119, s[12:15], s37 offen
    s_add_u32 s37, s38, 0x94000
    buffer_load_dword v86, v118, s[12:15], s37 offen
    buffer_load_dword v87, v119, s[12:15], s37 offen
    s_add_u32 s37, s38, 0xc0000
    buffer_load_dword v88, v118, s[12:15], s37 offen
    buffer_load_dword v89, v119, s[12:15], s37 offen
    s_add_u32 s37, s38, 0xd0000
    buffer_load_dword v90, v118, s[12:15], s37 offen
    buffer_load_dword v91, v119, s[12:15], s37 offen
    s_add_u32 s37, s38, 0xc4000
    buffer_load_dword v92, v118, s[12:15], s37 offen
    buffer_load_dword v93, v119, s[12:15], s37 offen
    s_add_u32 s37, s38, 0xd4000
    buffer_load_dword v94, v118, s[12:15], s37 offen
    buffer_load_dword v95, v119, s[12:15], s37 offen
    s_waitcnt vmcnt(48)
    v_perm_b32 v128, v33, v32, s35
    v_perm_b32 v129, v35, v34, s35
    v_perm_b32 v130, v37, v36, s35
    v_perm_b32 v131, v39, v38, s35
    v_perm_b32 v132, v41, v40, s35
    v_perm_b32 v133, v43, v42, s35
    v_perm_b32 v134, v45, v44, s35
    v_perm_b32 v135, v47, v46, s35
    v_perm_b32 v104, v33, v32, s36
    v_perm_b32 v105, v35, v34, s36
    v_perm_b32 v106, v37, v36, s36
    v_perm_b32 v107, v39, v38, s36
    v_perm_b32 v108, v41, v40, s36
    v_perm_b32 v109, v43, v42, s36
    v_perm_b32 v110, v45, v44, s36
    v_perm_b32 v111, v47, v46, s36
    ds_write_b128 v4, v[104:107] offset:4096
    ds_write_b128 v4, v[108:111] offset:5120
    s_waitcnt lgkmcnt(0)
    s_xor_b32 s38, s33, 2
    s_lshl_b32 s38, s38, 20
    s_add_u32 s37, s38, 0x0
    buffer_load_dword v32, v118, s[12:15], s37 offen
    buffer_load_dword v33, v119, s[12:15], s37 offen
    s_add_u32 s37, s38, 0x10000
    buffer_load_dword v34, v118, s[12:15], s37 offen
    buffer_load_dword v35, v119, s[12:15], s37 offen
    s_waitcnt vmcnt(50)
    s_add_u32 s37, s38, 0x4000
    buffer_load_dword v36, v118, s[12:15], s37 offen
    buffer_load_dword v37, v119, s[12:15], s37 offen
    s_add_u32 s37, s38, 0x14000
    buffer_load_dword v38, v118, s[12:15], s37 offen
    buffer_load_dword v39, v119, s[12:15], s37 offen
    s_add_u32 s37, s38, 0x40000
    buffer_load_dword v40, v118, s[12:15], s37 offen
    buffer_load_dword v41, v119, s[12:15], s37 offen
    s_add_u32 s37, s38, 0x50000
    buffer_load_dword v42, v118, s[12:15], s37 offen
    buffer_load_dword v43, v119, s[12:15], s37 offen
    s_add_u32 s37, s38, 0x44000
    buffer_load_dword v44, v118, s[12:15], s37 offen
    buffer_load_dword v45, v119, s[12:15], s37 offen
    s_add_u32 s37, s38, 0x54000
    buffer_load_dword v46, v118, s[12:15], s37 offen
    buffer_load_dword v47, v119, s[12:15], s37 offen
    s_waitcnt vmcnt(48)
    v_perm_b32 v144, v49, v48, s35
    v_perm_b32 v145, v51, v50, s35
    v_perm_b32 v146, v53, v52, s35
    v_perm_b32 v147, v55, v54, s35
    v_perm_b32 v148, v57, v56, s35
    v_perm_b32 v149, v59, v58, s35
    v_perm_b32 v150, v61, v60, s35
    v_perm_b32 v151, v63, v62, s35
    v_perm_b32 v152, v49, v48, s36
    v_perm_b32 v153, v51, v50, s36
    v_perm_b32 v154, v53, v52, s36
    v_perm_b32 v155, v55, v54, s36
    v_perm_b32 v156, v57, v56, s36
    v_perm_b32 v157, v59, v58, s36
    v_perm_b32 v158, v61, v60, s36
    v_perm_b32 v159, v63, v62, s36
    s_xor_b32 s38, s33, 2
    s_lshl_b32 s38, s38, 20
    s_add_u32 s37, s38, 0x80000
    buffer_load_dword v48, v118, s[12:15], s37 offen
    buffer_load_dword v49, v119, s[12:15], s37 offen
    s_add_u32 s37, s38, 0x90000
    buffer_load_dword v50, v118, s[12:15], s37 offen
    buffer_load_dword v51, v119, s[12:15], s37 offen
    s_waitcnt vmcnt(50)
    s_add_u32 s37, s38, 0x84000
    buffer_load_dword v52, v118, s[12:15], s37 offen
    buffer_load_dword v53, v119, s[12:15], s37 offen
    s_add_u32 s37, s38, 0x94000
    buffer_load_dword v54, v118, s[12:15], s37 offen
    buffer_load_dword v55, v119, s[12:15], s37 offen
    s_add_u32 s37, s38, 0xc0000
    buffer_load_dword v56, v118, s[12:15], s37 offen
    buffer_load_dword v57, v119, s[12:15], s37 offen
    s_add_u32 s37, s38, 0xd0000
    buffer_load_dword v58, v118, s[12:15], s37 offen
    buffer_load_dword v59, v119, s[12:15], s37 offen
    s_add_u32 s37, s38, 0xc4000
    buffer_load_dword v60, v118, s[12:15], s37 offen
    buffer_load_dword v61, v119, s[12:15], s37 offen
    s_add_u32 s37, s38, 0xd4000
    buffer_load_dword v62, v118, s[12:15], s37 offen
    buffer_load_dword v63, v119, s[12:15], s37 offen
    s_waitcnt vmcnt(48)
    v_perm_b32 v160, v65, v64, s35
    v_perm_b32 v161, v67, v66, s35
    v_perm_b32 v162, v69, v68, s35
    v_perm_b32 v163, v71, v70, s35
    v_perm_b32 v164, v73, v72, s35
    v_perm_b32 v165, v75, v74, s35
    v_perm_b32 v166, v77, v76, s35
    v_perm_b32 v167, v79, v78, s35
    v_perm_b32 v168, v65, v64, s36
    v_perm_b32 v169, v67, v66, s36
    v_perm_b32 v170, v69, v68, s36
    v_perm_b32 v171, v71, v70, s36
    v_perm_b32 v172, v73, v72, s36
    v_perm_b32 v173, v75, v74, s36
    v_perm_b32 v174, v77, v76, s36
    v_perm_b32 v175, v79, v78, s36
    s_xor_b32 s38, s33, 3
    s_lshl_b32 s38, s38, 20
    s_add_u32 s37, s38, 0x0
    buffer_load_dword v64, v118, s[12:15], s37 offen
    buffer_load_dword v65, v119, s[12:15], s37 offen
    s_add_u32 s37, s38, 0x10000
    buffer_load_dword v66, v118, s[12:15], s37 offen
    buffer_load_dword v67, v119, s[12:15], s37 offen
    s_waitcnt vmcnt(50)
    s_add_u32 s37, s38, 0x4000
    buffer_load_dword v68, v118, s[12:15], s37 offen
    buffer_load_dword v69, v119, s[12:15], s37 offen
    s_add_u32 s37, s38, 0x14000
    buffer_load_dword v70, v118, s[12:15], s37 offen
    buffer_load_dword v71, v119, s[12:15], s37 offen
    s_add_u32 s37, s38, 0x40000
    buffer_load_dword v72, v118, s[12:15], s37 offen
    buffer_load_dword v73, v119, s[12:15], s37 offen
    s_add_u32 s37, s38, 0x50000
    buffer_load_dword v74, v118, s[12:15], s37 offen
    buffer_load_dword v75, v119, s[12:15], s37 offen
    s_add_u32 s37, s38, 0x44000
    buffer_load_dword v76, v118, s[12:15], s37 offen
    buffer_load_dword v77, v119, s[12:15], s37 offen
    s_add_u32 s37, s38, 0x54000
    buffer_load_dword v78, v118, s[12:15], s37 offen
    buffer_load_dword v79, v119, s[12:15], s37 offen
    s_waitcnt vmcnt(48)
    v_perm_b32 v176, v81, v80, s35
    v_perm_b32 v177, v83, v82, s35
    v_perm_b32 v178, v85, v84, s35
    v_perm_b32 v179, v87, v86, s35
    v_perm_b32 v180, v89, v88, s35
    v_perm_b32 v181, v91, v90, s35
    v_perm_b32 v182, v93, v92, s35
    v_perm_b32 v183, v95, v94, s35
    v_perm_b32 v184, v81, v80, s36
    v_perm_b32 v185, v83, v82, s36
    v_perm_b32 v186, v85, v84, s36
    v_perm_b32 v187, v87, v86, s36
    v_perm_b32 v188, v89, v88, s36
    v_perm_b32 v189, v91, v90, s36
    v_perm_b32 v190, v93, v92, s36
    v_perm_b32 v191, v95, v94, s36
    s_xor_b32 s38, s33, 3
    s_lshl_b32 s38, s38, 20
    s_add_u32 s37, s38, 0x80000
    buffer_load_dword v80, v118, s[12:15], s37 offen
    buffer_load_dword v81, v119, s[12:15], s37 offen
    s_add_u32 s37, s38, 0x90000
    buffer_load_dword v82, v118, s[12:15], s37 offen
    buffer_load_dword v83, v119, s[12:15], s37 offen
    s_waitcnt vmcnt(50)
    s_add_u32 s37, s38, 0x84000
    buffer_load_dword v84, v118, s[12:15], s37 offen
    buffer_load_dword v85, v119, s[12:15], s37 offen
    s_add_u32 s37, s38, 0x94000
    buffer_load_dword v86, v118, s[12:15], s37 offen
    buffer_load_dword v87, v119, s[12:15], s37 offen
    s_add_u32 s37, s38, 0xc0000
    buffer_load_dword v88, v118, s[12:15], s37 offen
    buffer_load_dword v89, v119, s[12:15], s37 offen
    s_add_u32 s37, s38, 0xd0000
    buffer_load_dword v90, v118, s[12:15], s37 offen
    buffer_load_dword v91, v119, s[12:15], s37 offen
    s_add_u32 s37, s38, 0xc4000
    buffer_load_dword v92, v118, s[12:15], s37 offen
    buffer_load_dword v93, v119, s[12:15], s37 offen
    s_add_u32 s37, s38, 0xd4000
    buffer_load_dword v94, v118, s[12:15], s37 offen
    buffer_load_dword v95, v119, s[12:15], s37 offen
    s_waitcnt vmcnt(48)
    v_perm_b32 v192, v33, v32, s35
    v_perm_b32 v193, v35, v34, s35
    v_perm_b32 v194, v37, v36, s35
    v_perm_b32 v195, v39, v38, s35
    v_perm_b32 v196, v41, v40, s35
    v_perm_b32 v197, v43, v42, s35
    v_perm_b32 v198, v45, v44, s35
    v_perm_b32 v199, v47, v46, s35
    v_perm_b32 v200, v33, v32, s36
    v_perm_b32 v201, v35, v34, s36
    v_perm_b32 v202, v37, v36, s36
    v_perm_b32 v203, v39, v38, s36
    v_perm_b32 v204, v41, v40, s36
    v_perm_b32 v205, v43, v42, s36
    v_perm_b32 v206, v45, v44, s36
    v_perm_b32 v207, v47, v46, s36
    s_xor_b32 s38, s33, 0
    s_lshl_b32 s38, s38, 20
    s_add_u32 s37, s38, 0x0
    buffer_load_dword v32, v118, s[4:7], s37 offen
    buffer_load_dword v33, v119, s[4:7], s37 offen
    s_add_u32 s37, s38, 0x10000
    buffer_load_dword v34, v118, s[4:7], s37 offen
    buffer_load_dword v35, v119, s[4:7], s37 offen
    s_waitcnt vmcnt(50)
    s_add_u32 s37, s38, 0x4000
    buffer_load_dword v36, v118, s[4:7], s37 offen
    buffer_load_dword v37, v119, s[4:7], s37 offen
    s_add_u32 s37, s38, 0x14000
    buffer_load_dword v38, v118, s[4:7], s37 offen
    buffer_load_dword v39, v119, s[4:7], s37 offen
    s_add_u32 s37, s38, 0x40000
    buffer_load_dword v40, v118, s[4:7], s37 offen
    buffer_load_dword v41, v119, s[4:7], s37 offen
    s_add_u32 s37, s38, 0x50000
    buffer_load_dword v42, v118, s[4:7], s37 offen
    buffer_load_dword v43, v119, s[4:7], s37 offen
    s_add_u32 s37, s38, 0x44000
    buffer_load_dword v44, v118, s[4:7], s37 offen
    buffer_load_dword v45, v119, s[4:7], s37 offen
    s_add_u32 s37, s38, 0x54000
    buffer_load_dword v46, v118, s[4:7], s37 offen
    buffer_load_dword v47, v119, s[4:7], s37 offen
    s_waitcnt vmcnt(48)
    v_perm_b32 v208, v49, v48, s35
    v_perm_b32 v209, v51, v50, s35
    v_perm_b32 v210, v53, v52, s35
    v_perm_b32 v211, v55, v54, s35
    v_perm_b32 v212, v57, v56, s35
    v_perm_b32 v213, v59, v58, s35
    v_perm_b32 v214, v61, v60, s35
    v_perm_b32 v215, v63, v62, s35
    v_perm_b32 v216, v49, v48, s36
    v_perm_b32 v217, v51, v50, s36
    v_perm_b32 v218, v53, v52, s36
    v_perm_b32 v219, v55, v54, s36
    v_perm_b32 v220, v57, v56, s36
    v_perm_b32 v221, v59, v58, s36
    v_perm_b32 v222, v61, v60, s36
    v_perm_b32 v223, v63, v62, s36
    s_xor_b32 s38, s33, 0
    s_lshl_b32 s38, s38, 20
    s_add_u32 s37, s38, 0x80000
    buffer_load_dword v48, v118, s[4:7], s37 offen
    buffer_load_dword v49, v119, s[4:7], s37 offen
    s_add_u32 s37, s38, 0x90000
    buffer_load_dword v50, v118, s[4:7], s37 offen
    buffer_load_dword v51, v119, s[4:7], s37 offen
    s_waitcnt vmcnt(50)
    s_add_u32 s37, s38, 0x84000
    buffer_load_dword v52, v118, s[4:7], s37 offen
    buffer_load_dword v53, v119, s[4:7], s37 offen
    s_add_u32 s37, s38, 0x94000
    buffer_load_dword v54, v118, s[4:7], s37 offen
    buffer_load_dword v55, v119, s[4:7], s37 offen
    s_add_u32 s37, s38, 0xc0000
    buffer_load_dword v56, v118, s[4:7], s37 offen
    buffer_load_dword v57, v119, s[4:7], s37 offen
    s_add_u32 s37, s38, 0xd0000
    buffer_load_dword v58, v118, s[4:7], s37 offen
    buffer_load_dword v59, v119, s[4:7], s37 offen
    s_add_u32 s37, s38, 0xc4000
    buffer_load_dword v60, v118, s[4:7], s37 offen
    buffer_load_dword v61, v119, s[4:7], s37 offen
    s_add_u32 s37, s38, 0xd4000
    buffer_load_dword v62, v118, s[4:7], s37 offen
    buffer_load_dword v63, v119, s[4:7], s37 offen
    s_waitcnt vmcnt(48)
    v_perm_b32 v224, v65, v64, s35
    v_perm_b32 v225, v67, v66, s35
    v_perm_b32 v226, v69, v68, s35
    v_perm_b32 v227, v71, v70, s35
    v_perm_b32 v228, v73, v72, s35
    v_perm_b32 v229, v75, v74, s35
    v_perm_b32 v230, v77, v76, s35
    v_perm_b32 v231, v79, v78, s35
    v_perm_b32 v232, v65, v64, s36
    v_perm_b32 v233, v67, v66, s36
    v_perm_b32 v234, v69, v68, s36
    v_perm_b32 v235, v71, v70, s36
    v_perm_b32 v236, v73, v72, s36
    v_perm_b32 v237, v75, v74, s36
    v_perm_b32 v238, v77, v76, s36
    v_perm_b32 v239, v79, v78, s36
    s_xor_b32 s38, s33, 1
    s_lshl_b32 s38, s38, 20
    s_add_u32 s37, s38, 0x0
    buffer_load_dword v64, v118, s[4:7], s37 offen
    buffer_load_dword v65, v119, s[4:7], s37 offen
    s_add_u32 s37, s38, 0x10000
    buffer_load_dword v66, v118, s[4:7], s37 offen
    buffer_load_dword v67, v119, s[4:7], s37 offen
    s_waitcnt vmcnt(50)
    s_add_u32 s37, s38, 0x4000
    buffer_load_dword v68, v118, s[4:7], s37 offen
    buffer_load_dword v69, v119, s[4:7], s37 offen
    s_add_u32 s37, s38, 0x14000
    buffer_load_dword v70, v118, s[4:7], s37 offen
    buffer_load_dword v71, v119, s[4:7], s37 offen
    s_add_u32 s37, s38, 0x40000
    buffer_load_dword v72, v118, s[4:7], s37 offen
    buffer_load_dword v73, v119, s[4:7], s37 offen
    s_add_u32 s37, s38, 0x50000
    buffer_load_dword v74, v118, s[4:7], s37 offen
    buffer_load_dword v75, v119, s[4:7], s37 offen
    s_add_u32 s37, s38, 0x44000
    buffer_load_dword v76, v118, s[4:7], s37 offen
    buffer_load_dword v77, v119, s[4:7], s37 offen
    s_add_u32 s37, s38, 0x54000
    buffer_load_dword v78, v118, s[4:7], s37 offen
    buffer_load_dword v79, v119, s[4:7], s37 offen
    s_waitcnt vmcnt(48)
    v_perm_b32 v240, v81, v80, s35
    v_perm_b32 v241, v83, v82, s35
    v_perm_b32 v242, v85, v84, s35
    v_perm_b32 v243, v87, v86, s35
    v_perm_b32 v244, v89, v88, s35
    v_perm_b32 v245, v91, v90, s35
    v_perm_b32 v246, v93, v92, s35
    v_perm_b32 v247, v95, v94, s35
    v_perm_b32 v248, v81, v80, s36
    v_perm_b32 v249, v83, v82, s36
    v_perm_b32 v250, v85, v84, s36
    v_perm_b32 v251, v87, v86, s36
    v_perm_b32 v252, v89, v88, s36
    v_perm_b32 v253, v91, v90, s36
    v_perm_b32 v254, v93, v92, s36
    v_perm_b32 v255, v95, v94, s36
    s_xor_b32 s38, s33, 1
    s_lshl_b32 s38, s38, 20
    s_add_u32 s37, s38, 0x80000
    buffer_load_dword v80, v118, s[4:7], s37 offen
    buffer_load_dword v81, v119, s[4:7], s37 offen
    s_add_u32 s37, s38, 0x90000
    buffer_load_dword v82, v118, s[4:7], s37 offen
    buffer_load_dword v83, v119, s[4:7], s37 offen
    s_waitcnt vmcnt(50)
    s_add_u32 s37, s38, 0x84000
    buffer_load_dword v84, v118, s[4:7], s37 offen
    buffer_load_dword v85, v119, s[4:7], s37 offen
    s_add_u32 s37, s38, 0x94000
    buffer_load_dword v86, v118, s[4:7], s37 offen
    buffer_load_dword v87, v119, s[4:7], s37 offen
    s_add_u32 s37, s38, 0xc0000
    buffer_load_dword v88, v118, s[4:7], s37 offen
    buffer_load_dword v89, v119, s[4:7], s37 offen
    s_add_u32 s37, s38, 0xd0000
    buffer_load_dword v90, v118, s[4:7], s37 offen
    buffer_load_dword v91, v119, s[4:7], s37 offen
    s_add_u32 s37, s38, 0xc4000
    buffer_load_dword v92, v118, s[4:7], s37 offen
    buffer_load_dword v93, v119, s[4:7], s37 offen
    s_add_u32 s37, s38, 0xd4000
    buffer_load_dword v94, v118, s[4:7], s37 offen
    buffer_load_dword v95, v119, s[4:7], s37 offen
    s_waitcnt vmcnt(48)
    v_perm_b32 v96, v33, v32, s35
    v_perm_b32 v97, v35, v34, s35
    v_perm_b32 v98, v37, v36, s35
    v_perm_b32 v99, v39, v38, s35
    v_perm_b32 v100, v41, v40, s35
    v_perm_b32 v101, v43, v42, s35
    v_perm_b32 v102, v45, v44, s35
    v_perm_b32 v103, v47, v46, s35
    v_accvgpr_write_b32 a0, v96
    v_accvgpr_write_b32 a1, v97
    v_accvgpr_write_b32 a2, v98
    v_accvgpr_write_b32 a3, v99
    v_accvgpr_write_b32 a4, v100
    v_accvgpr_write_b32 a5, v101
    v_accvgpr_write_b32 a6, v102
    v_accvgpr_write_b32 a7, v103
    v_perm_b32 v104, v33, v32, s36
    v_perm_b32 v105, v35, v34, s36
    v_perm_b32 v106, v37, v36, s36
    v_perm_b32 v107, v39, v38, s36
    v_perm_b32 v108, v41, v40, s36
    v_perm_b32 v109, v43, v42, s36
    v_perm_b32 v110, v45, v44, s36
    v_perm_b32 v111, v47, v46, s36
    ds_write_b128 v4, v[104:107] offset:24576
    ds_write_b128 v4, v[108:111] offset:25600
    s_waitcnt lgkmcnt(0)
    s_xor_b32 s38, s33, 2
    s_lshl_b32 s38, s38, 20
    s_add_u32 s37, s38, 0x0
    buffer_load_dword v32, v118, s[4:7], s37 offen
    buffer_load_dword v33, v119, s[4:7], s37 offen
    s_add_u32 s37, s38, 0x10000
    buffer_load_dword v34, v118, s[4:7], s37 offen
    buffer_load_dword v35, v119, s[4:7], s37 offen
    s_waitcnt vmcnt(50)
    s_add_u32 s37, s38, 0x4000
    buffer_load_dword v36, v118, s[4:7], s37 offen
    buffer_load_dword v37, v119, s[4:7], s37 offen
    s_add_u32 s37, s38, 0x14000
    buffer_load_dword v38, v118, s[4:7], s37 offen
    buffer_load_dword v39, v119, s[4:7], s37 offen
    s_add_u32 s37, s38, 0x40000
    buffer_load_dword v40, v118, s[4:7], s37 offen
    buffer_load_dword v41, v119, s[4:7], s37 offen
    s_add_u32 s37, s38, 0x50000
    buffer_load_dword v42, v118, s[4:7], s37 offen
    buffer_load_dword v43, v119, s[4:7], s37 offen
    s_add_u32 s37, s38, 0x44000
    buffer_load_dword v44, v118, s[4:7], s37 offen
    buffer_load_dword v45, v119, s[4:7], s37 offen
    s_add_u32 s37, s38, 0x54000
    buffer_load_dword v46, v118, s[4:7], s37 offen
    buffer_load_dword v47, v119, s[4:7], s37 offen
    s_waitcnt vmcnt(48)
    v_perm_b32 v96, v49, v48, s35
    v_perm_b32 v97, v51, v50, s35
    v_perm_b32 v98, v53, v52, s35
    v_perm_b32 v99, v55, v54, s35
    v_perm_b32 v100, v57, v56, s35
    v_perm_b32 v101, v59, v58, s35
    v_perm_b32 v102, v61, v60, s35
    v_perm_b32 v103, v63, v62, s35
    v_accvgpr_write_b32 a16, v96
    v_accvgpr_write_b32 a17, v97
    v_accvgpr_write_b32 a18, v98
    v_accvgpr_write_b32 a19, v99
    v_accvgpr_write_b32 a20, v100
    v_accvgpr_write_b32 a21, v101
    v_accvgpr_write_b32 a22, v102
    v_accvgpr_write_b32 a23, v103
    v_perm_b32 v104, v49, v48, s36
    v_perm_b32 v105, v51, v50, s36
    v_perm_b32 v106, v53, v52, s36
    v_perm_b32 v107, v55, v54, s36
    v_perm_b32 v108, v57, v56, s36
    v_perm_b32 v109, v59, v58, s36
    v_perm_b32 v110, v61, v60, s36
    v_perm_b32 v111, v63, v62, s36
    ds_write_b128 v4, v[104:107] offset:2048
    ds_write_b128 v4, v[108:111] offset:3072
    s_waitcnt lgkmcnt(0)
    v_mov_b32 v123, 32
    buffer_load_dword v125, v123, s[28:31], 0 offen sc1
    v_lshrrev_b32 v121, 2, v113
    v_and_b32 v122, 1, v113
    v_lshl_add_u32 v121, v121, 1, v122
    v_lshlrev_b32 v121, 10, v121
    v_lshl_add_u32 v121, v114, 5, v121
    v_and_b32 v122, 2, v113
    v_lshl_add_u32 v121, v122, 3, v121
    s_lshl_b32 s37, s33, 8
    buffer_load_dwordx4 v[20:23], v121, s[24:27], s37 offen
    buffer_load_dwordx4 v[24:27], v121, s[24:27], s37 offen offset:128
    s_mov_b32 s43, 0
    s_lshr_b32 s38, s32, 1
    s_lshl_b32 s38, s38, 9
    s_and_b32 s39, s32, 1
    s_lshl_b32 s39, s39, 3
    s_add_u32 s38, s38, s39
    s_add_u32 s53, s38, 4096
    v_bfe_u32 v28, v2, 4, 4
    v_mul_u32_u24 v28, 1092, v28
    v_and_b32 v28, 0x2184, v28
    buffer_load_dword v30, v28, s[20:23], s53 offen sc1
    s_xor_b32 s38, s33, 2
    s_lshl_b32 s38, s38, 20
    s_add_u32 s37, s38, 0x80000
    buffer_load_dword v48, v118, s[4:7], s37 offen
    buffer_load_dword v49, v119, s[4:7], s37 offen
    s_add_u32 s37, s38, 0x90000
    buffer_load_dword v50, v118, s[4:7], s37 offen
    buffer_load_dword v51, v119, s[4:7], s37 offen
    s_waitcnt vmcnt(50)
    s_add_u32 s37, s38, 0x84000
    buffer_load_dword v52, v118, s[4:7], s37 offen
    buffer_load_dword v53, v119, s[4:7], s37 offen
    s_add_u32 s37, s38, 0x94000
    buffer_load_dword v54, v118, s[4:7], s37 offen
    buffer_load_dword v55, v119, s[4:7], s37 offen
    s_add_u32 s37, s38, 0xc0000
    buffer_load_dword v56, v118, s[4:7], s37 offen
    buffer_load_dword v57, v119, s[4:7], s37 offen
    s_add_u32 s37, s38, 0xd0000
    buffer_load_dword v58, v118, s[4:7], s37 offen
    buffer_load_dword v59, v119, s[4:7], s37 offen
    s_add_u32 s37, s38, 0xc4000
    buffer_load_dword v60, v118, s[4:7], s37 offen
    buffer_load_dword v61, v119, s[4:7], s37 offen
    s_add_u32 s37, s38, 0xd4000
    buffer_load_dword v62, v118, s[4:7], s37 offen
    buffer_load_dword v63, v119, s[4:7], s37 offen
    s_waitcnt vmcnt(52)
    v_perm_b32 v96, v65, v64, s35
    v_perm_b32 v97, v67, v66, s35
    v_perm_b32 v98, v69, v68, s35
    v_perm_b32 v99, v71, v70, s35
    v_perm_b32 v100, v73, v72, s35
    v_perm_b32 v101, v75, v74, s35
    v_perm_b32 v102, v77, v76, s35
    v_perm_b32 v103, v79, v78, s35
    v_accvgpr_write_b32 a32, v96
    v_accvgpr_write_b32 a33, v97
    v_accvgpr_write_b32 a34, v98
    v_accvgpr_write_b32 a35, v99
    v_accvgpr_write_b32 a36, v100
    v_accvgpr_write_b32 a37, v101
    v_accvgpr_write_b32 a38, v102
    v_accvgpr_write_b32 a39, v103
    v_perm_b32 v104, v65, v64, s36
    v_perm_b32 v105, v67, v66, s36
    v_perm_b32 v106, v69, v68, s36
    v_perm_b32 v107, v71, v70, s36
    v_perm_b32 v108, v73, v72, s36
    v_perm_b32 v109, v75, v74, s36
    v_perm_b32 v110, v77, v76, s36
    v_perm_b32 v111, v79, v78, s36
    v_accvgpr_write_b32 a40, v104
    v_accvgpr_write_b32 a41, v105
    v_accvgpr_write_b32 a42, v106
    v_accvgpr_write_b32 a43, v107
    v_accvgpr_write_b32 a44, v108
    v_accvgpr_write_b32 a45, v109
    v_accvgpr_write_b32 a46, v110
    v_accvgpr_write_b32 a47, v111
    s_xor_b32 s38, s33, 3
    s_lshl_b32 s38, s38, 20
    s_add_u32 s37, s38, 0x0
    buffer_load_dword v64, v118, s[4:7], s37 offen
    buffer_load_dword v65, v119, s[4:7], s37 offen
    s_add_u32 s37, s38, 0x10000
    buffer_load_dword v66, v118, s[4:7], s37 offen
    buffer_load_dword v67, v119, s[4:7], s37 offen
    s_waitcnt vmcnt(50)
    s_add_u32 s37, s38, 0x4000
    buffer_load_dword v68, v118, s[4:7], s37 offen
    buffer_load_dword v69, v119, s[4:7], s37 offen
    s_add_u32 s37, s38, 0x14000
    buffer_load_dword v70, v118, s[4:7], s37 offen
    buffer_load_dword v71, v119, s[4:7], s37 offen
    s_add_u32 s37, s38, 0x40000
    buffer_load_dword v72, v118, s[4:7], s37 offen
    buffer_load_dword v73, v119, s[4:7], s37 offen
    s_add_u32 s37, s38, 0x50000
    buffer_load_dword v74, v118, s[4:7], s37 offen
    buffer_load_dword v75, v119, s[4:7], s37 offen
    s_add_u32 s37, s38, 0x44000
    buffer_load_dword v76, v118, s[4:7], s37 offen
    buffer_load_dword v77, v119, s[4:7], s37 offen
    s_add_u32 s37, s38, 0x54000
    buffer_load_dword v78, v118, s[4:7], s37 offen
    buffer_load_dword v79, v119, s[4:7], s37 offen
    s_waitcnt vmcnt(52)
    v_perm_b32 v96, v81, v80, s35
    v_perm_b32 v97, v83, v82, s35
    v_perm_b32 v98, v85, v84, s35
    v_perm_b32 v99, v87, v86, s35
    v_perm_b32 v100, v89, v88, s35
    v_perm_b32 v101, v91, v90, s35
    v_perm_b32 v102, v93, v92, s35
    v_perm_b32 v103, v95, v94, s35
    v_accvgpr_write_b32 a48, v96
    v_accvgpr_write_b32 a49, v97
    v_accvgpr_write_b32 a50, v98
    v_accvgpr_write_b32 a51, v99
    v_accvgpr_write_b32 a52, v100
    v_accvgpr_write_b32 a53, v101
    v_accvgpr_write_b32 a54, v102
    v_accvgpr_write_b32 a55, v103
    v_perm_b32 v104, v81, v80, s36
    v_perm_b32 v105, v83, v82, s36
    v_perm_b32 v106, v85, v84, s36
    v_perm_b32 v107, v87, v86, s36
    v_perm_b32 v108, v89, v88, s36
    v_perm_b32 v109, v91, v90, s36
    v_perm_b32 v110, v93, v92, s36
    v_perm_b32 v111, v95, v94, s36
    v_accvgpr_write_b32 a56, v104
    v_accvgpr_write_b32 a57, v105
    v_accvgpr_write_b32 a58, v106
    v_accvgpr_write_b32 a59, v107
    v_accvgpr_write_b32 a60, v108
    v_accvgpr_write_b32 a61, v109
    v_accvgpr_write_b32 a62, v110
    v_accvgpr_write_b32 a63, v111
    s_xor_b32 s38, s33, 3
    s_lshl_b32 s38, s38, 20
    s_add_u32 s37, s38, 0x80000
    buffer_load_dword v80, v118, s[4:7], s37 offen
    buffer_load_dword v81, v119, s[4:7], s37 offen
    s_add_u32 s37, s38, 0x90000
    buffer_load_dword v82, v118, s[4:7], s37 offen
    buffer_load_dword v83, v119, s[4:7], s37 offen
    s_waitcnt vmcnt(50)
    s_add_u32 s37, s38, 0x84000
    buffer_load_dword v84, v118, s[4:7], s37 offen
    buffer_load_dword v85, v119, s[4:7], s37 offen
    s_add_u32 s37, s38, 0x94000
    buffer_load_dword v86, v118, s[4:7], s37 offen
    buffer_load_dword v87, v119, s[4:7], s37 offen
    s_add_u32 s37, s38, 0xc0000
    buffer_load_dword v88, v118, s[4:7], s37 offen
    buffer_load_dword v89, v119, s[4:7], s37 offen
    s_add_u32 s37, s38, 0xd0000
    buffer_load_dword v90, v118, s[4:7], s37 offen
    buffer_load_dword v91, v119, s[4:7], s37 offen
    s_add_u32 s37, s38, 0xc4000
    buffer_load_dword v92, v118, s[4:7], s37 offen
    buffer_load_dword v93, v119, s[4:7], s37 offen
    s_add_u32 s37, s38, 0xd4000
    buffer_load_dword v94, v118, s[4:7], s37 offen
    buffer_load_dword v95, v119, s[4:7], s37 offen
    s_waitcnt vmcnt(52)
    v_perm_b32 v96, v33, v32, s35
    v_perm_b32 v97, v35, v34, s35
    v_perm_b32 v98, v37, v36, s35
    v_perm_b32 v99, v39, v38, s35
    v_perm_b32 v100, v41, v40, s35
    v_perm_b32 v101, v43, v42, s35
    v_perm_b32 v102, v45, v44, s35
    v_perm_b32 v103, v47, v46, s35
    v_accvgpr_write_b32 a64, v96
    v_accvgpr_write_b32 a65, v97
    v_accvgpr_write_b32 a66, v98
    v_accvgpr_write_b32 a67, v99
    v_accvgpr_write_b32 a68, v100
    v_accvgpr_write_b32 a69, v101
    v_accvgpr_write_b32 a70, v102
    v_accvgpr_write_b32 a71, v103
    v_perm_b32 v104, v33, v32, s36
    v_perm_b32 v105, v35, v34, s36
    v_perm_b32 v106, v37, v36, s36
    v_perm_b32 v107, v39, v38, s36
    v_perm_b32 v108, v41, v40, s36
    v_perm_b32 v109, v43, v42, s36
    v_perm_b32 v110, v45, v44, s36
    v_perm_b32 v111, v47, v46, s36
    v_accvgpr_write_b32 a72, v104
    v_accvgpr_write_b32 a73, v105
    v_accvgpr_write_b32 a74, v106
    v_accvgpr_write_b32 a75, v107
    v_accvgpr_write_b32 a76, v108
    v_accvgpr_write_b32 a77, v109
    v_accvgpr_write_b32 a78, v110
    v_accvgpr_write_b32 a79, v111
    s_waitcnt vmcnt(32)
    v_bfe_u32 v28, v2, 5, 2
    v_lshl_add_u32 v30, v30, 2, v28
    s_nop 1
    v_min_u32_dpp v30, v30, v30 row_ror:8 row_mask:0xf bank_mask:0xf
    s_nop 1
    v_min_u32_dpp v30, v30, v30 row_ror:4 row_mask:0xf bank_mask:0xf
    s_nop 1
    v_min_u32_dpp v30, v30, v30 row_ror:2 row_mask:0xf bank_mask:0xf
    s_nop 1
    v_min_u32_dpp v30, v30, v30 row_ror:1 row_mask:0xf bank_mask:0xf
    s_nop 0
    v_readfirstlane_b32 s38, v30
    s_nop 0
    s_lshl_b32 s38, s38, 1
    s_max_u32 s43, s43, s38
    s_cmp_ge_u32 s43, 64
    s_cselect_b32 s43, 128, s43
    s_cselect_b32 s53, 0x40000000, s53
    s_add_u32 s51, s57, 0xe0000
    s_add_u32 s52, s57, 0x10e0000
    s_cmp_lt_u32 s43, 2
    s_cselect_b32 s51, 0x40000000, s51
    s_cselect_b32 s52, 0x40000000, s52
    s_mov_b32 m0, s60
    s_nop 0
    buffer_load_dwordx4 v2, s[20:23], s51 offen offset:0 sc1 lds
    buffer_load_dwordx4 v2, s[20:23], s51 offen offset:1024 sc1 lds
    s_mov_b32 m0, s61
    s_nop 0
    buffer_load_dwordx4 v2, s[20:23], s52 offen offset:0 sc1 lds
    buffer_load_dwordx4 v2, s[20:23], s52 offen offset:1024 sc1 lds
    v_perm_b32 v96, v49, v48, s35
    v_perm_b32 v97, v51, v50, s35
    v_perm_b32 v98, v53, v52, s35
    v_perm_b32 v99, v55, v54, s35
    v_perm_b32 v100, v57, v56, s35
    v_perm_b32 v101, v59, v58, s35
    v_perm_b32 v102, v61, v60, s35
    v_perm_b32 v103, v63, v62, s35
    v_accvgpr_write_b32 a80, v96
    v_accvgpr_write_b32 a81, v97
    v_accvgpr_write_b32 a82, v98
    v_accvgpr_write_b32 a83, v99
    v_accvgpr_write_b32 a84, v100
    v_accvgpr_write_b32 a85, v101
    v_accvgpr_write_b32 a86, v102
    v_accvgpr_write_b32 a87, v103
    v_perm_b32 v104, v49, v48, s36
    v_perm_b32 v105, v51, v50, s36
    v_perm_b32 v106, v53, v52, s36
    v_perm_b32 v107, v55, v54, s36
    v_perm_b32 v108, v57, v56, s36
    v_perm_b32 v109, v59, v58, s36
    v_perm_b32 v110, v61, v60, s36
    v_perm_b32 v111, v63, v62, s36
    v_accvgpr_write_b32 a88, v104
    v_accvgpr_write_b32 a89, v105
    v_accvgpr_write_b32 a90, v106
    v_accvgpr_write_b32 a91, v107
    v_accvgpr_write_b32 a92, v108
    v_accvgpr_write_b32 a93, v109
    v_accvgpr_write_b32 a94, v110
    v_accvgpr_write_b32 a95, v111
    s_waitcnt vmcnt(20)
    v_perm_b32 v96, v65, v64, s35
    v_perm_b32 v97, v67, v66, s35
    v_perm_b32 v98, v69, v68, s35
    v_perm_b32 v99, v71, v70, s35
    v_perm_b32 v100, v73, v72, s35
    v_perm_b32 v101, v75, v74, s35
    v_perm_b32 v102, v77, v76, s35
    v_perm_b32 v103, v79, v78, s35
    ds_write_b128 v4, v[96:99] offset:6144
    ds_write_b128 v4, v[100:103] offset:7168
    v_perm_b32 v104, v65, v64, s36
    v_perm_b32 v105, v67, v66, s36
    v_perm_b32 v106, v69, v68, s36
    v_perm_b32 v107, v71, v70, s36
    v_perm_b32 v108, v73, v72, s36
    v_perm_b32 v109, v75, v74, s36
    v_perm_b32 v110, v77, v76, s36
    v_perm_b32 v111, v79, v78, s36
    ds_write_b128 v4, v[104:107] offset:10240
    ds_write_b128 v4, v[108:111] offset:11264
    s_waitcnt lgkmcnt(0)
    s_waitcnt vmcnt(4)
    v_perm_b32 v96, v81, v80, s35
    v_perm_b32 v97, v83, v82, s35
    v_perm_b32 v98, v85, v84, s35
    v_perm_b32 v99, v87, v86, s35
    v_perm_b32 v100, v89, v88, s35
    v_perm_b32 v101, v91, v90, s35
    v_perm_b32 v102, v93, v92, s35
    v_perm_b32 v103, v95, v94, s35
    ds_write_b128 v4, v[96:99] offset:12288
    ds_write_b128 v4, v[100:103] offset:13312
    v_perm_b32 v104, v81, v80, s36
    v_perm_b32 v105, v83, v82, s36
    v_perm_b32 v106, v85, v84, s36
    v_perm_b32 v107, v87, v86, s36
    v_perm_b32 v108, v89, v88, s36
    v_perm_b32 v109, v91, v90, s36
    v_perm_b32 v110, v93, v92, s36
    v_perm_b32 v111, v95, v94, s36
    ds_write_b128 v4, v[104:107] offset:14336
    ds_write_b128 v4, v[108:111] offset:15360
    s_waitcnt lgkmcnt(0)
CLOOP_START:
    s_waitcnt vmcnt(0)
    v_cmp_ne_u32 vcc, 32, v125
    v_min_u32 v32, s59, v20
    v_min_u32 v33, s59, v21
    v_min_u32 v34, s59, v22
    v_min_u32 v35, s59, v23
    v_min_u32 v36, s59, v24
    v_min_u32 v37, s59, v25
    v_min_u32 v38, s59, v26
    v_min_u32 v39, s59, v27
    v_mov_b64 v[20:21], 0
    v_mov_b64 v[22:23], 0
    v_mov_b64 v[24:25], 0
    v_mov_b64 v[26:27], 0
    s_cbranch_vccz CTOK_8
    s_mov_b32 s40, 0
    v_mov_b32 v64, 32
CTEAM_6:
    buffer_load_dword v65, v64, s[28:31], 0 offen sc1
    s_add_u32 s40, s40, 1
    s_cmp_gt_u32 s40, 0x40000
    s_cbranch_scc1 CABORT_7
    s_waitcnt vmcnt(0)
    v_cmp_ne_u32 vcc, 32, v65
    s_cbranch_vccnz CTEAM_6
CTOK_8:
    s_mov_b32 s34, 0
    s_cmp_ge_u32 s43, 2
    s_cbranch_scc1 CHAVE_9
    s_add_u32 s37, s34, 1
    s_cmp_lt_u32 s37, s43
    s_cbranch_scc1 CKVOK_11
    s_mov_b32 s40, 0
CKV_10:
    v_bfe_u32 v28, v2, 4, 4
    v_mul_u32_u24 v28, 1092, v28
    v_and_b32 v28, 0x2184, v28
    buffer_load_dword v30, v28, s[20:23], s53 offen sc1
    s_add_u32 s40, s40, 1
    s_cmp_gt_u32 s40, 0x40000
    s_cbranch_scc1 CABORT_7
    s_waitcnt vmcnt(0)
    v_bfe_u32 v28, v2, 5, 2
    v_lshl_add_u32 v30, v30, 2, v28
    s_nop 1
    v_min_u32_dpp v30, v30, v30 row_ror:8 row_mask:0xf bank_mask:0xf
    s_nop 1
    v_min_u32_dpp v30, v30, v30 row_ror:4 row_mask:0xf bank_mask:0xf
    s_nop 1
    v_min_u32_dpp v30, v30, v30 row_ror:2 row_mask:0xf bank_mask:0xf
    s_nop 1
    v_min_u32_dpp v30, v30, v30 row_ror:1 row_mask:0xf bank_mask:0xf
    s_nop 0
    v_readfirstlane_b32 s38, v30
    s_nop 0
    s_lshl_b32 s38, s38, 1
    s_max_u32 s43, s43, s38
    s_cmp_ge_u32 s43, 64
    s_cselect_b32 s43, 128, s43
    s_cselect_b32 s53, 0x40000000, s53
    s_cmp_lt_u32 s37, s43
    s_cbranch_scc0 CKV_10
    s_mov_b32 s40, 0
CKVOK_11:
    s_add_u32 s51, s57, 0xe0000
    s_add_u32 s52, s57, 0x10e0000
    s_mov_b32 m0, s60
    s_nop 0
    buffer_load_dwordx4 v2, s[20:23], s51 offen offset:0 sc1 lds
    buffer_load_dwordx4 v2, s[20:23], s51 offen offset:1024 sc1 lds
    s_mov_b32 m0, s61
    s_nop 0
    buffer_load_dwordx4 v2, s[20:23], s52 offen offset:0 sc1 lds
    buffer_load_dwordx4 v2, s[20:23], s52 offen offset:1024 sc1 lds
    s_waitcnt vmcnt(0)
CHAVE_9:
    s_lshl_b32 s37, s32, 5
    s_add_u32 s37, s37, s33
    s_lshl_b32 s37, s37, 2
    s_add_u32 s37, s37, 0
    v_cmp_eq_u32 vcc, 0x20000, v2
    v_mov_b32 v28, 0x40000000
    v_mov_b32 v29, s37
    v_cndmask_b32 v31, v28, v29, vcc
    s_mov_b32 s46, 0
    s_mov_b32 s47, 8192
    s_mov_b32 s48, 16384
    s_mov_b32 s54, 0x40000000
    s_mov_b32 s41, 0x8000
    s_mov_b32 s87, s53
    s_mov_b32 s44, 0
    s_mov_b32 s55, 0
    s_add_u32 s51, s51, 0x40000
    s_add_u32 s52, s52, 0x40000
    ds_read_b128 v[40:43], v4 offset:24576
    ds_read_b128 v[44:47], v4 offset:25600
    ds_read_b128 v[48:51], v4 offset:2048
    ds_read_b128 v[52:55], v4 offset:3072
    ds_read_b128 v[88:91], v4 offset:6144
    ds_read_b128 v[92:95], v4 offset:7168
    ds_read_b128 v[96:99], v4 offset:10240
    ds_read_b128 v[100:103], v4 offset:11264
    ds_read_b128 v[104:107], v4 offset:12288
    ds_read_b128 v[108:111], v4 offset:13312
    ds_read_b128 v[112:115], v4 offset:14336
    ds_read_b128 v[116:119], v4 offset:15360
    ds_read_b128 v[56:59], v4 offset:4096
    ds_read_b128 v[60:63], v4 offset:5120
    v_mov_b64 v[64:65], 0
    v_mov_b64 v[66:67], 0
    v_mov_b64 v[68:69], 0
    v_mov_b64 v[70:71], 0
    v_mov_b64 v[72:73], 0
    v_mov_b64 v[74:75], 0
    v_mov_b64 v[76:77], 0
    v_mov_b64 v[78:79], 0
    v_mov_b64 v[80:81], 0
    v_mov_b64 v[82:83], 0
    v_mov_b64 v[84:85], 0
    v_mov_b64 v[86:87], 0
    s_waitcnt lgkmcnt(0)
    s_branch CGOT_14
CTOP_13:
    buffer_load_dwordx4 v[32:35], v2, s[20:23], s50 offen offset:0 sc1
    buffer_load_dwordx4 v[36:39], v2, s[20:23], s50 offen offset:1024 sc1
    s_nop 15
    s_nop 7
    buffer_load_dwordx4 v[120:123], v2, s[20:23], s50 offen offset:0 sc1
    buffer_load_dwordx4 v[124:127], v2, s[20:23], s50 offen offset:1024 sc1
    s_waitcnt vmcnt(3) lgkmcnt(0)
    v_smfmac_f32_16x16x64_bf16 v[64:67], v[32:35], a[0:7], v1
    ds_write_b128 v3, v[32:35] offset:16384
    v_max3_u32 v29, v32, v33, v34
    v_smfmac_f32_16x16x64_bf16 v[68:71], v[32:35], v[40:47], v1
    s_waitcnt vmcnt(2)
    v_max3_u32 v29, v29, v35, v36
    v_max3_u32 v29, v29, v37, v38
    v_smfmac_f32_16x16x64_bf16 v[64:67], v[36:39], a[16:23], v1
    ds_write_b128 v3, v[36:39] offset:17408
    v_max_u32 v29, v29, v39
    v_cmp_eq_u32 vcc, -1, v29
    v_smfmac_f32_16x16x64_bf16 v[68:71], v[36:39], v[48:55], v1
    s_cbranch_vccnz CREDO_15
    v_xor_b32 v0, 0x800, v3
    v_smfmac_f32_16x16x64_bf16 v[80:83], v[32:35], v[128:135], v1
    s_mov_b32 m0, s61
    s_cmp_eq_u32 s34, 63
    v_xor_b32 v28, 0x1000, v3
    v_smfmac_f32_16x16x64_bf16 v[84:87], v[32:35], v[56:63], v1
    s_waitcnt lgkmcnt(0)
    s_barrier
    v_smfmac_f32_16x16x64_bf16 v[80:83], v[36:39], v[144:151], v1
    ds_read_b128 v[40:43], v0 offset:16384
    v_xor_b32 v30, 0x1800, v3
    v_smfmac_f32_16x16x64_bf16 v[84:87], v[36:39], v[152:159], v1
    ds_read_b128 v[44:47], v0 offset:17408
    v_smfmac_f32_16x16x64_bf16 v[72:75], v[32:35], a[128:135], v1
    ds_read_b128 v[48:51], v28 offset:16384
    v_smfmac_f32_16x16x64_bf16 v[76:79], v[32:35], a[136:143], v1
    ds_read_b128 v[52:55], v28 offset:17408
    v_smfmac_f32_16x16x64_bf16 v[72:75], v[36:39], a[144:151], v1
    ds_read_b128 v[56:59], v30 offset:16384
    v_smfmac_f32_16x16x64_bf16 v[76:79], v[36:39], a[152:159], v1
    ds_read_b128 v[60:63], v30 offset:17408
    s_waitcnt lgkmcnt(5)
COWN_16:
    v_smfmac_f32_16x16x64_bf16 v[64:67], v[40:43], a[32:39], v1
    s_cbranch_scc1 CFIN_17
    s_waitcnt lgkmcnt(4)
    s_waitcnt vmcnt(0)
    v_bfe_u32 v28, v2, 4, 4
    v_smfmac_f32_16x16x64_bf16 v[68:71], v[40:43], a[40:47], v1
    ds_read_b128 v[120:123], v3 offset:8192
    v_mul_u32_u24 v28, 1092, v28
    v_smfmac_f32_16x16x64_bf16 v[64:67], v[44:47], a[48:55], v1
    s_waitcnt lgkmcnt(4)
    v_and_b32 v28, 0x2184, v28
    v_smfmac_f32_16x16x64_bf16 v[68:71], v[44:47], a[56:63], v1
    ds_read_b128 v[124:127], v3 offset:9216
    buffer_load_dword v30, v28, s[20:23], s87 offen sc1
    v_mov_b32 v29, s44
    v_smfmac_f32_16x16x64_bf16 v[64:67], v[48:51], a[64:71], v1
    s_waitcnt lgkmcnt(4)
    v_smfmac_f32_16x16x64_bf16 v[68:71], v[48:51], a[72:79], v1
    v_smfmac_f32_16x16x64_bf16 v[64:67], v[52:55], a[80:87], v1
    s_waitcnt lgkmcnt(3)
    buffer_load_dwordx4 v2, s[20:23], s52 offen offset:0 sc1 lds
    v_smfmac_f32_16x16x64_bf16 v[68:71], v[52:55], a[88:95], v1
    ds_read_b128 v[32:35], v4 offset:0
    v_smfmac_f32_16x16x64_bf16 v[64:67], v[56:59], v[88:95], v1
    s_waitcnt lgkmcnt(1)
    v_smfmac_f32_16x16x64_bf16 v[68:71], v[56:59], v[96:103], v1
    s_mov_b64 exec, 1
    buffer_store_dword v29, v31, s[20:23], 0 offen sc1
    s_mov_b64 exec, -1
    v_smfmac_f32_16x16x64_bf16 v[64:67], v[60:63], v[104:111], v1
    ds_read_b128 v[36:39], v4 offset:1024
    v_smfmac_f32_16x16x64_bf16 v[68:71], v[60:63], v[112:119], v1
    buffer_load_dwordx4 v2, s[20:23], s52 offen offset:1024 sc1 lds
    v_smfmac_f32_16x16x64_bf16 v[72:75], v[40:43], a[160:167], v1
    ds_read_b128 v[88:91], v2 offset:0
    v_add_f32 v64, v64, v66
    v_smfmac_f32_16x16x64_bf16 v[76:79], v[40:43], a[168:175], v1
    v_add_f32 v65, v65, v67
    v_add_f32 v68, v68, v70
    v_smfmac_f32_16x16x64_bf16 v[72:75], v[44:47], a[176:183], v1
    v_add_f32 v69, v69, v71
    v_cvt_pk_bf16_f32 v66, v64, v68
    v_smfmac_f32_16x16x64_bf16 v[76:79], v[44:47], a[184:191], v1
    ds_read_b128 v[92:95], v2 offset:1024
    v_cvt_pk_bf16_f32 v67, v65, v69
    v_smfmac_f32_16x16x64_bf16 v[72:75], v[48:51], a[192:199], v1
    ds_write2_b32 v5, v66, v67 offset0:0 offset1:72
    v_smfmac_f32_16x16x64_bf16 v[76:79], v[48:51], a[200:207], v1
    ds_read_b128 v[96:99], v2 offset:2048
    buffer_store_dwordx4 v[20:23], v2, s[20:23], s54 offen sc1
    v_smfmac_f32_16x16x64_bf16 v[72:75], v[52:55], a[208:215], v1
    ds_read_b128 v[100:103], v2 offset:3072
    v_smfmac_f32_16x16x64_bf16 v[76:79], v[52:55], a[216:223], v1
    v_add_u32 v0, 2304, v5
    v_smfmac_f32_16x16x64_bf16 v[72:75], v[56:59], a[224:231], v1
    s_waitcnt lgkmcnt(2)
    s_barrier
    v_smfmac_f32_16x16x64_bf16 v[76:79], v[56:59], a[232:239], v1
    ds_read_b128 v[104:107], v8 offset:0
    v_smfmac_f32_16x16x64_bf16 v[72:75], v[60:63], a[240:247], v1
    ds_read_b128 v[108:111], v8 offset:64
    v_smfmac_f32_16x16x64_bf16 v[76:79], v[60:63], a[248:255], v1
    ds_read_b128 v[112:115], v8 offset:128
    v_smfmac_f32_16x16x64_bf16 v[80:83], v[40:43], v[160:167], v1
    ds_read_b128 v[116:119], v8 offset:192
    v_add_f32 v72, v72, v74
    v_smfmac_f32_16x16x64_bf16 v[84:87], v[40:43], v[168:175], v1
    s_waitcnt lgkmcnt(3)
    v_add_f32 v73, v73, v75
    v_add_f32 v76, v76, v78
    v_mfma_f32_16x16x32_bf16 v[64:67], v[88:91], v[104:107], 0
    s_waitcnt lgkmcnt(2)
    v_add_f32 v77, v77, v79
    v_cvt_pk_bf16_f32 v74, v72, v76
    v_mfma_f32_16x16x32_bf16 v[64:67], v[92:95], v[108:111], v[64:67]
    ds_read_b128 v[88:91], v2 offset:4096
    v_cvt_pk_bf16_f32 v75, v73, v77
    s_waitcnt lgkmcnt(2)
    v_mfma_f32_16x16x32_bf16 v[64:67], v[96:99], v[112:115], v[64:67]
    ds_write2_b32 v0, v74, v75 offset0:0 offset1:72
    s_waitcnt lgkmcnt(2)
    v_mfma_f32_16x16x32_bf16 v[64:67], v[100:103], v[116:119], v[64:67]
    ds_read_b128 v[92:95], v2 offset:5120
    v_smfmac_f32_16x16x64_bf16 v[80:83], v[44:47], v[176:183], v1
    ds_read_b128 v[96:99], v2 offset:6144
    s_mov_b32 m0, s60
    v_smfmac_f32_16x16x64_bf16 v[84:87], v[44:47], v[184:191], v1
    ds_read_b128 v[100:103], v2 offset:7168
    s_waitcnt lgkmcnt(4)
    v_mfma_f32_16x16x32_bf16 v[68:71], v[88:91], v[104:107], 0
    s_waitcnt lgkmcnt(2)
    v_exp_f32 v64, v64
    v_mfma_f32_16x16x32_bf16 v[68:71], v[92:95], v[108:111], v[68:71]
    s_waitcnt lgkmcnt(1)
    v_exp_f32 v65, v65
    v_mfma_f32_16x16x32_bf16 v[68:71], v[96:99], v[112:115], v[68:71]
    s_waitcnt lgkmcnt(0)
    s_barrier
    v_mfma_f32_16x16x32_bf16 v[68:71], v[100:103], v[116:119], v[68:71]
    ds_read_b128 v[88:91], v8 offset:2304
    v_cvt_pk_bf16_f32 v64, v64, v65
    v_smfmac_f32_16x16x64_bf16 v[80:83], v[48:51], v[192:199], v1
    ds_read_b128 v[92:95], v8 offset:2368
    buffer_load_dwordx4 v2, s[20:23], s51 offen offset:0 sc1 lds
    v_exp_f32 v66, v66
    v_smfmac_f32_16x16x64_bf16 v[80:83], v[52:55], v[208:215], v1
    ds_read_b128 v[96:99], v8 offset:2432
    v_exp_f32 v67, v67
    v_smfmac_f32_16x16x64_bf16 v[80:83], v[56:59], v[224:231], v1
    ds_read_b128 v[100:103], v8 offset:2496
    v_exp_f32 v68, v68
    v_smfmac_f32_16x16x64_bf16 v[80:83], v[60:63], v[240:247], v1
    buffer_load_dwordx4 v2, s[20:23], s51 offen offset:1024 sc1 lds
    s_waitcnt lgkmcnt(3)
    v_cvt_pk_bf16_f32 v65, v66, v67
    v_mfma_f32_16x16x32_bf16 v[72:75], v[88:91], v[104:107], 0
    s_waitcnt lgkmcnt(2)
    v_exp_f32 v69, v69
    v_mfma_f32_16x16x32_bf16 v[72:75], v[92:95], v[108:111], v[72:75]
    s_waitcnt lgkmcnt(1)
    v_exp_f32 v70, v70
    v_mfma_f32_16x16x32_bf16 v[72:75], v[96:99], v[112:115], v[72:75]
    s_waitcnt lgkmcnt(0)
    v_exp_f32 v71, v71
    v_mfma_f32_16x16x32_bf16 v[72:75], v[100:103], v[116:119], v[72:75]
    v_cvt_pk_bf16_f32 v66, v68, v69
    v_cvt_pk_bf16_f32 v67, v70, v71
    v_smfmac_f32_16x16x64_bf16 v[84:87], v[48:51], v[200:207], v1
    ds_read_b128 v[108:111], v4 offset:17408
    v_add_f32 v80, v80, v82
    v_mfma_f32_16x16x32_bf16 v[120:123], v[120:123], v[64:67], 0
    v_add_f32 v81, v81, v83
    v_mul_f32 v72, s58, v72
    v_mfma_f32_16x16x32_bf16 v[124:127], v[124:127], v[64:67], 0
    v_mul_f32 v73, s58, v73
    v_cvt_pk_bf16_f32 v20, v80, v81
    v_mfma_f32_16x16x32_bf16 v[76:79], v[16:19], v[64:67], 0
    ds_read_b64 v[22:23], v6 offset:2304
    v_smfmac_f32_16x16x64_bf16 v[84:87], v[52:55], v[216:223], v1
    ds_read_b128 v[40:43], v4 offset:8192
    v_exp_f32 v72, v72
    v_smfmac_f32_16x16x64_bf16 v[84:87], v[56:59], v[232:239], v1
    ds_read_b128 v[44:47], v4 offset:9216
    v_exp_f32 v73, v73
    v_smfmac_f32_16x16x64_bf16 v[84:87], v[60:63], v[248:255], v1
    ds_read_b128 v[104:107], v4 offset:16384
    v_cvt_pk_bf16_f32 v24, v72, v73
    v_cvt_pk_bf16_f32 v27, v72, v73
    s_nop 0
    v_mfma_f32_16x16x16_bf16 v[76:79], v[16:17], v[24:25], v[76:79]
    v_mfma_f32_16x16x16_bf16 v[120:123], v[20:21], v[24:25], v[120:123]
    v_add_f32 v84, v84, v86
    v_add_f32 v85, v85, v87
    v_cvt_pk_bf16_f32 v21, v84, v85
    s_nop 1
    v_mfma_f32_16x16x16_bf16 v[124:127], v[20:21], v[26:27], v[124:127]
CRJ_23:
    v_rcp_f32 v28, v76
    v_mov_b64 v[88:89], 0
    v_mul_f32 v120, v120, v28
    v_mul_f32 v122, v122, v28
    v_mul_f32 v121, v121, v28
    v_mul_f32 v123, v123, v28
    v_max_f32 v29, v28, v76
    s_nop 0
    v_mul_f32 v124, v124, v28
    v_mul_f32 v126, v126, v28
    v_cvt_pk_bf16_f32 v72, v120, v124
    v_cvt_pk_bf16_f32 v74, v122, v126
    v_mul_f32 v125, v125, v28
    v_mul_f32 v127, v127, v28
    v_cndmask_b32 v76, v72, v74, s[66:67]
    v_cvt_pk_bf16_f32 v73, v121, v125
    v_cvt_pk_bf16_f32 v75, v123, v127
    v_cndmask_b32 v77, v73, v75, s[66:67]
    ds_write_b64 v6, v[76:77] offset:4608
    v_cmp_nle_f32 vcc, v29, s63
    v_mov_b64 v[90:91], 0
    v_mov_b64 v[92:93], 0
    v_mov_b64 v[94:95], 0
    v_add_u32 v0, s42, v8
    s_cbranch_vccnz CFB_22
CRJ2_24:
    s_waitcnt lgkmcnt(1)
    v_smfmac_f32_16x16x64_bf16 v[88:91], v[72:75], v[32:39], v1
    v_mov_b64 v[96:97], 0
    v_mov_b64 v[98:99], 0
    v_smfmac_f32_16x16x64_bf16 v[92:95], v[72:75], v[40:47], v1
    v_mov_b64 v[100:101], 0
    v_mov_b64 v[102:103], 0
    s_waitcnt lgkmcnt(0)
    s_barrier
    ds_read_b128 v[76:79], v7 offset:4608
    v_smfmac_f32_16x16x64_bf16 v[96:99], v[72:75], v[104:111], v1
    ds_read_b128 v[80:83], v9 offset:4608
    ds_read_b128 v[84:87], v0 offset:4608
    v_smfmac_f32_16x16x64_bf16 v[100:103], v[72:75], a[8:15], v1
    ds_read_b128 v[48:51], v4 offset:18432
    ds_read_b128 v[52:55], v4 offset:19456
    s_waitcnt lgkmcnt(4)
    v_smfmac_f32_16x16x64_bf16 v[88:91], v[76:79], a[24:31], v1
    s_waitcnt lgkmcnt(3)
    ds_read_b128 v[56:59], v4 offset:20480
    v_smfmac_f32_16x16x64_bf16 v[88:91], v[80:83], v[136:143], v1
    s_waitcnt lgkmcnt(3)
    ds_read_b128 v[60:63], v4 offset:21504
    v_smfmac_f32_16x16x64_bf16 v[88:91], v[84:87], a[96:103], v1
    ds_read_b128 v[112:115], v4 offset:22528
    v_smfmac_f32_16x16x64_bf16 v[92:95], v[76:79], a[104:111], v1
    ds_read_b128 v[116:119], v4 offset:23552
    v_smfmac_f32_16x16x64_bf16 v[92:95], v[80:83], a[112:119], v1
    ds_read_b128 v[64:67], v4 offset:26624
    v_cvt_pk_bf16_f32 v88, v88, v90
    v_smfmac_f32_16x16x64_bf16 v[92:95], v[84:87], a[120:127], v1
    s_waitcnt lgkmcnt(5)
    ds_read_b128 v[68:71], v4 offset:27648
    v_cmp_eq_u32 vcc, v88, v12
    v_smfmac_f32_16x16x64_bf16 v[96:99], v[76:79], v[48:55], v1
    s_waitcnt lgkmcnt(4)
    ds_read_b128 v[120:123], v4 offset:28672
    v_cvt_pk_bf16_f32 v89, v89, v91
    v_addc_co_u32 v88, vcc, 0, v88, vcc
    v_smfmac_f32_16x16x64_bf16 v[96:99], v[80:83], v[56:63], v1
    s_waitcnt lgkmcnt(3)
    ds_read_b128 v[124:127], v4 offset:29696
    v_cvt_pk_bf16_f32 v90, v92, v94
    v_cvt_pk_bf16_f32 v91, v93, v95
    v_smfmac_f32_16x16x64_bf16 v[96:99], v[84:87], v[112:119], v1
    buffer_store_dwordx4 v[88:91], v10, s[20:23], 0 offen
    s_waitcnt lgkmcnt(2)
    v_smfmac_f32_16x16x64_bf16 v[100:103], v[76:79], v[64:71], v1
    ds_read_b128 v[32:35], v4 offset:30720
    ds_read_b128 v[36:39], v4 offset:31744
    s_waitcnt lgkmcnt(2)
    v_smfmac_f32_16x16x64_bf16 v[100:103], v[80:83], v[120:127], v1
    s_waitcnt lgkmcnt(0)
    v_cvt_pk_bf16_f32 v96, v96, v98
    v_smfmac_f32_16x16x64_bf16 v[100:103], v[84:87], v[32:39], v1
    ds_read_b128 v[56:59], v2 offset:31488
    v_cvt_pk_bf16_f32 v97, v97, v99
    v_cmp_eq_u32 vcc, v96, v13
    s_add_u32 s34, s34, 1
    s_mov_b32 s46, s47
    v_addc_co_u32 v96, vcc, 0, v96, vcc
    s_mov_b32 s47, s48
    s_add_u32 s48, s48, 8192
    v_cvt_pk_bf16_f32 v98, v100, v102
    v_cvt_pk_bf16_f32 v99, v101, v103
    buffer_store_dwordx4 v[96:99], v10, s[20:23], s41 offen
    v_mov_b32 v12, v88
    v_mov_b32 v13, v96
    ds_read_b128 v[40:43], v4 offset:24576
    s_and_b32 s48, s48, 0x7fff
    s_lshl_b32 s54, s34, 17
    ds_read_b128 v[44:47], v4 offset:25600
    s_add_u32 s54, s54, s56
    s_add_u32 s54, s54, 0x48c0000
    ds_read_b128 v[48:51], v4 offset:2048
    s_add_u32 s51, s51, 0x40000
    s_add_u32 s52, s52, 0x40000
    ds_read_b128 v[52:55], v4 offset:3072
    s_add_u32 s50, s46, s49
    s_mov_b32 s40, 0
    ds_read_b128 v[88:91], v4 offset:6144
    s_sub_u32 s44, s34, 1
    s_and_b32 s55, s34, 3
    ds_read_b128 v[92:95], v4 offset:7168
    s_cselect_b32 s55, 0, 1
    s_cmp_ge_u32 s34, 56
    ds_read_b128 v[96:99], v4 offset:10240
    s_cselect_b32 s55, 1, s55
    s_cmp_ge_u32 s34, 63
    ds_read_b128 v[100:103], v4 offset:11264
    s_cselect_b32 s51, 0x40000000, s51
    s_cselect_b32 s52, 0x40000000, s52
    ds_read_b128 v[104:107], v4 offset:12288
    v_mov_b64 v[64:65], 0
    v_mov_b64 v[66:67], 0
    ds_read_b128 v[108:111], v4 offset:13312
    v_mov_b64 v[68:69], 0
    v_mov_b64 v[70:71], 0
    ds_read_b128 v[112:115], v4 offset:14336
    v_mov_b64 v[72:73], 0
    buffer_load_dwordx4 v[32:35], v2, s[20:23], s45 offen offset:0 sc1
    buffer_load_dwordx4 v[36:39], v2, s[20:23], s45 offen offset:1024 sc1
    v_mov_b64 v[74:75], 0
    ds_read_b128 v[116:119], v4 offset:15360
    v_mov_b64 v[76:77], 0
    v_mov_b64 v[78:79], 0
    v_mov_b64 v[80:81], 0
    v_mov_b64 v[82:83], 0
    v_mov_b64 v[84:85], 0
    v_mov_b64 v[86:87], 0
    s_nop 15
    s_nop 3
CP1_25:
    s_nop 0
    buffer_load_dwordx4 v[120:123], v2, s[20:23], s45 offen offset:0 sc1
    buffer_load_dwordx4 v[124:127], v2, s[20:23], s45 offen offset:1024 sc1
    s_waitcnt vmcnt(3) lgkmcnt(0)
    v_mfma_f32_16x16x32_bf16 v[60:63], v[56:59], v[32:35], 0
    v_cmp_eq_u32 s[38:39], v32, v14
    s_waitcnt vmcnt(2)
    v_mfma_f32_16x16x32_bf16 v[60:63], v[56:59], v[36:39], v[60:63]
    v_cmp_eq_u32 vcc, v36, v15
    v_mov_b32 v29, -1
    s_or_b64 vcc, vcc, s[38:39]
    s_cbranch_vccnz CB1_26
    s_nop 2
    s_nop 0
    v_add_f32_dpp v60, v60, v60 row_ror:8 row_mask:0xf bank_mask:0xf
    v_add_f32_dpp v61, v61, v61 row_ror:8 row_mask:0xf bank_mask:0xf
    s_nop 0
    v_add_f32_dpp v60, v60, v60 row_ror:4 row_mask:0xf bank_mask:0xf
    v_add_f32_dpp v61, v61, v61 row_ror:4 row_mask:0xf bank_mask:0xf
    v_cvt_pk_bf16_f32 v0, v60, v61
    v_min_u32 v0, s59, v0
    buffer_store_dword v0, v11, s[20:23], s46 offen
    v_mov_b32 v14, v32
    v_mov_b32 v15, v36
    s_branch CJN_27
CB1_26:
    s_add_u32 s40, s40, 1
    s_cmp_gt_u32 s40, 0x40000
    s_cbranch_scc1 CABORT_7
    buffer_load_dwordx4 v[32:35], v2, s[20:23], s45 offen offset:0 sc1
    buffer_load_dwordx4 v[36:39], v2, s[20:23], s45 offen offset:1024 sc1
    s_waitcnt vmcnt(3) lgkmcnt(0)
    v_mfma_f32_16x16x32_bf16 v[60:63], v[56:59], v[120:123], 0
    v_cmp_eq_u32 s[38:39], v120, v14
    s_waitcnt vmcnt(2)
    v_mfma_f32_16x16x32_bf16 v[60:63], v[56:59], v[124:127], v[60:63]
    v_cmp_eq_u32 vcc, v124, v15
    v_mov_b32 v29, -1
    s_or_b64 vcc, vcc, s[38:39]
    s_cbranch_vccnz CP1_25
    s_nop 2
    s_nop 0
    v_add_f32_dpp v60, v60, v60 row_ror:8 row_mask:0xf bank_mask:0xf
    v_add_f32_dpp v61, v61, v61 row_ror:8 row_mask:0xf bank_mask:0xf
    s_nop 0
    v_add_f32_dpp v60, v60, v60 row_ror:4 row_mask:0xf bank_mask:0xf
    v_add_f32_dpp v61, v61, v61 row_ror:4 row_mask:0xf bank_mask:0xf
    v_cvt_pk_bf16_f32 v0, v60, v61
    v_min_u32 v0, s59, v0
    buffer_store_dword v0, v11, s[20:23], s46 offen
    v_mov_b32 v14, v120
    v_mov_b32 v15, v124
CJN_27:
    s_mov_b32 s40, 0
    buffer_store_dword v29, v11, s[20:23], s48 offen
    ds_read_b128 v[56:59], v4 offset:4096
    ds_read_b128 v[60:63], v4 offset:5120
    s_waitcnt vmcnt(2)
    s_cmp_ge_u32 s43, 128
    s_cbranch_scc1 CKVS_30
    v_bfe_u32 v28, v2, 5, 2
    v_lshl_add_u32 v30, v30, 2, v28
    s_nop 1
    v_min_u32_dpp v30, v30, v30 row_ror:8 row_mask:0xf bank_mask:0xf
    s_nop 1
    v_min_u32_dpp v30, v30, v30 row_ror:4 row_mask:0xf bank_mask:0xf
    s_nop 1
    v_min_u32_dpp v30, v30, v30 row_ror:2 row_mask:0xf bank_mask:0xf
    s_nop 1
    v_min_u32_dpp v30, v30, v30 row_ror:1 row_mask:0xf bank_mask:0xf
    s_nop 0
    v_readfirstlane_b32 s38, v30
    s_nop 0
    s_lshl_b32 s38, s38, 1
    s_max_u32 s43, s43, s38
    s_cmp_ge_u32 s43, 64
    s_cselect_b32 s43, 128, s43
    s_cselect_b32 s53, 0x40000000, s53
    s_add_u32 s37, s34, 1
    s_cmp_lt_u32 s37, s43
    s_cbranch_scc1 CKVOK_29
    s_mov_b32 s40, 0
CKV_28:
    v_bfe_u32 v28, v2, 4, 4
    v_mul_u32_u24 v28, 1092, v28
    v_and_b32 v28, 0x2184, v28
    buffer_load_dword v30, v28, s[20:23], s53 offen sc1
    s_add_u32 s40, s40, 1
    s_cmp_gt_u32 s40, 0x40000
    s_cbranch_scc1 CABORT_7
    s_waitcnt vmcnt(0)
    v_bfe_u32 v28, v2, 5, 2
    v_lshl_add_u32 v30, v30, 2, v28
    s_nop 1
    v_min_u32_dpp v30, v30, v30 row_ror:8 row_mask:0xf bank_mask:0xf
    s_nop 1
    v_min_u32_dpp v30, v30, v30 row_ror:4 row_mask:0xf bank_mask:0xf
    s_nop 1
    v_min_u32_dpp v30, v30, v30 row_ror:2 row_mask:0xf bank_mask:0xf
    s_nop 1
    v_min_u32_dpp v30, v30, v30 row_ror:1 row_mask:0xf bank_mask:0xf
    s_nop 0
    v_readfirstlane_b32 s38, v30
    s_nop 0
    s_lshl_b32 s38, s38, 1
    s_max_u32 s43, s43, s38
    s_cmp_ge_u32 s43, 64
    s_cselect_b32 s43, 128, s43
    s_cselect_b32 s53, 0x40000000, s53
    s_cmp_lt_u32 s37, s43
    s_cbranch_scc0 CKV_28
    s_mov_b32 s40, 0
    s_branch CKVOK_29
CKVS_30:
    s_nop 15
    s_nop 11
CKVOK_29:
    s_add_u32 s37, s34, 5
    s_cmp_ge_u32 s37, s43
    s_cselect_b32 s87, s53, 0x40000000
    s_branch CTOP_13
CREDO_15:
CRD_31:
    buffer_load_dwordx4 v[32:35], v2, s[20:23], s50 offen offset:0 sc1
    buffer_load_dwordx4 v[36:39], v2, s[20:23], s50 offen offset:1024 sc1
    s_waitcnt vmcnt(2)
    v_max3_u32 v29, v120, v121, v122
    v_max3_u32 v29, v29, v123, v124
    v_max3_u32 v29, v29, v125, v126
    v_max_u32 v29, v29, v127
    v_cmp_eq_u32 vcc, -1, v29
    v_mov_b64 v[64:65], 0
    v_mov_b64 v[66:67], 0
    v_mov_b64 v[68:69], 0
    v_mov_b64 v[70:71], 0
    s_cbranch_vccz CGB_32
    buffer_load_dwordx4 v[120:123], v2, s[20:23], s50 offen offset:0 sc1
    buffer_load_dwordx4 v[124:127], v2, s[20:23], s50 offen offset:1024 sc1
    s_waitcnt vmcnt(2)
    v_max3_u32 v29, v32, v33, v34
    v_max3_u32 v29, v29, v35, v36
    v_max3_u32 v29, v29, v37, v38
    v_max_u32 v29, v29, v39
    v_cmp_eq_u32 vcc, -1, v29
    s_add_u32 s40, s40, 1
    s_cmp_gt_u32 s40, 0x40000
    s_cbranch_scc1 CABORT_7
    s_cbranch_vccnz CRD_31
CGOT_14:
    s_waitcnt lgkmcnt(0)
    v_smfmac_f32_16x16x64_bf16 v[64:67], v[32:35], a[0:7], v1
    ds_write_b128 v3, v[32:35] offset:16384
    v_smfmac_f32_16x16x64_bf16 v[68:71], v[32:35], v[40:47], v1
    ds_write_b128 v3, v[36:39] offset:17408
    v_smfmac_f32_16x16x64_bf16 v[64:67], v[36:39], a[16:23], v1
    v_smfmac_f32_16x16x64_bf16 v[68:71], v[36:39], v[48:55], v1
    v_xor_b32 v0, 0x800, v3
    v_smfmac_f32_16x16x64_bf16 v[80:83], v[32:35], v[128:135], v1
    s_mov_b32 m0, s61
    s_cmp_eq_u32 s34, 63
    v_xor_b32 v28, 0x1000, v3
    v_smfmac_f32_16x16x64_bf16 v[84:87], v[32:35], v[56:63], v1
    s_waitcnt lgkmcnt(0)
    s_barrier
    v_smfmac_f32_16x16x64_bf16 v[80:83], v[36:39], v[144:151], v1
    ds_read_b128 v[40:43], v0 offset:16384
    v_xor_b32 v30, 0x1800, v3
    v_smfmac_f32_16x16x64_bf16 v[84:87], v[36:39], v[152:159], v1
    ds_read_b128 v[44:47], v0 offset:17408
    v_smfmac_f32_16x16x64_bf16 v[72:75], v[32:35], a[128:135], v1
    ds_read_b128 v[48:51], v28 offset:16384
    v_smfmac_f32_16x16x64_bf16 v[76:79], v[32:35], a[136:143], v1
    ds_read_b128 v[52:55], v28 offset:17408
    v_smfmac_f32_16x16x64_bf16 v[72:75], v[36:39], a[144:151], v1
    ds_read_b128 v[56:59], v30 offset:16384
    v_smfmac_f32_16x16x64_bf16 v[76:79], v[36:39], a[152:159], v1
    ds_read_b128 v[60:63], v30 offset:17408
    s_waitcnt lgkmcnt(5)
    s_branch COWN_16
CGB_32:
    ds_write_b128 v3, v[120:123] offset:16384
    ds_write_b128 v3, v[124:127] offset:17408
    v_smfmac_f32_16x16x64_bf16 v[64:67], v[120:123], a[0:7], v1
    v_smfmac_f32_16x16x64_bf16 v[68:71], v[120:123], v[40:47], v1
    v_smfmac_f32_16x16x64_bf16 v[64:67], v[124:127], a[16:23], v1
    v_smfmac_f32_16x16x64_bf16 v[68:71], v[124:127], v[48:55], v1
    v_xor_b32 v0, 0x800, v3
    v_smfmac_f32_16x16x64_bf16 v[80:83], v[120:123], v[128:135], v1
    s_mov_b32 m0, s61
    s_cmp_eq_u32 s34, 63
    v_xor_b32 v28, 0x1000, v3
    v_smfmac_f32_16x16x64_bf16 v[84:87], v[120:123], v[56:63], v1
    s_waitcnt lgkmcnt(0)
    s_barrier
    v_smfmac_f32_16x16x64_bf16 v[80:83], v[124:127], v[144:151], v1
    ds_read_b128 v[40:43], v0 offset:16384
    v_xor_b32 v30, 0x1800, v3
    v_smfmac_f32_16x16x64_bf16 v[84:87], v[124:127], v[152:159], v1
    ds_read_b128 v[44:47], v0 offset:17408
    v_smfmac_f32_16x16x64_bf16 v[72:75], v[120:123], a[128:135], v1
    ds_read_b128 v[48:51], v28 offset:16384
    v_smfmac_f32_16x16x64_bf16 v[76:79], v[120:123], a[136:143], v1
    ds_read_b128 v[52:55], v28 offset:17408
    v_smfmac_f32_16x16x64_bf16 v[72:75], v[124:127], a[144:151], v1
    ds_read_b128 v[56:59], v30 offset:16384
    v_smfmac_f32_16x16x64_bf16 v[76:79], v[124:127], a[152:159], v1
    ds_read_b128 v[60:63], v30 offset:17408
    s_waitcnt lgkmcnt(5)
    s_branch COWN_16
CFB_22:
    s_lshl_b32 s37, s34, 18
    s_lshl_b32 s38, s32, 13
    s_add_u32 s37, s37, s38
    s_add_u32 s38, s37, 0x10e0000
    s_add_u32 s37, s37, 0xe0000
    s_waitcnt lgkmcnt(0)
    buffer_load_dwordx4 v[88:91], v2, s[20:23], s37 offen offset:0 sc1
    buffer_load_dwordx4 v[92:95], v2, s[20:23], s37 offen offset:1024 sc1
    buffer_load_dwordx4 v[96:99], v2, s[20:23], s37 offen offset:2048 sc1
    buffer_load_dwordx4 v[100:103], v2, s[20:23], s37 offen offset:3072 sc1
    s_add_u32 s37, s37, 4096
    buffer_load_dwordx4 v[104:107], v2, s[20:23], s37 offen offset:0 sc1
    buffer_load_dwordx4 v[108:111], v2, s[20:23], s37 offen offset:1024 sc1
    buffer_load_dwordx4 v[112:115], v2, s[20:23], s37 offen offset:2048 sc1
    buffer_load_dwordx4 v[116:119], v2, s[20:23], s37 offen offset:3072 sc1
    s_lshl_b32 s39, s33, 11
    s_add_u32 s38, s38, s39
    buffer_load_dwordx4 v[120:123], v2, s[20:23], s38 offen offset:0 sc1
    buffer_load_dwordx4 v[124:127], v2, s[20:23], s38 offen offset:1024 sc1
    ds_read_b128 v[48:51], v8 offset:0
    ds_read_b128 v[52:55], v8 offset:64
    ds_read_b128 v[56:59], v8 offset:128
    ds_read_b128 v[60:63], v8 offset:192
    s_waitcnt vmcnt(0) lgkmcnt(0)
    v_mfma_f32_16x16x32_bf16 v[64:67], v[88:91], v[48:51], 0
    v_mfma_f32_16x16x32_bf16 v[68:71], v[104:107], v[48:51], 0
    v_mfma_f32_16x16x32_bf16 v[64:67], v[92:95], v[52:55], v[64:67]
    v_mfma_f32_16x16x32_bf16 v[68:71], v[108:111], v[52:55], v[68:71]
    v_mfma_f32_16x16x32_bf16 v[64:67], v[96:99], v[56:59], v[64:67]
    v_mfma_f32_16x16x32_bf16 v[68:71], v[112:115], v[56:59], v[68:71]
    v_mfma_f32_16x16x32_bf16 v[64:67], v[100:103], v[60:63], v[64:67]
    v_mfma_f32_16x16x32_bf16 v[68:71], v[116:119], v[60:63], v[68:71]
    ds_read_b128 v[88:91], v8 offset:2304
    ds_read_b128 v[92:95], v8 offset:2368
    ds_read_b128 v[96:99], v8 offset:2432
    ds_read_b128 v[100:103], v8 offset:2496
    s_waitcnt lgkmcnt(0)
    v_mfma_f32_16x16x32_bf16 v[72:75], v[88:91], v[48:51], 0
    v_mfma_f32_16x16x32_bf16 v[72:75], v[92:95], v[52:55], v[72:75]
    v_mfma_f32_16x16x32_bf16 v[72:75], v[96:99], v[56:59], v[72:75]
    v_mfma_f32_16x16x32_bf16 v[72:75], v[100:103], v[60:63], v[72:75]
    s_nop 7
    v_mul_f32 v72, s58, v72
    v_mul_f32 v73, s58, v73
    v_max3_f32 v28, v64, v65, v66
    v_max3_f32 v28, v28, v67, v68
    v_max3_f32 v28, v28, v69, v70
    v_max3_f32 v28, v28, v71, v72
    v_max_f32 v28, v28, v73
    v_mov_b32 v29, v28
    s_nop 1
    v_permlane32_swap_b32 v28, v29
    v_max_f32 v28, v28, v29
    v_mov_b32 v29, v28
    s_nop 1
    v_permlane16_swap_b32 v28, v29
    v_max_f32 v28, v28, v29
    v_sub_f32 v64, v64, v28
    v_exp_f32 v64, v64
    v_sub_f32 v65, v65, v28
    v_exp_f32 v65, v65
    v_sub_f32 v66, v66, v28
    v_exp_f32 v66, v66
    v_sub_f32 v67, v67, v28
    v_exp_f32 v67, v67
    v_sub_f32 v68, v68, v28
    v_exp_f32 v68, v68
    v_sub_f32 v69, v69, v28
    v_exp_f32 v69, v69
    v_sub_f32 v70, v70, v28
    v_exp_f32 v70, v70
    v_sub_f32 v71, v71, v28
    v_exp_f32 v71, v71
    v_sub_f32 v72, v72, v28
    v_exp_f32 v72, v72
    v_sub_f32 v73, v73, v28
    v_exp_f32 v73, v73
    v_cvt_pk_bf16_f32 v64, v64, v65
    v_cvt_pk_bf16_f32 v65, v66, v67
    v_cvt_pk_bf16_f32 v66, v68, v69
    v_cvt_pk_bf16_f32 v67, v70, v71
    v_cvt_pk_bf16_f32 v24, v72, v73
    v_cvt_pk_bf16_f32 v27, v72, v73
    v_mfma_f32_16x16x32_bf16 v[120:123], v[120:123], v[64:67], 0
    v_mfma_f32_16x16x32_bf16 v[124:127], v[124:127], v[64:67], 0
    v_mfma_f32_16x16x32_bf16 v[76:79], v[16:19], v[64:67], 0
    s_nop 5
    v_mfma_f32_16x16x16_bf16 v[76:79], v[16:17], v[24:25], v[76:79]
    v_mfma_f32_16x16x16_bf16 v[120:123], v[20:21], v[24:25], v[120:123]
    v_mfma_f32_16x16x16_bf16 v[124:127], v[20:21], v[26:27], v[124:127]
    ds_read_b128 v[104:107], v4 offset:16384
    ds_read_b128 v[108:111], v4 offset:17408
    s_nop 7
    v_rcp_f32 v28, v76
    v_mov_b64 v[88:89], 0
    v_mul_f32 v120, v120, v28
    v_mul_f32 v122, v122, v28
    v_mul_f32 v121, v121, v28
    v_mul_f32 v123, v123, v28
    v_max_f32 v29, v28, v76
    v_mul_f32 v124, v124, v28
    v_mul_f32 v126, v126, v28
    v_cvt_pk_bf16_f32 v72, v120, v124
    v_cvt_pk_bf16_f32 v74, v122, v126
    v_mul_f32 v125, v125, v28
    v_mul_f32 v127, v127, v28
    v_cndmask_b32 v76, v72, v74, s[66:67]
    v_cvt_pk_bf16_f32 v73, v121, v125
    v_cvt_pk_bf16_f32 v75, v123, v127
    v_cndmask_b32 v77, v73, v75, s[66:67]
    ds_write_b64 v6, v[76:77] offset:4608
    v_mov_b64 v[90:91], 0
    v_mov_b64 v[92:93], 0
    v_mov_b64 v[94:95], 0
    s_waitcnt lgkmcnt(0)
    s_branch CRJ2_24
CFIN_17:
    v_mov_b32 v29, s44
    buffer_store_dword v29, v31, s[20:23], 0 offen sc1
    v_add_u32 v0, 2304, v5
    buffer_store_dwordx4 v[20:23], v2, s[20:23], s54 offen sc1
    s_lshl_b32 s54, s34, 17
    s_add_u32 s54, s54, s56
    s_add_u32 s54, s54, 0x48e0000
    v_smfmac_f32_16x16x64_bf16 v[72:75], v[40:43], a[160:167], v1
    s_waitcnt lgkmcnt(4)
    v_smfmac_f32_16x16x64_bf16 v[76:79], v[40:43], a[168:175], v1
    v_smfmac_f32_16x16x64_bf16 v[72:75], v[44:47], a[176:183], v1
    s_waitcnt lgkmcnt(3)
    v_smfmac_f32_16x16x64_bf16 v[76:79], v[44:47], a[184:191], v1
    v_smfmac_f32_16x16x64_bf16 v[72:75], v[48:51], a[192:199], v1
    s_waitcnt lgkmcnt(2)
    v_smfmac_f32_16x16x64_bf16 v[76:79], v[48:51], a[200:207], v1
    v_smfmac_f32_16x16x64_bf16 v[72:75], v[52:55], a[208:215], v1
    s_waitcnt lgkmcnt(1)
    v_smfmac_f32_16x16x64_bf16 v[76:79], v[52:55], a[216:223], v1
    v_smfmac_f32_16x16x64_bf16 v[72:75], v[56:59], a[224:231], v1
    s_waitcnt lgkmcnt(0)
    v_smfmac_f32_16x16x64_bf16 v[76:79], v[56:59], a[232:239], v1
    v_smfmac_f32_16x16x64_bf16 v[72:75], v[60:63], a[240:247], v1
    v_smfmac_f32_16x16x64_bf16 v[76:79], v[60:63], a[248:255], v1
    v_smfmac_f32_16x16x64_bf16 v[80:83], v[40:43], v[160:167], v1
    v_add_f32 v72, v72, v74
    v_smfmac_f32_16x16x64_bf16 v[80:83], v[44:47], v[176:183], v1
    v_add_f32 v73, v73, v75
    v_add_f32 v76, v76, v78
    v_smfmac_f32_16x16x64_bf16 v[80:83], v[48:51], v[192:199], v1
    v_add_f32 v77, v77, v79
    v_cvt_pk_bf16_f32 v74, v72, v76
    v_smfmac_f32_16x16x64_bf16 v[80:83], v[52:55], v[208:215], v1
    v_cvt_pk_bf16_f32 v75, v73, v77
    v_smfmac_f32_16x16x64_bf16 v[80:83], v[56:59], v[224:231], v1
    ds_write2_b32 v0, v74, v75 offset0:0 offset1:72
    v_smfmac_f32_16x16x64_bf16 v[80:83], v[60:63], v[240:247], v1
    ds_read_b64 v[22:23], v6 offset:2304
    v_smfmac_f32_16x16x64_bf16 v[84:87], v[40:43], v[168:175], v1
    v_smfmac_f32_16x16x64_bf16 v[84:87], v[44:47], v[184:191], v1
    v_add_f32 v80, v80, v82
    v_smfmac_f32_16x16x64_bf16 v[84:87], v[48:51], v[200:207], v1
    v_smfmac_f32_16x16x64_bf16 v[84:87], v[52:55], v[216:223], v1
    v_add_f32 v81, v81, v83
    v_smfmac_f32_16x16x64_bf16 v[84:87], v[56:59], v[232:239], v1
    v_cvt_pk_bf16_f32 v20, v80, v81
    v_smfmac_f32_16x16x64_bf16 v[84:87], v[60:63], v[248:255], v1
    s_waitcnt lgkmcnt(0)
    s_nop 6
    v_add_f32 v84, v84, v86
    v_add_f32 v85, v85, v87
    v_cvt_pk_bf16_f32 v21, v84, v85
    buffer_store_dwordx4 v[20:23], v2, s[20:23], s54 offen sc1
    v_mov_b32 v29, 63
    s_waitcnt vmcnt(1)
    buffer_store_dword v29, v31, s[20:23], 0 offen sc1
    s_nop 0
    s_waitcnt vmcnt(1)
    v_mov_b32 v29, 64
    buffer_store_dword v29, v31, s[20:23], 0 offen sc1
CABORT_7:
    s_branch KEND
KEND:
    s_endpgm
CHAINS:
    s_load_dwordx2 s[4:5], s[0:1], 16
    s_load_dwordx2 s[8:9], s[0:1], 24
    s_load_dwordx2 s[12:13], s[0:1], 32
    s_load_dwordx2 s[16:17], s[0:1], 40
    s_load_dwordx2 s[20:21], s[0:1], 120
    s_load_dwordx2 s[24:25], s[0:1], 8
    s_load_dwordx2 s[28:29], s[0:1], 112
    s_xor_b32 s32, s65, 0
    v_lshrrev_b32 v121, 6, v0
    v_and_b32 v112, 63, v0
    v_readfirstlane_b32 s33, v121
    v_and_b32 v113, 15, v112
    v_lshrrev_b32 v114, 4, v112
    s_mov_b32 s35, 0x5040100
    s_mov_b32 s36, 0x7060302
    s_waitcnt lgkmcnt(0)
    s_and_b32 s5, s5, 0xffff
    s_mov_b32 s6, 0x400000
    s_mov_b32 s7, 0x20000
    s_and_b32 s9, s9, 0xffff
    s_mov_b32 s10, 0x400000
    s_mov_b32 s11, 0x20000
    s_and_b32 s13, s13, 0xffff
    s_mov_b32 s14, 0x400000
    s_mov_b32 s15, 0x20000
    s_and_b32 s17, s17, 0xffff
    s_mov_b32 s18, 0x400000
    s_mov_b32 s19, 0x20000
    s_and_b32 s21, s21, 0xffff
    s_mov_b32 s22, 0x10000000
    s_mov_b32 s23, 0x20000
    s_and_b32 s25, s25, 0xffff
    s_mov_b32 s26, 0x2000
    s_mov_b32 s27, 0x20000
    s_and_b32 s29, s29, 0xffff
    s_mov_b32 s30, 0x100
    s_mov_b32 s31, 0x20000
    v_lshrrev_b32 v115, 1, v114
    v_and_b32 v116, 1, v114
    v_lshlrev_b32 v117, 2, v116
    v_lshl_add_u32 v117, v115, 4, v117
    s_lshl_b32 s37, s32, 8
    s_lshl_b32 s38, s33, 6
    s_add_u32 s37, s37, s38
    v_lshl_add_u32 v121, v113, 2, s37
    v_lshl_add_u32 v118, v117, 13, v121
    v_add_u32 v119, 8192, v118
    s_lshl_b32 s37, s32, 17
    s_lshl_b32 s38, s33, 8
    s_add_u32 s37, s37, s38
    v_lshl_add_u32 v121, v113, 2, s37
    v_lshlrev_b32 v122, 2, v114
    v_lshl_add_u32 v120, v122, 10, v121
    s_lshl_b32 s37, s33, 15
    s_xor_b32 s37, s37, 0x0
    buffer_load_dword v32, v120, s[16:19], s37 offen offset:0
    buffer_load_dword v33, v120, s[16:19], s37 offen offset:1024
    s_lshl_b32 s37, s33, 15
    s_xor_b32 s37, s37, 0x800
    buffer_load_dword v34, v120, s[16:19], s37 offen offset:0
    buffer_load_dword v35, v120, s[16:19], s37 offen offset:1024
    s_waitcnt vmcnt(50)
    s_lshl_b32 s37, s33, 15
    s_xor_b32 s37, s37, 0x4000
    buffer_load_dword v36, v120, s[16:19], s37 offen offset:0
    buffer_load_dword v37, v120, s[16:19], s37 offen offset:1024
    s_lshl_b32 s37, s33, 15
    s_xor_b32 s37, s37, 0x4800
    buffer_load_dword v38, v120, s[16:19], s37 offen offset:0
    buffer_load_dword v39, v120, s[16:19], s37 offen offset:1024
    s_lshl_b32 s37, s33, 15
    s_xor_b32 s37, s37, 0x8000
    buffer_load_dword v40, v120, s[16:19], s37 offen offset:0
    buffer_load_dword v41, v120, s[16:19], s37 offen offset:1024
    s_lshl_b32 s37, s33, 15
    s_xor_b32 s37, s37, 0x8800
    buffer_load_dword v42, v120, s[16:19], s37 offen offset:0
    buffer_load_dword v43, v120, s[16:19], s37 offen offset:1024
    s_lshl_b32 s37, s33, 15
    s_xor_b32 s37, s37, 0xc000
    buffer_load_dword v44, v120, s[16:19], s37 offen offset:0
    buffer_load_dword v45, v120, s[16:19], s37 offen offset:1024
    s_lshl_b32 s37, s33, 15
    s_xor_b32 s37, s37, 0xc800
    buffer_load_dword v46, v120, s[16:19], s37 offen offset:0
    buffer_load_dword v47, v120, s[16:19], s37 offen offset:1024
    s_lshl_b32 s37, s33, 15
    s_xor_b32 s37, s37, 0x10000
    buffer_load_dword v48, v120, s[16:19], s37 offen offset:0
    buffer_load_dword v49, v120, s[16:19], s37 offen offset:1024
    s_lshl_b32 s37, s33, 15
    s_xor_b32 s37, s37, 0x10800
    buffer_load_dword v50, v120, s[16:19], s37 offen offset:0
    buffer_load_dword v51, v120, s[16:19], s37 offen offset:1024
    s_waitcnt vmcnt(50)
    s_lshl_b32 s37, s33, 15
    s_xor_b32 s37, s37, 0x14000
    buffer_load_dword v52, v120, s[16:19], s37 offen offset:0
    buffer_load_dword v53, v120, s[16:19], s37 offen offset:1024
    s_lshl_b32 s37, s33, 15
    s_xor_b32 s37, s37, 0x14800
    buffer_load_dword v54, v120, s[16:19], s37 offen offset:0
    buffer_load_dword v55, v120, s[16:19], s37 offen offset:1024
    s_lshl_b32 s37, s33, 15
    s_xor_b32 s37, s37, 0x18000
    buffer_load_dword v56, v120, s[16:19], s37 offen offset:0
    buffer_load_dword v57, v120, s[16:19], s37 offen offset:1024
    s_lshl_b32 s37, s33, 15
    s_xor_b32 s37, s37, 0x18800
    buffer_load_dword v58, v120, s[16:19], s37 offen offset:0
    buffer_load_dword v59, v120, s[16:19], s37 offen offset:1024
    s_lshl_b32 s37, s33, 15
    s_xor_b32 s37, s37, 0x1c000
    buffer_load_dword v60, v120, s[16:19], s37 offen offset:0
    buffer_load_dword v61, v120, s[16:19], s37 offen offset:1024
    s_lshl_b32 s37, s33, 15
    s_xor_b32 s37, s37, 0x1c800
    buffer_load_dword v62, v120, s[16:19], s37 offen offset:0
    buffer_load_dword v63, v120, s[16:19], s37 offen offset:1024
    s_lshl_b32 s37, s33, 15
    s_xor_b32 s37, s37, 0x0
    buffer_load_dword v64, v120, s[16:19], s37 offen offset:64
    buffer_load_dword v65, v120, s[16:19], s37 offen offset:1088
    s_lshl_b32 s37, s33, 15
    s_xor_b32 s37, s37, 0x800
    buffer_load_dword v66, v120, s[16:19], s37 offen offset:64
    buffer_load_dword v67, v120, s[16:19], s37 offen offset:1088
    s_waitcnt vmcnt(50)
    s_lshl_b32 s37, s33, 15
    s_xor_b32 s37, s37, 0x4000
    buffer_load_dword v68, v120, s[16:19], s37 offen offset:64
    buffer_load_dword v69, v120, s[16:19], s37 offen offset:1088
    s_lshl_b32 s37, s33, 15
    s_xor_b32 s37, s37, 0x4800
    buffer_load_dword v70, v120, s[16:19], s37 offen offset:64
    buffer_load_dword v71, v120, s[16:19], s37 offen offset:1088
    s_lshl_b32 s37, s33, 15
    s_xor_b32 s37, s37, 0x8000
    buffer_load_dword v72, v120, s[16:19], s37 offen offset:64
    buffer_load_dword v73, v120, s[16:19], s37 offen offset:1088
    s_lshl_b32 s37, s33, 15
    s_xor_b32 s37, s37, 0x8800
    buffer_load_dword v74, v120, s[16:19], s37 offen offset:64
    buffer_load_dword v75, v120, s[16:19], s37 offen offset:1088
    s_lshl_b32 s37, s33, 15
    s_xor_b32 s37, s37, 0xc000
    buffer_load_dword v76, v120, s[16:19], s37 offen offset:64
    buffer_load_dword v77, v120, s[16:19], s37 offen offset:1088
    s_lshl_b32 s37, s33, 15
    s_xor_b32 s37, s37, 0xc800
    buffer_load_dword v78, v120, s[16:19], s37 offen offset:64
    buffer_load_dword v79, v120, s[16:19], s37 offen offset:1088
    v_and_b32 v121, 2, v113
    v_cmp_eq_u32 vcc, 0, v121
    v_mov_b32 v121, 0xeeee
    v_mov_b32 v122, 0x4444
    v_cndmask_b32 v1, v121, v122, vcc
    v_lshlrev_b32 v124, 4, v112
    v_add_u32 v2, 0x20000, v124
    s_lshl_b32 s37, s33, 11
    s_add_u32 s49, s37, 0x0
    v_add_u32 v3, s37, v2
    s_lshl_b32 s38, s33, 15
    v_add_u32 v4, s38, v124
    s_lshl_b32 s38, s32, 13
    s_add_u32 s57, s38, s37
    s_add_u32 s60, s37, 0x20000
    s_add_u32 s61, s37, 0x22000
    s_lshr_b32 s56, s57, 1
    v_mul_u32_u24 v121, 576, v114
    v_lshl_add_u32 v121, v113, 2, v121
    s_lshl_b32 s62, s33, 6
    s_add_u32 s38, s62, 0x26000
    v_add_u32 v5, s38, v121
    v_lshrrev_b32 v121, 2, v113
    v_and_b32 v122, 1, v113
    v_lshl_add_u32 v121, v121, 1, v122
    v_mul_u32_u24 v121, 288, v121
    v_lshl_add_u32 v121, v114, 4, v121
    v_add_u32 v8, 0x26000, v121
    v_and_b32 v122, 2, v113
    v_lshl_add_u32 v121, v122, 2, v8
    v_add_u32 v6, s62, v121
    s_xor_b32 s38, s62, 64
    v_add_u32 v7, s38, v8
    s_xor_b32 s38, s62, 128
    v_add_u32 v9, s38, v8
    s_xor_b32 s42, s62, 192
    s_mov_b32 s66, 0xcccccccc
    s_mov_b32 s67, 0xcccccccc
    v_lshrrev_b32 v121, 2, v113
    v_lshl_add_u32 v121, v121, 2, v114
    v_lshlrev_b32 v121, 11, v121
    v_and_b32 v122, 3, v113
    v_lshl_add_u32 v121, v122, 4, v121
    s_lshl_b32 s38, s33, 16
    s_lshl_b32 s39, s32, 6
    s_add_u32 s38, s38, s39
    s_add_u32 s38, s38, 0x40000
    v_add_u32 v10, s38, v121
    s_lshr_b32 s72, s32, 3
    s_bfe_u32 s86, s32, 0x10002
    s_and_b32 s73, s32, 3
    s_mov_b32 s74, s33
    s_lshl_b32 s38, s72, 1
    s_add_u32 s38, s38, s86
    s_lshl_b32 s39, s38, 2
    s_add_u32 s39, s39, s73
    s_lshl_b32 s39, s39, 2
    s_add_u32 s39, s39, s74
    s_lshl_b32 s39, s39, 11
    s_add_u32 s45, s39, 0x20000
    s_lshl_b32 s38, s38, 10
    s_and_b32 s39, s73, 2
    s_lshl_b32 s39, s39, 7
    s_add_u32 s38, s38, s39
    s_and_b32 s39, s73, 1
    s_lshl_b32 s39, s39, 5
    s_add_u32 s38, s38, s39
    s_lshl_b32 s39, s74, 6
    s_add_u32 s38, s38, s39
    s_add_u32 s38, s38, 0x20000
    v_lshlrev_b32 v121, 9, v115
    v_lshl_add_u32 v121, v116, 4, v121
    v_lshl_add_u32 v121, v113, 2, v121
    v_add_u32 v121, s38, v121
    v_cmp_gt_u32 vcc, 4, v113
    v_mov_b32 v122, 0x40000000
    s_nop 0
    v_cndmask_b32 v11, v122, v121, vcc
    v_and_b32 v121, 1, v113
    v_lshlrev_b32 v121, 4, v121
    v_mov_b32 v122, 0x3f80
    v_lshlrev_b32 v121, v121, v122
    v_and_b32 v122, 14, v113
    v_cmp_eq_u32 vcc, 0, v122
    s_nop 1
    v_cndmask_b32 v20, 0, v121, vcc
    v_cmp_eq_u32 vcc, 4, v122
    s_nop 1
    v_cndmask_b32 v21, 0, v121, vcc
    v_cmp_eq_u32 vcc, 8, v122
    s_nop 1
    v_cndmask_b32 v22, 0, v121, vcc
    v_cmp_eq_u32 vcc, 12, v122
    s_nop 1
    v_cndmask_b32 v23, 0, v121, vcc
    ds_write_b128 v2, v[20:23] offset:31488
    s_waitcnt lgkmcnt(0)
    s_mov_b32 s58, 0x3e0293ee
    s_mov_b32 s59, 0xfffffffe
    s_mov_b32 s63, 0x5f800000
    v_mov_b32 v16, 0x3f803f80
    v_mov_b32 v17, 0x3f803f80
    v_mov_b32 v18, 0x3f803f80
    v_mov_b32 v19, 0x3f803f80
    v_mov_b32 v20, 0
    v_mov_b32 v21, 0
    v_mov_b32 v22, 0
    v_mov_b32 v23, 0
    v_mov_b32 v24, 0
    v_mov_b32 v25, 0
    v_mov_b32 v26, 0
    v_mov_b32 v27, 0
    v_mov_b32 v12, 0
    v_mov_b32 v13, 0
    v_mov_b32 v14, 0
    v_mov_b32 v15, 0
    s_lshl_b32 s37, s33, 15
    s_xor_b32 s37, s37, 0x10000
    buffer_load_dword v80, v120, s[16:19], s37 offen offset:64
    buffer_load_dword v81, v120, s[16:19], s37 offen offset:1088
    s_lshl_b32 s37, s33, 15
    s_xor_b32 s37, s37, 0x10800
    buffer_load_dword v82, v120, s[16:19], s37 offen offset:64
    buffer_load_dword v83, v120, s[16:19], s37 offen offset:1088
    s_waitcnt vmcnt(50)
    s_lshl_b32 s37, s33, 15
    s_xor_b32 s37, s37, 0x14000
    buffer_load_dword v84, v120, s[16:19], s37 offen offset:64
    buffer_load_dword v85, v120, s[16:19], s37 offen offset:1088
    s_lshl_b32 s37, s33, 15
    s_xor_b32 s37, s37, 0x14800
    buffer_load_dword v86, v120, s[16:19], s37 offen offset:64
    buffer_load_dword v87, v120, s[16:19], s37 offen offset:1088
    s_lshl_b32 s37, s33, 15
    s_xor_b32 s37, s37, 0x18000
    buffer_load_dword v88, v120, s[16:19], s37 offen offset:64
    buffer_load_dword v89, v120, s[16:19], s37 offen offset:1088
    s_lshl_b32 s37, s33, 15
    s_xor_b32 s37, s37, 0x18800
    buffer_load_dword v90, v120, s[16:19], s37 offen offset:64
    buffer_load_dword v91, v120, s[16:19], s37 offen offset:1088
    s_lshl_b32 s37, s33, 15
    s_xor_b32 s37, s37, 0x1c000
    buffer_load_dword v92, v120, s[16:19], s37 offen offset:64
    buffer_load_dword v93, v120, s[16:19], s37 offen offset:1088
    s_lshl_b32 s37, s33, 15
    s_xor_b32 s37, s37, 0x1c800
    buffer_load_dword v94, v120, s[16:19], s37 offen offset:64
    buffer_load_dword v95, v120, s[16:19], s37 offen offset:1088
    s_waitcnt vmcnt(48)
    v_perm_b32 v96, v33, v32, s35
    v_perm_b32 v97, v33, v32, s36
    v_perm_b32 v98, v35, v34, s35
    v_perm_b32 v99, v35, v34, s36
    v_perm_b32 v100, v37, v36, s35
    v_perm_b32 v101, v37, v36, s36
    v_perm_b32 v102, v39, v38, s35
    v_perm_b32 v103, v39, v38, s36
    ds_write_b128 v4, v[96:99] offset:0
    ds_write_b128 v4, v[100:103] offset:1024
    v_perm_b32 v104, v41, v40, s35
    v_perm_b32 v105, v41, v40, s36
    v_perm_b32 v106, v43, v42, s35
    v_perm_b32 v107, v43, v42, s36
    v_perm_b32 v108, v45, v44, s35
    v_perm_b32 v109, v45, v44, s36
    v_perm_b32 v110, v47, v46, s35
    v_perm_b32 v111, v47, v46, s36
    v_accvgpr_write_b32 a24, v104
    v_accvgpr_write_b32 a25, v105
    v_accvgpr_write_b32 a26, v106
    v_accvgpr_write_b32 a27, v107
    v_accvgpr_write_b32 a28, v108
    v_accvgpr_write_b32 a29, v109
    v_accvgpr_write_b32 a30, v110
    v_accvgpr_write_b32 a31, v111
    s_waitcnt lgkmcnt(0)
    s_lshl_b32 s37, s33, 15
    s_xor_b32 s37, s37, 0x0
    buffer_load_dword v32, v120, s[16:19], s37 offen offset:128
    buffer_load_dword v33, v120, s[16:19], s37 offen offset:1152
    s_lshl_b32 s37, s33, 15
    s_xor_b32 s37, s37, 0x800
    buffer_load_dword v34, v120, s[16:19], s37 offen offset:128
    buffer_load_dword v35, v120, s[16:19], s37 offen offset:1152
    s_waitcnt vmcnt(50)
    s_lshl_b32 s37, s33, 15
    s_xor_b32 s37, s37, 0x4000
    buffer_load_dword v36, v120, s[16:19], s37 offen offset:128
    buffer_load_dword v37, v120, s[16:19], s37 offen offset:1152
    s_lshl_b32 s37, s33, 15
    s_xor_b32 s37, s37, 0x4800
    buffer_load_dword v38, v120, s[16:19], s37 offen offset:128
    buffer_load_dword v39, v120, s[16:19], s37 offen offset:1152
    s_lshl_b32 s37, s33, 15
    s_xor_b32 s37, s37, 0x8000
    buffer_load_dword v40, v120, s[16:19], s37 offen offset:128
    buffer_load_dword v41, v120, s[16:19], s37 offen offset:1152
    s_lshl_b32 s37, s33, 15
    s_xor_b32 s37, s37, 0x8800
    buffer_load_dword v42, v120, s[16:19], s37 offen offset:128
    buffer_load_dword v43, v120, s[16:19], s37 offen offset:1152
    s_lshl_b32 s37, s33, 15
    s_xor_b32 s37, s37, 0xc000
    buffer_load_dword v44, v120, s[16:19], s37 offen offset:128
    buffer_load_dword v45, v120, s[16:19], s37 offen offset:1152
    s_lshl_b32 s37, s33, 15
    s_xor_b32 s37, s37, 0xc800
    buffer_load_dword v46, v120, s[16:19], s37 offen offset:128
    buffer_load_dword v47, v120, s[16:19], s37 offen offset:1152
    s_waitcnt vmcnt(48)
    v_perm_b32 v136, v49, v48, s35
    v_perm_b32 v137, v49, v48, s36
    v_perm_b32 v138, v51, v50, s35
    v_perm_b32 v139, v51, v50, s36
    v_perm_b32 v140, v53, v52, s35
    v_perm_b32 v141, v53, v52, s36
    v_perm_b32 v142, v55, v54, s35
    v_perm_b32 v143, v55, v54, s36
    v_perm_b32 v104, v57, v56, s35
    v_perm_b32 v105, v57, v56, s36
    v_perm_b32 v106, v59, v58, s35
    v_perm_b32 v107, v59, v58, s36
    v_perm_b32 v108, v61, v60, s35
    v_perm_b32 v109, v61, v60, s36
    v_perm_b32 v110, v63, v62, s35
    v_perm_b32 v111, v63, v62, s36
    v_accvgpr_write_b32 a96, v104
    v_accvgpr_write_b32 a97, v105
    v_accvgpr_write_b32 a98, v106
    v_accvgpr_write_b32 a99, v107
    v_accvgpr_write_b32 a100, v108
    v_accvgpr_write_b32 a101, v109
    v_accvgpr_write_b32 a102, v110
    v_accvgpr_write_b32 a103, v111
    s_lshl_b32 s37, s33, 15
    s_xor_b32 s37, s37, 0x10000
    buffer_load_dword v48, v120, s[16:19], s37 offen offset:128
    buffer_load_dword v49, v120, s[16:19], s37 offen offset:1152
    s_lshl_b32 s37, s33, 15
    s_xor_b32 s37, s37, 0x10800
    buffer_load_dword v50, v120, s[16:19], s37 offen offset:128
    buffer_load_dword v51, v120, s[16:19], s37 offen offset:1152
    s_waitcnt vmcnt(50)
    s_lshl_b32 s37, s33, 15
    s_xor_b32 s37, s37, 0x14000
    buffer_load_dword v52, v120, s[16:19], s37 offen offset:128
    buffer_load_dword v53, v120, s[16:19], s37 offen offset:1152
    s_lshl_b32 s37, s33, 15
    s_xor_b32 s37, s37, 0x14800
    buffer_load_dword v54, v120, s[16:19], s37 offen offset:128
    buffer_load_dword v55, v120, s[16:19], s37 offen offset:1152
    s_lshl_b32 s37, s33, 15
    s_xor_b32 s37, s37, 0x18000
    buffer_load_dword v56, v120, s[16:19], s37 offen offset:128
    buffer_load_dword v57, v120, s[16:19], s37 offen offset:1152
    s_lshl_b32 s37, s33, 15
    s_xor_b32 s37, s37, 0x18800
    buffer_load_dword v58, v120, s[16:19], s37 offen offset:128
    buffer_load_dword v59, v120, s[16:19], s37 offen offset:1152
    s_lshl_b32 s37, s33, 15
    s_xor_b32 s37, s37, 0x1c000
    buffer_load_dword v60, v120, s[16:19], s37 offen offset:128
    buffer_load_dword v61, v120, s[16:19], s37 offen offset:1152
    s_lshl_b32 s37, s33, 15
    s_xor_b32 s37, s37, 0x1c800
    buffer_load_dword v62, v120, s[16:19], s37 offen offset:128
    buffer_load_dword v63, v120, s[16:19], s37 offen offset:1152
    s_waitcnt vmcnt(48)
    v_perm_b32 v96, v65, v64, s35
    v_perm_b32 v97, v65, v64, s36
    v_perm_b32 v98, v67, v66, s35
    v_perm_b32 v99, v67, v66, s36
    v_perm_b32 v100, v69, v68, s35
    v_perm_b32 v101, v69, v68, s36
    v_perm_b32 v102, v71, v70, s35
    v_perm_b32 v103, v71, v70, s36
    ds_write_b128 v4, v[96:99] offset:8192
    ds_write_b128 v4, v[100:103] offset:9216
    v_perm_b32 v104, v73, v72, s35
    v_perm_b32 v105, v73, v72, s36
    v_perm_b32 v106, v75, v74, s35
    v_perm_b32 v107, v75, v74, s36
    v_perm_b32 v108, v77, v76, s35
    v_perm_b32 v109, v77, v76, s36
    v_perm_b32 v110, v79, v78, s35
    v_perm_b32 v111, v79, v78, s36
    v_accvgpr_write_b32 a104, v104
    v_accvgpr_write_b32 a105, v105
    v_accvgpr_write_b32 a106, v106
    v_accvgpr_write_b32 a107, v107
    v_accvgpr_write_b32 a108, v108
    v_accvgpr_write_b32 a109, v109
    v_accvgpr_write_b32 a110, v110
    v_accvgpr_write_b32 a111, v111
    s_waitcnt lgkmcnt(0)
    s_lshl_b32 s37, s33, 15
    s_xor_b32 s37, s37, 0x0
    buffer_load_dword v64, v120, s[16:19], s37 offen offset:192
    buffer_load_dword v65, v120, s[16:19], s37 offen offset:1216
    s_lshl_b32 s37, s33, 15
    s_xor_b32 s37, s37, 0x800
    buffer_load_dword v66, v120, s[16:19], s37 offen offset:192
    buffer_load_dword v67, v120, s[16:19], s37 offen offset:1216
    s_waitcnt vmcnt(50)
    s_lshl_b32 s37, s33, 15
    s_xor_b32 s37, s37, 0x4000
    buffer_load_dword v68, v120, s[16:19], s37 offen offset:192
    buffer_load_dword v69, v120, s[16:19], s37 offen offset:1216
    s_lshl_b32 s37, s33, 15
    s_xor_b32 s37, s37, 0x4800
    buffer_load_dword v70, v120, s[16:19], s37 offen offset:192
    buffer_load_dword v71, v120, s[16:19], s37 offen offset:1216
    s_lshl_b32 s37, s33, 15
    s_xor_b32 s37, s37, 0x8000
    buffer_load_dword v72, v120, s[16:19], s37 offen offset:192
    buffer_load_dword v73, v120, s[16:19], s37 offen offset:1216
    s_lshl_b32 s37, s33, 15
    s_xor_b32 s37, s37, 0x8800
    buffer_load_dword v74, v120, s[16:19], s37 offen offset:192
    buffer_load_dword v75, v120, s[16:19], s37 offen offset:1216
    s_lshl_b32 s37, s33, 15
    s_xor_b32 s37, s37, 0xc000
    buffer_load_dword v76, v120, s[16:19], s37 offen offset:192
    buffer_load_dword v77, v120, s[16:19], s37 offen offset:1216
    s_lshl_b32 s37, s33, 15
    s_xor_b32 s37, s37, 0xc800
    buffer_load_dword v78, v120, s[16:19], s37 offen offset:192
    buffer_load_dword v79, v120, s[16:19], s37 offen offset:1216
    s_waitcnt vmcnt(48)
    v_perm_b32 v96, v81, v80, s35
    v_perm_b32 v97, v81, v80, s36
    v_perm_b32 v98, v83, v82, s35
    v_perm_b32 v99, v83, v82, s36
    v_perm_b32 v100, v85, v84, s35
    v_perm_b32 v101, v85, v84, s36
    v_perm_b32 v102, v87, v86, s35
    v_perm_b32 v103, v87, v86, s36
    v_accvgpr_write_b32 a112, v96
    v_accvgpr_write_b32 a113, v97
    v_accvgpr_write_b32 a114, v98
    v_accvgpr_write_b32 a115, v99
    v_accvgpr_write_b32 a116, v100
    v_accvgpr_write_b32 a117, v101
    v_accvgpr_write_b32 a118, v102
    v_accvgpr_write_b32 a119, v103
    v_perm_b32 v104, v89, v88, s35
    v_perm_b32 v105, v89, v88, s36
    v_perm_b32 v106, v91, v90, s35
    v_perm_b32 v107, v91, v90, s36
    v_perm_b32 v108, v93, v92, s35
    v_perm_b32 v109, v93, v92, s36
    v_perm_b32 v110, v95, v94, s35
    v_perm_b32 v111, v95, v94, s36
    v_accvgpr_write_b32 a120, v104
    v_accvgpr_write_b32 a121, v105
    v_accvgpr_write_b32 a122, v106
    v_accvgpr_write_b32 a123, v107
    v_accvgpr_write_b32 a124, v108
    v_accvgpr_write_b32 a125, v109
    v_accvgpr_write_b32 a126, v110
    v_accvgpr_write_b32 a127, v111
    s_lshl_b32 s37, s33, 15
    s_xor_b32 s37, s37, 0x10000
    buffer_load_dword v80, v120, s[16:19], s37 offen offset:192
    buffer_load_dword v81, v120, s[16:19], s37 offen offset:1216
    s_lshl_b32 s37, s33, 15
    s_xor_b32 s37, s37, 0x10800
    buffer_load_dword v82, v120, s[16:19], s37 offen offset:192
    buffer_load_dword v83, v120, s[16:19], s37 offen offset:1216
    s_waitcnt vmcnt(50)
    s_lshl_b32 s37, s33, 15
    s_xor_b32 s37, s37, 0x14000
    buffer_load_dword v84, v120, s[16:19], s37 offen offset:192
    buffer_load_dword v85, v120, s[16:19], s37 offen offset:1216
    s_lshl_b32 s37, s33, 15
    s_xor_b32 s37, s37, 0x14800
    buffer_load_dword v86, v120, s[16:19], s37 offen offset:192
    buffer_load_dword v87, v120, s[16:19], s37 offen offset:1216
    s_lshl_b32 s37, s33, 15
    s_xor_b32 s37, s37, 0x18000
    buffer_load_dword v88, v120, s[16:19], s37 offen offset:192
    buffer_load_dword v89, v120, s[16:19], s37 offen offset:1216
    s_lshl_b32 s37, s33, 15
    s_xor_b32 s37, s37, 0x18800
    buffer_load_dword v90, v120, s[16:19], s37 offen offset:192
    buffer_load_dword v91, v120, s[16:19], s37 offen offset:1216
    s_lshl_b32 s37, s33, 15
    s_xor_b32 s37, s37, 0x1c000
    buffer_load_dword v92, v120, s[16:19], s37 offen offset:192
    buffer_load_dword v93, v120, s[16:19], s37 offen offset:1216
    s_lshl_b32 s37, s33, 15
    s_xor_b32 s37, s37, 0x1c800
    buffer_load_dword v94, v120, s[16:19], s37 offen offset:192
    buffer_load_dword v95, v120, s[16:19], s37 offen offset:1216
    s_waitcnt vmcnt(48)
    v_perm_b32 v96, v33, v32, s35
    v_perm_b32 v97, v33, v32, s36
    v_perm_b32 v98, v35, v34, s35
    v_perm_b32 v99, v35, v34, s36
    v_perm_b32 v100, v37, v36, s35
    v_perm_b32 v101, v37, v36, s36
    v_perm_b32 v102, v39, v38, s35
    v_perm_b32 v103, v39, v38, s36
    ds_write_b128 v4, v[96:99] offset:16384
    ds_write_b128 v4, v[100:103] offset:17408
    v_perm_b32 v104, v41, v40, s35
    v_perm_b32 v105, v41, v40, s36
    v_perm_b32 v106, v43, v42, s35
    v_perm_b32 v107, v43, v42, s36
    v_perm_b32 v108, v45, v44, s35
    v_perm_b32 v109, v45, v44, s36
    v_perm_b32 v110, v47, v46, s35
    v_perm_b32 v111, v47, v46, s36
    ds_write_b128 v4, v[104:107] offset:18432
    ds_write_b128 v4, v[108:111] offset:19456
    s_waitcnt lgkmcnt(0)
    s_xor_b32 s38, s33, 0
    s_lshl_b32 s38, s38, 20
    s_add_u32 s37, s38, 0x0
    buffer_load_dword v32, v118, s[8:11], s37 offen
    buffer_load_dword v33, v119, s[8:11], s37 offen
    s_add_u32 s37, s38, 0x10000
    buffer_load_dword v34, v118, s[8:11], s37 offen
    buffer_load_dword v35, v119, s[8:11], s37 offen
    s_waitcnt vmcnt(50)
    s_add_u32 s37, s38, 0x4000
    buffer_load_dword v36, v118, s[8:11], s37 offen
    buffer_load_dword v37, v119, s[8:11], s37 offen
    s_add_u32 s37, s38, 0x14000
    buffer_load_dword v38, v118, s[8:11], s37 offen
    buffer_load_dword v39, v119, s[8:11], s37 offen
    s_add_u32 s37, s38, 0x40000
    buffer_load_dword v40, v118, s[8:11], s37 offen
    buffer_load_dword v41, v119, s[8:11], s37 offen
    s_add_u32 s37, s38, 0x50000
    buffer_load_dword v42, v118, s[8:11], s37 offen
    buffer_load_dword v43, v119, s[8:11], s37 offen
    s_add_u32 s37, s38, 0x44000
    buffer_load_dword v44, v118, s[8:11], s37 offen
    buffer_load_dword v45, v119, s[8:11], s37 offen
    s_add_u32 s37, s38, 0x54000
    buffer_load_dword v46, v118, s[8:11], s37 offen
    buffer_load_dword v47, v119, s[8:11], s37 offen
    s_waitcnt vmcnt(48)
    v_perm_b32 v96, v49, v48, s35
    v_perm_b32 v97, v49, v48, s36
    v_perm_b32 v98, v51, v50, s35
    v_perm_b32 v99, v51, v50, s36
    v_perm_b32 v100, v53, v52, s35
    v_perm_b32 v101, v53, v52, s36
    v_perm_b32 v102, v55, v54, s35
    v_perm_b32 v103, v55, v54, s36
    ds_write_b128 v4, v[96:99] offset:20480
    ds_write_b128 v4, v[100:103] offset:21504
    v_perm_b32 v104, v57, v56, s35
    v_perm_b32 v105, v57, v56, s36
    v_perm_b32 v106, v59, v58, s35
    v_perm_b32 v107, v59, v58, s36
    v_perm_b32 v108, v61, v60, s35
    v_perm_b32 v109, v61, v60, s36
    v_perm_b32 v110, v63, v62, s35
    v_perm_b32 v111, v63, v62, s36
    ds_write_b128 v4, v[104:107] offset:22528
    ds_write_b128 v4, v[108:111] offset:23552
    s_waitcnt lgkmcnt(0)
    s_xor_b32 s38, s33, 0
    s_lshl_b32 s38, s38, 20
    s_add_u32 s37, s38, 0x80000
    buffer_load_dword v48, v118, s[8:11], s37 offen
    buffer_load_dword v49, v119, s[8:11], s37 offen
    s_add_u32 s37, s38, 0x90000
    buffer_load_dword v50, v118, s[8:11], s37 offen
    buffer_load_dword v51, v119, s[8:11], s37 offen
    s_waitcnt vmcnt(50)
    s_add_u32 s37, s38, 0x84000
    buffer_load_dword v52, v118, s[8:11], s37 offen
    buffer_load_dword v53, v119, s[8:11], s37 offen
    s_add_u32 s37, s38, 0x94000
    buffer_load_dword v54, v118, s[8:11], s37 offen
    buffer_load_dword v55, v119, s[8:11], s37 offen
    s_add_u32 s37, s38, 0xc0000
    buffer_load_dword v56, v118, s[8:11], s37 offen
    buffer_load_dword v57, v119, s[8:11], s37 offen
    s_add_u32 s37, s38, 0xd0000
    buffer_load_dword v58, v118, s[8:11], s37 offen
    buffer_load_dword v59, v119, s[8:11], s37 offen
    s_add_u32 s37, s38, 0xc4000
    buffer_load_dword v60, v118, s[8:11], s37 offen
    buffer_load_dword v61, v119, s[8:11], s37 offen
    s_add_u32 s37, s38, 0xd4000
    buffer_load_dword v62, v118, s[8:11], s37 offen
    buffer_load_dword v63, v119, s[8:11], s37 offen
    s_waitcnt vmcnt(48)
    v_perm_b32 v96, v65, v64, s35
    v_perm_b32 v97, v65, v64, s36
    v_perm_b32 v98, v67, v66, s35
    v_perm_b32 v99, v67, v66, s36
    v_perm_b32 v100, v69, v68, s35
    v_perm_b32 v101, v69, v68, s36
    v_perm_b32 v102, v71, v70, s35
    v_perm_b32 v103, v71, v70, s36
    v_accvgpr_write_b32 a8, v96
    v_accvgpr_write_b32 a9, v97
    v_accvgpr_write_b32 a10, v98
    v_accvgpr_write_b32 a11, v99
    v_accvgpr_write_b32 a12, v100
    v_accvgpr_write_b32 a13, v101
    v_accvgpr_write_b32 a14, v102
    v_accvgpr_write_b32 a15, v103
    v_perm_b32 v104, v73, v72, s35
    v_perm_b32 v105, v73, v72, s36
    v_perm_b32 v106, v75, v74, s35
    v_perm_b32 v107, v75, v74, s36
    v_perm_b32 v108, v77, v76, s35
    v_perm_b32 v109, v77, v76, s36
    v_perm_b32 v110, v79, v78, s35
    v_perm_b32 v111, v79, v78, s36
    ds_write_b128 v4, v[104:107] offset:26624
    ds_write_b128 v4, v[108:111] offset:27648
    s_waitcnt lgkmcnt(0)
    s_xor_b32 s38, s33, 1
    s_lshl_b32 s38, s38, 20
    s_add_u32 s37, s38, 0x0
    buffer_load_dword v64, v118, s[8:11], s37 offen
    buffer_load_dword v65, v119, s[8:11], s37 offen
    s_add_u32 s37, s38, 0x10000
    buffer_load_dword v66, v118, s[8:11], s37 offen
    buffer_load_dword v67, v119, s[8:11], s37 offen
    s_waitcnt vmcnt(50)
    s_add_u32 s37, s38, 0x4000
    buffer_load_dword v68, v118, s[8:11], s37 offen
    buffer_load_dword v69, v119, s[8:11], s37 offen
    s_add_u32 s37, s38, 0x14000
    buffer_load_dword v70, v118, s[8:11], s37 offen
    buffer_load_dword v71, v119, s[8:11], s37 offen
    s_add_u32 s37, s38, 0x40000
    buffer_load_dword v72, v118, s[8:11], s37 offen
    buffer_load_dword v73, v119, s[8:11], s37 offen
    s_add_u32 s37, s38, 0x50000
    buffer_load_dword v74, v118, s[8:11], s37 offen
    buffer_load_dword v75, v119, s[8:11], s37 offen
    s_add_u32 s37, s38, 0x44000
    buffer_load_dword v76, v118, s[8:11], s37 offen
    buffer_load_dword v77, v119, s[8:11], s37 offen
    s_add_u32 s37, s38, 0x54000
    buffer_load_dword v78, v118, s[8:11], s37 offen
    buffer_load_dword v79, v119, s[8:11], s37 offen
    s_waitcnt vmcnt(48)
    v_perm_b32 v96, v81, v80, s35
    v_perm_b32 v97, v81, v80, s36
    v_perm_b32 v98, v83, v82, s35
    v_perm_b32 v99, v83, v82, s36
    v_perm_b32 v100, v85, v84, s35
    v_perm_b32 v101, v85, v84, s36
    v_perm_b32 v102, v87, v86, s35
    v_perm_b32 v103, v87, v86, s36
    ds_write_b128 v4, v[96:99] offset:28672
    ds_write_b128 v4, v[100:103] offset:29696
    v_perm_b32 v104, v89, v88, s35
    v_perm_b32 v105, v89, v88, s36
    v_perm_b32 v106, v91, v90, s35
    v_perm_b32 v107, v91, v90, s36
    v_perm_b32 v108, v93, v92, s35
    v_perm_b32 v109, v93, v92, s36
    v_perm_b32 v110, v95, v94, s35
    v_perm_b32 v111, v95, v94, s36
    ds_write_b128 v4, v[104:107] offset:30720
    ds_write_b128 v4, v[108:111] offset:31744
    s_waitcnt lgkmcnt(0)
    s_xor_b32 s38, s33, 1
    s_lshl_b32 s38, s38, 20
    s_add_u32 s37, s38, 0x80000
    buffer_load_dword v80, v118, s[8:11], s37 offen
    buffer_load_dword v81, v119, s[8:11], s37 offen
    s_add_u32 s37, s38, 0x90000
    buffer_load_dword v82, v118, s[8:11], s37 offen
    buffer_load_dword v83, v119, s[8:11], s37 offen
    s_waitcnt vmcnt(50)
    s_add_u32 s37, s38, 0x84000
    buffer_load_dword v84, v118, s[8:11], s37 offen
    buffer_load_dword v85, v119, s[8:11], s37 offen
    s_add_u32 s37, s38, 0x94000
    buffer_load_dword v86, v118, s[8:11], s37 offen
    buffer_load_dword v87, v119, s[8:11], s37 offen
    s_add_u32 s37, s38, 0xc0000
    buffer_load_dword v88, v118, s[8:11], s37 offen
    buffer_load_dword v89, v119, s[8:11], s37 offen
    s_add_u32 s37, s38, 0xd0000
    buffer_load_dword v90, v118, s[8:11], s37 offen
    buffer_load_dword v91, v119, s[8:11], s37 offen
    s_add_u32 s37, s38, 0xc4000
    buffer_load_dword v92, v118, s[8:11], s37 offen
    buffer_load_dword v93, v119, s[8:11], s37 offen
    s_add_u32 s37, s38, 0xd4000
    buffer_load_dword v94, v118, s[8:11], s37 offen
    buffer_load_dword v95, v119, s[8:11], s37 offen
    s_waitcnt vmcnt(48)
    v_mov_b32 v123, -1
    buffer_store_dwordx4 v[20:23], v2, s[20:23], s45 offen offset:0 sc1
    buffer_store_dwordx4 v[20:23], v2, s[20:23], s45 offen offset:1024 sc1
    s_mov_b32 s37, 0
    buffer_store_dword v123, v11, s[20:23], s37 offen sc1
    s_mov_b32 s37, 8192
    buffer_store_dword v123, v11, s[20:23], s37 offen sc1
    s_mov_b32 s37, 16384
    buffer_store_dword v123, v11, s[20:23], s37 offen sc1
    s_mov_b32 s37, 24576
    buffer_store_dword v123, v11, s[20:23], s37 offen sc1
    v_perm_b32 v96, v33, v32, s35
    v_perm_b32 v97, v35, v34, s35
    v_perm_b32 v98, v37, v36, s35
    v_perm_b32 v99, v39, v38, s35
    v_perm_b32 v100, v41, v40, s35
    v_perm_b32 v101, v43, v42, s35
    v_perm_b32 v102, v45, v44, s35
    v_perm_b32 v103, v47, v46, s35
    v_accvgpr_write_b32 a128, v96
    v_accvgpr_write_b32 a129, v97
    v_accvgpr_write_b32 a130, v98
    v_accvgpr_write_b32 a131, v99
    v_accvgpr_write_b32 a132, v100
    v_accvgpr_write_b32 a133, v101
    v_accvgpr_write_b32 a134, v102
    v_accvgpr_write_b32 a135, v103
    v_perm_b32 v104, v33, v32, s36
    v_perm_b32 v105, v35, v34, s36
    v_perm_b32 v106, v37, v36, s36
    v_perm_b32 v107, v39, v38, s36
    v_perm_b32 v108, v41, v40, s36
    v_perm_b32 v109, v43, v42, s36
    v_perm_b32 v110, v45, v44, s36
    v_perm_b32 v111, v47, v46, s36
    v_accvgpr_write_b32 a136, v104
    v_accvgpr_write_b32 a137, v105
    v_accvgpr_write_b32 a138, v106
    v_accvgpr_write_b32 a139, v107
    v_accvgpr_write_b32 a140, v108
    v_accvgpr_write_b32 a141, v109
    v_accvgpr_write_b32 a142, v110
    v_accvgpr_write_b32 a143, v111
    s_xor_b32 s38, s33, 2
    s_lshl_b32 s38, s38, 20
    s_add_u32 s37, s38, 0x0
    buffer_load_dword v32, v118, s[8:11], s37 offen
    buffer_load_dword v33, v119, s[8:11], s37 offen
    s_add_u32 s37, s38, 0x10000
    buffer_load_dword v34, v118, s[8:11], s37 offen
    buffer_load_dword v35, v119, s[8:11], s37 offen
    s_waitcnt vmcnt(50)
    s_add_u32 s37, s38, 0x4000
    buffer_load_dword v36, v118, s[8:11], s37 offen
    buffer_load_dword v37, v119, s[8:11], s37 offen
    s_add_u32 s37, s38, 0x14000
    buffer_load_dword v38, v118, s[8:11], s37 offen
    buffer_load_dword v39, v119, s[8:11], s37 offen
    s_add_u32 s37, s38, 0x40000
    buffer_load_dword v40, v118, s[8:11], s37 offen
    buffer_load_dword v41, v119, s[8:11], s37 offen
    s_add_u32 s37, s38, 0x50000
    buffer_load_dword v42, v118, s[8:11], s37 offen
    buffer_load_dword v43, v119, s[8:11], s37 offen
    s_add_u32 s37, s38, 0x44000
    buffer_load_dword v44, v118, s[8:11], s37 offen
    buffer_load_dword v45, v119, s[8:11], s37 offen
    s_add_u32 s37, s38, 0x54000
    buffer_load_dword v46, v118, s[8:11], s37 offen
    buffer_load_dword v47, v119, s[8:11], s37 offen
    s_waitcnt vmcnt(54)
    v_perm_b32 v96, v49, v48, s35
    v_perm_b32 v97, v51, v50, s35
    v_perm_b32 v98, v53, v52, s35
    v_perm_b32 v99, v55, v54, s35
    v_perm_b32 v100, v57, v56, s35
    v_perm_b32 v101, v59, v58, s35
    v_perm_b32 v102, v61, v60, s35
    v_perm_b32 v103, v63, v62, s35
    v_accvgpr_write_b32 a144, v96
    v_accvgpr_write_b32 a145, v97
    v_accvgpr_write_b32 a146, v98
    v_accvgpr_write_b32 a147, v99
    v_accvgpr_write_b32 a148, v100
    v_accvgpr_write_b32 a149, v101
    v_accvgpr_write_b32 a150, v102
    v_accvgpr_write_b32 a151, v103
    v_perm_b32 v104, v49, v48, s36
    v_perm_b32 v105, v51, v50, s36
    v_perm_b32 v106, v53, v52, s36
    v_perm_b32 v107, v55, v54, s36
    v_perm_b32 v108, v57, v56, s36
    v_perm_b32 v109, v59, v58, s36
    v_perm_b32 v110, v61, v60, s36
    v_perm_b32 v111, v63, v62, s36
    v_accvgpr_write_b32 a152, v104
    v_accvgpr_write_b32 a153, v105
    v_accvgpr_write_b32 a154, v106
    v_accvgpr_write_b32 a155, v107
    v_accvgpr_write_b32 a156, v108
    v_accvgpr_write_b32 a157, v109
    v_accvgpr_write_b32 a158, v110
    v_accvgpr_write_b32 a159, v111
    s_xor_b32 s38, s33, 2
    s_lshl_b32 s38, s38, 20
    s_add_u32 s37, s38, 0x80000
    buffer_load_dword v48, v118, s[8:11], s37 offen
    buffer_load_dword v49, v119, s[8:11], s37 offen
    s_add_u32 s37, s38, 0x90000
    buffer_load_dword v50, v118, s[8:11], s37 offen
    buffer_load_dword v51, v119, s[8:11], s37 offen
    s_waitcnt vmcnt(50)
    s_add_u32 s37, s38, 0x84000
    buffer_load_dword v52, v118, s[8:11], s37 offen
    buffer_load_dword v53, v119, s[8:11], s37 offen
    s_add_u32 s37, s38, 0x94000
    buffer_load_dword v54, v118, s[8:11], s37 offen
    buffer_load_dword v55, v119, s[8:11], s37 offen
    s_add_u32 s37, s38, 0xc0000
    buffer_load_dword v56, v118, s[8:11], s37 offen
    buffer_load_dword v57, v119, s[8:11], s37 offen
    s_add_u32 s37, s38, 0xd0000
    buffer_load_dword v58, v118, s[8:11], s37 offen
    buffer_load_dword v59, v119, s[8:11], s37 offen
    s_add_u32 s37, s38, 0xc4000
    buffer_load_dword v60, v118, s[8:11], s37 offen
    buffer_load_dword v61, v119, s[8:11], s37 offen
    s_add_u32 s37, s38, 0xd4000
    buffer_load_dword v62, v118, s[8:11], s37 offen
    buffer_load_dword v63, v119, s[8:11], s37 offen
    s_waitcnt vmcnt(54)
    v_perm_b32 v96, v65, v64, s35
    v_perm_b32 v97, v67, v66, s35
    v_perm_b32 v98, v69, v68, s35
    v_perm_b32 v99, v71, v70, s35
    v_perm_b32 v100, v73, v72, s35
    v_perm_b32 v101, v75, v74, s35
    v_perm_b32 v102, v77, v76, s35
    v_perm_b32 v103, v79, v78, s35
    v_accvgpr_write_b32 a160, v96
    v_accvgpr_write_b32 a161, v97
    v_accvgpr_write_b32 a162, v98
    v_accvgpr_write_b32 a163, v99
    v_accvgpr_write_b32 a164, v100
    v_accvgpr_write_b32 a165, v101
    v_accvgpr_write_b32 a166, v102
    v_accvgpr_write_b32 a167, v103
    v_perm_b32 v104, v65, v64, s36
    v_perm_b32 v105, v67, v66, s36
    v_perm_b32 v106, v69, v68, s36
    v_perm_b32 v107, v71, v70, s36
    v_perm_b32 v108, v73, v72, s36
    v_perm_b32 v109, v75, v74, s36
    v_perm_b32 v110, v77, v76, s36
    v_perm_b32 v111, v79, v78, s36
    v_accvgpr_write_b32 a168, v104
    v_accvgpr_write_b32 a169, v105
    v_accvgpr_write_b32 a170, v106
    v_accvgpr_write_b32 a171, v107
    v_accvgpr_write_b32 a172, v108
    v_accvgpr_write_b32 a173, v109
    v_accvgpr_write_b32 a174, v110
    v_accvgpr_write_b32 a175, v111
    s_xor_b32 s38, s33, 3
    s_lshl_b32 s38, s38, 20
    s_add_u32 s37, s38, 0x0
    buffer_load_dword v64, v118, s[8:11], s37 offen
    buffer_load_dword v65, v119, s[8:11], s37 offen
    s_add_u32 s37, s38, 0x10000
    buffer_load_dword v66, v118, s[8:11], s37 offen
    buffer_load_dword v67, v119, s[8:11], s37 offen
    s_waitcnt vmcnt(50)
    s_add_u32 s37, s38, 0x4000
    buffer_load_dword v68, v118, s[8:11], s37 offen
    buffer_load_dword v69, v119, s[8:11], s37 offen
    s_add_u32 s37, s38, 0x14000
    buffer_load_dword v70, v118, s[8:11], s37 offen
    buffer_load_dword v71, v119, s[8:11], s37 offen
    s_add_u32 s37, s38, 0x40000
    buffer_load_dword v72, v118, s[8:11], s37 offen
    buffer_load_dword v73, v119, s[8:11], s37 offen
    s_add_u32 s37, s38, 0x50000
    buffer_load_dword v74, v118, s[8:11], s37 offen
    buffer_load_dword v75, v119, s[8:11], s37 offen
    s_add_u32 s37, s38, 0x44000
    buffer_load_dword v76, v118, s[8:11], s37 offen
    buffer_load_dword v77, v119, s[8:11], s37 offen
    s_add_u32 s37, s38, 0x54000
    buffer_load_dword v78, v118, s[8:11], s37 offen
    buffer_load_dword v79, v119, s[8:11], s37 offen
    s_waitcnt vmcnt(54)
    v_perm_b32 v96, v81, v80, s35
    v_perm_b32 v97, v83, v82, s35
    v_perm_b32 v98, v85, v84, s35
    v_perm_b32 v99, v87, v86, s35
    v_perm_b32 v100, v89, v88, s35
    v_perm_b32 v101, v91, v90, s35
    v_perm_b32 v102, v93, v92, s35
    v_perm_b32 v103, v95, v94, s35
    v_accvgpr_write_b32 a176, v96
    v_accvgpr_write_b32 a177, v97
    v_accvgpr_write_b32 a178, v98
    v_accvgpr_write_b32 a179, v99
    v_accvgpr_write_b32 a180, v100
    v_accvgpr_write_b32 a181, v101
    v_accvgpr_write_b32 a182, v102
    v_accvgpr_write_b32 a183, v103
    v_perm_b32 v104, v81, v80, s36
    v_perm_b32 v105, v83, v82, s36
    v_perm_b32 v106, v85, v84, s36
    v_perm_b32 v107, v87, v86, s36
    v_perm_b32 v108, v89, v88, s36
    v_perm_b32 v109, v91, v90, s36
    v_perm_b32 v110, v93, v92, s36
    v_perm_b32 v111, v95, v94, s36
    v_accvgpr_write_b32 a184, v104
    v_accvgpr_write_b32 a185, v105
    v_accvgpr_write_b32 a186, v106
    v_accvgpr_write_b32 a187, v107
    v_accvgpr_write_b32 a188, v108
    v_accvgpr_write_b32 a189, v109
    v_accvgpr_write_b32 a190, v110
    v_accvgpr_write_b32 a191, v111
    s_xor_b32 s38, s33, 3
    s_lshl_b32 s38, s38, 20
    s_add_u32 s37, s38, 0x80000
    buffer_load_dword v80, v118, s[8:11], s37 offen
    buffer_load_dword v81, v119, s[8:11], s37 offen
    s_add_u32 s37, s38, 0x90000
    buffer_load_dword v82, v118, s[8:11], s37 offen
    buffer_load_dword v83, v119, s[8:11], s37 offen
    s_waitcnt vmcnt(50)
    s_add_u32 s37, s38, 0x84000
    buffer_load_dword v84, v118, s[8:11], s37 offen
    buffer_load_dword v85, v119, s[8:11], s37 offen
    s_add_u32 s37, s38, 0x94000
    buffer_load_dword v86, v118, s[8:11], s37 offen
    buffer_load_dword v87, v119, s[8:11], s37 offen
    s_add_u32 s37, s38, 0xc0000
    buffer_load_dword v88, v118, s[8:11], s37 offen
    buffer_load_dword v89, v119, s[8:11], s37 offen
    s_add_u32 s37, s38, 0xd0000
    buffer_load_dword v90, v118, s[8:11], s37 offen
    buffer_load_dword v91, v119, s[8:11], s37 offen
    s_add_u32 s37, s38, 0xc4000
    buffer_load_dword v92, v118, s[8:11], s37 offen
    buffer_load_dword v93, v119, s[8:11], s37 offen
    s_add_u32 s37, s38, 0xd4000
    buffer_load_dword v94, v118, s[8:11], s37 offen
    buffer_load_dword v95, v119, s[8:11], s37 offen
    s_waitcnt vmcnt(48)
    s_barrier
    s_cmp_lg_u32 s33, 0
    s_cbranch_scc1 CARR_33
    v_mov_b32 v121, 1
    v_mov_b32 v122, 0x40000000
    v_cmp_eq_u32 vcc, 0, v112
    v_mov_b32 v123, 32
    s_nop 0
    v_cndmask_b32 v122, v122, v123, vcc
    buffer_atomic_add v121, v122, s[28:31], 0 offen
CARR_33:
    v_perm_b32 v96, v33, v32, s35
    v_perm_b32 v97, v35, v34, s35
    v_perm_b32 v98, v37, v36, s35
    v_perm_b32 v99, v39, v38, s35
    v_perm_b32 v100, v41, v40, s35
    v_perm_b32 v101, v43, v42, s35
    v_perm_b32 v102, v45, v44, s35
    v_perm_b32 v103, v47, v46, s35
    v_accvgpr_write_b32 a192, v96
    v_accvgpr_write_b32 a193, v97
    v_accvgpr_write_b32 a194, v98
    v_accvgpr_write_b32 a195, v99
    v_accvgpr_write_b32 a196, v100
    v_accvgpr_write_b32 a197, v101
    v_accvgpr_write_b32 a198, v102
    v_accvgpr_write_b32 a199, v103
    v_perm_b32 v104, v33, v32, s36
    v_perm_b32 v105, v35, v34, s36
    v_perm_b32 v106, v37, v36, s36
    v_perm_b32 v107, v39, v38, s36
    v_perm_b32 v108, v41, v40, s36
    v_perm_b32 v109, v43, v42, s36
    v_perm_b32 v110, v45, v44, s36
    v_perm_b32 v111, v47, v46, s36
    v_accvgpr_write_b32 a200, v104
    v_accvgpr_write_b32 a201, v105
    v_accvgpr_write_b32 a202, v106
    v_accvgpr_write_b32 a203, v107
    v_accvgpr_write_b32 a204, v108
    v_accvgpr_write_b32 a205, v109
    v_accvgpr_write_b32 a206, v110
    v_accvgpr_write_b32 a207, v111
    s_xor_b32 s38, s33, 0
    s_lshl_b32 s38, s38, 20
    s_add_u32 s37, s38, 0x0
    buffer_load_dword v32, v118, s[12:15], s37 offen
    buffer_load_dword v33, v119, s[12:15], s37 offen
    s_add_u32 s37, s38, 0x10000
    buffer_load_dword v34, v118, s[12:15], s37 offen
    buffer_load_dword v35, v119, s[12:15], s37 offen
    s_waitcnt vmcnt(50)
    s_add_u32 s37, s38, 0x4000
    buffer_load_dword v36, v118, s[12:15], s37 offen
    buffer_load_dword v37, v119, s[12:15], s37 offen
    s_add_u32 s37, s38, 0x14000
    buffer_load_dword v38, v118, s[12:15], s37 offen
    buffer_load_dword v39, v119, s[12:15], s37 offen
    s_add_u32 s37, s38, 0x40000
    buffer_load_dword v40, v118, s[12:15], s37 offen
    buffer_load_dword v41, v119, s[12:15], s37 offen
    s_add_u32 s37, s38, 0x50000
    buffer_load_dword v42, v118, s[12:15], s37 offen
    buffer_load_dword v43, v119, s[12:15], s37 offen
    s_add_u32 s37, s38, 0x44000
    buffer_load_dword v44, v118, s[12:15], s37 offen
    buffer_load_dword v45, v119, s[12:15], s37 offen
    s_add_u32 s37, s38, 0x54000
    buffer_load_dword v46, v118, s[12:15], s37 offen
    buffer_load_dword v47, v119, s[12:15], s37 offen
    s_waitcnt vmcnt(48)
    v_perm_b32 v96, v49, v48, s35
    v_perm_b32 v97, v51, v50, s35
    v_perm_b32 v98, v53, v52, s35
    v_perm_b32 v99, v55, v54, s35
    v_perm_b32 v100, v57, v56, s35
    v_perm_b32 v101, v59, v58, s35
    v_perm_b32 v102, v61, v60, s35
    v_perm_b32 v103, v63, v62, s35
    v_accvgpr_write_b32 a208, v96
    v_accvgpr_write_b32 a209, v97
    v_accvgpr_write_b32 a210, v98
    v_accvgpr_write_b32 a211, v99
    v_accvgpr_write_b32 a212, v100
    v_accvgpr_write_b32 a213, v101
    v_accvgpr_write_b32 a214, v102
    v_accvgpr_write_b32 a215, v103
    v_perm_b32 v104, v49, v48, s36
    v_perm_b32 v105, v51, v50, s36
    v_perm_b32 v106, v53, v52, s36
    v_perm_b32 v107, v55, v54, s36
    v_perm_b32 v108, v57, v56, s36
    v_perm_b32 v109, v59, v58, s36
    v_perm_b32 v110, v61, v60, s36
    v_perm_b32 v111, v63, v62, s36
    v_accvgpr_write_b32 a216, v104
    v_accvgpr_write_b32 a217, v105
    v_accvgpr_write_b32 a218, v106
    v_accvgpr_write_b32 a219, v107
    v_accvgpr_write_b32 a220, v108
    v_accvgpr_write_b32 a221, v109
    v_accvgpr_write_b32 a222, v110
    v_accvgpr_write_b32 a223, v111
    s_xor_b32 s38, s33, 0
    s_lshl_b32 s38, s38, 20
    s_add_u32 s37, s38, 0x80000
    buffer_load_dword v48, v118, s[12:15], s37 offen
    buffer_load_dword v49, v119, s[12:15], s37 offen
    s_add_u32 s37, s38, 0x90000
    buffer_load_dword v50, v118, s[12:15], s37 offen
    buffer_load_dword v51, v119, s[12:15], s37 offen
    s_waitcnt vmcnt(50)
    s_add_u32 s37, s38, 0x84000
    buffer_load_dword v52, v118, s[12:15], s37 offen
    buffer_load_dword v53, v119, s[12:15], s37 offen
    s_add_u32 s37, s38, 0x94000
    buffer_load_dword v54, v118, s[12:15], s37 offen
    buffer_load_dword v55, v119, s[12:15], s37 offen
    s_add_u32 s37, s38, 0xc0000
    buffer_load_dword v56, v118, s[12:15], s37 offen
    buffer_load_dword v57, v119, s[12:15], s37 offen
    s_add_u32 s37, s38, 0xd0000
    buffer_load_dword v58, v118, s[12:15], s37 offen
    buffer_load_dword v59, v119, s[12:15], s37 offen
    s_add_u32 s37, s38, 0xc4000
    buffer_load_dword v60, v118, s[12:15], s37 offen
    buffer_load_dword v61, v119, s[12:15], s37 offen
    s_add_u32 s37, s38, 0xd4000
    buffer_load_dword v62, v118, s[12:15], s37 offen
    buffer_load_dword v63, v119, s[12:15], s37 offen
    s_waitcnt vmcnt(48)
    v_perm_b32 v96, v65, v64, s35
    v_perm_b32 v97, v67, v66, s35
    v_perm_b32 v98, v69, v68, s35
    v_perm_b32 v99, v71, v70, s35
    v_perm_b32 v100, v73, v72, s35
    v_perm_b32 v101, v75, v74, s35
    v_perm_b32 v102, v77, v76, s35
    v_perm_b32 v103, v79, v78, s35
    v_accvgpr_write_b32 a224, v96
    v_accvgpr_write_b32 a225, v97
    v_accvgpr_write_b32 a226, v98
    v_accvgpr_write_b32 a227, v99
    v_accvgpr_write_b32 a228, v100
    v_accvgpr_write_b32 a229, v101
    v_accvgpr_write_b32 a230, v102
    v_accvgpr_write_b32 a231, v103
    v_perm_b32 v104, v65, v64, s36
    v_perm_b32 v105, v67, v66, s36
    v_perm_b32 v106, v69, v68, s36
    v_perm_b32 v107, v71, v70, s36
    v_perm_b32 v108, v73, v72, s36
    v_perm_b32 v109, v75, v74, s36
    v_perm_b32 v110, v77, v76, s36
    v_perm_b32 v111, v79, v78, s36
    v_accvgpr_write_b32 a232, v104
    v_accvgpr_write_b32 a233, v105
    v_accvgpr_write_b32 a234, v106
    v_accvgpr_write_b32 a235, v107
    v_accvgpr_write_b32 a236, v108
    v_accvgpr_write_b32 a237, v109
    v_accvgpr_write_b32 a238, v110
    v_accvgpr_write_b32 a239, v111
    s_xor_b32 s38, s33, 1
    s_lshl_b32 s38, s38, 20
    s_add_u32 s37, s38, 0x0
    buffer_load_dword v64, v118, s[12:15], s37 offen
    buffer_load_dword v65, v119, s[12:15], s37 offen
    s_add_u32 s37, s38, 0x10000
    buffer_load_dword v66, v118, s[12:15], s37 offen
    buffer_load_dword v67, v119, s[12:15], s37 offen
    s_waitcnt vmcnt(50)
    s_add_u32 s37, s38, 0x4000
    buffer_load_dword v68, v118, s[12:15], s37 offen
    buffer_load_dword v69, v119, s[12:15], s37 offen
    s_add_u32 s37, s38, 0x14000
    buffer_load_dword v70, v118, s[12:15], s37 offen
    buffer_load_dword v71, v119, s[12:15], s37 offen
    s_add_u32 s37, s38, 0x40000
    buffer_load_dword v72, v118, s[12:15], s37 offen
    buffer_load_dword v73, v119, s[12:15], s37 offen
    s_add_u32 s37, s38, 0x50000
    buffer_load_dword v74, v118, s[12:15], s37 offen
    buffer_load_dword v75, v119, s[12:15], s37 offen
    s_add_u32 s37, s38, 0x44000
    buffer_load_dword v76, v118, s[12:15], s37 offen
    buffer_load_dword v77, v119, s[12:15], s37 offen
    s_add_u32 s37, s38, 0x54000
    buffer_load_dword v78, v118, s[12:15], s37 offen
    buffer_load_dword v79, v119, s[12:15], s37 offen
    s_waitcnt vmcnt(48)
    v_perm_b32 v96, v81, v80, s35
    v_perm_b32 v97, v83, v82, s35
    v_perm_b32 v98, v85, v84, s35
    v_perm_b32 v99, v87, v86, s35
    v_perm_b32 v100, v89, v88, s35
    v_perm_b32 v101, v91, v90, s35
    v_perm_b32 v102, v93, v92, s35
    v_perm_b32 v103, v95, v94, s35
    v_accvgpr_write_b32 a240, v96
    v_accvgpr_write_b32 a241, v97
    v_accvgpr_write_b32 a242, v98
    v_accvgpr_write_b32 a243, v99
    v_accvgpr_write_b32 a244, v100
    v_accvgpr_write_b32 a245, v101
    v_accvgpr_write_b32 a246, v102
    v_accvgpr_write_b32 a247, v103
    v_perm_b32 v104, v81, v80, s36
    v_perm_b32 v105, v83, v82, s36
    v_perm_b32 v106, v85, v84, s36
    v_perm_b32 v107, v87, v86, s36
    v_perm_b32 v108, v89, v88, s36
    v_perm_b32 v109, v91, v90, s36
    v_perm_b32 v110, v93, v92, s36
    v_perm_b32 v111, v95, v94, s36
    v_accvgpr_write_b32 a248, v104
    v_accvgpr_write_b32 a249, v105
    v_accvgpr_write_b32 a250, v106
    v_accvgpr_write_b32 a251, v107
    v_accvgpr_write_b32 a252, v108
    v_accvgpr_write_b32 a253, v109
    v_accvgpr_write_b32 a254, v110
    v_accvgpr_write_b32 a255, v111
    s_xor_b32 s38, s33, 1
    s_lshl_b32 s38, s38, 20
    s_add_u32 s37, s38, 0x80000
    buffer_load_dword v80, v118, s[12:15], s37 offen
    buffer_load_dword v81, v119, s[12:15], s37 offen
    s_add_u32 s37, s38, 0x90000
    buffer_load_dword v82, v118, s[12:15], s37 offen
    buffer_load_dword v83, v119, s[12:15], s37 offen
    s_waitcnt vmcnt(50)
    s_add_u32 s37, s38, 0x84000
    buffer_load_dword v84, v118, s[12:15], s37 offen
    buffer_load_dword v85, v119, s[12:15], s37 offen
    s_add_u32 s37, s38, 0x94000
    buffer_load_dword v86, v118, s[12:15], s37 offen
    buffer_load_dword v87, v119, s[12:15], s37 offen
    s_add_u32 s37, s38, 0xc0000
    buffer_load_dword v88, v118, s[12:15], s37 offen
    buffer_load_dword v89, v119, s[12:15], s37 offen
    s_add_u32 s37, s38, 0xd0000
    buffer_load_dword v90, v118, s[12:15], s37 offen
    buffer_load_dword v91, v119, s[12:15], s37 offen
    s_add_u32 s37, s38, 0xc4000
    buffer_load_dword v92, v118, s[12:15], s37 offen
    buffer_load_dword v93, v119, s[12:15], s37 offen
    s_add_u32 s37, s38, 0xd4000
    buffer_load_dword v94, v118, s[12:15], s37 offen
    buffer_load_dword v95, v119, s[12:15], s37 offen
    s_waitcnt vmcnt(48)
    v_perm_b32 v128, v33, v32, s35
    v_perm_b32 v129, v35, v34, s35
    v_perm_b32 v130, v37, v36, s35
    v_perm_b32 v131, v39, v38, s35
    v_perm_b32 v132, v41, v40, s35
    v_perm_b32 v133, v43, v42, s35
    v_perm_b32 v134, v45, v44, s35
    v_perm_b32 v135, v47, v46, s35
    v_perm_b32 v104, v33, v32, s36
    v_perm_b32 v105, v35, v34, s36
    v_perm_b32 v106, v37, v36, s36
    v_perm_b32 v107, v39, v38, s36
    v_perm_b32 v108, v41, v40, s36
    v_perm_b32 v109, v43, v42, s36
    v_perm_b32 v110, v45, v44, s36
    v_perm_b32 v111, v47, v46, s36
    ds_write_b128 v4, v[104:107] offset:4096
    ds_write_b128 v4, v[108:111] offset:5120
    s_waitcnt lgkmcnt(0)
    s_xor_b32 s38, s33, 2
    s_lshl_b32 s38, s38, 20
    s_add_u32 s37, s38, 0x0
    buffer_load_dword v32, v118, s[12:15], s37 offen
    buffer_load_dword v33, v119, s[12:15], s37 offen
    s_add_u32 s37, s38, 0x10000
    buffer_load_dword v34, v118, s[12:15], s37 offen
    buffer_load_dword v35, v119, s[12:15], s37 offen
    s_waitcnt vmcnt(50)
    s_add_u32 s37, s38, 0x4000
    buffer_load_dword v36, v118, s[12:15], s37 offen
    buffer_load_dword v37, v119, s[12:15], s37 offen
    s_add_u32 s37, s38, 0x14000
    buffer_load_dword v38, v118, s[12:15], s37 offen
    buffer_load_dword v39, v119, s[12:15], s37 offen
    s_add_u32 s37, s38, 0x40000
    buffer_load_dword v40, v118, s[12:15], s37 offen
    buffer_load_dword v41, v119, s[12:15], s37 offen
    s_add_u32 s37, s38, 0x50000
    buffer_load_dword v42, v118, s[12:15], s37 offen
    buffer_load_dword v43, v119, s[12:15], s37 offen
    s_add_u32 s37, s38, 0x44000
    buffer_load_dword v44, v118, s[12:15], s37 offen
    buffer_load_dword v45, v119, s[12:15], s37 offen
    s_add_u32 s37, s38, 0x54000
    buffer_load_dword v46, v118, s[12:15], s37 offen
    buffer_load_dword v47, v119, s[12:15], s37 offen
    s_waitcnt vmcnt(48)
    v_perm_b32 v144, v49, v48, s35
    v_perm_b32 v145, v51, v50, s35
    v_perm_b32 v146, v53, v52, s35
    v_perm_b32 v147, v55, v54, s35
    v_perm_b32 v148, v57, v56, s35
    v_perm_b32 v149, v59, v58, s35
    v_perm_b32 v150, v61, v60, s35
    v_perm_b32 v151, v63, v62, s35
    v_perm_b32 v152, v49, v48, s36
    v_perm_b32 v153, v51, v50, s36
    v_perm_b32 v154, v53, v52, s36
    v_perm_b32 v155, v55, v54, s36
    v_perm_b32 v156, v57, v56, s36
    v_perm_b32 v157, v59, v58, s36
    v_perm_b32 v158, v61, v60, s36
    v_perm_b32 v159, v63, v62, s36
    s_xor_b32 s38, s33, 2
    s_lshl_b32 s38, s38, 20
    s_add_u32 s37, s38, 0x80000
    buffer_load_dword v48, v118, s[12:15], s37 offen
    buffer_load_dword v49, v119, s[12:15], s37 offen
    s_add_u32 s37, s38, 0x90000
    buffer_load_dword v50, v118, s[12:15], s37 offen
    buffer_load_dword v51, v119, s[12:15], s37 offen
    s_waitcnt vmcnt(50)
    s_add_u32 s37, s38, 0x84000
    buffer_load_dword v52, v118, s[12:15], s37 offen
    buffer_load_dword v53, v119, s[12:15], s37 offen
    s_add_u32 s37, s38, 0x94000
    buffer_load_dword v54, v118, s[12:15], s37 offen
    buffer_load_dword v55, v119, s[12:15], s37 offen
    s_add_u32 s37, s38, 0xc0000
    buffer_load_dword v56, v118, s[12:15], s37 offen
    buffer_load_dword v57, v119, s[12:15], s37 offen
    s_add_u32 s37, s38, 0xd0000
    buffer_load_dword v58, v118, s[12:15], s37 offen
    buffer_load_dword v59, v119, s[12:15], s37 offen
    s_add_u32 s37, s38, 0xc4000
    buffer_load_dword v60, v118, s[12:15], s37 offen
    buffer_load_dword v61, v119, s[12:15], s37 offen
    s_add_u32 s37, s38, 0xd4000
    buffer_load_dword v62, v118, s[12:15], s37 offen
    buffer_load_dword v63, v119, s[12:15], s37 offen
    s_waitcnt vmcnt(48)
    v_perm_b32 v160, v65, v64, s35
    v_perm_b32 v161, v67, v66, s35
    v_perm_b32 v162, v69, v68, s35
    v_perm_b32 v163, v71, v70, s35
    v_perm_b32 v164, v73, v72, s35
    v_perm_b32 v165, v75, v74, s35
    v_perm_b32 v166, v77, v76, s35
    v_perm_b32 v167, v79, v78, s35
    v_perm_b32 v168, v65, v64, s36
    v_perm_b32 v169, v67, v66, s36
    v_perm_b32 v170, v69, v68, s36
    v_perm_b32 v171, v71, v70, s36
    v_perm_b32 v172, v73, v72, s36
    v_perm_b32 v173, v75, v74, s36
    v_perm_b32 v174, v77, v76, s36
    v_perm_b32 v175, v79, v78, s36
    s_xor_b32 s38, s33, 3
    s_lshl_b32 s38, s38, 20
    s_add_u32 s37, s38, 0x0
    buffer_load_dword v64, v118, s[12:15], s37 offen
    buffer_load_dword v65, v119, s[12:15], s37 offen
    s_add_u32 s37, s38, 0x10000
    buffer_load_dword v66, v118, s[12:15], s37 offen
    buffer_load_dword v67, v119, s[12:15], s37 offen
    s_waitcnt vmcnt(50)
    s_add_u32 s37, s38, 0x4000
    buffer_load_dword v68, v118, s[12:15], s37 offen
    buffer_load_dword v69, v119, s[12:15], s37 offen
    s_add_u32 s37, s38, 0x14000
    buffer_load_dword v70, v118, s[12:15], s37 offen
    buffer_load_dword v71, v119, s[12:15], s37 offen
    s_add_u32 s37, s38, 0x40000
    buffer_load_dword v72, v118, s[12:15], s37 offen
    buffer_load_dword v73, v119, s[12:15], s37 offen
    s_add_u32 s37, s38, 0x50000
    buffer_load_dword v74, v118, s[12:15], s37 offen
    buffer_load_dword v75, v119, s[12:15], s37 offen
    s_add_u32 s37, s38, 0x44000
    buffer_load_dword v76, v118, s[12:15], s37 offen
    buffer_load_dword v77, v119, s[12:15], s37 offen
    s_add_u32 s37, s38, 0x54000
    buffer_load_dword v78, v118, s[12:15], s37 offen
    buffer_load_dword v79, v119, s[12:15], s37 offen
    s_waitcnt vmcnt(48)
    v_perm_b32 v176, v81, v80, s35
    v_perm_b32 v177, v83, v82, s35
    v_perm_b32 v178, v85, v84, s35
    v_perm_b32 v179, v87, v86, s35
    v_perm_b32 v180, v89, v88, s35
    v_perm_b32 v181, v91, v90, s35
    v_perm_b32 v182, v93, v92, s35
    v_perm_b32 v183, v95, v94, s35
    v_perm_b32 v184, v81, v80, s36
    v_perm_b32 v185, v83, v82, s36
    v_perm_b32 v186, v85, v84, s36
    v_perm_b32 v187, v87, v86, s36
    v_perm_b32 v188, v89, v88, s36
    v_perm_b32 v189, v91, v90, s36
    v_perm_b32 v190, v93, v92, s36
    v_perm_b32 v191, v95, v94, s36
    s_xor_b32 s38, s33, 3
    s_lshl_b32 s38, s38, 20
    s_add_u32 s37, s38, 0x80000
    buffer_load_dword v80, v118, s[12:15], s37 offen
    buffer_load_dword v81, v119, s[12:15], s37 offen
    s_add_u32 s37, s38, 0x90000
    buffer_load_dword v82, v118, s[12:15], s37 offen
    buffer_load_dword v83, v119, s[12:15], s37 offen
    s_waitcnt vmcnt(50)
    s_add_u32 s37, s38, 0x84000
    buffer_load_dword v84, v118, s[12:15], s37 offen
    buffer_load_dword v85, v119, s[12:15], s37 offen
    s_add_u32 s37, s38, 0x94000
    buffer_load_dword v86, v118, s[12:15], s37 offen
    buffer_load_dword v87, v119, s[12:15], s37 offen
    s_add_u32 s37, s38, 0xc0000
    buffer_load_dword v88, v118, s[12:15], s37 offen
    buffer_load_dword v89, v119, s[12:15], s37 offen
    s_add_u32 s37, s38, 0xd0000
    buffer_load_dword v90, v118, s[12:15], s37 offen
    buffer_load_dword v91, v119, s[12:15], s37 offen
    s_add_u32 s37, s38, 0xc4000
    buffer_load_dword v92, v118, s[12:15], s37 offen
    buffer_load_dword v93, v119, s[12:15], s37 offen
    s_add_u32 s37, s38, 0xd4000
    buffer_load_dword v94, v118, s[12:15], s37 offen
    buffer_load_dword v95, v119, s[12:15], s37 offen
    s_waitcnt vmcnt(48)
    v_perm_b32 v192, v33, v32, s35
    v_perm_b32 v193, v35, v34, s35
    v_perm_b32 v194, v37, v36, s35
    v_perm_b32 v195, v39, v38, s35
    v_perm_b32 v196, v41, v40, s35
    v_perm_b32 v197, v43, v42, s35
    v_perm_b32 v198, v45, v44, s35
    v_perm_b32 v199, v47, v46, s35
    v_perm_b32 v200, v33, v32, s36
    v_perm_b32 v201, v35, v34, s36
    v_perm_b32 v202, v37, v36, s36
    v_perm_b32 v203, v39, v38, s36
    v_perm_b32 v204, v41, v40, s36
    v_perm_b32 v205, v43, v42, s36
    v_perm_b32 v206, v45, v44, s36
    v_perm_b32 v207, v47, v46, s36
    s_xor_b32 s38, s33, 0
    s_lshl_b32 s38, s38, 20
    s_add_u32 s37, s38, 0x0
    buffer_load_dword v32, v118, s[4:7], s37 offen
    buffer_load_dword v33, v119, s[4:7], s37 offen
    s_add_u32 s37, s38, 0x10000
    buffer_load_dword v34, v118, s[4:7], s37 offen
    buffer_load_dword v35, v119, s[4:7], s37 offen
    s_waitcnt vmcnt(50)
    s_add_u32 s37, s38, 0x4000
    buffer_load_dword v36, v118, s[4:7], s37 offen
    buffer_load_dword v37, v119, s[4:7], s37 offen
    s_add_u32 s37, s38, 0x14000
    buffer_load_dword v38, v118, s[4:7], s37 offen
    buffer_load_dword v39, v119, s[4:7], s37 offen
    s_add_u32 s37, s38, 0x40000
    buffer_load_dword v40, v118, s[4:7], s37 offen
    buffer_load_dword v41, v119, s[4:7], s37 offen
    s_add_u32 s37, s38, 0x50000
    buffer_load_dword v42, v118, s[4:7], s37 offen
    buffer_load_dword v43, v119, s[4:7], s37 offen
    s_add_u32 s37, s38, 0x44000
    buffer_load_dword v44, v118, s[4:7], s37 offen
    buffer_load_dword v45, v119, s[4:7], s37 offen
    s_add_u32 s37, s38, 0x54000
    buffer_load_dword v46, v118, s[4:7], s37 offen
    buffer_load_dword v47, v119, s[4:7], s37 offen
    s_waitcnt vmcnt(48)
    v_perm_b32 v208, v49, v48, s35
    v_perm_b32 v209, v51, v50, s35
    v_perm_b32 v210, v53, v52, s35
    v_perm_b32 v211, v55, v54, s35
    v_perm_b32 v212, v57, v56, s35
    v_perm_b32 v213, v59, v58, s35
    v_perm_b32 v214, v61, v60, s35
    v_perm_b32 v215, v63, v62, s35
    v_perm_b32 v216, v49, v48, s36
    v_perm_b32 v217, v51, v50, s36
    v_perm_b32 v218, v53, v52, s36
    v_perm_b32 v219, v55, v54, s36
    v_perm_b32 v220, v57, v56, s36
    v_perm_b32 v221, v59, v58, s36
    v_perm_b32 v222, v61, v60, s36
    v_perm_b32 v223, v63, v62, s36
    s_xor_b32 s38, s33, 0
    s_lshl_b32 s38, s38, 20
    s_add_u32 s37, s38, 0x80000
    buffer_load_dword v48, v118, s[4:7], s37 offen
    buffer_load_dword v49, v119, s[4:7], s37 offen
    s_add_u32 s37, s38, 0x90000
    buffer_load_dword v50, v118, s[4:7], s37 offen
    buffer_load_dword v51, v119, s[4:7], s37 offen
    s_waitcnt vmcnt(50)
    s_add_u32 s37, s38, 0x84000
    buffer_load_dword v52, v118, s[4:7], s37 offen
    buffer_load_dword v53, v119, s[4:7], s37 offen
    s_add_u32 s37, s38, 0x94000
    buffer_load_dword v54, v118, s[4:7], s37 offen
    buffer_load_dword v55, v119, s[4:7], s37 offen
    s_add_u32 s37, s38, 0xc0000
    buffer_load_dword v56, v118, s[4:7], s37 offen
    buffer_load_dword v57, v119, s[4:7], s37 offen
    s_add_u32 s37, s38, 0xd0000
    buffer_load_dword v58, v118, s[4:7], s37 offen
    buffer_load_dword v59, v119, s[4:7], s37 offen
    s_add_u32 s37, s38, 0xc4000
    buffer_load_dword v60, v118, s[4:7], s37 offen
    buffer_load_dword v61, v119, s[4:7], s37 offen
    s_add_u32 s37, s38, 0xd4000
    buffer_load_dword v62, v118, s[4:7], s37 offen
    buffer_load_dword v63, v119, s[4:7], s37 offen
    s_waitcnt vmcnt(48)
    v_perm_b32 v224, v65, v64, s35
    v_perm_b32 v225, v67, v66, s35
    v_perm_b32 v226, v69, v68, s35
    v_perm_b32 v227, v71, v70, s35
    v_perm_b32 v228, v73, v72, s35
    v_perm_b32 v229, v75, v74, s35
    v_perm_b32 v230, v77, v76, s35
    v_perm_b32 v231, v79, v78, s35
    v_perm_b32 v232, v65, v64, s36
    v_perm_b32 v233, v67, v66, s36
    v_perm_b32 v234, v69, v68, s36
    v_perm_b32 v235, v71, v70, s36
    v_perm_b32 v236, v73, v72, s36
    v_perm_b32 v237, v75, v74, s36
    v_perm_b32 v238, v77, v76, s36
    v_perm_b32 v239, v79, v78, s36
    s_xor_b32 s38, s33, 1
    s_lshl_b32 s38, s38, 20
    s_add_u32 s37, s38, 0x0
    buffer_load_dword v64, v118, s[4:7], s37 offen
    buffer_load_dword v65, v119, s[4:7], s37 offen
    s_add_u32 s37, s38, 0x10000
    buffer_load_dword v66, v118, s[4:7], s37 offen
    buffer_load_dword v67, v119, s[4:7], s37 offen
    s_waitcnt vmcnt(50)
    s_add_u32 s37, s38, 0x4000
    buffer_load_dword v68, v118, s[4:7], s37 offen
    buffer_load_dword v69, v119, s[4:7], s37 offen
    s_add_u32 s37, s38, 0x14000
    buffer_load_dword v70, v118, s[4:7], s37 offen
    buffer_load_dword v71, v119, s[4:7], s37 offen
    s_add_u32 s37, s38, 0x40000
    buffer_load_dword v72, v118, s[4:7], s37 offen
    buffer_load_dword v73, v119, s[4:7], s37 offen
    s_add_u32 s37, s38, 0x50000
    buffer_load_dword v74, v118, s[4:7], s37 offen
    buffer_load_dword v75, v119, s[4:7], s37 offen
    s_add_u32 s37, s38, 0x44000
    buffer_load_dword v76, v118, s[4:7], s37 offen
    buffer_load_dword v77, v119, s[4:7], s37 offen
    s_add_u32 s37, s38, 0x54000
    buffer_load_dword v78, v118, s[4:7], s37 offen
    buffer_load_dword v79, v119, s[4:7], s37 offen
    s_waitcnt vmcnt(48)
    v_perm_b32 v240, v81, v80, s35
    v_perm_b32 v241, v83, v82, s35
    v_perm_b32 v242, v85, v84, s35
    v_perm_b32 v243, v87, v86, s35
    v_perm_b32 v244, v89, v88, s35
    v_perm_b32 v245, v91, v90, s35
    v_perm_b32 v246, v93, v92, s35
    v_perm_b32 v247, v95, v94, s35
    v_perm_b32 v248, v81, v80, s36
    v_perm_b32 v249, v83, v82, s36
    v_perm_b32 v250, v85, v84, s36
    v_perm_b32 v251, v87, v86, s36
    v_perm_b32 v252, v89, v88, s36
    v_perm_b32 v253, v91, v90, s36
    v_perm_b32 v254, v93, v92, s36
    v_perm_b32 v255, v95, v94, s36
    s_xor_b32 s38, s33, 1
    s_lshl_b32 s38, s38, 20
    s_add_u32 s37, s38, 0x80000
    buffer_load_dword v80, v118, s[4:7], s37 offen
    buffer_load_dword v81, v119, s[4:7], s37 offen
    s_add_u32 s37, s38, 0x90000
    buffer_load_dword v82, v118, s[4:7], s37 offen
    buffer_load_dword v83, v119, s[4:7], s37 offen
    s_waitcnt vmcnt(50)
    s_add_u32 s37, s38, 0x84000
    buffer_load_dword v84, v118, s[4:7], s37 offen
    buffer_load_dword v85, v119, s[4:7], s37 offen
    s_add_u32 s37, s38, 0x94000
    buffer_load_dword v86, v118, s[4:7], s37 offen
    buffer_load_dword v87, v119, s[4:7], s37 offen
    s_add_u32 s37, s38, 0xc0000
    buffer_load_dword v88, v118, s[4:7], s37 offen
    buffer_load_dword v89, v119, s[4:7], s37 offen
    s_add_u32 s37, s38, 0xd0000
    buffer_load_dword v90, v118, s[4:7], s37 offen
    buffer_load_dword v91, v119, s[4:7], s37 offen
    s_add_u32 s37, s38, 0xc4000
    buffer_load_dword v92, v118, s[4:7], s37 offen
    buffer_load_dword v93, v119, s[4:7], s37 offen
    s_add_u32 s37, s38, 0xd4000
    buffer_load_dword v94, v118, s[4:7], s37 offen
    buffer_load_dword v95, v119, s[4:7], s37 offen
    s_waitcnt vmcnt(48)
    v_perm_b32 v96, v33, v32, s35
    v_perm_b32 v97, v35, v34, s35
    v_perm_b32 v98, v37, v36, s35
    v_perm_b32 v99, v39, v38, s35
    v_perm_b32 v100, v41, v40, s35
    v_perm_b32 v101, v43, v42, s35
    v_perm_b32 v102, v45, v44, s35
    v_perm_b32 v103, v47, v46, s35
    v_accvgpr_write_b32 a0, v96
    v_accvgpr_write_b32 a1, v97
    v_accvgpr_write_b32 a2, v98
    v_accvgpr_write_b32 a3, v99
    v_accvgpr_write_b32 a4, v100
    v_accvgpr_write_b32 a5, v101
    v_accvgpr_write_b32 a6, v102
    v_accvgpr_write_b32 a7, v103
    v_perm_b32 v104, v33, v32, s36
    v_perm_b32 v105, v35, v34, s36
    v_perm_b32 v106, v37, v36, s36
    v_perm_b32 v107, v39, v38, s36
    v_perm_b32 v108, v41, v40, s36
    v_perm_b32 v109, v43, v42, s36
    v_perm_b32 v110, v45, v44, s36
    v_perm_b32 v111, v47, v46, s36
    ds_write_b128 v4, v[104:107] offset:24576
    ds_write_b128 v4, v[108:111] offset:25600
    s_waitcnt lgkmcnt(0)
    s_xor_b32 s38, s33, 2
    s_lshl_b32 s38, s38, 20
    s_add_u32 s37, s38, 0x0
    buffer_load_dword v32, v118, s[4:7], s37 offen
    buffer_load_dword v33, v119, s[4:7], s37 offen
    s_add_u32 s37, s38, 0x10000
    buffer_load_dword v34, v118, s[4:7], s37 offen
    buffer_load_dword v35, v119, s[4:7], s37 offen
    s_waitcnt vmcnt(50)
    s_add_u32 s37, s38, 0x4000
    buffer_load_dword v36, v118, s[4:7], s37 offen
    buffer_load_dword v37, v119, s[4:7], s37 offen
    s_add_u32 s37, s38, 0x14000
    buffer_load_dword v38, v118, s[4:7], s37 offen
    buffer_load_dword v39, v119, s[4:7], s37 offen
    s_add_u32 s37, s38, 0x40000
    buffer_load_dword v40, v118, s[4:7], s37 offen
    buffer_load_dword v41, v119, s[4:7], s37 offen
    s_add_u32 s37, s38, 0x50000
    buffer_load_dword v42, v118, s[4:7], s37 offen
    buffer_load_dword v43, v119, s[4:7], s37 offen
    s_add_u32 s37, s38, 0x44000
    buffer_load_dword v44, v118, s[4:7], s37 offen
    buffer_load_dword v45, v119, s[4:7], s37 offen
    s_add_u32 s37, s38, 0x54000
    buffer_load_dword v46, v118, s[4:7], s37 offen
    buffer_load_dword v47, v119, s[4:7], s37 offen
    s_waitcnt vmcnt(48)
    v_perm_b32 v96, v49, v48, s35
    v_perm_b32 v97, v51, v50, s35
    v_perm_b32 v98, v53, v52, s35
    v_perm_b32 v99, v55, v54, s35
    v_perm_b32 v100, v57, v56, s35
    v_perm_b32 v101, v59, v58, s35
    v_perm_b32 v102, v61, v60, s35
    v_perm_b32 v103, v63, v62, s35
    v_accvgpr_write_b32 a16, v96
    v_accvgpr_write_b32 a17, v97
    v_accvgpr_write_b32 a18, v98
    v_accvgpr_write_b32 a19, v99
    v_accvgpr_write_b32 a20, v100
    v_accvgpr_write_b32 a21, v101
    v_accvgpr_write_b32 a22, v102
    v_accvgpr_write_b32 a23, v103
    v_perm_b32 v104, v49, v48, s36
    v_perm_b32 v105, v51, v50, s36
    v_perm_b32 v106, v53, v52, s36
    v_perm_b32 v107, v55, v54, s36
    v_perm_b32 v108, v57, v56, s36
    v_perm_b32 v109, v59, v58, s36
    v_perm_b32 v110, v61, v60, s36
    v_perm_b32 v111, v63, v62, s36
    ds_write_b128 v4, v[104:107] offset:2048
    ds_write_b128 v4, v[108:111] offset:3072
    s_waitcnt lgkmcnt(0)
    v_mov_b32 v123, 32
    buffer_load_dword v125, v123, s[28:31], 0 offen sc1
    v_lshrrev_b32 v121, 2, v113
    v_and_b32 v122, 1, v113
    v_lshl_add_u32 v121, v121, 1, v122
    v_lshlrev_b32 v121, 10, v121
    v_lshl_add_u32 v121, v114, 5, v121
    v_and_b32 v122, 2, v113
    v_lshl_add_u32 v121, v122, 3, v121
    s_lshl_b32 s37, s33, 8
    buffer_load_dwordx4 v[20:23], v121, s[24:27], s37 offen
    buffer_load_dwordx4 v[24:27], v121, s[24:27], s37 offen offset:128
    s_mov_b32 s43, 0
    s_lshr_b32 s38, s32, 1
    s_lshl_b32 s38, s38, 9
    s_and_b32 s39, s32, 1
    s_lshl_b32 s39, s39, 3
    s_add_u32 s38, s38, s39
    s_add_u32 s53, s38, 4096
    v_bfe_u32 v28, v2, 4, 4
    v_mul_u32_u24 v28, 1092, v28
    v_and_b32 v28, 0x2184, v28
    buffer_load_dword v30, v28, s[20:23], s53 offen sc1
    s_xor_b32 s38, s33, 2
    s_lshl_b32 s38, s38, 20
    s_add_u32 s37, s38, 0x80000
    buffer_load_dword v48, v118, s[4:7], s37 offen
    buffer_load_dword v49, v119, s[4:7], s37 offen
    s_add_u32 s37, s38, 0x90000
    buffer_load_dword v50, v118, s[4:7], s37 offen
    buffer_load_dword v51, v119, s[4:7], s37 offen
    s_waitcnt vmcnt(50)
    s_add_u32 s37, s38, 0x84000
    buffer_load_dword v52, v118, s[4:7], s37 offen
    buffer_load_dword v53, v119, s[4:7], s37 offen
    s_add_u32 s37, s38, 0x94000
    buffer_load_dword v54, v118, s[4:7], s37 offen
    buffer_load_dword v55, v119, s[4:7], s37 offen
    s_add_u32 s37, s38, 0xc0000
    buffer_load_dword v56, v118, s[4:7], s37 offen
    buffer_load_dword v57, v119, s[4:7], s37 offen
    s_add_u32 s37, s38, 0xd0000
    buffer_load_dword v58, v118, s[4:7], s37 offen
    buffer_load_dword v59, v119, s[4:7], s37 offen
    s_add_u32 s37, s38, 0xc4000
    buffer_load_dword v60, v118, s[4:7], s37 offen
    buffer_load_dword v61, v119, s[4:7], s37 offen
    s_add_u32 s37, s38, 0xd4000
    buffer_load_dword v62, v118, s[4:7], s37 offen
    buffer_load_dword v63, v119, s[4:7], s37 offen
    s_waitcnt vmcnt(52)
    v_perm_b32 v96, v65, v64, s35
    v_perm_b32 v97, v67, v66, s35
    v_perm_b32 v98, v69, v68, s35
    v_perm_b32 v99, v71, v70, s35
    v_perm_b32 v100, v73, v72, s35
    v_perm_b32 v101, v75, v74, s35
    v_perm_b32 v102, v77, v76, s35
    v_perm_b32 v103, v79, v78, s35
    v_accvgpr_write_b32 a32, v96
    v_accvgpr_write_b32 a33, v97
    v_accvgpr_write_b32 a34, v98
    v_accvgpr_write_b32 a35, v99
    v_accvgpr_write_b32 a36, v100
    v_accvgpr_write_b32 a37, v101
    v_accvgpr_write_b32 a38, v102
    v_accvgpr_write_b32 a39, v103
    v_perm_b32 v104, v65, v64, s36
    v_perm_b32 v105, v67, v66, s36
    v_perm_b32 v106, v69, v68, s36
    v_perm_b32 v107, v71, v70, s36
    v_perm_b32 v108, v73, v72, s36
    v_perm_b32 v109, v75, v74, s36
    v_perm_b32 v110, v77, v76, s36
    v_perm_b32 v111, v79, v78, s36
    v_accvgpr_write_b32 a40, v104
    v_accvgpr_write_b32 a41, v105
    v_accvgpr_write_b32 a42, v106
    v_accvgpr_write_b32 a43, v107
    v_accvgpr_write_b32 a44, v108
    v_accvgpr_write_b32 a45, v109
    v_accvgpr_write_b32 a46, v110
    v_accvgpr_write_b32 a47, v111
    s_xor_b32 s38, s33, 3
    s_lshl_b32 s38, s38, 20
    s_add_u32 s37, s38, 0x0
    buffer_load_dword v64, v118, s[4:7], s37 offen
    buffer_load_dword v65, v119, s[4:7], s37 offen
    s_add_u32 s37, s38, 0x10000
    buffer_load_dword v66, v118, s[4:7], s37 offen
    buffer_load_dword v67, v119, s[4:7], s37 offen
    s_waitcnt vmcnt(50)
    s_add_u32 s37, s38, 0x4000
    buffer_load_dword v68, v118, s[4:7], s37 offen
    buffer_load_dword v69, v119, s[4:7], s37 offen
    s_add_u32 s37, s38, 0x14000
    buffer_load_dword v70, v118, s[4:7], s37 offen
    buffer_load_dword v71, v119, s[4:7], s37 offen
    s_add_u32 s37, s38, 0x40000
    buffer_load_dword v72, v118, s[4:7], s37 offen
    buffer_load_dword v73, v119, s[4:7], s37 offen
    s_add_u32 s37, s38, 0x50000
    buffer_load_dword v74, v118, s[4:7], s37 offen
    buffer_load_dword v75, v119, s[4:7], s37 offen
    s_add_u32 s37, s38, 0x44000
    buffer_load_dword v76, v118, s[4:7], s37 offen
    buffer_load_dword v77, v119, s[4:7], s37 offen
    s_add_u32 s37, s38, 0x54000
    buffer_load_dword v78, v118, s[4:7], s37 offen
    buffer_load_dword v79, v119, s[4:7], s37 offen
    s_waitcnt vmcnt(52)
    v_perm_b32 v96, v81, v80, s35
    v_perm_b32 v97, v83, v82, s35
    v_perm_b32 v98, v85, v84, s35
    v_perm_b32 v99, v87, v86, s35
    v_perm_b32 v100, v89, v88, s35
    v_perm_b32 v101, v91, v90, s35
    v_perm_b32 v102, v93, v92, s35
    v_perm_b32 v103, v95, v94, s35
    v_accvgpr_write_b32 a48, v96
    v_accvgpr_write_b32 a49, v97
    v_accvgpr_write_b32 a50, v98
    v_accvgpr_write_b32 a51, v99
    v_accvgpr_write_b32 a52, v100
    v_accvgpr_write_b32 a53, v101
    v_accvgpr_write_b32 a54, v102
    v_accvgpr_write_b32 a55, v103
    v_perm_b32 v104, v81, v80, s36
    v_perm_b32 v105, v83, v82, s36
    v_perm_b32 v106, v85, v84, s36
    v_perm_b32 v107, v87, v86, s36
    v_perm_b32 v108, v89, v88, s36
    v_perm_b32 v109, v91, v90, s36
    v_perm_b32 v110, v93, v92, s36
    v_perm_b32 v111, v95, v94, s36
    v_accvgpr_write_b32 a56, v104
    v_accvgpr_write_b32 a57, v105
    v_accvgpr_write_b32 a58, v106
    v_accvgpr_write_b32 a59, v107
    v_accvgpr_write_b32 a60, v108
    v_accvgpr_write_b32 a61, v109
    v_accvgpr_write_b32 a62, v110
    v_accvgpr_write_b32 a63, v111
    s_xor_b32 s38, s33, 3
    s_lshl_b32 s38, s38, 20
    s_add_u32 s37, s38, 0x80000
    buffer_load_dword v80, v118, s[4:7], s37 offen
    buffer_load_dword v81, v119, s[4:7], s37 offen
    s_add_u32 s37, s38, 0x90000
    buffer_load_dword v82, v118, s[4:7], s37 offen
    buffer_load_dword v83, v119, s[4:7], s37 offen
    s_waitcnt vmcnt(50)
    s_add_u32 s37, s38, 0x84000
    buffer_load_dword v84, v118, s[4:7], s37 offen
    buffer_load_dword v85, v119, s[4:7], s37 offen
    s_add_u32 s37, s38, 0x94000
    buffer_load_dword v86, v118, s[4:7], s37 offen
    buffer_load_dword v87, v119, s[4:7], s37 offen
    s_add_u32 s37, s38, 0xc0000
    buffer_load_dword v88, v118, s[4:7], s37 offen
    buffer_load_dword v89, v119, s[4:7], s37 offen
    s_add_u32 s37, s38, 0xd0000
    buffer_load_dword v90, v118, s[4:7], s37 offen
    buffer_load_dword v91, v119, s[4:7], s37 offen
    s_add_u32 s37, s38, 0xc4000
    buffer_load_dword v92, v118, s[4:7], s37 offen
    buffer_load_dword v93, v119, s[4:7], s37 offen
    s_add_u32 s37, s38, 0xd4000
    buffer_load_dword v94, v118, s[4:7], s37 offen
    buffer_load_dword v95, v119, s[4:7], s37 offen
    s_waitcnt vmcnt(52)
    v_perm_b32 v96, v33, v32, s35
    v_perm_b32 v97, v35, v34, s35
    v_perm_b32 v98, v37, v36, s35
    v_perm_b32 v99, v39, v38, s35
    v_perm_b32 v100, v41, v40, s35
    v_perm_b32 v101, v43, v42, s35
    v_perm_b32 v102, v45, v44, s35
    v_perm_b32 v103, v47, v46, s35
    v_accvgpr_write_b32 a64, v96
    v_accvgpr_write_b32 a65, v97
    v_accvgpr_write_b32 a66, v98
    v_accvgpr_write_b32 a67, v99
    v_accvgpr_write_b32 a68, v100
    v_accvgpr_write_b32 a69, v101
    v_accvgpr_write_b32 a70, v102
    v_accvgpr_write_b32 a71, v103
    v_perm_b32 v104, v33, v32, s36
    v_perm_b32 v105, v35, v34, s36
    v_perm_b32 v106, v37, v36, s36
    v_perm_b32 v107, v39, v38, s36
    v_perm_b32 v108, v41, v40, s36
    v_perm_b32 v109, v43, v42, s36
    v_perm_b32 v110, v45, v44, s36
    v_perm_b32 v111, v47, v46, s36
    v_accvgpr_write_b32 a72, v104
    v_accvgpr_write_b32 a73, v105
    v_accvgpr_write_b32 a74, v106
    v_accvgpr_write_b32 a75, v107
    v_accvgpr_write_b32 a76, v108
    v_accvgpr_write_b32 a77, v109
    v_accvgpr_write_b32 a78, v110
    v_accvgpr_write_b32 a79, v111
    s_waitcnt vmcnt(32)
    v_bfe_u32 v28, v2, 5, 2
    v_lshl_add_u32 v30, v30, 2, v28
    s_nop 1
    v_min_u32_dpp v30, v30, v30 row_ror:8 row_mask:0xf bank_mask:0xf
    s_nop 1
    v_min_u32_dpp v30, v30, v30 row_ror:4 row_mask:0xf bank_mask:0xf
    s_nop 1
    v_min_u32_dpp v30, v30, v30 row_ror:2 row_mask:0xf bank_mask:0xf
    s_nop 1
    v_min_u32_dpp v30, v30, v30 row_ror:1 row_mask:0xf bank_mask:0xf
    s_nop 0
    v_readfirstlane_b32 s38, v30
    s_nop 0
    s_lshl_b32 s38, s38, 1
    s_max_u32 s43, s43, s38
    s_cmp_ge_u32 s43, 64
    s_cselect_b32 s43, 128, s43
    s_cselect_b32 s53, 0x40000000, s53
    s_add_u32 s51, s57, 0xe0000
    s_add_u32 s52, s57, 0x10e0000
    s_cmp_lt_u32 s43, 2
    s_cselect_b32 s51, 0x40000000, s51
    s_cselect_b32 s52, 0x40000000, s52
    s_mov_b32 m0, s60
    s_nop 0
    buffer_load_dwordx4 v2, s[20:23], s51 offen offset:0 sc1 lds
    buffer_load_dwordx4 v2, s[20:23], s51 offen offset:1024 sc1 lds
    s_mov_b32 m0, s61
    s_nop 0
    buffer_load_dwordx4 v2, s[20:23], s52 offen offset:0 sc1 lds
    buffer_load_dwordx4 v2, s[20:23], s52 offen offset:1024 sc1 lds
    v_perm_b32 v96, v49, v48, s35
    v_perm_b32 v97, v51, v50, s35
    v_perm_b32 v98, v53, v52, s35
    v_perm_b32 v99, v55, v54, s35
    v_perm_b32 v100, v57, v56, s35
    v_perm_b32 v101, v59, v58, s35
    v_perm_b32 v102, v61, v60, s35
    v_perm_b32 v103, v63, v62, s35
    v_accvgpr_write_b32 a80, v96
    v_accvgpr_write_b32 a81, v97
    v_accvgpr_write_b32 a82, v98
    v_accvgpr_write_b32 a83, v99
    v_accvgpr_write_b32 a84, v100
    v_accvgpr_write_b32 a85, v101
    v_accvgpr_write_b32 a86, v102
    v_accvgpr_write_b32 a87, v103
    v_perm_b32 v104, v49, v48, s36
    v_perm_b32 v105, v51, v50, s36
    v_perm_b32 v106, v53, v52, s36
    v_perm_b32 v107, v55, v54, s36
    v_perm_b32 v108, v57, v56, s36
    v_perm_b32 v109, v59, v58, s36
    v_perm_b32 v110, v61, v60, s36
    v_perm_b32 v111, v63, v62, s36
    v_accvgpr_write_b32 a88, v104
    v_accvgpr_write_b32 a89, v105
    v_accvgpr_write_b32 a90, v106
    v_accvgpr_write_b32 a91, v107
    v_accvgpr_write_b32 a92, v108
    v_accvgpr_write_b32 a93, v109
    v_accvgpr_write_b32 a94, v110
    v_accvgpr_write_b32 a95, v111
    s_waitcnt vmcnt(20)
    v_perm_b32 v96, v65, v64, s35
    v_perm_b32 v97, v67, v66, s35
    v_perm_b32 v98, v69, v68, s35
    v_perm_b32 v99, v71, v70, s35
    v_perm_b32 v100, v73, v72, s35
    v_perm_b32 v101, v75, v74, s35
    v_perm_b32 v102, v77, v76, s35
    v_perm_b32 v103, v79, v78, s35
    ds_write_b128 v4, v[96:99] offset:6144
    ds_write_b128 v4, v[100:103] offset:7168
    v_perm_b32 v104, v65, v64, s36
    v_perm_b32 v105, v67, v66, s36
    v_perm_b32 v106, v69, v68, s36
    v_perm_b32 v107, v71, v70, s36
    v_perm_b32 v108, v73, v72, s36
    v_perm_b32 v109, v75, v74, s36
    v_perm_b32 v110, v77, v76, s36
    v_perm_b32 v111, v79, v78, s36
    ds_write_b128 v4, v[104:107] offset:10240
    ds_write_b128 v4, v[108:111] offset:11264
    s_waitcnt lgkmcnt(0)
    s_waitcnt vmcnt(4)
    v_perm_b32 v96, v81, v80, s35
    v_perm_b32 v97, v83, v82, s35
    v_perm_b32 v98, v85, v84, s35
    v_perm_b32 v99, v87, v86, s35
    v_perm_b32 v100, v89, v88, s35
    v_perm_b32 v101, v91, v90, s35
    v_perm_b32 v102, v93, v92, s35
    v_perm_b32 v103, v95, v94, s35
    ds_write_b128 v4, v[96:99] offset:12288
    ds_write_b128 v4, v[100:103] offset:13312
    v_perm_b32 v104, v81, v80, s36
    v_perm_b32 v105, v83, v82, s36
    v_perm_b32 v106, v85, v84, s36
    v_perm_b32 v107, v87, v86, s36
    v_perm_b32 v108, v89, v88, s36
    v_perm_b32 v109, v91, v90, s36
    v_perm_b32 v110, v93, v92, s36
    v_perm_b32 v111, v95, v94, s36
    ds_write_b128 v4, v[104:107] offset:14336
    ds_write_b128 v4, v[108:111] offset:15360
    s_waitcnt lgkmcnt(0)
    s_waitcnt vmcnt(0)
    v_cmp_ne_u32 vcc, 32, v125
    v_min_u32 v32, s59, v20
    v_min_u32 v33, s59, v21
    v_min_u32 v34, s59, v22
    v_min_u32 v35, s59, v23
    v_min_u32 v36, s59, v24
    v_min_u32 v37, s59, v25
    v_min_u32 v38, s59, v26
    v_min_u32 v39, s59, v27
    v_mov_b64 v[20:21], 0
    v_mov_b64 v[22:23], 0
    v_mov_b64 v[24:25], 0
    v_mov_b64 v[26:27], 0
    s_cbranch_vccz CTOK_36
    s_mov_b32 s40, 0
    v_mov_b32 v64, 32
CTEAM_34:
    buffer_load_dword v65, v64, s[28:31], 0 offen sc1
    s_add_u32 s40, s40, 1
    s_cmp_gt_u32 s40, 0x40000
    s_cbranch_scc1 CABORT_35
    s_waitcnt vmcnt(0)
    v_cmp_ne_u32 vcc, 32, v65
    s_cbranch_vccnz CTEAM_34
CTOK_36:
    s_mov_b32 s34, 0
    s_cmp_ge_u32 s43, 2
    s_cbranch_scc1 CHAVE_37
    s_add_u32 s37, s34, 1
    s_cmp_lt_u32 s37, s43
    s_cbranch_scc1 CKVOK_39
    s_mov_b32 s40, 0
CKV_38:
    v_bfe_u32 v28, v2, 4, 4
    v_mul_u32_u24 v28, 1092, v28
    v_and_b32 v28, 0x2184, v28
    buffer_load_dword v30, v28, s[20:23], s53 offen sc1
    s_add_u32 s40, s40, 1
    s_cmp_gt_u32 s40, 0x40000
    s_cbranch_scc1 CABORT_35
    s_waitcnt vmcnt(0)
    v_bfe_u32 v28, v2, 5, 2
    v_lshl_add_u32 v30, v30, 2, v28
    s_nop 1
    v_min_u32_dpp v30, v30, v30 row_ror:8 row_mask:0xf bank_mask:0xf
    s_nop 1
    v_min_u32_dpp v30, v30, v30 row_ror:4 row_mask:0xf bank_mask:0xf
    s_nop 1
    v_min_u32_dpp v30, v30, v30 row_ror:2 row_mask:0xf bank_mask:0xf
    s_nop 1
    v_min_u32_dpp v30, v30, v30 row_ror:1 row_mask:0xf bank_mask:0xf
    s_nop 0
    v_readfirstlane_b32 s38, v30
    s_nop 0
    s_lshl_b32 s38, s38, 1
    s_max_u32 s43, s43, s38
    s_cmp_ge_u32 s43, 64
    s_cselect_b32 s43, 128, s43
    s_cselect_b32 s53, 0x40000000, s53
    s_cmp_lt_u32 s37, s43
    s_cbranch_scc0 CKV_38
    s_mov_b32 s40, 0
CKVOK_39:
    s_add_u32 s51, s57, 0xe0000
    s_add_u32 s52, s57, 0x10e0000
    s_mov_b32 m0, s60
    s_nop 0
    buffer_load_dwordx4 v2, s[20:23], s51 offen offset:0 sc1 lds
    buffer_load_dwordx4 v2, s[20:23], s51 offen offset:1024 sc1 lds
    s_mov_b32 m0, s61
    s_nop 0
    buffer_load_dwordx4 v2, s[20:23], s52 offen offset:0 sc1 lds
    buffer_load_dwordx4 v2, s[20:23], s52 offen offset:1024 sc1 lds
    s_waitcnt vmcnt(0)
CHAVE_37:
    s_lshl_b32 s37, s32, 5
    s_add_u32 s37, s37, s33
    s_lshl_b32 s37, s37, 2
    s_add_u32 s37, s37, 0
    v_cmp_eq_u32 vcc, 0x20000, v2
    v_mov_b32 v28, 0x40000000
    v_mov_b32 v29, s37
    v_cndmask_b32 v31, v28, v29, vcc
    s_mov_b32 s46, 0
    s_mov_b32 s47, 8192
    s_mov_b32 s48, 16384
    s_mov_b32 s54, 0x40000000
    s_mov_b32 s41, 0x8000
    s_mov_b32 s87, s53
    s_mov_b32 s44, 0
    s_mov_b32 s55, 0
    s_add_u32 s51, s51, 0x40000
    s_add_u32 s52, s52, 0x40000
    ds_read_b128 v[40:43], v4 offset:24576
    ds_read_b128 v[44:47], v4 offset:25600
    ds_read_b128 v[48:51], v4 offset:2048
    ds_read_b128 v[52:55], v4 offset:3072
    ds_read_b128 v[88:91], v4 offset:6144
    ds_read_b128 v[92:95], v4 offset:7168
    ds_read_b128 v[96:99], v4 offset:10240
    ds_read_b128 v[100:103], v4 offset:11264
    ds_read_b128 v[104:107], v4 offset:12288
    ds_read_b128 v[108:111], v4 offset:13312
    ds_read_b128 v[112:115], v4 offset:14336
    ds_read_b128 v[116:119], v4 offset:15360
    ds_read_b128 v[56:59], v4 offset:4096
    ds_read_b128 v[60:63], v4 offset:5120
    v_mov_b64 v[64:65], 0
    v_mov_b64 v[66:67], 0
    v_mov_b64 v[68:69], 0
    v_mov_b64 v[70:71], 0
    v_mov_b64 v[72:73], 0
    v_mov_b64 v[74:75], 0
    v_mov_b64 v[76:77], 0
    v_mov_b64 v[78:79], 0
    v_mov_b64 v[80:81], 0
    v_mov_b64 v[82:83], 0
    v_mov_b64 v[84:85], 0
    v_mov_b64 v[86:87], 0
    s_waitcnt lgkmcnt(0)
    s_branch CGOT_42
CTOP_41:
    buffer_load_dwordx4 v[32:35], v2, s[20:23], s50 offen offset:0 sc1
    buffer_load_dwordx4 v[36:39], v2, s[20:23], s50 offen offset:1024 sc1
    s_nop 15
    s_nop 7
    buffer_load_dwordx4 v[120:123], v2, s[20:23], s50 offen offset:0 sc1
    buffer_load_dwordx4 v[124:127], v2, s[20:23], s50 offen offset:1024 sc1
    s_waitcnt vmcnt(3) lgkmcnt(0)
    v_smfmac_f32_16x16x64_bf16 v[64:67], v[32:35], a[0:7], v1
    ds_write_b128 v3, v[32:35] offset:16384
    v_max3_u32 v29, v32, v33, v34
    v_smfmac_f32_16x16x64_bf16 v[68:71], v[32:35], v[40:47], v1
    s_waitcnt vmcnt(2)
    v_max3_u32 v29, v29, v35, v36
    v_max3_u32 v29, v29, v37, v38
    v_smfmac_f32_16x16x64_bf16 v[64:67], v[36:39], a[16:23], v1
    ds_write_b128 v3, v[36:39] offset:17408
    v_max_u32 v29, v29, v39
    v_cmp_eq_u32 vcc, -1, v29
    v_smfmac_f32_16x16x64_bf16 v[68:71], v[36:39], v[48:55], v1
    s_cbranch_vccnz CREDO_43
    v_xor_b32 v0, 0x800, v3
    v_smfmac_f32_16x16x64_bf16 v[80:83], v[32:35], v[128:135], v1
    s_mov_b32 m0, s61
    s_cmp_eq_u32 s34, 63
    v_xor_b32 v28, 0x1000, v3
    v_smfmac_f32_16x16x64_bf16 v[84:87], v[32:35], v[56:63], v1
    s_waitcnt lgkmcnt(0)
    s_barrier
    v_smfmac_f32_16x16x64_bf16 v[80:83], v[36:39], v[144:151], v1
    ds_read_b128 v[40:43], v0 offset:16384
    v_xor_b32 v30, 0x1800, v3
    v_smfmac_f32_16x16x64_bf16 v[84:87], v[36:39], v[152:159], v1
    ds_read_b128 v[44:47], v0 offset:17408
    v_smfmac_f32_16x16x64_bf16 v[72:75], v[32:35], a[128:135], v1
    ds_read_b128 v[48:51], v28 offset:16384
    v_smfmac_f32_16x16x64_bf16 v[76:79], v[32:35], a[136:143], v1
    ds_read_b128 v[52:55], v28 offset:17408
    v_smfmac_f32_16x16x64_bf16 v[72:75], v[36:39], a[144:151], v1
    ds_read_b128 v[56:59], v30 offset:16384
    v_smfmac_f32_16x16x64_bf16 v[76:79], v[36:39], a[152:159], v1
    ds_read_b128 v[60:63], v30 offset:17408
    s_waitcnt lgkmcnt(5)
COWN_44:
    v_smfmac_f32_16x16x64_bf16 v[64:67], v[40:43], a[32:39], v1
    s_cbranch_scc1 CFIN_45
    s_waitcnt lgkmcnt(4)
    s_waitcnt vmcnt(0)
    v_bfe_u32 v28, v2, 4, 4
    v_smfmac_f32_16x16x64_bf16 v[68:71], v[40:43], a[40:47], v1
    ds_read_b128 v[120:123], v3 offset:8192
    v_mul_u32_u24 v28, 1092, v28
    v_smfmac_f32_16x16x64_bf16 v[64:67], v[44:47], a[48:55], v1
    s_waitcnt lgkmcnt(4)
    v_and_b32 v28, 0x2184, v28
    v_smfmac_f32_16x16x64_bf16 v[68:71], v[44:47], a[56:63], v1
    ds_read_b128 v[124:127], v3 offset:9216
    buffer_load_dword v30, v28, s[20:23], s87 offen sc1
    v_mov_b32 v29, s44
    v_smfmac_f32_16x16x64_bf16 v[64:67], v[48:51], a[64:71], v1
    s_waitcnt lgkmcnt(4)
    v_smfmac_f32_16x16x64_bf16 v[68:71], v[48:51], a[72:79], v1
    v_smfmac_f32_16x16x64_bf16 v[64:67], v[52:55], a[80:87], v1
    s_waitcnt lgkmcnt(3)
    buffer_load_dwordx4 v2, s[20:23], s52 offen offset:0 sc1 lds
    v_smfmac_f32_16x16x64_bf16 v[68:71], v[52:55], a[88:95], v1
    ds_read_b128 v[32:35], v4 offset:0
    v_smfmac_f32_16x16x64_bf16 v[64:67], v[56:59], v[88:95], v1
    s_waitcnt lgkmcnt(1)
    v_smfmac_f32_16x16x64_bf16 v[68:71], v[56:59], v[96:103], v1
    s_mov_b64 exec, 1
    buffer_store_dword v29, v31, s[20:23], 0 offen sc1
    s_mov_b64 exec, -1
    v_smfmac_f32_16x16x64_bf16 v[64:67], v[60:63], v[104:111], v1
    ds_read_b128 v[36:39], v4 offset:1024
    v_smfmac_f32_16x16x64_bf16 v[68:71], v[60:63], v[112:119], v1
    buffer_load_dwordx4 v2, s[20:23], s52 offen offset:1024 sc1 lds
    v_smfmac_f32_16x16x64_bf16 v[72:75], v[40:43], a[160:167], v1
    ds_read_b128 v[88:91], v2 offset:0
    v_add_f32 v64, v64, v66
    v_smfmac_f32_16x16x64_bf16 v[76:79], v[40:43], a[168:175], v1
    v_add_f32 v65, v65, v67
    v_add_f32 v68, v68, v70
    v_smfmac_f32_16x16x64_bf16 v[72:75], v[44:47], a[176:183], v1
    v_add_f32 v69, v69, v71
    v_cvt_pk_bf16_f32 v66, v64, v68
    v_smfmac_f32_16x16x64_bf16 v[76:79], v[44:47], a[184:191], v1
    ds_read_b128 v[92:95], v2 offset:1024
    v_cvt_pk_bf16_f32 v67, v65, v69
    v_smfmac_f32_16x16x64_bf16 v[72:75], v[48:51], a[192:199], v1
    ds_write2_b32 v5, v66, v67 offset0:0 offset1:72
    v_smfmac_f32_16x16x64_bf16 v[76:79], v[48:51], a[200:207], v1
    ds_read_b128 v[96:99], v2 offset:2048
    buffer_store_dwordx4 v[20:23], v2, s[20:23], s54 offen sc1
    v_smfmac_f32_16x16x64_bf16 v[72:75], v[52:55], a[208:215], v1
    ds_read_b128 v[100:103], v2 offset:3072
    v_smfmac_f32_16x16x64_bf16 v[76:79], v[52:55], a[216:223], v1
    v_add_u32 v0, 2304, v5
    v_smfmac_f32_16x16x64_bf16 v[72:75], v[56:59], a[224:231], v1
    s_waitcnt lgkmcnt(2)
    s_barrier
    v_smfmac_f32_16x16x64_bf16 v[76:79], v[56:59], a[232:239], v1
    ds_read_b128 v[104:107], v8 offset:0
    v_smfmac_f32_16x16x64_bf16 v[72:75], v[60:63], a[240:247], v1
    ds_read_b128 v[108:111], v8 offset:64
    v_smfmac_f32_16x16x64_bf16 v[76:79], v[60:63], a[248:255], v1
    ds_read_b128 v[112:115], v8 offset:128
    v_smfmac_f32_16x16x64_bf16 v[80:83], v[40:43], v[160:167], v1
    ds_read_b128 v[116:119], v8 offset:192
    v_add_f32 v72, v72, v74
    v_smfmac_f32_16x16x64_bf16 v[84:87], v[40:43], v[168:175], v1
    s_waitcnt lgkmcnt(3)
    v_add_f32 v73, v73, v75
    v_add_f32 v76, v76, v78
    v_mfma_f32_16x16x32_bf16 v[64:67], v[88:91], v[104:107], 0
    s_waitcnt lgkmcnt(2)
    v_add_f32 v77, v77, v79
    v_cvt_pk_bf16_f32 v74, v72, v76
    v_mfma_f32_16x16x32_bf16 v[64:67], v[92:95], v[108:111], v[64:67]
    ds_read_b128 v[88:91], v2 offset:4096
    v_cvt_pk_bf16_f32 v75, v73, v77
    s_waitcnt lgkmcnt(2)
    v_mfma_f32_16x16x32_bf16 v[64:67], v[96:99], v[112:115], v[64:67]
    ds_write2_b32 v0, v74, v75 offset0:0 offset1:72
    s_waitcnt lgkmcnt(2)
    v_mfma_f32_16x16x32_bf16 v[64:67], v[100:103], v[116:119], v[64:67]
    ds_read_b128 v[92:95], v2 offset:5120
    v_smfmac_f32_16x16x64_bf16 v[80:83], v[44:47], v[176:183], v1
    ds_read_b128 v[96:99], v2 offset:6144
    s_mov_b32 m0, s60
    v_smfmac_f32_16x16x64_bf16 v[84:87], v[44:47], v[184:191], v1
    ds_read_b128 v[100:103], v2 offset:7168
    s_waitcnt lgkmcnt(4)
    v_mfma_f32_16x16x32_bf16 v[68:71], v[88:91], v[104:107], 0
    s_waitcnt lgkmcnt(2)
    v_exp_f32 v64, v64
    v_mfma_f32_16x16x32_bf16 v[68:71], v[92:95], v[108:111], v[68:71]
    s_waitcnt lgkmcnt(1)
    v_exp_f32 v65, v65
    v_mfma_f32_16x16x32_bf16 v[68:71], v[96:99], v[112:115], v[68:71]
    s_waitcnt lgkmcnt(0)
    s_barrier
    v_mfma_f32_16x16x32_bf16 v[68:71], v[100:103], v[116:119], v[68:71]
    ds_read_b128 v[88:91], v8 offset:2304
    v_cvt_pk_bf16_f32 v64, v64, v65
    v_smfmac_f32_16x16x64_bf16 v[80:83], v[48:51], v[192:199], v1
    ds_read_b128 v[92:95], v8 offset:2368
    buffer_load_dwordx4 v2, s[20:23], s51 offen offset:0 sc1 lds
    v_exp_f32 v66, v66
    v_smfmac_f32_16x16x64_bf16 v[80:83], v[52:55], v[208:215], v1
    ds_read_b128 v[96:99], v8 offset:2432
    v_exp_f32 v67, v67
    v_smfmac_f32_16x16x64_bf16 v[80:83], v[56:59], v[224:231], v1
    ds_read_b128 v[100:103], v8 offset:2496
    v_exp_f32 v68, v68
    v_smfmac_f32_16x16x64_bf16 v[80:83], v[60:63], v[240:247], v1
    buffer_load_dwordx4 v2, s[20:23], s51 offen offset:1024 sc1 lds
    s_waitcnt lgkmcnt(3)
    v_cvt_pk_bf16_f32 v65, v66, v67
    v_mfma_f32_16x16x32_bf16 v[72:75], v[88:91], v[104:107], 0
    s_waitcnt lgkmcnt(2)
    v_exp_f32 v69, v69
    v_mfma_f32_16x16x32_bf16 v[72:75], v[92:95], v[108:111], v[72:75]
    s_waitcnt lgkmcnt(1)
    v_exp_f32 v70, v70
    v_mfma_f32_16x16x32_bf16 v[72:75], v[96:99], v[112:115], v[72:75]
    s_waitcnt lgkmcnt(0)
    v_exp_f32 v71, v71
    v_mfma_f32_16x16x32_bf16 v[72:75], v[100:103], v[116:119], v[72:75]
    v_cvt_pk_bf16_f32 v66, v68, v69
    v_cvt_pk_bf16_f32 v67, v70, v71
    v_smfmac_f32_16x16x64_bf16 v[84:87], v[48:51], v[200:207], v1
    ds_read_b128 v[108:111], v4 offset:17408
    v_add_f32 v80, v80, v82
    v_mfma_f32_16x16x32_bf16 v[120:123], v[120:123], v[64:67], 0
    v_add_f32 v81, v81, v83
    v_mul_f32 v72, s58, v72
    v_mfma_f32_16x16x32_bf16 v[124:127], v[124:127], v[64:67], 0
    v_mul_f32 v73, s58, v73
    v_cvt_pk_bf16_f32 v20, v80, v81
    v_mfma_f32_16x16x32_bf16 v[76:79], v[16:19], v[64:67], 0
    ds_read_b64 v[22:23], v6 offset:2304
    v_smfmac_f32_16x16x64_bf16 v[84:87], v[52:55], v[216:223], v1
    ds_read_b128 v[40:43], v4 offset:8192
    v_exp_f32 v72, v72
    v_smfmac_f32_16x16x64_bf16 v[84:87], v[56:59], v[232:239], v1
    ds_read_b128 v[44:47], v4 offset:9216
    v_exp_f32 v73, v73
    v_smfmac_f32_16x16x64_bf16 v[84:87], v[60:63], v[248:255], v1
    ds_read_b128 v[104:107], v4 offset:16384
    v_cvt_pk_bf16_f32 v24, v72, v73
    v_cvt_pk_bf16_f32 v27, v72, v73
    s_nop 0
    v_mfma_f32_16x16x16_bf16 v[76:79], v[16:17], v[24:25], v[76:79]
    v_mfma_f32_16x16x16_bf16 v[120:123], v[20:21], v[24:25], v[120:123]
    v_add_f32 v84, v84, v86
    v_add_f32 v85, v85, v87
    v_cvt_pk_bf16_f32 v21, v84, v85
    s_nop 1
    v_mfma_f32_16x16x16_bf16 v[124:127], v[20:21], v[26:27], v[124:127]
CRJ_51:
    v_rcp_f32 v28, v76
    v_mov_b64 v[88:89], 0
    v_mul_f32 v120, v120, v28
    v_mul_f32 v122, v122, v28
    v_mul_f32 v121, v121, v28
    v_mul_f32 v123, v123, v28
    v_max_f32 v29, v28, v76
    s_nop 0
    v_mul_f32 v124, v124, v28
    v_mul_f32 v126, v126, v28
    v_cvt_pk_bf16_f32 v72, v120, v124
    v_cvt_pk_bf16_f32 v74, v122, v126
    v_mul_f32 v125, v125, v28
    v_mul_f32 v127, v127, v28
    v_cndmask_b32 v76, v72, v74, s[66:67]
    v_cvt_pk_bf16_f32 v73, v121, v125
    v_cvt_pk_bf16_f32 v75, v123, v127
    v_cndmask_b32 v77, v73, v75, s[66:67]
    ds_write_b64 v6, v[76:77] offset:4608
    v_cmp_nle_f32 vcc, v29, s63
    v_mov_b64 v[90:91], 0
    v_mov_b64 v[92:93], 0
    v_mov_b64 v[94:95], 0
    v_add_u32 v0, s42, v8
    s_cbranch_vccnz CFB_50
CRJ2_52:
    s_waitcnt lgkmcnt(1)
    v_smfmac_f32_16x16x64_bf16 v[88:91], v[72:75], v[32:39], v1
    v_mov_b64 v[96:97], 0
    v_mov_b64 v[98:99], 0
    v_smfmac_f32_16x16x64_bf16 v[92:95], v[72:75], v[40:47], v1
    v_mov_b64 v[100:101], 0
    v_mov_b64 v[102:103], 0
    s_waitcnt lgkmcnt(0)
    s_barrier
    ds_read_b128 v[76:79], v7 offset:4608
    v_smfmac_f32_16x16x64_bf16 v[96:99], v[72:75], v[104:111], v1
    ds_read_b128 v[80:83], v9 offset:4608
    ds_read_b128 v[84:87], v0 offset:4608
    v_smfmac_f32_16x16x64_bf16 v[100:103], v[72:75], a[8:15], v1
    ds_read_b128 v[48:51], v4 offset:18432
    ds_read_b128 v[52:55], v4 offset:19456
    s_waitcnt lgkmcnt(4)
    v_smfmac_f32_16x16x64_bf16 v[88:91], v[76:79], a[24:31], v1
    s_waitcnt lgkmcnt(3)
    ds_read_b128 v[56:59], v4 offset:20480
    v_smfmac_f32_16x16x64_bf16 v[88:91], v[80:83], v[136:143], v1
    s_waitcnt lgkmcnt(3)
    ds_read_b128 v[60:63], v4 offset:21504
    v_smfmac_f32_16x16x64_bf16 v[88:91], v[84:87], a[96:103], v1
    ds_read_b128 v[112:115], v4 offset:22528
    v_smfmac_f32_16x16x64_bf16 v[92:95], v[76:79], a[104:111], v1
    ds_read_b128 v[116:119], v4 offset:23552
    v_smfmac_f32_16x16x64_bf16 v[92:95], v[80:83], a[112:119], v1
    ds_read_b128 v[64:67], v4 offset:26624
    v_cvt_pk_bf16_f32 v88, v88, v90
    v_smfmac_f32_16x16x64_bf16 v[92:95], v[84:87], a[120:127], v1
    s_waitcnt lgkmcnt(5)
    ds_read_b128 v[68:71], v4 offset:27648
    v_cmp_eq_u32 vcc, v88, v12
    v_smfmac_f32_16x16x64_bf16 v[96:99], v[76:79], v[48:55], v1
    s_waitcnt lgkmcnt(4)
    ds_read_b128 v[120:123], v4 offset:28672
    v_cvt_pk_bf16_f32 v89, v89, v91
    v_addc_co_u32 v88, vcc, 0, v88, vcc
    v_smfmac_f32_16x16x64_bf16 v[96:99], v[80:83], v[56:63], v1
    s_waitcnt lgkmcnt(3)
    ds_read_b128 v[124:127], v4 offset:29696
    v_cvt_pk_bf16_f32 v90, v92, v94
    v_cvt_pk_bf16_f32 v91, v93, v95
    v_smfmac_f32_16x16x64_bf16 v[96:99], v[84:87], v[112:119], v1
    buffer_store_dwordx4 v[88:91], v10, s[20:23], 0 offen sc1
    s_waitcnt lgkmcnt(2)
    v_smfmac_f32_16x16x64_bf16 v[100:103], v[76:79], v[64:71], v1
    ds_read_b128 v[32:35], v4 offset:30720
    ds_read_b128 v[36:39], v4 offset:31744
    s_waitcnt lgkmcnt(2)
    v_smfmac_f32_16x16x64_bf16 v[100:103], v[80:83], v[120:127], v1
    s_waitcnt lgkmcnt(0)
    v_cvt_pk_bf16_f32 v96, v96, v98
    v_smfmac_f32_16x16x64_bf16 v[100:103], v[84:87], v[32:39], v1
    ds_read_b128 v[56:59], v2 offset:31488
    v_cvt_pk_bf16_f32 v97, v97, v99
    v_cmp_eq_u32 vcc, v96, v13
    s_add_u32 s34, s34, 1
    s_mov_b32 s46, s47
    v_addc_co_u32 v96, vcc, 0, v96, vcc
    s_mov_b32 s47, s48
    s_add_u32 s48, s48, 8192
    v_cvt_pk_bf16_f32 v98, v100, v102
    v_cvt_pk_bf16_f32 v99, v101, v103
    buffer_store_dwordx4 v[96:99], v10, s[20:23], s41 offen sc1
    v_mov_b32 v12, v88
    v_mov_b32 v13, v96
    ds_read_b128 v[40:43], v4 offset:24576
    s_and_b32 s48, s48, 0x7fff
    s_lshl_b32 s54, s34, 17
    ds_read_b128 v[44:47], v4 offset:25600
    s_add_u32 s54, s54, s56
    s_add_u32 s54, s54, 0x48c0000
    ds_read_b128 v[48:51], v4 offset:2048
    s_add_u32 s51, s51, 0x40000
    s_add_u32 s52, s52, 0x40000
    ds_read_b128 v[52:55], v4 offset:3072
    s_add_u32 s50, s46, s49
    s_mov_b32 s40, 0
    ds_read_b128 v[88:91], v4 offset:6144
    s_sub_u32 s44, s34, 1
    s_and_b32 s55, s34, 3
    ds_read_b128 v[92:95], v4 offset:7168
    s_cselect_b32 s55, 0, 1
    s_cmp_ge_u32 s34, 56
    ds_read_b128 v[96:99], v4 offset:10240
    s_cselect_b32 s55, 1, s55
    s_cmp_ge_u32 s34, 63
    ds_read_b128 v[100:103], v4 offset:11264
    s_cselect_b32 s51, 0x40000000, s51
    s_cselect_b32 s52, 0x40000000, s52
    ds_read_b128 v[104:107], v4 offset:12288
    v_mov_b64 v[64:65], 0
    v_mov_b64 v[66:67], 0
    ds_read_b128 v[108:111], v4 offset:13312
    v_mov_b64 v[68:69], 0
    v_mov_b64 v[70:71], 0
    ds_read_b128 v[112:115], v4 offset:14336
    v_mov_b64 v[72:73], 0
    buffer_load_dwordx4 v[32:35], v2, s[20:23], s45 offen offset:0 sc1
    buffer_load_dwordx4 v[36:39], v2, s[20:23], s45 offen offset:1024 sc1
    v_mov_b64 v[74:75], 0
    ds_read_b128 v[116:119], v4 offset:15360
    v_mov_b64 v[76:77], 0
    v_mov_b64 v[78:79], 0
    v_mov_b64 v[80:81], 0
    v_mov_b64 v[82:83], 0
    v_mov_b64 v[84:85], 0
    v_mov_b64 v[86:87], 0
    s_nop 15
    s_nop 3
CP1_53:
    s_nop 0
    buffer_load_dwordx4 v[120:123], v2, s[20:23], s45 offen offset:0 sc1
    buffer_load_dwordx4 v[124:127], v2, s[20:23], s45 offen offset:1024 sc1
    s_waitcnt vmcnt(3) lgkmcnt(0)
    v_mfma_f32_16x16x32_bf16 v[60:63], v[56:59], v[32:35], 0
    v_cmp_eq_u32 s[38:39], v32, v14
    s_waitcnt vmcnt(2)
    v_mfma_f32_16x16x32_bf16 v[60:63], v[56:59], v[36:39], v[60:63]
    v_cmp_eq_u32 vcc, v36, v15
    v_mov_b32 v29, -1
    s_or_b64 vcc, vcc, s[38:39]
    s_cbranch_vccnz CB1_54
    s_nop 2
    s_nop 0
    v_add_f32_dpp v60, v60, v60 row_ror:8 row_mask:0xf bank_mask:0xf
    v_add_f32_dpp v61, v61, v61 row_ror:8 row_mask:0xf bank_mask:0xf
    s_nop 0
    v_add_f32_dpp v60, v60, v60 row_ror:4 row_mask:0xf bank_mask:0xf
    v_add_f32_dpp v61, v61, v61 row_ror:4 row_mask:0xf bank_mask:0xf
    v_cvt_pk_bf16_f32 v0, v60, v61
    v_min_u32 v0, s59, v0
    buffer_store_dword v0, v11, s[20:23], s46 offen sc1
    v_mov_b32 v14, v32
    v_mov_b32 v15, v36
    s_branch CJN_55
CB1_54:
    s_add_u32 s40, s40, 1
    s_cmp_gt_u32 s40, 0x40000
    s_cbranch_scc1 CABORT_35
    buffer_load_dwordx4 v[32:35], v2, s[20:23], s45 offen offset:0 sc1
    buffer_load_dwordx4 v[36:39], v2, s[20:23], s45 offen offset:1024 sc1
    s_waitcnt vmcnt(3) lgkmcnt(0)
    v_mfma_f32_16x16x32_bf16 v[60:63], v[56:59], v[120:123], 0
    v_cmp_eq_u32 s[38:39], v120, v14
    s_waitcnt vmcnt(2)
    v_mfma_f32_16x16x32_bf16 v[60:63], v[56:59], v[124:127], v[60:63]
    v_cmp_eq_u32 vcc, v124, v15
    v_mov_b32 v29, -1
    s_or_b64 vcc, vcc, s[38:39]
    s_cbranch_vccnz CP1_53
    s_nop 2
    s_nop 0
    v_add_f32_dpp v60, v60, v60 row_ror:8 row_mask:0xf bank_mask:0xf
    v_add_f32_dpp v61, v61, v61 row_ror:8 row_mask:0xf bank_mask:0xf
    s_nop 0
    v_add_f32_dpp v60, v60, v60 row_ror:4 row_mask:0xf bank_mask:0xf
    v_add_f32_dpp v61, v61, v61 row_ror:4 row_mask:0xf bank_mask:0xf
    v_cvt_pk_bf16_f32 v0, v60, v61
    v_min_u32 v0, s59, v0
    buffer_store_dword v0, v11, s[20:23], s46 offen sc1
    v_mov_b32 v14, v120
    v_mov_b32 v15, v124
CJN_55:
    s_mov_b32 s40, 0
    buffer_store_dword v29, v11, s[20:23], s48 offen sc1
    ds_read_b128 v[56:59], v4 offset:4096
    ds_read_b128 v[60:63], v4 offset:5120
    s_waitcnt vmcnt(2)
    s_cmp_ge_u32 s43, 128
    s_cbranch_scc1 CKVS_58
    v_bfe_u32 v28, v2, 5, 2
    v_lshl_add_u32 v30, v30, 2, v28
    s_nop 1
    v_min_u32_dpp v30, v30, v30 row_ror:8 row_mask:0xf bank_mask:0xf
    s_nop 1
    v_min_u32_dpp v30, v30, v30 row_ror:4 row_mask:0xf bank_mask:0xf
    s_nop 1
    v_min_u32_dpp v30, v30, v30 row_ror:2 row_mask:0xf bank_mask:0xf
    s_nop 1
    v_min_u32_dpp v30, v30, v30 row_ror:1 row_mask:0xf bank_mask:0xf
    s_nop 0
    v_readfirstlane_b32 s38, v30
    s_nop 0
    s_lshl_b32 s38, s38, 1
    s_max_u32 s43, s43, s38
    s_cmp_ge_u32 s43, 64
    s_cselect_b32 s43, 128, s43
    s_cselect_b32 s53, 0x40000000, s53
    s_add_u32 s37, s34, 1
    s_cmp_lt_u32 s37, s43
    s_cbranch_scc1 CKVOK_57
    s_mov_b32 s40, 0
CKV_56:
    v_bfe_u32 v28, v2, 4, 4
    v_mul_u32_u24 v28, 1092, v28
    v_and_b32 v28, 0x2184, v28
    buffer_load_dword v30, v28, s[20:23], s53 offen sc1
    s_add_u32 s40, s40, 1
    s_cmp_gt_u32 s40, 0x40000
    s_cbranch_scc1 CABORT_35
    s_waitcnt vmcnt(0)
    v_bfe_u32 v28, v2, 5, 2
    v_lshl_add_u32 v30, v30, 2, v28
    s_nop 1
    v_min_u32_dpp v30, v30, v30 row_ror:8 row_mask:0xf bank_mask:0xf
    s_nop 1
    v_min_u32_dpp v30, v30, v30 row_ror:4 row_mask:0xf bank_mask:0xf
    s_nop 1
    v_min_u32_dpp v30, v30, v30 row_ror:2 row_mask:0xf bank_mask:0xf
    s_nop 1
    v_min_u32_dpp v30, v30, v30 row_ror:1 row_mask:0xf bank_mask:0xf
    s_nop 0
    v_readfirstlane_b32 s38, v30
    s_nop 0
    s_lshl_b32 s38, s38, 1
    s_max_u32 s43, s43, s38
    s_cmp_ge_u32 s43, 64
    s_cselect_b32 s43, 128, s43
    s_cselect_b32 s53, 0x40000000, s53
    s_cmp_lt_u32 s37, s43
    s_cbranch_scc0 CKV_56
    s_mov_b32 s40, 0
    s_branch CKVOK_57
CKVS_58:
    s_nop 15
    s_nop 11
CKVOK_57:
    s_add_u32 s37, s34, 5
    s_cmp_ge_u32 s37, s43
    s_cselect_b32 s87, s53, 0x40000000
    s_branch CTOP_41
CREDO_43:
CRD_59:
    buffer_load_dwordx4 v[32:35], v2, s[20:23], s50 offen offset:0 sc1
    buffer_load_dwordx4 v[36:39], v2, s[20:23], s50 offen offset:1024 sc1
    s_waitcnt vmcnt(2)
    v_max3_u32 v29, v120, v121, v122
    v_max3_u32 v29, v29, v123, v124
    v_max3_u32 v29, v29, v125, v126
    v_max_u32 v29, v29, v127
    v_cmp_eq_u32 vcc, -1, v29
    v_mov_b64 v[64:65], 0
    v_mov_b64 v[66:67], 0
    v_mov_b64 v[68:69], 0
    v_mov_b64 v[70:71], 0
    s_cbranch_vccz CGB_60
    buffer_load_dwordx4 v[120:123], v2, s[20:23], s50 offen offset:0 sc1
    buffer_load_dwordx4 v[124:127], v2, s[20:23], s50 offen offset:1024 sc1
    s_waitcnt vmcnt(2)
    v_max3_u32 v29, v32, v33, v34
    v_max3_u32 v29, v29, v35, v36
    v_max3_u32 v29, v29, v37, v38
    v_max_u32 v29, v29, v39
    v_cmp_eq_u32 vcc, -1, v29
    s_add_u32 s40, s40, 1
    s_cmp_gt_u32 s40, 0x40000
    s_cbranch_scc1 CABORT_35
    s_cbranch_vccnz CRD_59
CGOT_42:
    s_waitcnt lgkmcnt(0)
    v_smfmac_f32_16x16x64_bf16 v[64:67], v[32:35], a[0:7], v1
    ds_write_b128 v3, v[32:35] offset:16384
    v_smfmac_f32_16x16x64_bf16 v[68:71], v[32:35], v[40:47], v1
    ds_write_b128 v3, v[36:39] offset:17408
    v_smfmac_f32_16x16x64_bf16 v[64:67], v[36:39], a[16:23], v1
    v_smfmac_f32_16x16x64_bf16 v[68:71], v[36:39], v[48:55], v1
    v_xor_b32 v0, 0x800, v3
    v_smfmac_f32_16x16x64_bf16 v[80:83], v[32:35], v[128:135], v1
    s_mov_b32 m0, s61
    s_cmp_eq_u32 s34, 63
    v_xor_b32 v28, 0x1000, v3
    v_smfmac_f32_16x16x64_bf16 v[84:87], v[32:35], v[56:63], v1
    s_waitcnt lgkmcnt(0)
    s_barrier
    v_smfmac_f32_16x16x64_bf16 v[80:83], v[36:39], v[144:151], v1
    ds_read_b128 v[40:43], v0 offset:16384
    v_xor_b32 v30, 0x1800, v3
    v_smfmac_f32_16x16x64_bf16 v[84:87], v[36:39], v[152:159], v1
    ds_read_b128 v[44:47], v0 offset:17408
    v_smfmac_f32_16x16x64_bf16 v[72:75], v[32:35], a[128:135], v1
    ds_read_b128 v[48:51], v28 offset:16384
    v_smfmac_f32_16x16x64_bf16 v[76:79], v[32:35], a[136:143], v1
    ds_read_b128 v[52:55], v28 offset:17408
    v_smfmac_f32_16x16x64_bf16 v[72:75], v[36:39], a[144:151], v1
    ds_read_b128 v[56:59], v30 offset:16384
    v_smfmac_f32_16x16x64_bf16 v[76:79], v[36:39], a[152:159], v1
    ds_read_b128 v[60:63], v30 offset:17408
    s_waitcnt lgkmcnt(5)
    s_branch COWN_44
CGB_60:
    ds_write_b128 v3, v[120:123] offset:16384
    ds_write_b128 v3, v[124:127] offset:17408
    v_smfmac_f32_16x16x64_bf16 v[64:67], v[120:123], a[0:7], v1
    v_smfmac_f32_16x16x64_bf16 v[68:71], v[120:123], v[40:47], v1
    v_smfmac_f32_16x16x64_bf16 v[64:67], v[124:127], a[16:23], v1
    v_smfmac_f32_16x16x64_bf16 v[68:71], v[124:127], v[48:55], v1
    v_xor_b32 v0, 0x800, v3
    v_smfmac_f32_16x16x64_bf16 v[80:83], v[120:123], v[128:135], v1
    s_mov_b32 m0, s61
    s_cmp_eq_u32 s34, 63
    v_xor_b32 v28, 0x1000, v3
    v_smfmac_f32_16x16x64_bf16 v[84:87], v[120:123], v[56:63], v1
    s_waitcnt lgkmcnt(0)
    s_barrier
    v_smfmac_f32_16x16x64_bf16 v[80:83], v[124:127], v[144:151], v1
    ds_read_b128 v[40:43], v0 offset:16384
    v_xor_b32 v30, 0x1800, v3
    v_smfmac_f32_16x16x64_bf16 v[84:87], v[124:127], v[152:159], v1
    ds_read_b128 v[44:47], v0 offset:17408
    v_smfmac_f32_16x16x64_bf16 v[72:75], v[120:123], a[128:135], v1
    ds_read_b128 v[48:51], v28 offset:16384
    v_smfmac_f32_16x16x64_bf16 v[76:79], v[120:123], a[136:143], v1
    ds_read_b128 v[52:55], v28 offset:17408
    v_smfmac_f32_16x16x64_bf16 v[72:75], v[124:127], a[144:151], v1
    ds_read_b128 v[56:59], v30 offset:16384
    v_smfmac_f32_16x16x64_bf16 v[76:79], v[124:127], a[152:159], v1
    ds_read_b128 v[60:63], v30 offset:17408
    s_waitcnt lgkmcnt(5)
    s_branch COWN_44
CFB_50:
    s_lshl_b32 s37, s34, 18
    s_lshl_b32 s38, s32, 13
    s_add_u32 s37, s37, s38
    s_add_u32 s38, s37, 0x10e0000
    s_add_u32 s37, s37, 0xe0000
    s_waitcnt lgkmcnt(0)
    buffer_load_dwordx4 v[88:91], v2, s[20:23], s37 offen offset:0 sc1
    buffer_load_dwordx4 v[92:95], v2, s[20:23], s37 offen offset:1024 sc1
    buffer_load_dwordx4 v[96:99], v2, s[20:23], s37 offen offset:2048 sc1
    buffer_load_dwordx4 v[100:103], v2, s[20:23], s37 offen offset:3072 sc1
    s_add_u32 s37, s37, 4096
    buffer_load_dwordx4 v[104:107], v2, s[20:23], s37 offen offset:0 sc1
    buffer_load_dwordx4 v[108:111], v2, s[20:23], s37 offen offset:1024 sc1
    buffer_load_dwordx4 v[112:115], v2, s[20:23], s37 offen offset:2048 sc1
    buffer_load_dwordx4 v[116:119], v2, s[20:23], s37 offen offset:3072 sc1
    s_lshl_b32 s39, s33, 11
    s_add_u32 s38, s38, s39
    buffer_load_dwordx4 v[120:123], v2, s[20:23], s38 offen offset:0 sc1
    buffer_load_dwordx4 v[124:127], v2, s[20:23], s38 offen offset:1024 sc1
    ds_read_b128 v[48:51], v8 offset:0
    ds_read_b128 v[52:55], v8 offset:64
    ds_read_b128 v[56:59], v8 offset:128
    ds_read_b128 v[60:63], v8 offset:192
    s_waitcnt vmcnt(0) lgkmcnt(0)
    v_mfma_f32_16x16x32_bf16 v[64:67], v[88:91], v[48:51], 0
    v_mfma_f32_16x16x32_bf16 v[68:71], v[104:107], v[48:51], 0
    v_mfma_f32_16x16x32_bf16 v[64:67], v[92:95], v[52:55], v[64:67]
    v_mfma_f32_16x16x32_bf16 v[68:71], v[108:111], v[52:55], v[68:71]
    v_mfma_f32_16x16x32_bf16 v[64:67], v[96:99], v[56:59], v[64:67]
    v_mfma_f32_16x16x32_bf16 v[68:71], v[112:115], v[56:59], v[68:71]
    v_mfma_f32_16x16x32_bf16 v[64:67], v[100:103], v[60:63], v[64:67]
    v_mfma_f32_16x16x32_bf16 v[68:71], v[116:119], v[60:63], v[68:71]
    ds_read_b128 v[88:91], v8 offset:2304
    ds_read_b128 v[92:95], v8 offset:2368
    ds_read_b128 v[96:99], v8 offset:2432
    ds_read_b128 v[100:103], v8 offset:2496
    s_waitcnt lgkmcnt(0)
    v_mfma_f32_16x16x32_bf16 v[72:75], v[88:91], v[48:51], 0
    v_mfma_f32_16x16x32_bf16 v[72:75], v[92:95], v[52:55], v[72:75]
    v_mfma_f32_16x16x32_bf16 v[72:75], v[96:99], v[56:59], v[72:75]
    v_mfma_f32_16x16x32_bf16 v[72:75], v[100:103], v[60:63], v[72:75]
    s_nop 7
    v_mul_f32 v72, s58, v72
    v_mul_f32 v73, s58, v73
    v_max3_f32 v28, v64, v65, v66
    v_max3_f32 v28, v28, v67, v68
    v_max3_f32 v28, v28, v69, v70
    v_max3_f32 v28, v28, v71, v72
    v_max_f32 v28, v28, v73
    v_mov_b32 v29, v28
    s_nop 1
    v_permlane32_swap_b32 v28, v29
    v_max_f32 v28, v28, v29
    v_mov_b32 v29, v28
    s_nop 1
    v_permlane16_swap_b32 v28, v29
    v_max_f32 v28, v28, v29
    v_sub_f32 v64, v64, v28
    v_exp_f32 v64, v64
    v_sub_f32 v65, v65, v28
    v_exp_f32 v65, v65
    v_sub_f32 v66, v66, v28
    v_exp_f32 v66, v66
    v_sub_f32 v67, v67, v28
    v_exp_f32 v67, v67
    v_sub_f32 v68, v68, v28
    v_exp_f32 v68, v68
    v_sub_f32 v69, v69, v28
    v_exp_f32 v69, v69
    v_sub_f32 v70, v70, v28
    v_exp_f32 v70, v70
    v_sub_f32 v71, v71, v28
    v_exp_f32 v71, v71
    v_sub_f32 v72, v72, v28
    v_exp_f32 v72, v72
    v_sub_f32 v73, v73, v28
    v_exp_f32 v73, v73
    v_cvt_pk_bf16_f32 v64, v64, v65
    v_cvt_pk_bf16_f32 v65, v66, v67
    v_cvt_pk_bf16_f32 v66, v68, v69
    v_cvt_pk_bf16_f32 v67, v70, v71
    v_cvt_pk_bf16_f32 v24, v72, v73
    v_cvt_pk_bf16_f32 v27, v72, v73
    v_mfma_f32_16x16x32_bf16 v[120:123], v[120:123], v[64:67], 0
    v_mfma_f32_16x16x32_bf16 v[124:127], v[124:127], v[64:67], 0
    v_mfma_f32_16x16x32_bf16 v[76:79], v[16:19], v[64:67], 0
    s_nop 5
    v_mfma_f32_16x16x16_bf16 v[76:79], v[16:17], v[24:25], v[76:79]
    v_mfma_f32_16x16x16_bf16 v[120:123], v[20:21], v[24:25], v[120:123]
    v_mfma_f32_16x16x16_bf16 v[124:127], v[20:21], v[26:27], v[124:127]
    ds_read_b128 v[104:107], v4 offset:16384
    ds_read_b128 v[108:111], v4 offset:17408
    s_nop 7
    v_rcp_f32 v28, v76
    v_mov_b64 v[88:89], 0
    v_mul_f32 v120, v120, v28
    v_mul_f32 v122, v122, v28
    v_mul_f32 v121, v121, v28
    v_mul_f32 v123, v123, v28
    v_max_f32 v29, v28, v76
    v_mul_f32 v124, v124, v28
    v_mul_f32 v126, v126, v28
    v_cvt_pk_bf16_f32 v72, v120, v124
    v_cvt_pk_bf16_f32 v74, v122, v126
    v_mul_f32 v125, v125, v28
    v_mul_f32 v127, v127, v28
    v_cndmask_b32 v76, v72, v74, s[66:67]
    v_cvt_pk_bf16_f32 v73, v121, v125
    v_cvt_pk_bf16_f32 v75, v123, v127
    v_cndmask_b32 v77, v73, v75, s[66:67]
    ds_write_b64 v6, v[76:77] offset:4608
    v_mov_b64 v[90:91], 0
    v_mov_b64 v[92:93], 0
    v_mov_b64 v[94:95], 0
    s_waitcnt lgkmcnt(0)
    s_branch CRJ2_52
CFIN_45:
    v_mov_b32 v29, s44
    buffer_store_dword v29, v31, s[20:23], 0 offen sc1
    v_add_u32 v0, 2304, v5
    buffer_store_dwordx4 v[20:23], v2, s[20:23], s54 offen sc1
    s_lshl_b32 s54, s34, 17
    s_add_u32 s54, s54, s56
    s_add_u32 s54, s54, 0x48e0000
    v_smfmac_f32_16x16x64_bf16 v[72:75], v[40:43], a[160:167], v1
    s_waitcnt lgkmcnt(4)
    v_smfmac_f32_16x16x64_bf16 v[76:79], v[40:43], a[168:175], v1
    v_smfmac_f32_16x16x64_bf16 v[72:75], v[44:47], a[176:183], v1
    s_waitcnt lgkmcnt(3)
    v_smfmac_f32_16x16x64_bf16 v[76:79], v[44:47], a[184:191], v1
    v_smfmac_f32_16x16x64_bf16 v[72:75], v[48:51], a[192:199], v1
    s_waitcnt lgkmcnt(2)
    v_smfmac_f32_16x16x64_bf16 v[76:79], v[48:51], a[200:207], v1
    v_smfmac_f32_16x16x64_bf16 v[72:75], v[52:55], a[208:215], v1
    s_waitcnt lgkmcnt(1)
    v_smfmac_f32_16x16x64_bf16 v[76:79], v[52:55], a[216:223], v1
    v_smfmac_f32_16x16x64_bf16 v[72:75], v[56:59], a[224:231], v1
    s_waitcnt lgkmcnt(0)
    v_smfmac_f32_16x16x64_bf16 v[76:79], v[56:59], a[232:239], v1
    v_smfmac_f32_16x16x64_bf16 v[72:75], v[60:63], a[240:247], v1
    v_smfmac_f32_16x16x64_bf16 v[76:79], v[60:63], a[248:255], v1
    v_smfmac_f32_16x16x64_bf16 v[80:83], v[40:43], v[160:167], v1
    v_add_f32 v72, v72, v74
    v_smfmac_f32_16x16x64_bf16 v[80:83], v[44:47], v[176:183], v1
    v_add_f32 v73, v73, v75
    v_add_f32 v76, v76, v78
    v_smfmac_f32_16x16x64_bf16 v[80:83], v[48:51], v[192:199], v1
    v_add_f32 v77, v77, v79
    v_cvt_pk_bf16_f32 v74, v72, v76
    v_smfmac_f32_16x16x64_bf16 v[80:83], v[52:55], v[208:215], v1
    v_cvt_pk_bf16_f32 v75, v73, v77
    v_smfmac_f32_16x16x64_bf16 v[80:83], v[56:59], v[224:231], v1
    ds_write2_b32 v0, v74, v75 offset0:0 offset1:72
    v_smfmac_f32_16x16x64_bf16 v[80:83], v[60:63], v[240:247], v1
    ds_read_b64 v[22:23], v6 offset:2304
    v_smfmac_f32_16x16x64_bf16 v[84:87], v[40:43], v[168:175], v1
    v_smfmac_f32_16x16x64_bf16 v[84:87], v[44:47], v[184:191], v1
    v_add_f32 v80, v80, v82
    v_smfmac_f32_16x16x64_bf16 v[84:87], v[48:51], v[200:207], v1
    v_smfmac_f32_16x16x64_bf16 v[84:87], v[52:55], v[216:223], v1
    v_add_f32 v81, v81, v83
    v_smfmac_f32_16x16x64_bf16 v[84:87], v[56:59], v[232:239], v1
    v_cvt_pk_bf16_f32 v20, v80, v81
    v_smfmac_f32_16x16x64_bf16 v[84:87], v[60:63], v[248:255], v1
    s_waitcnt lgkmcnt(0)
    s_nop 6
    v_add_f32 v84, v84, v86
    v_add_f32 v85, v85, v87
    v_cvt_pk_bf16_f32 v21, v84, v85
    buffer_store_dwordx4 v[20:23], v2, s[20:23], s54 offen sc1
    v_mov_b32 v29, 63
    s_waitcnt vmcnt(1)
    buffer_store_dword v29, v31, s[20:23], 0 offen sc1
    s_nop 0
    s_waitcnt vmcnt(1)
    v_mov_b32 v29, 64
    buffer_store_dword v29, v31, s[20:23], 0 offen sc1
CABORT_35:
    s_branch KEND2
KEND2:
    s_endpgm
WORK:
    s_sub_u32 s20, s64, 1
    s_lshl_b32 s20, s20, 3
    s_lshr_b32 s30, s65, 2
    s_add_u32 s20, s20, s30
    s_and_b32 s21, s65, 3
    s_lshr_b32 s25, s20, 4
    s_mov_b32 s30, 24
    s_cmp_eq_u32 s25, 1
    s_cselect_b32 s30, 32, s30
    s_cmp_eq_u32 s25, 2
    s_cselect_b32 s30, 16, s30
    s_cmp_eq_u32 s25, 3
    s_cselect_b32 s30, 64, s30
    s_load_dwordx2 s[4:5], s[0:1], s30
    s_load_dwordx2 s[8:9], s[0:1], 0
    s_load_dwordx2 s[12:13], s[0:1], 120
    s_load_dwordx2 s[16:17], s[0:1], 72
    v_lshrrev_b32 v21, 6, v0
    v_and_b32 v1, 63, v0
    v_readfirstlane_b32 s22, v21
    s_mov_b32 s26, 0x5040100
    s_mov_b32 s27, 0x7060302
    s_cmp_eq_u32 s25, 3
    s_mov_b32 s23, 0x2000
    s_cselect_b32 s23, 0xac0, s23
    s_mov_b32 s31, 0x400000
    s_cselect_b32 s31, 0x158000, s31
    s_waitcnt lgkmcnt(0)
    s_and_b32 s5, s5, 0xffff
    s_mov_b32 s6, s31
    s_mov_b32 s7, 0x20000
    s_and_b32 s9, s9, 0xffff
    s_mov_b32 s10, 0x200000
    s_mov_b32 s11, 0x20000
    s_and_b32 s13, s13, 0xffff
    s_mov_b32 s14, 0x10000000
    s_mov_b32 s15, 0x20000
    s_and_b32 s17, s17, 0xffff
    s_mov_b32 s18, 0xac0
    s_mov_b32 s19, 0x20000
    s_cmp_lt_u32 s25, 2
    s_cbranch_scc1 WARM_61
    s_sub_u32 s30, s20, 32
    s_lshl_b32 s30, s30, 2
    s_add_u32 s30, s30, s21
    s_lshl_b32 s30, s30, 2
    s_add_u32 s30, s30, s22
    s_mul_i32 s30, s30, 11008
    s_add_u32 s31, s30, 8192
    v_lshlrev_b32 v247, 7, v1
    s_load_dwordx2 s[44:45], s[0:1], 40
    s_load_dwordx2 s[48:49], s[0:1], 24
    s_waitcnt lgkmcnt(0)
    s_and_b32 s45, s45, 0xffff
    s_mov_b32 s46, 0x400000
    s_mov_b32 s47, 0x20000
    buffer_load_dword v248, v247, s[44:47], s30 offen
    s_mov_b64 exec, 0x3fffff
    buffer_load_dword v249, v247, s[44:47], s31 offen
    s_mov_b64 exec, -1
    s_and_b32 s49, s49, 0xffff
    s_mov_b32 s50, 0x400000
    s_mov_b32 s51, 0x20000
    buffer_load_dword v250, v247, s[48:51], s30 offen
    s_mov_b64 exec, 0x3fffff
    buffer_load_dword v251, v247, s[48:51], s31 offen
    s_mov_b64 exec, -1
    s_waitcnt vmcnt(4)
    s_or_b32 s92, s91, s22
    s_or_b32 s92, s92, s88
    s_cbranch_scc1 REP_62
    s_load_dwordx2 s[40:41], s[0:1], 112
    s_waitcnt lgkmcnt(0)
    s_and_b32 s41, s41, 0xffff
    s_mov_b32 s42, 0x100
    s_mov_b32 s43, 0x20000
    s_and_b32 s92, s64, 3
    s_lshl_b32 s92, s92, 6
    s_and_b32 s93, s64, 4
    s_lshl_b32 s93, s93, 1
    s_add_u32 s92, s92, s93
    v_mov_b32 v59, s92
    s_lshr_b32 s93, s2, 3
    s_lshl_b32 s93, 1, s93
    v_mov_b32 v60, 1
    v_mov_b32 v61, s93
    s_mov_b64 exec, 1
    buffer_atomic_add_x2 v[60:61], v59, s[40:43], 0 offen
    s_mov_b64 exec, -1
REP_62:
    s_waitcnt vmcnt(0)
    s_mov_b32 s88, 1
WARM_61:
    s_lshl_b32 s30, s64, 5
    s_add_u32 s30, s30, s65
    s_lshl_b32 s30, s30, 5
    s_add_u32 s30, s30, s22
    s_lshl_b32 s30, s30, 2
    s_add_u32 s30, s30, 0
    v_cmp_eq_u32 vcc, 0, v1
    v_mov_b32 v240, 0x40000000
    v_mov_b32 v241, s30
    v_cndmask_b32 v240, v240, v241, vcc
    s_cmp_lt_u32 s20, 54
    s_cbranch_scc1 P1NG_63
    s_waitcnt vmcnt(0)
    s_or_b32 s92, s91, s22
    s_or_b32 s92, s92, s88
    s_cbranch_scc1 REP_64
    s_load_dwordx2 s[40:41], s[0:1], 112
    s_waitcnt lgkmcnt(0)
    s_and_b32 s41, s41, 0xffff
    s_mov_b32 s42, 0x100
    s_mov_b32 s43, 0x20000
    s_and_b32 s92, s64, 3
    s_lshl_b32 s92, s92, 6
    s_and_b32 s93, s64, 4
    s_lshl_b32 s93, s93, 1
    s_add_u32 s92, s92, s93
    v_mov_b32 v2, s92
    s_lshr_b32 s93, s2, 3
    s_lshl_b32 s93, 1, s93
    v_mov_b32 v4, 1
    v_mov_b32 v5, s93
    s_mov_b64 exec, 1
    buffer_atomic_add_x2 v[4:5], v2, s[40:43], 0 offen
    s_mov_b64 exec, -1
REP_64:
    s_cmp_lg_u32 s91, 0
    s_cbranch_scc1 VEROK_66
    s_load_dwordx2 s[40:41], s[0:1], 112
    v_and_b32 v2, 63, v0
    v_lshlrev_b32 v2, 2, v2
    s_mov_b32 s31, 0
    s_waitcnt lgkmcnt(0)
    s_and_b32 s41, s41, 0xffff
    s_mov_b32 s42, 0x100
    s_mov_b32 s43, 0x20000
VER_65:
    buffer_load_dword v3, v2, s[40:43], 0 offen sc1
    s_add_u32 s31, s31, 1
    s_cmp_gt_u32 s31, 0x40000
    s_cbranch_scc1 KABORT
    s_waitcnt vmcnt(0)
    v_readlane_b32 s30, v3, 0
    v_readlane_b32 s44, v3, 2
    s_nop 0
    s_add_u32 s30, s30, s44
    v_readlane_b32 s44, v3, 16
    s_nop 0
    s_add_u32 s30, s30, s44
    v_readlane_b32 s44, v3, 18
    s_nop 0
    s_add_u32 s30, s30, s44
    v_readlane_b32 s44, v3, 32
    s_nop 0
    s_add_u32 s30, s30, s44
    v_readlane_b32 s44, v3, 34
    s_nop 0
    s_add_u32 s30, s30, s44
    v_readlane_b32 s44, v3, 48
    s_nop 0
    s_add_u32 s30, s30, s44
    v_readlane_b32 s44, v3, 50
    s_nop 0
    s_add_u32 s30, s30, s44
    s_cmp_lt_u32 s30, 256
    s_cbranch_scc1 VER_65
    v_cmp_eq_u32 vcc, 32, v3
    s_nop 0
    s_and_b32 s30, vcc_lo, vcc_hi
    s_and_b32 s30, s30, 0x50005
    s_cmp_lg_u32 s30, 0x50005
    s_cbranch_scc1 KSAFE
    v_cmp_eq_u32 vcc, -1, v3
    s_nop 0
    s_and_b32 s30, vcc_lo, vcc_hi
    s_and_b32 s30, s30, 0xa000a
    s_cmp_lg_u32 s30, 0xa000a
    s_cbranch_scc1 KTICK
    s_mov_b32 s91, 1
VEROK_66:
    s_load_dwordx2 s[40:41], s[0:1], 96
    s_sub_u32 s30, s20, 54
    s_lshl_b32 s30, s30, 2
    s_add_u32 s30, s30, s21
    s_lshl_b32 s30, s30, 8
    v_add_u32 v2, s30, v0
    v_lshlrev_b32 v3, 10, v2
    v_mov_b32 v4, 0
    v_mov_b32 v5, 0
    s_mov_b32 s31, 0
    s_waitcnt lgkmcnt(0)
GL_67:
    s_load_dwordx16 s[44:59], s[40:41], s31
    buffer_load_dwordx4 v[8:11], v3, s[8:11], s31 offen offset:0
    buffer_load_dwordx4 v[12:15], v3, s[8:11], s31 offen offset:16
    buffer_load_dwordx4 v[16:19], v3, s[8:11], s31 offen offset:32
    buffer_load_dwordx4 v[20:23], v3, s[8:11], s31 offen offset:48
    s_waitcnt vmcnt(0) lgkmcnt(0)
    s_lshl_b32 s60, s44, 16
    s_and_b32 s61, s44, 0xffff0000
    v_lshlrev_b32 v6, 16, v8
    v_and_b32 v7, 0xffff0000, v8
    v_fmac_f32 v4, s60, v6
    v_fmac_f32 v5, s61, v7
    s_lshl_b32 s60, s45, 16
    s_and_b32 s61, s45, 0xffff0000
    v_lshlrev_b32 v6, 16, v9
    v_and_b32 v7, 0xffff0000, v9
    v_fmac_f32 v4, s60, v6
    v_fmac_f32 v5, s61, v7
    s_lshl_b32 s60, s46, 16
    s_and_b32 s61, s46, 0xffff0000
    v_lshlrev_b32 v6, 16, v10
    v_and_b32 v7, 0xffff0000, v10
    v_fmac_f32 v4, s60, v6
    v_fmac_f32 v5, s61, v7
    s_lshl_b32 s60, s47, 16
    s_and_b32 s61, s47, 0xffff0000
    v_lshlrev_b32 v6, 16, v11
    v_and_b32 v7, 0xffff0000, v11
    v_fmac_f32 v4, s60, v6
    v_fmac_f32 v5, s61, v7
    s_lshl_b32 s60, s48, 16
    s_and_b32 s61, s48, 0xffff0000
    v_lshlrev_b32 v6, 16, v12
    v_and_b32 v7, 0xffff0000, v12
    v_fmac_f32 v4, s60, v6
    v_fmac_f32 v5, s61, v7
    s_lshl_b32 s60, s49, 16
    s_and_b32 s61, s49, 0xffff0000
    v_lshlrev_b32 v6, 16, v13
    v_and_b32 v7, 0xffff0000, v13
    v_fmac_f32 v4, s60, v6
    v_fmac_f32 v5, s61, v7
    s_lshl_b32 s60, s50, 16
    s_and_b32 s61, s50, 0xffff0000
    v_lshlrev_b32 v6, 16, v14
    v_and_b32 v7, 0xffff0000, v14
    v_fmac_f32 v4, s60, v6
    v_fmac_f32 v5, s61, v7
    s_lshl_b32 s60, s51, 16
    s_and_b32 s61, s51, 0xffff0000
    v_lshlrev_b32 v6, 16, v15
    v_and_b32 v7, 0xffff0000, v15
    v_fmac_f32 v4, s60, v6
    v_fmac_f32 v5, s61, v7
    s_lshl_b32 s60, s52, 16
    s_and_b32 s61, s52, 0xffff0000
    v_lshlrev_b32 v6, 16, v16
    v_and_b32 v7, 0xffff0000, v16
    v_fmac_f32 v4, s60, v6
    v_fmac_f32 v5, s61, v7
    s_lshl_b32 s60, s53, 16
    s_and_b32 s61, s53, 0xffff0000
    v_lshlrev_b32 v6, 16, v17
    v_and_b32 v7, 0xffff0000, v17
    v_fmac_f32 v4, s60, v6
    v_fmac_f32 v5, s61, v7
    s_lshl_b32 s60, s54, 16
    s_and_b32 s61, s54, 0xffff0000
    v_lshlrev_b32 v6, 16, v18
    v_and_b32 v7, 0xffff0000, v18
    v_fmac_f32 v4, s60, v6
    v_fmac_f32 v5, s61, v7
    s_lshl_b32 s60, s55, 16
    s_and_b32 s61, s55, 0xffff0000
    v_lshlrev_b32 v6, 16, v19
    v_and_b32 v7, 0xffff0000, v19
    v_fmac_f32 v4, s60, v6
    v_fmac_f32 v5, s61, v7
    s_lshl_b32 s60, s56, 16
    s_and_b32 s61, s56, 0xffff0000
    v_lshlrev_b32 v6, 16, v20
    v_and_b32 v7, 0xffff0000, v20
    v_fmac_f32 v4, s60, v6
    v_fmac_f32 v5, s61, v7
    s_lshl_b32 s60, s57, 16
    s_and_b32 s61, s57, 0xffff0000
    v_lshlrev_b32 v6, 16, v21
    v_and_b32 v7, 0xffff0000, v21
    v_fmac_f32 v4, s60, v6
    v_fmac_f32 v5, s61, v7
    s_lshl_b32 s60, s58, 16
    s_and_b32 s61, s58, 0xffff0000
    v_lshlrev_b32 v6, 16, v22
    v_and_b32 v7, 0xffff0000, v22
    v_fmac_f32 v4, s60, v6
    v_fmac_f32 v5, s61, v7
    s_lshl_b32 s60, s59, 16
    s_and_b32 s61, s59, 0xffff0000
    v_lshlrev_b32 v6, 16, v23
    v_and_b32 v7, 0xffff0000, v23
    v_fmac_f32 v4, s60, v6
    v_fmac_f32 v5, s61, v7
    s_add_u32 s31, s31, 64
    s_cmp_lt_u32 s31, 1024
    s_cbranch_scc1 GL_67
    v_add_f32 v4, v4, v5
    v_cvt_pk_bf16_f32 v4, v4, v4
    v_lshlrev_b32 v4, 16, v4
    v_mul_f32 v4, 0xbfb8aa3b, v4
    v_exp_f32 v4, v4
    s_nop 0
    v_add_f32 v4, 1.0, v4
    v_rcp_f32 v4, v4
    s_nop 0
    v_cvt_pk_bf16_f32 v4, v4, v4
    v_lshlrev_b32 v4, 16, v4
    v_lshlrev_b32 v2, 2, v2
    s_mov_b32 s30, 0xc0000
    buffer_store_dword v4, v2, s[12:15], s30 offen sc1
    v_mov_b32 v23, 8
    s_waitcnt vmcnt(0)
    buffer_store_dword v23, v240, s[12:15], 0 offen sc1
    s_branch P1END
P1NG_63:
    s_and_b32 s30, s20, 15
    s_lshl_b32 s24, s30, 8
    s_lshl_b32 s31, s22, 6
    s_add_u32 s24, s24, s31
    v_lshlrev_b32 v10, 4, v1
    s_lshl_b32 s34, s21, 16
    s_lshl_b32 s32, s22, 14
    s_add_u32 s34, s34, s32
    s_add_u32 m0, s32, 0
    s_add_u32 s31, s34, 0
    v_xor_b32 v21, 0, v10
    buffer_load_dwordx4 v21, s[8:11], s31 offen offset:0 lds
    v_xor_b32 v22, 16, v10
    buffer_load_dwordx4 v22, s[8:11], s31 offen offset:1024 lds
    v_xor_b32 v21, 32, v10
    buffer_load_dwordx4 v21, s[8:11], s31 offen offset:2048 lds
    v_xor_b32 v22, 48, v10
    buffer_load_dwordx4 v22, s[8:11], s31 offen offset:3072 lds
    s_add_u32 m0, s32, 4096
    s_add_u32 s31, s34, 4096
    v_xor_b32 v21, 64, v10
    buffer_load_dwordx4 v21, s[8:11], s31 offen offset:0 lds
    v_xor_b32 v22, 80, v10
    buffer_load_dwordx4 v22, s[8:11], s31 offen offset:1024 lds
    v_xor_b32 v21, 96, v10
    buffer_load_dwordx4 v21, s[8:11], s31 offen offset:2048 lds
    v_xor_b32 v22, 112, v10
    buffer_load_dwordx4 v22, s[8:11], s31 offen offset:3072 lds
    s_add_u32 m0, s32, 8192
    s_add_u32 s31, s34, 8192
    v_xor_b32 v21, 128, v10
    buffer_load_dwordx4 v21, s[8:11], s31 offen offset:0 lds
    v_xor_b32 v22, 144, v10
    buffer_load_dwordx4 v22, s[8:11], s31 offen offset:1024 lds
    v_xor_b32 v21, 160, v10
    buffer_load_dwordx4 v21, s[8:11], s31 offen offset:2048 lds
    v_xor_b32 v22, 176, v10
    buffer_load_dwordx4 v22, s[8:11], s31 offen offset:3072 lds
    s_add_u32 m0, s32, 12288
    s_add_u32 s31, s34, 12288
    v_xor_b32 v21, 192, v10
    buffer_load_dwordx4 v21, s[8:11], s31 offen offset:0 lds
    v_xor_b32 v22, 208, v10
    buffer_load_dwordx4 v22, s[8:11], s31 offen offset:1024 lds
    v_xor_b32 v21, 224, v10
    buffer_load_dwordx4 v21, s[8:11], s31 offen offset:2048 lds
    v_xor_b32 v22, 240, v10
    buffer_load_dwordx4 v22, s[8:11], s31 offen offset:3072 lds
    v_and_b32 v56, 31, v1
    v_lshrrev_b32 v57, 5, v1
    v_lshl_add_u32 v58, v56, 1, s24
    s_lshl_b32 s30, s23, 3
    v_mul_lo_u32 v59, v57, s30
    v_lshl_add_u32 v59, v58, 1, v59
    s_cmp_eq_u32 s25, 3
    s_mov_b32 s30, 0x1000
    s_cselect_b32 s30, 0x560, s30
    v_cmp_gt_u32 vcc, s30, v58
    v_mov_b32 v60, 0x40000000
    s_nop 0
    v_cndmask_b32 v13, v60, v59, vcc
    v_add_u32 v14, s23, v13
    v_add_u32 v15, s23, v14
    v_add_u32 v16, s23, v15
    v_add_u32 v17, s23, v16
    v_add_u32 v18, s23, v17
    v_add_u32 v19, s23, v18
    v_add_u32 v20, s23, v19
    s_lshl_b32 s35, s23, 4
    s_mov_b32 s30, 0
    buffer_load_dword v64, v13, s[4:7], s30 offen
    buffer_load_dword v65, v14, s[4:7], s30 offen
    buffer_load_dword v66, v15, s[4:7], s30 offen
    buffer_load_dword v67, v16, s[4:7], s30 offen
    buffer_load_dword v68, v17, s[4:7], s30 offen
    buffer_load_dword v69, v18, s[4:7], s30 offen
    buffer_load_dword v70, v19, s[4:7], s30 offen
    buffer_load_dword v71, v20, s[4:7], s30 offen
    s_add_u32 s30, s30, s35
    buffer_load_dword v72, v13, s[4:7], s30 offen
    buffer_load_dword v73, v14, s[4:7], s30 offen
    buffer_load_dword v74, v15, s[4:7], s30 offen
    buffer_load_dword v75, v16, s[4:7], s30 offen
    buffer_load_dword v76, v17, s[4:7], s30 offen
    buffer_load_dword v77, v18, s[4:7], s30 offen
    buffer_load_dword v78, v19, s[4:7], s30 offen
    buffer_load_dword v79, v20, s[4:7], s30 offen
    s_add_u32 s30, s30, s35
    buffer_load_dword v80, v13, s[4:7], s30 offen
    buffer_load_dword v81, v14, s[4:7], s30 offen
    buffer_load_dword v82, v15, s[4:7], s30 offen
    buffer_load_dword v83, v16, s[4:7], s30 offen
    buffer_load_dword v84, v17, s[4:7], s30 offen
    buffer_load_dword v85, v18, s[4:7], s30 offen
    buffer_load_dword v86, v19, s[4:7], s30 offen
    buffer_load_dword v87, v20, s[4:7], s30 offen
    s_add_u32 s30, s30, s35
    buffer_load_dword v88, v13, s[4:7], s30 offen
    buffer_load_dword v89, v14, s[4:7], s30 offen
    buffer_load_dword v90, v15, s[4:7], s30 offen
    buffer_load_dword v91, v16, s[4:7], s30 offen
    buffer_load_dword v92, v17, s[4:7], s30 offen
    buffer_load_dword v93, v18, s[4:7], s30 offen
    buffer_load_dword v94, v19, s[4:7], s30 offen
    s_waitcnt vmcnt(62)
    buffer_load_dword v95, v20, s[4:7], s30 offen
    s_add_u32 s30, s30, s35
    v_and_b32 v60, 15, v56
    v_or_b32 v61, 0, v57
    v_xor_b32 v61, v61, v60
    v_lshlrev_b32 v61, 4, v61
    v_lshl_add_u32 v2, v56, 10, v61
    v_or_b32 v61, 2, v57
    v_xor_b32 v61, v61, v60
    v_lshlrev_b32 v61, 4, v61
    v_lshl_add_u32 v3, v56, 10, v61
    v_or_b32 v61, 4, v57
    v_xor_b32 v61, v61, v60
    v_lshlrev_b32 v61, 4, v61
    v_lshl_add_u32 v4, v56, 10, v61
    v_or_b32 v61, 6, v57
    v_xor_b32 v61, v61, v60
    v_lshlrev_b32 v61, 4, v61
    v_lshl_add_u32 v5, v56, 10, v61
    v_or_b32 v61, 8, v57
    v_xor_b32 v61, v61, v60
    v_lshlrev_b32 v61, 4, v61
    v_lshl_add_u32 v6, v56, 10, v61
    v_or_b32 v61, 10, v57
    v_xor_b32 v61, v61, v60
    v_lshlrev_b32 v61, 4, v61
    v_lshl_add_u32 v7, v56, 10, v61
    v_or_b32 v61, 12, v57
    v_xor_b32 v61, v61, v60
    v_lshlrev_b32 v61, 4, v61
    v_lshl_add_u32 v8, v56, 10, v61
    v_or_b32 v61, 14, v57
    v_xor_b32 v61, v61, v60
    v_lshlrev_b32 v61, 4, v61
    v_lshl_add_u32 v9, v56, 10, v61
    v_and_b32 v62, 7, v56
    v_lshrrev_b32 v61, 4, v56
    v_lshl_add_u32 v62, v61, 3, v62
    v_bfe_u32 v61, v56, 3, 1
    v_lshl_add_u32 v62, v61, 4, v62
    s_lshl_b32 s28, s21, 19
    s_mov_b32 s29, 0x40000
    s_lshr_b32 s31, s24, 7
    s_lshl_b32 s31, s31, 13
    s_add_u32 s28, s28, s31
    s_and_b32 s31, s22, 1
    s_cmp_eq_u32 s25, 1
    s_cbranch_scc1 P1V_68
    s_cmp_eq_u32 s25, 3
    s_cbranch_scc1 P1H_69
    v_lshrrev_b32 v61, 4, v62
    v_and_b32 v63, 15, v62
    v_lshlrev_b32 v63, 4, v63
    v_lshl_add_u32 v63, v61, 12, v63
    v_lshl_add_u32 v11, v57, 8, v63
    v_mov_b32 v12, v11
    s_lshl_b32 s31, s31, 11
    s_add_u32 s28, s28, s31
    s_cmp_eq_u32 s25, 0
    s_mov_b32 s31, 0x2100000
    s_cselect_b32 s31, 0x100000, s31
    s_add_u32 s28, s28, s31
    s_branch P1J_70
P1V_68:
    v_and_b32 v63, 15, v56
    v_lshlrev_b32 v63, 4, v63
    v_lshl_add_u32 v63, v57, 8, v63
    v_lshrrev_b32 v61, 4, v56
    v_lshl_add_u32 v11, v61, 11, v63
    v_mov_b32 v12, v11
    s_lshl_b32 s31, s31, 12
    s_add_u32 s28, s28, s31
    s_add_u32 s28, s28, 0x1100000
    s_branch P1J_70
P1H_69:
    v_lshlrev_b32 v63, 4, v62
    v_lshl_add_u32 v11, v57, 9, v63
    v_mov_b32 v12, v11
    s_mov_b32 s29, 98304
    s_mul_i32 s28, s21, 196608
    s_lshl_b32 s31, s24, 6
    s_add_u32 s28, s28, s31
    s_add_u32 s28, s28, 0x4100000
P1J_70:
    s_waitcnt vmcnt(48)
    s_or_b32 s92, s91, s22
    s_or_b32 s92, s92, s88
    s_cbranch_scc1 REP_71
    s_load_dwordx2 s[40:41], s[0:1], 112
    s_waitcnt lgkmcnt(0)
    s_and_b32 s41, s41, 0xffff
    s_mov_b32 s42, 0x100
    s_mov_b32 s43, 0x20000
    s_and_b32 s92, s64, 3
    s_lshl_b32 s92, s92, 6
    s_and_b32 s93, s64, 4
    s_lshl_b32 s93, s93, 1
    s_add_u32 s92, s92, s93
    v_mov_b32 v59, s92
    s_lshr_b32 s93, s2, 3
    s_lshl_b32 s93, 1, s93
    v_mov_b32 v60, 1
    v_mov_b32 v61, s93
    s_mov_b64 exec, 1
    buffer_atomic_add_x2 v[60:61], v59, s[40:43], 0 offen
    s_mov_b64 exec, -1
REP_71:
    s_waitcnt vmcnt(30)
    buffer_load_dword v96, v13, s[4:7], s30 offen
    buffer_load_dword v97, v14, s[4:7], s30 offen
    buffer_load_dword v98, v15, s[4:7], s30 offen
    buffer_load_dword v99, v16, s[4:7], s30 offen
    buffer_load_dword v100, v17, s[4:7], s30 offen
    buffer_load_dword v101, v18, s[4:7], s30 offen
    buffer_load_dword v102, v19, s[4:7], s30 offen
    buffer_load_dword v103, v20, s[4:7], s30 offen
    s_add_u32 s30, s30, s35
    buffer_load_dword v104, v13, s[4:7], s30 offen
    buffer_load_dword v105, v14, s[4:7], s30 offen
    buffer_load_dword v106, v15, s[4:7], s30 offen
    buffer_load_dword v107, v16, s[4:7], s30 offen
    buffer_load_dword v108, v17, s[4:7], s30 offen
    buffer_load_dword v109, v18, s[4:7], s30 offen
    buffer_load_dword v110, v19, s[4:7], s30 offen
    buffer_load_dword v111, v20, s[4:7], s30 offen
    s_add_u32 s30, s30, s35
    buffer_load_dword v112, v13, s[4:7], s30 offen
    buffer_load_dword v113, v14, s[4:7], s30 offen
    buffer_load_dword v114, v15, s[4:7], s30 offen
    buffer_load_dword v115, v16, s[4:7], s30 offen
    buffer_load_dword v116, v17, s[4:7], s30 offen
    buffer_load_dword v117, v18, s[4:7], s30 offen
    buffer_load_dword v118, v19, s[4:7], s30 offen
    buffer_load_dword v119, v20, s[4:7], s30 offen
    s_add_u32 s30, s30, s35
    buffer_load_dword v120, v13, s[4:7], s30 offen
    buffer_load_dword v121, v14, s[4:7], s30 offen
    buffer_load_dword v122, v15, s[4:7], s30 offen
    buffer_load_dword v123, v16, s[4:7], s30 offen
    buffer_load_dword v124, v17, s[4:7], s30 offen
    buffer_load_dword v125, v18, s[4:7], s30 offen
    buffer_load_dword v126, v19, s[4:7], s30 offen
    s_waitcnt vmcnt(62)
    buffer_load_dword v127, v20, s[4:7], s30 offen
    s_add_u32 s30, s30, s35
    s_waitcnt vmcnt(32)
    v_perm_b32 v224, v65, v64, s26
    v_perm_b32 v225, v65, v64, s27
    v_perm_b32 v226, v67, v66, s26
    v_perm_b32 v227, v67, v66, s27
    v_perm_b32 v228, v69, v68, s26
    v_perm_b32 v229, v69, v68, s27
    v_perm_b32 v230, v71, v70, s26
    v_perm_b32 v231, v71, v70, s27
    v_accvgpr_write_b32 a0, v224
    v_accvgpr_write_b32 a128, v225
    v_accvgpr_write_b32 a1, v226
    v_accvgpr_write_b32 a129, v227
    v_accvgpr_write_b32 a2, v228
    v_accvgpr_write_b32 a130, v229
    v_accvgpr_write_b32 a3, v230
    v_accvgpr_write_b32 a131, v231
    v_perm_b32 v224, v73, v72, s26
    v_perm_b32 v225, v73, v72, s27
    v_perm_b32 v226, v75, v74, s26
    v_perm_b32 v227, v75, v74, s27
    v_perm_b32 v228, v77, v76, s26
    v_perm_b32 v229, v77, v76, s27
    v_perm_b32 v230, v79, v78, s26
    v_perm_b32 v231, v79, v78, s27
    v_accvgpr_write_b32 a4, v224
    v_accvgpr_write_b32 a132, v225
    v_accvgpr_write_b32 a5, v226
    v_accvgpr_write_b32 a133, v227
    v_accvgpr_write_b32 a6, v228
    v_accvgpr_write_b32 a134, v229
    v_accvgpr_write_b32 a7, v230
    v_accvgpr_write_b32 a135, v231
    v_perm_b32 v224, v81, v80, s26
    v_perm_b32 v225, v81, v80, s27
    v_perm_b32 v226, v83, v82, s26
    v_perm_b32 v227, v83, v82, s27
    v_perm_b32 v228, v85, v84, s26
    v_perm_b32 v229, v85, v84, s27
    v_perm_b32 v230, v87, v86, s26
    v_perm_b32 v231, v87, v86, s27
    v_accvgpr_write_b32 a8, v224
    v_accvgpr_write_b32 a136, v225
    v_accvgpr_write_b32 a9, v226
    v_accvgpr_write_b32 a137, v227
    v_accvgpr_write_b32 a10, v228
    v_accvgpr_write_b32 a138, v229
    v_accvgpr_write_b32 a11, v230
    v_accvgpr_write_b32 a139, v231
    v_perm_b32 v224, v89, v88, s26
    v_perm_b32 v225, v89, v88, s27
    v_perm_b32 v226, v91, v90, s26
    v_perm_b32 v227, v91, v90, s27
    v_perm_b32 v228, v93, v92, s26
    v_perm_b32 v229, v93, v92, s27
    v_perm_b32 v230, v95, v94, s26
    v_perm_b32 v231, v95, v94, s27
    v_accvgpr_write_b32 a12, v224
    v_accvgpr_write_b32 a140, v225
    v_accvgpr_write_b32 a13, v226
    v_accvgpr_write_b32 a141, v227
    v_accvgpr_write_b32 a14, v228
    v_accvgpr_write_b32 a142, v229
    v_accvgpr_write_b32 a15, v230
    v_accvgpr_write_b32 a143, v231
    buffer_load_dword v64, v13, s[4:7], s30 offen
    buffer_load_dword v65, v14, s[4:7], s30 offen
    buffer_load_dword v66, v15, s[4:7], s30 offen
    buffer_load_dword v67, v16, s[4:7], s30 offen
    buffer_load_dword v68, v17, s[4:7], s30 offen
    buffer_load_dword v69, v18, s[4:7], s30 offen
    buffer_load_dword v70, v19, s[4:7], s30 offen
    buffer_load_dword v71, v20, s[4:7], s30 offen
    s_add_u32 s30, s30, s35
    buffer_load_dword v72, v13, s[4:7], s30 offen
    buffer_load_dword v73, v14, s[4:7], s30 offen
    buffer_load_dword v74, v15, s[4:7], s30 offen
    buffer_load_dword v75, v16, s[4:7], s30 offen
    buffer_load_dword v76, v17, s[4:7], s30 offen
    buffer_load_dword v77, v18, s[4:7], s30 offen
    buffer_load_dword v78, v19, s[4:7], s30 offen
    buffer_load_dword v79, v20, s[4:7], s30 offen
    s_add_u32 s30, s30, s35
    buffer_load_dword v80, v13, s[4:7], s30 offen
    buffer_load_dword v81, v14, s[4:7], s30 offen
    buffer_load_dword v82, v15, s[4:7], s30 offen
    buffer_load_dword v83, v16, s[4:7], s30 offen
    buffer_load_dword v84, v17, s[4:7], s30 offen
    buffer_load_dword v85, v18, s[4:7], s30 offen
    buffer_load_dword v86, v19, s[4:7], s30 offen
    buffer_load_dword v87, v20, s[4:7], s30 offen
    s_add_u32 s30, s30, s35
    buffer_load_dword v88, v13, s[4:7], s30 offen
    buffer_load_dword v89, v14, s[4:7], s30 offen
    buffer_load_dword v90, v15, s[4:7], s30 offen
    buffer_load_dword v91, v16, s[4:7], s30 offen
    buffer_load_dword v92, v17, s[4:7], s30 offen
    buffer_load_dword v93, v18, s[4:7], s30 offen
    buffer_load_dword v94, v19, s[4:7], s30 offen
    s_waitcnt vmcnt(62)
    buffer_load_dword v95, v20, s[4:7], s30 offen
    s_add_u32 s30, s30, s35
    s_waitcnt vmcnt(32)
    v_perm_b32 v224, v97, v96, s26
    v_perm_b32 v225, v97, v96, s27
    v_perm_b32 v226, v99, v98, s26
    v_perm_b32 v227, v99, v98, s27
    v_perm_b32 v228, v101, v100, s26
    v_perm_b32 v229, v101, v100, s27
    v_perm_b32 v230, v103, v102, s26
    v_perm_b32 v231, v103, v102, s27
    v_accvgpr_write_b32 a16, v224
    v_accvgpr_write_b32 a144, v225
    v_accvgpr_write_b32 a17, v226
    v_accvgpr_write_b32 a145, v227
    v_accvgpr_write_b32 a18, v228
    v_accvgpr_write_b32 a146, v229
    v_accvgpr_write_b32 a19, v230
    v_accvgpr_write_b32 a147, v231
    v_perm_b32 v224, v105, v104, s26
    v_perm_b32 v225, v105, v104, s27
    v_perm_b32 v226, v107, v106, s26
    v_perm_b32 v227, v107, v106, s27
    v_perm_b32 v228, v109, v108, s26
    v_perm_b32 v229, v109, v108, s27
    v_perm_b32 v230, v111, v110, s26
    v_perm_b32 v231, v111, v110, s27
    v_accvgpr_write_b32 a20, v224
    v_accvgpr_write_b32 a148, v225
    v_accvgpr_write_b32 a21, v226
    v_accvgpr_write_b32 a149, v227
    v_accvgpr_write_b32 a22, v228
    v_accvgpr_write_b32 a150, v229
    v_accvgpr_write_b32 a23, v230
    v_accvgpr_write_b32 a151, v231
    v_perm_b32 v224, v113, v112, s26
    v_perm_b32 v225, v113, v112, s27
    v_perm_b32 v226, v115, v114, s26
    v_perm_b32 v227, v115, v114, s27
    v_perm_b32 v228, v117, v116, s26
    v_perm_b32 v229, v117, v116, s27
    v_perm_b32 v230, v119, v118, s26
    v_perm_b32 v231, v119, v118, s27
    v_accvgpr_write_b32 a24, v224
    v_accvgpr_write_b32 a152, v225
    v_accvgpr_write_b32 a25, v226
    v_accvgpr_write_b32 a153, v227
    v_accvgpr_write_b32 a26, v228
    v_accvgpr_write_b32 a154, v229
    v_accvgpr_write_b32 a27, v230
    v_accvgpr_write_b32 a155, v231
    v_perm_b32 v224, v121, v120, s26
    v_perm_b32 v225, v121, v120, s27
    v_perm_b32 v226, v123, v122, s26
    v_perm_b32 v227, v123, v122, s27
    v_perm_b32 v228, v125, v124, s26
    v_perm_b32 v229, v125, v124, s27
    v_perm_b32 v230, v127, v126, s26
    v_perm_b32 v231, v127, v126, s27
    v_accvgpr_write_b32 a28, v224
    v_accvgpr_write_b32 a156, v225
    v_accvgpr_write_b32 a29, v226
    v_accvgpr_write_b32 a157, v227
    v_accvgpr_write_b32 a30, v228
    v_accvgpr_write_b32 a158, v229
    v_accvgpr_write_b32 a31, v230
    v_accvgpr_write_b32 a159, v231
    buffer_load_dword v96, v13, s[4:7], s30 offen
    buffer_load_dword v97, v14, s[4:7], s30 offen
    buffer_load_dword v98, v15, s[4:7], s30 offen
    buffer_load_dword v99, v16, s[4:7], s30 offen
    buffer_load_dword v100, v17, s[4:7], s30 offen
    buffer_load_dword v101, v18, s[4:7], s30 offen
    buffer_load_dword v102, v19, s[4:7], s30 offen
    buffer_load_dword v103, v20, s[4:7], s30 offen
    s_add_u32 s30, s30, s35
    buffer_load_dword v104, v13, s[4:7], s30 offen
    buffer_load_dword v105, v14, s[4:7], s30 offen
    buffer_load_dword v106, v15, s[4:7], s30 offen
    buffer_load_dword v107, v16, s[4:7], s30 offen
    buffer_load_dword v108, v17, s[4:7], s30 offen
    buffer_load_dword v109, v18, s[4:7], s30 offen
    buffer_load_dword v110, v19, s[4:7], s30 offen
    buffer_load_dword v111, v20, s[4:7], s30 offen
    s_add_u32 s30, s30, s35
    buffer_load_dword v112, v13, s[4:7], s30 offen
    buffer_load_dword v113, v14, s[4:7], s30 offen
    buffer_load_dword v114, v15, s[4:7], s30 offen
    buffer_load_dword v115, v16, s[4:7], s30 offen
    buffer_load_dword v116, v17, s[4:7], s30 offen
    buffer_load_dword v117, v18, s[4:7], s30 offen
    buffer_load_dword v118, v19, s[4:7], s30 offen
    buffer_load_dword v119, v20, s[4:7], s30 offen
    s_add_u32 s30, s30, s35
    buffer_load_dword v120, v13, s[4:7], s30 offen
    buffer_load_dword v121, v14, s[4:7], s30 offen
    buffer_load_dword v122, v15, s[4:7], s30 offen
    buffer_load_dword v123, v16, s[4:7], s30 offen
    buffer_load_dword v124, v17, s[4:7], s30 offen
    buffer_load_dword v125, v18, s[4:7], s30 offen
    buffer_load_dword v126, v19, s[4:7], s30 offen
    s_waitcnt vmcnt(62)
    buffer_load_dword v127, v20, s[4:7], s30 offen
    s_add_u32 s30, s30, s35
    s_waitcnt vmcnt(32)
    v_perm_b32 v224, v65, v64, s26
    v_perm_b32 v225, v65, v64, s27
    v_perm_b32 v226, v67, v66, s26
    v_perm_b32 v227, v67, v66, s27
    v_perm_b32 v228, v69, v68, s26
    v_perm_b32 v229, v69, v68, s27
    v_perm_b32 v230, v71, v70, s26
    v_perm_b32 v231, v71, v70, s27
    v_accvgpr_write_b32 a32, v224
    v_accvgpr_write_b32 a160, v225
    v_accvgpr_write_b32 a33, v226
    v_accvgpr_write_b32 a161, v227
    v_accvgpr_write_b32 a34, v228
    v_accvgpr_write_b32 a162, v229
    v_accvgpr_write_b32 a35, v230
    v_accvgpr_write_b32 a163, v231
    v_perm_b32 v224, v73, v72, s26
    v_perm_b32 v225, v73, v72, s27
    v_perm_b32 v226, v75, v74, s26
    v_perm_b32 v227, v75, v74, s27
    v_perm_b32 v228, v77, v76, s26
    v_perm_b32 v229, v77, v76, s27
    v_perm_b32 v230, v79, v78, s26
    v_perm_b32 v231, v79, v78, s27
    v_accvgpr_write_b32 a36, v224
    v_accvgpr_write_b32 a164, v225
    v_accvgpr_write_b32 a37, v226
    v_accvgpr_write_b32 a165, v227
    v_accvgpr_write_b32 a38, v228
    v_accvgpr_write_b32 a166, v229
    v_accvgpr_write_b32 a39, v230
    v_accvgpr_write_b32 a167, v231
    v_perm_b32 v224, v81, v80, s26
    v_perm_b32 v225, v81, v80, s27
    v_perm_b32 v226, v83, v82, s26
    v_perm_b32 v227, v83, v82, s27
    v_perm_b32 v228, v85, v84, s26
    v_perm_b32 v229, v85, v84, s27
    v_perm_b32 v230, v87, v86, s26
    v_perm_b32 v231, v87, v86, s27
    v_accvgpr_write_b32 a40, v224
    v_accvgpr_write_b32 a168, v225
    v_accvgpr_write_b32 a41, v226
    v_accvgpr_write_b32 a169, v227
    v_accvgpr_write_b32 a42, v228
    v_accvgpr_write_b32 a170, v229
    v_accvgpr_write_b32 a43, v230
    v_accvgpr_write_b32 a171, v231
    v_perm_b32 v224, v89, v88, s26
    v_perm_b32 v225, v89, v88, s27
    v_perm_b32 v226, v91, v90, s26
    v_perm_b32 v227, v91, v90, s27
    v_perm_b32 v228, v93, v92, s26
    v_perm_b32 v229, v93, v92, s27
    v_perm_b32 v230, v95, v94, s26
    v_perm_b32 v231, v95, v94, s27
    v_accvgpr_write_b32 a44, v224
    v_accvgpr_write_b32 a172, v225
    v_accvgpr_write_b32 a45, v226
    v_accvgpr_write_b32 a173, v227
    v_accvgpr_write_b32 a46, v228
    v_accvgpr_write_b32 a174, v229
    v_accvgpr_write_b32 a47, v230
    v_accvgpr_write_b32 a175, v231
    buffer_load_dword v64, v13, s[4:7], s30 offen
    buffer_load_dword v65, v14, s[4:7], s30 offen
    buffer_load_dword v66, v15, s[4:7], s30 offen
    buffer_load_dword v67, v16, s[4:7], s30 offen
    buffer_load_dword v68, v17, s[4:7], s30 offen
    buffer_load_dword v69, v18, s[4:7], s30 offen
    buffer_load_dword v70, v19, s[4:7], s30 offen
    buffer_load_dword v71, v20, s[4:7], s30 offen
    s_add_u32 s30, s30, s35
    buffer_load_dword v72, v13, s[4:7], s30 offen
    buffer_load_dword v73, v14, s[4:7], s30 offen
    buffer_load_dword v74, v15, s[4:7], s30 offen
    buffer_load_dword v75, v16, s[4:7], s30 offen
    buffer_load_dword v76, v17, s[4:7], s30 offen
    buffer_load_dword v77, v18, s[4:7], s30 offen
    buffer_load_dword v78, v19, s[4:7], s30 offen
    buffer_load_dword v79, v20, s[4:7], s30 offen
    s_add_u32 s30, s30, s35
    buffer_load_dword v80, v13, s[4:7], s30 offen
    buffer_load_dword v81, v14, s[4:7], s30 offen
    buffer_load_dword v82, v15, s[4:7], s30 offen
    buffer_load_dword v83, v16, s[4:7], s30 offen
    buffer_load_dword v84, v17, s[4:7], s30 offen
    buffer_load_dword v85, v18, s[4:7], s30 offen
    buffer_load_dword v86, v19, s[4:7], s30 offen
    buffer_load_dword v87, v20, s[4:7], s30 offen
    s_add_u32 s30, s30, s35
    buffer_load_dword v88, v13, s[4:7], s30 offen
    buffer_load_dword v89, v14, s[4:7], s30 offen
    buffer_load_dword v90, v15, s[4:7], s30 offen
    buffer_load_dword v91, v16, s[4:7], s30 offen
    buffer_load_dword v92, v17, s[4:7], s30 offen
    buffer_load_dword v93, v18, s[4:7], s30 offen
    buffer_load_dword v94, v19, s[4:7], s30 offen
    s_waitcnt vmcnt(62)
    buffer_load_dword v95, v20, s[4:7], s30 offen
    s_add_u32 s30, s30, s35
    s_waitcnt vmcnt(32)
    v_perm_b32 v224, v97, v96, s26
    v_perm_b32 v225, v97, v96, s27
    v_perm_b32 v226, v99, v98, s26
    v_perm_b32 v227, v99, v98, s27
    v_perm_b32 v228, v101, v100, s26
    v_perm_b32 v229, v101, v100, s27
    v_perm_b32 v230, v103, v102, s26
    v_perm_b32 v231, v103, v102, s27
    v_accvgpr_write_b32 a48, v224
    v_accvgpr_write_b32 a176, v225
    v_accvgpr_write_b32 a49, v226
    v_accvgpr_write_b32 a177, v227
    v_accvgpr_write_b32 a50, v228
    v_accvgpr_write_b32 a178, v229
    v_accvgpr_write_b32 a51, v230
    v_accvgpr_write_b32 a179, v231
    v_perm_b32 v224, v105, v104, s26
    v_perm_b32 v225, v105, v104, s27
    v_perm_b32 v226, v107, v106, s26
    v_perm_b32 v227, v107, v106, s27
    v_perm_b32 v228, v109, v108, s26
    v_perm_b32 v229, v109, v108, s27
    v_perm_b32 v230, v111, v110, s26
    v_perm_b32 v231, v111, v110, s27
    v_accvgpr_write_b32 a52, v224
    v_accvgpr_write_b32 a180, v225
    v_accvgpr_write_b32 a53, v226
    v_accvgpr_write_b32 a181, v227
    v_accvgpr_write_b32 a54, v228
    v_accvgpr_write_b32 a182, v229
    v_accvgpr_write_b32 a55, v230
    v_accvgpr_write_b32 a183, v231
    v_perm_b32 v224, v113, v112, s26
    v_perm_b32 v225, v113, v112, s27
    v_perm_b32 v226, v115, v114, s26
    v_perm_b32 v227, v115, v114, s27
    v_perm_b32 v228, v117, v116, s26
    v_perm_b32 v229, v117, v116, s27
    v_perm_b32 v230, v119, v118, s26
    v_perm_b32 v231, v119, v118, s27
    v_accvgpr_write_b32 a56, v224
    v_accvgpr_write_b32 a184, v225
    v_accvgpr_write_b32 a57, v226
    v_accvgpr_write_b32 a185, v227
    v_accvgpr_write_b32 a58, v228
    v_accvgpr_write_b32 a186, v229
    v_accvgpr_write_b32 a59, v230
    v_accvgpr_write_b32 a187, v231
    v_perm_b32 v224, v121, v120, s26
    v_perm_b32 v225, v121, v120, s27
    v_perm_b32 v226, v123, v122, s26
    v_perm_b32 v227, v123, v122, s27
    v_perm_b32 v228, v125, v124, s26
    v_perm_b32 v229, v125, v124, s27
    v_perm_b32 v230, v127, v126, s26
    v_perm_b32 v231, v127, v126, s27
    v_accvgpr_write_b32 a60, v224
    v_accvgpr_write_b32 a188, v225
    v_accvgpr_write_b32 a61, v226
    v_accvgpr_write_b32 a189, v227
    v_accvgpr_write_b32 a62, v228
    v_accvgpr_write_b32 a190, v229
    v_accvgpr_write_b32 a63, v230
    v_accvgpr_write_b32 a191, v231
    buffer_load_dword v96, v13, s[4:7], s30 offen
    buffer_load_dword v97, v14, s[4:7], s30 offen
    buffer_load_dword v98, v15, s[4:7], s30 offen
    buffer_load_dword v99, v16, s[4:7], s30 offen
    buffer_load_dword v100, v17, s[4:7], s30 offen
    buffer_load_dword v101, v18, s[4:7], s30 offen
    buffer_load_dword v102, v19, s[4:7], s30 offen
    buffer_load_dword v103, v20, s[4:7], s30 offen
    s_add_u32 s30, s30, s35
    buffer_load_dword v104, v13, s[4:7], s30 offen
    buffer_load_dword v105, v14, s[4:7], s30 offen
    buffer_load_dword v106, v15, s[4:7], s30 offen
    buffer_load_dword v107, v16, s[4:7], s30 offen
    buffer_load_dword v108, v17, s[4:7], s30 offen
    buffer_load_dword v109, v18, s[4:7], s30 offen
    buffer_load_dword v110, v19, s[4:7], s30 offen
    buffer_load_dword v111, v20, s[4:7], s30 offen
    s_add_u32 s30, s30, s35
    buffer_load_dword v112, v13, s[4:7], s30 offen
    buffer_load_dword v113, v14, s[4:7], s30 offen
    buffer_load_dword v114, v15, s[4:7], s30 offen
    buffer_load_dword v115, v16, s[4:7], s30 offen
    buffer_load_dword v116, v17, s[4:7], s30 offen
    buffer_load_dword v117, v18, s[4:7], s30 offen
    buffer_load_dword v118, v19, s[4:7], s30 offen
    buffer_load_dword v119, v20, s[4:7], s30 offen
    s_add_u32 s30, s30, s35
    buffer_load_dword v120, v13, s[4:7], s30 offen
    buffer_load_dword v121, v14, s[4:7], s30 offen
    buffer_load_dword v122, v15, s[4:7], s30 offen
    buffer_load_dword v123, v16, s[4:7], s30 offen
    buffer_load_dword v124, v17, s[4:7], s30 offen
    buffer_load_dword v125, v18, s[4:7], s30 offen
    buffer_load_dword v126, v19, s[4:7], s30 offen
    s_waitcnt vmcnt(62)
    buffer_load_dword v127, v20, s[4:7], s30 offen
    s_add_u32 s30, s30, s35
    s_waitcnt vmcnt(32)
    v_perm_b32 v224, v65, v64, s26
    v_perm_b32 v225, v65, v64, s27
    v_perm_b32 v226, v67, v66, s26
    v_perm_b32 v227, v67, v66, s27
    v_perm_b32 v228, v69, v68, s26
    v_perm_b32 v229, v69, v68, s27
    v_perm_b32 v230, v71, v70, s26
    v_perm_b32 v231, v71, v70, s27
    v_accvgpr_write_b32 a64, v224
    v_accvgpr_write_b32 a192, v225
    v_accvgpr_write_b32 a65, v226
    v_accvgpr_write_b32 a193, v227
    v_accvgpr_write_b32 a66, v228
    v_accvgpr_write_b32 a194, v229
    v_accvgpr_write_b32 a67, v230
    v_accvgpr_write_b32 a195, v231
    v_perm_b32 v224, v73, v72, s26
    v_perm_b32 v225, v73, v72, s27
    v_perm_b32 v226, v75, v74, s26
    v_perm_b32 v227, v75, v74, s27
    v_perm_b32 v228, v77, v76, s26
    v_perm_b32 v229, v77, v76, s27
    v_perm_b32 v230, v79, v78, s26
    v_perm_b32 v231, v79, v78, s27
    v_accvgpr_write_b32 a68, v224
    v_accvgpr_write_b32 a196, v225
    v_accvgpr_write_b32 a69, v226
    v_accvgpr_write_b32 a197, v227
    v_accvgpr_write_b32 a70, v228
    v_accvgpr_write_b32 a198, v229
    v_accvgpr_write_b32 a71, v230
    v_accvgpr_write_b32 a199, v231
    v_perm_b32 v224, v81, v80, s26
    v_perm_b32 v225, v81, v80, s27
    v_perm_b32 v226, v83, v82, s26
    v_perm_b32 v227, v83, v82, s27
    v_perm_b32 v228, v85, v84, s26
    v_perm_b32 v229, v85, v84, s27
    v_perm_b32 v230, v87, v86, s26
    v_perm_b32 v231, v87, v86, s27
    v_accvgpr_write_b32 a72, v224
    v_accvgpr_write_b32 a200, v225
    v_accvgpr_write_b32 a73, v226
    v_accvgpr_write_b32 a201, v227
    v_accvgpr_write_b32 a74, v228
    v_accvgpr_write_b32 a202, v229
    v_accvgpr_write_b32 a75, v230
    v_accvgpr_write_b32 a203, v231
    v_perm_b32 v224, v89, v88, s26
    v_perm_b32 v225, v89, v88, s27
    v_perm_b32 v226, v91, v90, s26
    v_perm_b32 v227, v91, v90, s27
    v_perm_b32 v228, v93, v92, s26
    v_perm_b32 v229, v93, v92, s27
    v_perm_b32 v230, v95, v94, s26
    v_perm_b32 v231, v95, v94, s27
    v_accvgpr_write_b32 a76, v224
    v_accvgpr_write_b32 a204, v225
    v_accvgpr_write_b32 a77, v226
    v_accvgpr_write_b32 a205, v227
    v_accvgpr_write_b32 a78, v228
    v_accvgpr_write_b32 a206, v229
    v_accvgpr_write_b32 a79, v230
    v_accvgpr_write_b32 a207, v231
    buffer_load_dword v64, v13, s[4:7], s30 offen
    buffer_load_dword v65, v14, s[4:7], s30 offen
    buffer_load_dword v66, v15, s[4:7], s30 offen
    buffer_load_dword v67, v16, s[4:7], s30 offen
    buffer_load_dword v68, v17, s[4:7], s30 offen
    buffer_load_dword v69, v18, s[4:7], s30 offen
    buffer_load_dword v70, v19, s[4:7], s30 offen
    buffer_load_dword v71, v20, s[4:7], s30 offen
    s_add_u32 s30, s30, s35
    buffer_load_dword v72, v13, s[4:7], s30 offen
    buffer_load_dword v73, v14, s[4:7], s30 offen
    buffer_load_dword v74, v15, s[4:7], s30 offen
    buffer_load_dword v75, v16, s[4:7], s30 offen
    buffer_load_dword v76, v17, s[4:7], s30 offen
    buffer_load_dword v77, v18, s[4:7], s30 offen
    buffer_load_dword v78, v19, s[4:7], s30 offen
    buffer_load_dword v79, v20, s[4:7], s30 offen
    s_add_u32 s30, s30, s35
    buffer_load_dword v80, v13, s[4:7], s30 offen
    buffer_load_dword v81, v14, s[4:7], s30 offen
    buffer_load_dword v82, v15, s[4:7], s30 offen
    buffer_load_dword v83, v16, s[4:7], s30 offen
    buffer_load_dword v84, v17, s[4:7], s30 offen
    buffer_load_dword v85, v18, s[4:7], s30 offen
    buffer_load_dword v86, v19, s[4:7], s30 offen
    buffer_load_dword v87, v20, s[4:7], s30 offen
    s_add_u32 s30, s30, s35
    buffer_load_dword v88, v13, s[4:7], s30 offen
    buffer_load_dword v89, v14, s[4:7], s30 offen
    buffer_load_dword v90, v15, s[4:7], s30 offen
    buffer_load_dword v91, v16, s[4:7], s30 offen
    buffer_load_dword v92, v17, s[4:7], s30 offen
    buffer_load_dword v93, v18, s[4:7], s30 offen
    buffer_load_dword v94, v19, s[4:7], s30 offen
    s_waitcnt vmcnt(62)
    buffer_load_dword v95, v20, s[4:7], s30 offen
    s_add_u32 s30, s30, s35
    s_waitcnt vmcnt(32)
    v_perm_b32 v224, v97, v96, s26
    v_perm_b32 v225, v97, v96, s27
    v_perm_b32 v226, v99, v98, s26
    v_perm_b32 v227, v99, v98, s27
    v_perm_b32 v228, v101, v100, s26
    v_perm_b32 v229, v101, v100, s27
    v_perm_b32 v230, v103, v102, s26
    v_perm_b32 v231, v103, v102, s27
    v_accvgpr_write_b32 a80, v224
    v_accvgpr_write_b32 a208, v225
    v_accvgpr_write_b32 a81, v226
    v_accvgpr_write_b32 a209, v227
    v_accvgpr_write_b32 a82, v228
    v_accvgpr_write_b32 a210, v229
    v_accvgpr_write_b32 a83, v230
    v_accvgpr_write_b32 a211, v231
    v_perm_b32 v224, v105, v104, s26
    v_perm_b32 v225, v105, v104, s27
    v_perm_b32 v226, v107, v106, s26
    v_perm_b32 v227, v107, v106, s27
    v_perm_b32 v228, v109, v108, s26
    v_perm_b32 v229, v109, v108, s27
    v_perm_b32 v230, v111, v110, s26
    v_perm_b32 v231, v111, v110, s27
    v_accvgpr_write_b32 a84, v224
    v_accvgpr_write_b32 a212, v225
    v_accvgpr_write_b32 a85, v226
    v_accvgpr_write_b32 a213, v227
    v_accvgpr_write_b32 a86, v228
    v_accvgpr_write_b32 a214, v229
    v_accvgpr_write_b32 a87, v230
    v_accvgpr_write_b32 a215, v231
    v_perm_b32 v224, v113, v112, s26
    v_perm_b32 v225, v113, v112, s27
    v_perm_b32 v226, v115, v114, s26
    v_perm_b32 v227, v115, v114, s27
    v_perm_b32 v228, v117, v116, s26
    v_perm_b32 v229, v117, v116, s27
    v_perm_b32 v230, v119, v118, s26
    v_perm_b32 v231, v119, v118, s27
    v_accvgpr_write_b32 a88, v224
    v_accvgpr_write_b32 a216, v225
    v_accvgpr_write_b32 a89, v226
    v_accvgpr_write_b32 a217, v227
    v_accvgpr_write_b32 a90, v228
    v_accvgpr_write_b32 a218, v229
    v_accvgpr_write_b32 a91, v230
    v_accvgpr_write_b32 a219, v231
    v_perm_b32 v224, v121, v120, s26
    v_perm_b32 v225, v121, v120, s27
    v_perm_b32 v226, v123, v122, s26
    v_perm_b32 v227, v123, v122, s27
    v_perm_b32 v228, v125, v124, s26
    v_perm_b32 v229, v125, v124, s27
    v_perm_b32 v230, v127, v126, s26
    v_perm_b32 v231, v127, v126, s27
    v_accvgpr_write_b32 a92, v224
    v_accvgpr_write_b32 a220, v225
    v_accvgpr_write_b32 a93, v226
    v_accvgpr_write_b32 a221, v227
    v_accvgpr_write_b32 a94, v228
    v_accvgpr_write_b32 a222, v229
    v_accvgpr_write_b32 a95, v230
    v_accvgpr_write_b32 a223, v231
    buffer_load_dword v96, v13, s[4:7], s30 offen
    buffer_load_dword v97, v14, s[4:7], s30 offen
    buffer_load_dword v98, v15, s[4:7], s30 offen
    buffer_load_dword v99, v16, s[4:7], s30 offen
    buffer_load_dword v100, v17, s[4:7], s30 offen
    buffer_load_dword v101, v18, s[4:7], s30 offen
    buffer_load_dword v102, v19, s[4:7], s30 offen
    buffer_load_dword v103, v20, s[4:7], s30 offen
    s_add_u32 s30, s30, s35
    buffer_load_dword v104, v13, s[4:7], s30 offen
    buffer_load_dword v105, v14, s[4:7], s30 offen
    buffer_load_dword v106, v15, s[4:7], s30 offen
    buffer_load_dword v107, v16, s[4:7], s30 offen
    buffer_load_dword v108, v17, s[4:7], s30 offen
    buffer_load_dword v109, v18, s[4:7], s30 offen
    buffer_load_dword v110, v19, s[4:7], s30 offen
    buffer_load_dword v111, v20, s[4:7], s30 offen
    s_add_u32 s30, s30, s35
    buffer_load_dword v112, v13, s[4:7], s30 offen
    buffer_load_dword v113, v14, s[4:7], s30 offen
    buffer_load_dword v114, v15, s[4:7], s30 offen
    buffer_load_dword v115, v16, s[4:7], s30 offen
    buffer_load_dword v116, v17, s[4:7], s30 offen
    buffer_load_dword v117, v18, s[4:7], s30 offen
    buffer_load_dword v118, v19, s[4:7], s30 offen
    buffer_load_dword v119, v20, s[4:7], s30 offen
    s_add_u32 s30, s30, s35
    buffer_load_dword v120, v13, s[4:7], s30 offen
    buffer_load_dword v121, v14, s[4:7], s30 offen
    buffer_load_dword v122, v15, s[4:7], s30 offen
    buffer_load_dword v123, v16, s[4:7], s30 offen
    buffer_load_dword v124, v17, s[4:7], s30 offen
    buffer_load_dword v125, v18, s[4:7], s30 offen
    buffer_load_dword v126, v19, s[4:7], s30 offen
    s_waitcnt vmcnt(62)
    buffer_load_dword v127, v20, s[4:7], s30 offen
    s_add_u32 s30, s30, s35
    s_waitcnt vmcnt(32)
    v_perm_b32 v224, v65, v64, s26
    v_perm_b32 v225, v65, v64, s27
    v_perm_b32 v226, v67, v66, s26
    v_perm_b32 v227, v67, v66, s27
    v_perm_b32 v228, v69, v68, s26
    v_perm_b32 v229, v69, v68, s27
    v_perm_b32 v230, v71, v70, s26
    v_perm_b32 v231, v71, v70, s27
    v_accvgpr_write_b32 a96, v224
    v_accvgpr_write_b32 a224, v225
    v_accvgpr_write_b32 a97, v226
    v_accvgpr_write_b32 a225, v227
    v_accvgpr_write_b32 a98, v228
    v_accvgpr_write_b32 a226, v229
    v_accvgpr_write_b32 a99, v230
    v_accvgpr_write_b32 a227, v231
    v_perm_b32 v224, v73, v72, s26
    v_perm_b32 v225, v73, v72, s27
    v_perm_b32 v226, v75, v74, s26
    v_perm_b32 v227, v75, v74, s27
    v_perm_b32 v228, v77, v76, s26
    v_perm_b32 v229, v77, v76, s27
    v_perm_b32 v230, v79, v78, s26
    v_perm_b32 v231, v79, v78, s27
    v_accvgpr_write_b32 a100, v224
    v_accvgpr_write_b32 a228, v225
    v_accvgpr_write_b32 a101, v226
    v_accvgpr_write_b32 a229, v227
    v_accvgpr_write_b32 a102, v228
    v_accvgpr_write_b32 a230, v229
    v_accvgpr_write_b32 a103, v230
    v_accvgpr_write_b32 a231, v231
    v_perm_b32 v224, v81, v80, s26
    v_perm_b32 v225, v81, v80, s27
    v_perm_b32 v226, v83, v82, s26
    v_perm_b32 v227, v83, v82, s27
    v_perm_b32 v228, v85, v84, s26
    v_perm_b32 v229, v85, v84, s27
    v_perm_b32 v230, v87, v86, s26
    v_perm_b32 v231, v87, v86, s27
    v_accvgpr_write_b32 a104, v224
    v_accvgpr_write_b32 a232, v225
    v_accvgpr_write_b32 a105, v226
    v_accvgpr_write_b32 a233, v227
    v_accvgpr_write_b32 a106, v228
    v_accvgpr_write_b32 a234, v229
    v_accvgpr_write_b32 a107, v230
    v_accvgpr_write_b32 a235, v231
    v_perm_b32 v224, v89, v88, s26
    v_perm_b32 v225, v89, v88, s27
    v_perm_b32 v226, v91, v90, s26
    v_perm_b32 v227, v91, v90, s27
    v_perm_b32 v228, v93, v92, s26
    v_perm_b32 v229, v93, v92, s27
    v_perm_b32 v230, v95, v94, s26
    v_perm_b32 v231, v95, v94, s27
    v_accvgpr_write_b32 a108, v224
    v_accvgpr_write_b32 a236, v225
    v_accvgpr_write_b32 a109, v226
    v_accvgpr_write_b32 a237, v227
    v_accvgpr_write_b32 a110, v228
    v_accvgpr_write_b32 a238, v229
    v_accvgpr_write_b32 a111, v230
    v_accvgpr_write_b32 a239, v231
    s_waitcnt vmcnt(0)
    v_perm_b32 v224, v97, v96, s26
    v_perm_b32 v225, v97, v96, s27
    v_perm_b32 v226, v99, v98, s26
    v_perm_b32 v227, v99, v98, s27
    v_perm_b32 v228, v101, v100, s26
    v_perm_b32 v229, v101, v100, s27
    v_perm_b32 v230, v103, v102, s26
    v_perm_b32 v231, v103, v102, s27
    v_accvgpr_write_b32 a112, v224
    v_accvgpr_write_b32 a240, v225
    v_accvgpr_write_b32 a113, v226
    v_accvgpr_write_b32 a241, v227
    v_accvgpr_write_b32 a114, v228
    v_accvgpr_write_b32 a242, v229
    v_accvgpr_write_b32 a115, v230
    v_accvgpr_write_b32 a243, v231
    v_perm_b32 v224, v105, v104, s26
    v_perm_b32 v225, v105, v104, s27
    v_perm_b32 v226, v107, v106, s26
    v_perm_b32 v227, v107, v106, s27
    v_perm_b32 v228, v109, v108, s26
    v_perm_b32 v229, v109, v108, s27
    v_perm_b32 v230, v111, v110, s26
    v_perm_b32 v231, v111, v110, s27
    v_accvgpr_write_b32 a116, v224
    v_accvgpr_write_b32 a244, v225
    v_accvgpr_write_b32 a117, v226
    v_accvgpr_write_b32 a245, v227
    v_accvgpr_write_b32 a118, v228
    v_accvgpr_write_b32 a246, v229
    v_accvgpr_write_b32 a119, v230
    v_accvgpr_write_b32 a247, v231
    v_perm_b32 v224, v113, v112, s26
    v_perm_b32 v225, v113, v112, s27
    v_perm_b32 v226, v115, v114, s26
    v_perm_b32 v227, v115, v114, s27
    v_perm_b32 v228, v117, v116, s26
    v_perm_b32 v229, v117, v116, s27
    v_perm_b32 v230, v119, v118, s26
    v_perm_b32 v231, v119, v118, s27
    v_accvgpr_write_b32 a120, v224
    v_accvgpr_write_b32 a248, v225
    v_accvgpr_write_b32 a121, v226
    v_accvgpr_write_b32 a249, v227
    v_accvgpr_write_b32 a122, v228
    v_accvgpr_write_b32 a250, v229
    v_accvgpr_write_b32 a123, v230
    v_accvgpr_write_b32 a251, v231
    v_perm_b32 v224, v121, v120, s26
    v_perm_b32 v225, v121, v120, s27
    v_perm_b32 v226, v123, v122, s26
    v_perm_b32 v227, v123, v122, s27
    v_perm_b32 v228, v125, v124, s26
    v_perm_b32 v229, v125, v124, s27
    v_perm_b32 v230, v127, v126, s26
    v_perm_b32 v231, v127, v126, s27
    v_accvgpr_write_b32 a124, v224
    v_accvgpr_write_b32 a252, v225
    v_accvgpr_write_b32 a125, v226
    v_accvgpr_write_b32 a253, v227
    v_accvgpr_write_b32 a126, v228
    v_accvgpr_write_b32 a254, v229
    v_accvgpr_write_b32 a127, v230
    v_accvgpr_write_b32 a255, v231
    s_cmp_lg_u32 s91, 0
    s_cbranch_scc1 VEROK_73
    s_load_dwordx2 s[40:41], s[0:1], 112
    v_and_b32 v60, 63, v0
    v_lshlrev_b32 v60, 2, v60
    s_mov_b32 s31, 0
    s_waitcnt lgkmcnt(0)
    s_and_b32 s41, s41, 0xffff
    s_mov_b32 s42, 0x100
    s_mov_b32 s43, 0x20000
VER_72:
    buffer_load_dword v61, v60, s[40:43], 0 offen sc1
    s_add_u32 s31, s31, 1
    s_cmp_gt_u32 s31, 0x40000
    s_cbranch_scc1 KABORT
    s_waitcnt vmcnt(0)
    v_readlane_b32 s30, v61, 0
    v_readlane_b32 s44, v61, 2
    s_nop 0
    s_add_u32 s30, s30, s44
    v_readlane_b32 s44, v61, 16
    s_nop 0
    s_add_u32 s30, s30, s44
    v_readlane_b32 s44, v61, 18
    s_nop 0
    s_add_u32 s30, s30, s44
    v_readlane_b32 s44, v61, 32
    s_nop 0
    s_add_u32 s30, s30, s44
    v_readlane_b32 s44, v61, 34
    s_nop 0
    s_add_u32 s30, s30, s44
    v_readlane_b32 s44, v61, 48
    s_nop 0
    s_add_u32 s30, s30, s44
    v_readlane_b32 s44, v61, 50
    s_nop 0
    s_add_u32 s30, s30, s44
    s_cmp_lt_u32 s30, 256
    s_cbranch_scc1 VER_72
    v_cmp_eq_u32 vcc, 32, v61
    s_nop 0
    s_and_b32 s30, vcc_lo, vcc_hi
    s_and_b32 s30, s30, 0x50005
    s_cmp_lg_u32 s30, 0x50005
    s_cbranch_scc1 KSAFE
    v_cmp_eq_u32 vcc, -1, v61
    s_nop 0
    s_and_b32 s30, vcc_lo, vcc_hi
    s_and_b32 s30, s30, 0xa000a
    s_cmp_lg_u32 s30, 0xa000a
    s_cbranch_scc1 KTICK
    s_mov_b32 s91, 1
VEROK_73:
    s_cmp_eq_u32 s25, 1
    s_cbranch_scc1 P1V_74
    s_cmp_eq_u32 s25, 3
    s_cbranch_scc1 P1H_75
    s_cmp_eq_u32 s25, 0
    s_mov_b32 s36, 0x3f800000
    s_cselect_b32 s36, 0x3e0293ee, s36
    s_mov_b32 s33, 0
    s_mov_b32 s38, s28
    s_mov_b32 s28, 0x40000000
    s_mov_b32 s37, 0x40000000
P1L_76:
    s_waitcnt vmcnt(1)
    s_barrier
    s_add_u32 s34, s34, 0x40000
    s_xor_b32 s32, s32, 0x10000
    ds_read_b128 v[24:27], v2 offset:0
    ds_read_b128 v[28:31], v2 offset:32768
    ds_read_b128 v[32:35], v3 offset:0
    ds_read_b128 v[36:39], v3 offset:32768
    ds_read_b128 v[40:43], v4 offset:0
    ds_read_b128 v[44:47], v4 offset:32768
    s_waitcnt lgkmcnt(4)
    v_mfma_f32_32x32x16_bf16 v[64:79], a[0:3], v[24:27], 0
    ds_read_b128 v[48:51], v5 offset:0
    v_mfma_f32_32x32x16_bf16 v[80:95], a[128:131], v[24:27], 0
    ds_read_b128 v[52:55], v5 offset:32768
    v_mfma_f32_32x32x16_bf16 v[96:111], a[0:3], v[28:31], 0
    v_mfma_f32_32x32x16_bf16 v[112:127], a[128:131], v[28:31], 0
    s_waitcnt lgkmcnt(4)
    v_mfma_f32_32x32x16_bf16 v[64:79], a[4:7], v[32:35], v[64:79]
    ds_read_b128 v[24:27], v6 offset:0
    v_mul_f32 v128, s36, v128
    v_mul_f32 v129, s36, v129
    v_mfma_f32_32x32x16_bf16 v[80:95], a[132:135], v[32:35], v[80:95]
    ds_read_b128 v[28:31], v6 offset:32768
    v_mul_f32 v130, s36, v130
    v_mul_f32 v131, s36, v131
    v_mfma_f32_32x32x16_bf16 v[96:111], a[4:7], v[36:39], v[96:111]
    v_mul_f32 v144, s36, v144
    v_mul_f32 v145, s36, v145
    v_mul_f32 v146, s36, v146
    v_mfma_f32_32x32x16_bf16 v[112:127], a[132:135], v[36:39], v[112:127]
    v_mul_f32 v147, s36, v147
    v_cvt_pk_bf16_f32 v128, v128, v144
    v_cvt_pk_bf16_f32 v129, v129, v145
    s_waitcnt lgkmcnt(4)
    v_mfma_f32_32x32x16_bf16 v[64:79], a[8:11], v[40:43], v[64:79]
    ds_read_b128 v[32:35], v7 offset:0
    v_cvt_pk_bf16_f32 v130, v130, v146
    v_cvt_pk_bf16_f32 v131, v131, v147
    v_mfma_f32_32x32x16_bf16 v[80:95], a[136:139], v[40:43], v[80:95]
    ds_read_b128 v[36:39], v7 offset:32768
    buffer_store_dwordx4 v[128:131], v11, s[12:15], s28 offen offset:0 sc1
    v_mul_f32 v132, s36, v132
    v_mfma_f32_32x32x16_bf16 v[96:111], a[8:11], v[44:47], v[96:111]
    v_mul_f32 v133, s36, v133
    v_mul_f32 v134, s36, v134
    v_mul_f32 v135, s36, v135
    v_mfma_f32_32x32x16_bf16 v[112:127], a[136:139], v[44:47], v[112:127]
    v_mul_f32 v148, s36, v148
    v_mul_f32 v149, s36, v149
    v_mul_f32 v150, s36, v150
    s_waitcnt lgkmcnt(4)
    v_mfma_f32_32x32x16_bf16 v[64:79], a[12:15], v[48:51], v[64:79]
    ds_read_b128 v[40:43], v8 offset:0
    v_mul_f32 v151, s36, v151
    v_cvt_pk_bf16_f32 v132, v132, v148
    v_mfma_f32_32x32x16_bf16 v[80:95], a[140:143], v[48:51], v[80:95]
    ds_read_b128 v[44:47], v8 offset:32768
    v_cvt_pk_bf16_f32 v133, v133, v149
    v_cvt_pk_bf16_f32 v134, v134, v150
    v_mfma_f32_32x32x16_bf16 v[96:111], a[12:15], v[52:55], v[96:111]
    v_cvt_pk_bf16_f32 v135, v135, v151
    buffer_store_dwordx4 v[132:135], v11, s[12:15], s28 offen offset:512 sc1
    v_mul_f32 v136, s36, v136
    v_mfma_f32_32x32x16_bf16 v[112:127], a[140:143], v[52:55], v[112:127]
    v_mul_f32 v137, s36, v137
    v_mul_f32 v138, s36, v138
    v_mul_f32 v139, s36, v139
    s_waitcnt lgkmcnt(4)
    v_mfma_f32_32x32x16_bf16 v[64:79], a[16:19], v[24:27], v[64:79]
    ds_read_b128 v[48:51], v9 offset:0
    v_mul_f32 v152, s36, v152
    v_mul_f32 v153, s36, v153
    v_mfma_f32_32x32x16_bf16 v[80:95], a[144:147], v[24:27], v[80:95]
    ds_read_b128 v[52:55], v9 offset:32768
    v_mul_f32 v154, s36, v154
    v_mul_f32 v155, s36, v155
    v_mfma_f32_32x32x16_bf16 v[96:111], a[16:19], v[28:31], v[96:111]
    v_cvt_pk_bf16_f32 v136, v136, v152
    v_cvt_pk_bf16_f32 v137, v137, v153
    v_cvt_pk_bf16_f32 v138, v138, v154
    v_mfma_f32_32x32x16_bf16 v[112:127], a[144:147], v[28:31], v[112:127]
    v_cvt_pk_bf16_f32 v139, v139, v155
    buffer_store_dwordx4 v[136:139], v11, s[12:15], s28 offen offset:1024 sc1
    v_mul_f32 v140, s36, v140
    s_waitcnt lgkmcnt(4)
    v_mfma_f32_32x32x16_bf16 v[64:79], a[20:23], v[32:35], v[64:79]
    ds_read_b128 v[24:27], v2 offset:256
    v_mul_f32 v141, s36, v141
    v_mul_f32 v142, s36, v142
    v_mfma_f32_32x32x16_bf16 v[80:95], a[148:151], v[32:35], v[80:95]
    ds_read_b128 v[28:31], v2 offset:33024
    v_mul_f32 v143, s36, v143
    v_mul_f32 v156, s36, v156
    v_mfma_f32_32x32x16_bf16 v[96:111], a[20:23], v[36:39], v[96:111]
    v_mul_f32 v157, s36, v157
    v_mul_f32 v158, s36, v158
    v_mul_f32 v159, s36, v159
    v_mfma_f32_32x32x16_bf16 v[112:127], a[148:151], v[36:39], v[112:127]
    v_cvt_pk_bf16_f32 v140, v140, v156
    v_cvt_pk_bf16_f32 v141, v141, v157
    v_cvt_pk_bf16_f32 v142, v142, v158
    s_waitcnt lgkmcnt(4)
    v_mfma_f32_32x32x16_bf16 v[64:79], a[24:27], v[40:43], v[64:79]
    ds_read_b128 v[32:35], v3 offset:256
    v_cvt_pk_bf16_f32 v143, v143, v159
    buffer_store_dwordx4 v[140:143], v11, s[12:15], s28 offen offset:1536 sc1
    v_mfma_f32_32x32x16_bf16 v[80:95], a[152:155], v[40:43], v[80:95]
    ds_read_b128 v[36:39], v3 offset:33024
    v_mul_f32 v160, s36, v160
    v_mul_f32 v161, s36, v161
    v_mfma_f32_32x32x16_bf16 v[96:111], a[24:27], v[44:47], v[96:111]
    v_mul_f32 v162, s36, v162
    v_mul_f32 v163, s36, v163
    v_mul_f32 v176, s36, v176
    v_mfma_f32_32x32x16_bf16 v[112:127], a[152:155], v[44:47], v[112:127]
    v_mul_f32 v177, s36, v177
    v_mul_f32 v178, s36, v178
    v_mul_f32 v179, s36, v179
    s_waitcnt lgkmcnt(4)
    v_mfma_f32_32x32x16_bf16 v[64:79], a[28:31], v[48:51], v[64:79]
    ds_read_b128 v[40:43], v4 offset:256
    v_cvt_pk_bf16_f32 v160, v160, v176
    v_cvt_pk_bf16_f32 v161, v161, v177
    v_mfma_f32_32x32x16_bf16 v[80:95], a[156:159], v[48:51], v[80:95]
    ds_read_b128 v[44:47], v4 offset:33024
    v_cvt_pk_bf16_f32 v162, v162, v178
    v_cvt_pk_bf16_f32 v163, v163, v179
    v_mfma_f32_32x32x16_bf16 v[96:111], a[28:31], v[52:55], v[96:111]
    buffer_store_dwordx4 v[160:163], v11, s[12:15], s37 offen offset:0 sc1
    v_mul_f32 v164, s36, v164
    v_mul_f32 v165, s36, v165
    v_mfma_f32_32x32x16_bf16 v[112:127], a[156:159], v[52:55], v[112:127]
    v_mul_f32 v166, s36, v166
    v_mul_f32 v167, s36, v167
    v_mul_f32 v180, s36, v180
    s_waitcnt lgkmcnt(4)
    v_mfma_f32_32x32x16_bf16 v[64:79], a[32:35], v[24:27], v[64:79]
    ds_read_b128 v[48:51], v5 offset:256
    v_mul_f32 v181, s36, v181
    v_mul_f32 v182, s36, v182
    v_mfma_f32_32x32x16_bf16 v[80:95], a[160:163], v[24:27], v[80:95]
    ds_read_b128 v[52:55], v5 offset:33024
    v_mul_f32 v183, s36, v183
    v_cvt_pk_bf16_f32 v164, v164, v180
    v_mfma_f32_32x32x16_bf16 v[96:111], a[32:35], v[28:31], v[96:111]
    v_cvt_pk_bf16_f32 v165, v165, v181
    v_cvt_pk_bf16_f32 v166, v166, v182
    v_cvt_pk_bf16_f32 v167, v167, v183
    v_mfma_f32_32x32x16_bf16 v[112:127], a[160:163], v[28:31], v[112:127]
    buffer_store_dwordx4 v[164:167], v11, s[12:15], s37 offen offset:512 sc1
    v_mul_f32 v168, s36, v168
    v_mul_f32 v169, s36, v169
    s_waitcnt lgkmcnt(4)
    v_mfma_f32_32x32x16_bf16 v[64:79], a[36:39], v[32:35], v[64:79]
    ds_read_b128 v[24:27], v6 offset:256
    v_mul_f32 v170, s36, v170
    v_mul_f32 v171, s36, v171
    v_mfma_f32_32x32x16_bf16 v[80:95], a[164:167], v[32:35], v[80:95]
    ds_read_b128 v[28:31], v6 offset:33024
    v_mul_f32 v184, s36, v184
    v_mul_f32 v185, s36, v185
    v_mfma_f32_32x32x16_bf16 v[96:111], a[36:39], v[36:39], v[96:111]
    v_mul_f32 v186, s36, v186
    v_mul_f32 v187, s36, v187
    v_cvt_pk_bf16_f32 v168, v168, v184
    v_mfma_f32_32x32x16_bf16 v[112:127], a[164:167], v[36:39], v[112:127]
    v_cvt_pk_bf16_f32 v169, v169, v185
    v_cvt_pk_bf16_f32 v170, v170, v186
    v_cvt_pk_bf16_f32 v171, v171, v187
    s_waitcnt lgkmcnt(4)
    v_mfma_f32_32x32x16_bf16 v[64:79], a[40:43], v[40:43], v[64:79]
    ds_read_b128 v[32:35], v7 offset:256
    buffer_store_dwordx4 v[168:171], v11, s[12:15], s37 offen offset:1024 sc1
    v_mul_f32 v172, s36, v172
    v_mfma_f32_32x32x16_bf16 v[80:95], a[168:171], v[40:43], v[80:95]
    ds_read_b128 v[36:39], v7 offset:33024
    v_mul_f32 v173, s36, v173
    v_mul_f32 v174, s36, v174
    v_mfma_f32_32x32x16_bf16 v[96:111], a[40:43], v[44:47], v[96:111]
    v_mul_f32 v175, s36, v175
    v_mul_f32 v188, s36, v188
    v_mul_f32 v189, s36, v189
    v_mfma_f32_32x32x16_bf16 v[112:127], a[168:171], v[44:47], v[112:127]
    v_mul_f32 v190, s36, v190
    v_mul_f32 v191, s36, v191
    v_cvt_pk_bf16_f32 v172, v172, v188
    s_waitcnt lgkmcnt(4)
    v_mfma_f32_32x32x16_bf16 v[64:79], a[44:47], v[48:51], v[64:79]
    ds_read_b128 v[40:43], v8 offset:256
    v_cvt_pk_bf16_f32 v173, v173, v189
    v_cvt_pk_bf16_f32 v174, v174, v190
    v_mfma_f32_32x32x16_bf16 v[80:95], a[172:175], v[48:51], v[80:95]
    ds_read_b128 v[44:47], v8 offset:33024
    v_cvt_pk_bf16_f32 v175, v175, v191
    buffer_store_dwordx4 v[172:175], v11, s[12:15], s37 offen offset:1536 sc1
    v_mfma_f32_32x32x16_bf16 v[96:111], a[44:47], v[52:55], v[96:111]
    s_add_u32 m0, s32, 0
    s_add_u32 s31, s34, 0
    v_xor_b32 v21, 0, v10
    buffer_load_dwordx4 v21, s[8:11], s31 offen offset:0 lds
    v_xor_b32 v22, 16, v10
    buffer_load_dwordx4 v22, s[8:11], s31 offen offset:1024 lds
    v_mfma_f32_32x32x16_bf16 v[112:127], a[172:175], v[52:55], v[112:127]
    s_waitcnt lgkmcnt(4)
    v_mfma_f32_32x32x16_bf16 v[64:79], a[48:51], v[24:27], v[64:79]
    ds_read_b128 v[48:51], v9 offset:256
    v_mfma_f32_32x32x16_bf16 v[80:95], a[176:179], v[24:27], v[80:95]
    ds_read_b128 v[52:55], v9 offset:33024
    v_mfma_f32_32x32x16_bf16 v[96:111], a[48:51], v[28:31], v[96:111]
    v_xor_b32 v21, 32, v10
    buffer_load_dwordx4 v21, s[8:11], s31 offen offset:2048 lds
    v_xor_b32 v22, 48, v10
    buffer_load_dwordx4 v22, s[8:11], s31 offen offset:3072 lds
    v_mfma_f32_32x32x16_bf16 v[112:127], a[176:179], v[28:31], v[112:127]
    s_waitcnt lgkmcnt(4)
    v_mfma_f32_32x32x16_bf16 v[64:79], a[52:55], v[32:35], v[64:79]
    ds_read_b128 v[24:27], v2 offset:512
    v_mfma_f32_32x32x16_bf16 v[80:95], a[180:183], v[32:35], v[80:95]
    ds_read_b128 v[28:31], v2 offset:33280
    v_mfma_f32_32x32x16_bf16 v[96:111], a[52:55], v[36:39], v[96:111]
    s_add_u32 m0, s32, 4096
    s_add_u32 s31, s34, 4096
    v_xor_b32 v21, 64, v10
    buffer_load_dwordx4 v21, s[8:11], s31 offen offset:0 lds
    v_xor_b32 v22, 80, v10
    buffer_load_dwordx4 v22, s[8:11], s31 offen offset:1024 lds
    v_mfma_f32_32x32x16_bf16 v[112:127], a[180:183], v[36:39], v[112:127]
    s_waitcnt lgkmcnt(4)
    v_mfma_f32_32x32x16_bf16 v[64:79], a[56:59], v[40:43], v[64:79]
    ds_read_b128 v[32:35], v3 offset:512
    v_mfma_f32_32x32x16_bf16 v[80:95], a[184:187], v[40:43], v[80:95]
    ds_read_b128 v[36:39], v3 offset:33280
    v_mfma_f32_32x32x16_bf16 v[96:111], a[56:59], v[44:47], v[96:111]
    v_xor_b32 v21, 96, v10
    buffer_load_dwordx4 v21, s[8:11], s31 offen offset:2048 lds
    v_xor_b32 v22, 112, v10
    buffer_load_dwordx4 v22, s[8:11], s31 offen offset:3072 lds
    v_mfma_f32_32x32x16_bf16 v[112:127], a[184:187], v[44:47], v[112:127]
    s_waitcnt lgkmcnt(4)
    v_mfma_f32_32x32x16_bf16 v[64:79], a[60:63], v[48:51], v[64:79]
    ds_read_b128 v[40:43], v4 offset:512
    v_mfma_f32_32x32x16_bf16 v[80:95], a[188:191], v[48:51], v[80:95]
    ds_read_b128 v[44:47], v4 offset:33280
    v_mfma_f32_32x32x16_bf16 v[96:111], a[60:63], v[52:55], v[96:111]
    s_add_u32 m0, s32, 8192
    s_add_u32 s31, s34, 8192
    v_xor_b32 v21, 128, v10
    buffer_load_dwordx4 v21, s[8:11], s31 offen offset:0 lds
    v_xor_b32 v22, 144, v10
    buffer_load_dwordx4 v22, s[8:11], s31 offen offset:1024 lds
    v_mfma_f32_32x32x16_bf16 v[112:127], a[188:191], v[52:55], v[112:127]
    s_waitcnt lgkmcnt(4)
    v_mfma_f32_32x32x16_bf16 v[64:79], a[64:67], v[24:27], v[64:79]
    ds_read_b128 v[48:51], v5 offset:512
    v_mfma_f32_32x32x16_bf16 v[80:95], a[192:195], v[24:27], v[80:95]
    ds_read_b128 v[52:55], v5 offset:33280
    v_mfma_f32_32x32x16_bf16 v[96:111], a[64:67], v[28:31], v[96:111]
    v_xor_b32 v21, 160, v10
    buffer_load_dwordx4 v21, s[8:11], s31 offen offset:2048 lds
    v_xor_b32 v22, 176, v10
    buffer_load_dwordx4 v22, s[8:11], s31 offen offset:3072 lds
    v_mfma_f32_32x32x16_bf16 v[112:127], a[192:195], v[28:31], v[112:127]
    s_waitcnt lgkmcnt(4)
    v_mfma_f32_32x32x16_bf16 v[64:79], a[68:71], v[32:35], v[64:79]
    ds_read_b128 v[24:27], v6 offset:512
    v_mfma_f32_32x32x16_bf16 v[80:95], a[196:199], v[32:35], v[80:95]
    ds_read_b128 v[28:31], v6 offset:33280
    v_mfma_f32_32x32x16_bf16 v[96:111], a[68:71], v[36:39], v[96:111]
    s_add_u32 m0, s32, 12288
    s_add_u32 s31, s34, 12288
    v_xor_b32 v21, 192, v10
    buffer_load_dwordx4 v21, s[8:11], s31 offen offset:0 lds
    v_xor_b32 v22, 208, v10
    buffer_load_dwordx4 v22, s[8:11], s31 offen offset:1024 lds
    v_mfma_f32_32x32x16_bf16 v[112:127], a[196:199], v[36:39], v[112:127]
    s_waitcnt lgkmcnt(4)
    v_mfma_f32_32x32x16_bf16 v[64:79], a[72:75], v[40:43], v[64:79]
    ds_read_b128 v[32:35], v7 offset:512
    v_mfma_f32_32x32x16_bf16 v[80:95], a[200:203], v[40:43], v[80:95]
    ds_read_b128 v[36:39], v7 offset:33280
    v_mfma_f32_32x32x16_bf16 v[96:111], a[72:75], v[44:47], v[96:111]
    v_xor_b32 v21, 224, v10
    buffer_load_dwordx4 v21, s[8:11], s31 offen offset:2048 lds
    v_xor_b32 v22, 240, v10
    buffer_load_dwordx4 v22, s[8:11], s31 offen offset:3072 lds
    v_mfma_f32_32x32x16_bf16 v[112:127], a[200:203], v[44:47], v[112:127]
    s_waitcnt lgkmcnt(4)
    v_mfma_f32_32x32x16_bf16 v[64:79], a[76:79], v[48:51], v[64:79]
    ds_read_b128 v[40:43], v8 offset:512
    v_mfma_f32_32x32x16_bf16 v[80:95], a[204:207], v[48:51], v[80:95]
    ds_read_b128 v[44:47], v8 offset:33280
    v_mfma_f32_32x32x16_bf16 v[96:111], a[76:79], v[52:55], v[96:111]
    v_mfma_f32_32x32x16_bf16 v[112:127], a[204:207], v[52:55], v[112:127]
    s_waitcnt lgkmcnt(4)
    v_mfma_f32_32x32x16_bf16 v[64:79], a[80:83], v[24:27], v[64:79]
    ds_read_b128 v[48:51], v9 offset:512
    v_mfma_f32_32x32x16_bf16 v[80:95], a[208:211], v[24:27], v[80:95]
    ds_read_b128 v[52:55], v9 offset:33280
    v_mfma_f32_32x32x16_bf16 v[96:111], a[80:83], v[28:31], v[96:111]
    v_mfma_f32_32x32x16_bf16 v[112:127], a[208:211], v[28:31], v[112:127]
    s_waitcnt lgkmcnt(4)
    v_mfma_f32_32x32x16_bf16 v[64:79], a[84:87], v[32:35], v[64:79]
    ds_read_b128 v[24:27], v2 offset:768
    v_mfma_f32_32x32x16_bf16 v[80:95], a[212:215], v[32:35], v[80:95]
    ds_read_b128 v[28:31], v2 offset:33536
    v_mfma_f32_32x32x16_bf16 v[96:111], a[84:87], v[36:39], v[96:111]
    v_mfma_f32_32x32x16_bf16 v[112:127], a[212:215], v[36:39], v[112:127]
    s_waitcnt lgkmcnt(4)
    v_mfma_f32_32x32x16_bf16 v[64:79], a[88:91], v[40:43], v[64:79]
    ds_read_b128 v[32:35], v3 offset:768
    v_mfma_f32_32x32x16_bf16 v[80:95], a[216:219], v[40:43], v[80:95]
    ds_read_b128 v[36:39], v3 offset:33536
    v_mfma_f32_32x32x16_bf16 v[96:111], a[88:91], v[44:47], v[96:111]
    v_mfma_f32_32x32x16_bf16 v[112:127], a[216:219], v[44:47], v[112:127]
    s_waitcnt lgkmcnt(4)
    v_mfma_f32_32x32x16_bf16 v[64:79], a[92:95], v[48:51], v[64:79]
    ds_read_b128 v[40:43], v4 offset:768
    v_mfma_f32_32x32x16_bf16 v[80:95], a[220:223], v[48:51], v[80:95]
    ds_read_b128 v[44:47], v4 offset:33536
    v_mfma_f32_32x32x16_bf16 v[96:111], a[92:95], v[52:55], v[96:111]
    v_mfma_f32_32x32x16_bf16 v[112:127], a[220:223], v[52:55], v[112:127]
    s_waitcnt lgkmcnt(4)
    v_mfma_f32_32x32x16_bf16 v[64:79], a[96:99], v[24:27], v[64:79]
    ds_read_b128 v[48:51], v5 offset:768
    v_mfma_f32_32x32x16_bf16 v[80:95], a[224:227], v[24:27], v[80:95]
    ds_read_b128 v[52:55], v5 offset:33536
    v_mfma_f32_32x32x16_bf16 v[96:111], a[96:99], v[28:31], v[96:111]
    v_mfma_f32_32x32x16_bf16 v[112:127], a[224:227], v[28:31], v[112:127]
    s_waitcnt lgkmcnt(4)
    v_mfma_f32_32x32x16_bf16 v[64:79], a[100:103], v[32:35], v[64:79]
    ds_read_b128 v[24:27], v6 offset:768
    v_mfma_f32_32x32x16_bf16 v[80:95], a[228:231], v[32:35], v[80:95]
    ds_read_b128 v[28:31], v6 offset:33536
    v_mfma_f32_32x32x16_bf16 v[96:111], a[100:103], v[36:39], v[96:111]
    v_mfma_f32_32x32x16_bf16 v[112:127], a[228:231], v[36:39], v[112:127]
    s_waitcnt lgkmcnt(4)
    v_mfma_f32_32x32x16_bf16 v[64:79], a[104:107], v[40:43], v[64:79]
    ds_read_b128 v[32:35], v7 offset:768
    v_mfma_f32_32x32x16_bf16 v[80:95], a[232:235], v[40:43], v[80:95]
    ds_read_b128 v[36:39], v7 offset:33536
    v_mfma_f32_32x32x16_bf16 v[96:111], a[104:107], v[44:47], v[96:111]
    v_mfma_f32_32x32x16_bf16 v[112:127], a[232:235], v[44:47], v[112:127]
    s_waitcnt lgkmcnt(4)
    v_mfma_f32_32x32x16_bf16 v[64:79], a[108:111], v[48:51], v[64:79]
    ds_read_b128 v[40:43], v8 offset:768
    v_mfma_f32_32x32x16_bf16 v[80:95], a[236:239], v[48:51], v[80:95]
    ds_read_b128 v[44:47], v8 offset:33536
    v_mfma_f32_32x32x16_bf16 v[96:111], a[108:111], v[52:55], v[96:111]
    v_mfma_f32_32x32x16_bf16 v[112:127], a[236:239], v[52:55], v[112:127]
    s_waitcnt lgkmcnt(4)
    v_mfma_f32_32x32x16_bf16 v[64:79], a[112:115], v[24:27], v[64:79]
    ds_read_b128 v[48:51], v9 offset:768
    v_mfma_f32_32x32x16_bf16 v[80:95], a[240:243], v[24:27], v[80:95]
    ds_read_b128 v[52:55], v9 offset:33536
    v_mfma_f32_32x32x16_bf16 v[96:111], a[112:115], v[28:31], v[96:111]
    v_mfma_f32_32x32x16_bf16 v[112:127], a[240:243], v[28:31], v[112:127]
    s_waitcnt lgkmcnt(4)
    v_mfma_f32_32x32x16_bf16 v[64:79], a[116:119], v[32:35], v[64:79]
    v_mfma_f32_32x32x16_bf16 v[80:95], a[244:247], v[32:35], v[80:95]
    v_xor_b32 v2, 0x10000, v2
    v_mfma_f32_32x32x16_bf16 v[96:111], a[116:119], v[36:39], v[96:111]
    v_xor_b32 v3, 0x10000, v3
    v_mfma_f32_32x32x16_bf16 v[112:127], a[244:247], v[36:39], v[112:127]
    v_xor_b32 v4, 0x10000, v4
    v_mov_b32 v23, s33
    s_waitcnt vmcnt(16)
    buffer_store_dword v23, v240, s[12:15], 0 offen sc1
    s_waitcnt lgkmcnt(2)
    v_mfma_f32_32x32x16_bf16 v[64:79], a[120:123], v[40:43], v[64:79]
    v_mfma_f32_32x32x16_bf16 v[80:95], a[248:251], v[40:43], v[80:95]
    v_xor_b32 v5, 0x10000, v5
    v_mfma_f32_32x32x16_bf16 v[96:111], a[120:123], v[44:47], v[96:111]
    v_xor_b32 v6, 0x10000, v6
    v_mfma_f32_32x32x16_bf16 v[112:127], a[248:251], v[44:47], v[112:127]
    v_xor_b32 v7, 0x10000, v7
    s_waitcnt lgkmcnt(0)
    v_mfma_f32_32x32x16_bf16 v[64:79], a[124:127], v[48:51], v[64:79]
    v_mfma_f32_32x32x16_bf16 v[80:95], a[252:255], v[48:51], v[80:95]
    v_xor_b32 v8, 0x10000, v8
    v_mfma_f32_32x32x16_bf16 v[96:111], a[124:127], v[52:55], v[96:111]
    v_xor_b32 v9, 0x10000, v9
    v_mfma_f32_32x32x16_bf16 v[112:127], a[252:255], v[52:55], v[112:127]
    s_mov_b32 s28, s38
    s_add_u32 s37, s28, s29
    s_lshl_b32 s30, s29, 3
    s_add_u32 s38, s38, s30
    s_add_u32 s33, s33, 1
    s_waitcnt vmcnt(1)
    s_barrier
    s_add_u32 s34, s34, 0x40000
    s_xor_b32 s32, s32, 0x10000
    ds_read_b128 v[24:27], v2 offset:0
    ds_read_b128 v[28:31], v2 offset:32768
    ds_read_b128 v[32:35], v3 offset:0
    ds_read_b128 v[36:39], v3 offset:32768
    ds_read_b128 v[40:43], v4 offset:0
    ds_read_b128 v[44:47], v4 offset:32768
    s_waitcnt lgkmcnt(4)
    v_mfma_f32_32x32x16_bf16 v[128:143], a[0:3], v[24:27], 0
    ds_read_b128 v[48:51], v5 offset:0
    v_mfma_f32_32x32x16_bf16 v[144:159], a[128:131], v[24:27], 0
    ds_read_b128 v[52:55], v5 offset:32768
    v_mfma_f32_32x32x16_bf16 v[160:175], a[0:3], v[28:31], 0
    v_mfma_f32_32x32x16_bf16 v[176:191], a[128:131], v[28:31], 0
    s_waitcnt lgkmcnt(4)
    v_mfma_f32_32x32x16_bf16 v[128:143], a[4:7], v[32:35], v[128:143]
    ds_read_b128 v[24:27], v6 offset:0
    v_mul_f32 v64, s36, v64
    v_mul_f32 v65, s36, v65
    v_mul_f32 v66, s36, v66
    v_mul_f32 v67, s36, v67
    v_mfma_f32_32x32x16_bf16 v[144:159], a[132:135], v[32:35], v[144:159]
    ds_read_b128 v[28:31], v6 offset:32768
    v_mul_f32 v80, s36, v80
    v_mul_f32 v81, s36, v81
    v_mul_f32 v82, s36, v82
    v_mul_f32 v83, s36, v83
    v_mfma_f32_32x32x16_bf16 v[160:175], a[4:7], v[36:39], v[160:175]
    v_cvt_pk_bf16_f32 v64, v64, v80
    v_cvt_pk_bf16_f32 v65, v65, v81
    v_cvt_pk_bf16_f32 v66, v66, v82
    v_cvt_pk_bf16_f32 v67, v67, v83
    buffer_store_dwordx4 v[64:67], v11, s[12:15], s28 offen offset:0 sc1
    v_mfma_f32_32x32x16_bf16 v[176:191], a[132:135], v[36:39], v[176:191]
    v_mul_f32 v68, s36, v68
    v_mul_f32 v69, s36, v69
    v_mul_f32 v70, s36, v70
    v_mul_f32 v71, s36, v71
    v_mul_f32 v84, s36, v84
    s_waitcnt lgkmcnt(4)
    v_mfma_f32_32x32x16_bf16 v[128:143], a[8:11], v[40:43], v[128:143]
    ds_read_b128 v[32:35], v7 offset:0
    v_mul_f32 v85, s36, v85
    v_mul_f32 v86, s36, v86
    v_mul_f32 v87, s36, v87
    v_cvt_pk_bf16_f32 v68, v68, v84
    v_mfma_f32_32x32x16_bf16 v[144:159], a[136:139], v[40:43], v[144:159]
    ds_read_b128 v[36:39], v7 offset:32768
    v_cvt_pk_bf16_f32 v69, v69, v85
    v_cvt_pk_bf16_f32 v70, v70, v86
    v_cvt_pk_bf16_f32 v71, v71, v87
    buffer_store_dwordx4 v[68:71], v11, s[12:15], s28 offen offset:512 sc1
    v_mfma_f32_32x32x16_bf16 v[160:175], a[8:11], v[44:47], v[160:175]
    v_mul_f32 v72, s36, v72
    v_mul_f32 v73, s36, v73
    v_mul_f32 v74, s36, v74
    v_mul_f32 v75, s36, v75
    v_mul_f32 v88, s36, v88
    v_mfma_f32_32x32x16_bf16 v[176:191], a[136:139], v[44:47], v[176:191]
    v_mul_f32 v89, s36, v89
    v_mul_f32 v90, s36, v90
    v_mul_f32 v91, s36, v91
    v_cvt_pk_bf16_f32 v72, v72, v88
    v_cvt_pk_bf16_f32 v73, v73, v89
    s_waitcnt lgkmcnt(4)
    v_mfma_f32_32x32x16_bf16 v[128:143], a[12:15], v[48:51], v[128:143]
    ds_read_b128 v[40:43], v8 offset:0
    v_cvt_pk_bf16_f32 v74, v74, v90
    v_cvt_pk_bf16_f32 v75, v75, v91
    buffer_store_dwordx4 v[72:75], v11, s[12:15], s28 offen offset:1024 sc1
    v_mul_f32 v76, s36, v76
    v_mfma_f32_32x32x16_bf16 v[144:159], a[140:143], v[48:51], v[144:159]
    ds_read_b128 v[44:47], v8 offset:32768
    v_mul_f32 v77, s36, v77
    v_mul_f32 v78, s36, v78
    v_mul_f32 v79, s36, v79
    v_mul_f32 v92, s36, v92
    v_mfma_f32_32x32x16_bf16 v[160:175], a[12:15], v[52:55], v[160:175]
    v_mul_f32 v93, s36, v93
    v_mul_f32 v94, s36, v94
    v_mul_f32 v95, s36, v95
    v_cvt_pk_bf16_f32 v76, v76, v92
    v_cvt_pk_bf16_f32 v77, v77, v93
    v_mfma_f32_32x32x16_bf16 v[176:191], a[140:143], v[52:55], v[176:191]
    v_cvt_pk_bf16_f32 v78, v78, v94
    v_cvt_pk_bf16_f32 v79, v79, v95
    buffer_store_dwordx4 v[76:79], v11, s[12:15], s28 offen offset:1536 sc1
    v_mul_f32 v96, s36, v96
    v_mul_f32 v97, s36, v97
    s_waitcnt lgkmcnt(4)
    v_mfma_f32_32x32x16_bf16 v[128:143], a[16:19], v[24:27], v[128:143]
    ds_read_b128 v[48:51], v9 offset:0
    v_mul_f32 v98, s36, v98
    v_mul_f32 v99, s36, v99
    v_mul_f32 v112, s36, v112
    v_mul_f32 v113, s36, v113
    v_mfma_f32_32x32x16_bf16 v[144:159], a[144:147], v[24:27], v[144:159]
    ds_read_b128 v[52:55], v9 offset:32768
    v_mul_f32 v114, s36, v114
    v_mul_f32 v115, s36, v115
    v_cvt_pk_bf16_f32 v96, v96, v112
    v_cvt_pk_bf16_f32 v97, v97, v113
    v_mfma_f32_32x32x16_bf16 v[160:175], a[16:19], v[28:31], v[160:175]
    v_cvt_pk_bf16_f32 v98, v98, v114
    v_cvt_pk_bf16_f32 v99, v99, v115
    buffer_store_dwordx4 v[96:99], v11, s[12:15], s37 offen offset:0 sc1
    v_mul_f32 v100, s36, v100
    v_mul_f32 v101, s36, v101
    v_mfma_f32_32x32x16_bf16 v[176:191], a[144:147], v[28:31], v[176:191]
    v_mul_f32 v102, s36, v102
    v_mul_f32 v103, s36, v103
    v_mul_f32 v116, s36, v116
    v_mul_f32 v117, s36, v117
    v_mul_f32 v118, s36, v118
    s_waitcnt lgkmcnt(4)
    v_mfma_f32_32x32x16_bf16 v[128:143], a[20:23], v[32:35], v[128:143]
    ds_read_b128 v[24:27], v2 offset:256
    v_mul_f32 v119, s36, v119
    v_cvt_pk_bf16_f32 v100, v100, v116
    v_cvt_pk_bf16_f32 v101, v101, v117
    v_cvt_pk_bf16_f32 v102, v102, v118
    v_mfma_f32_32x32x16_bf16 v[144:159], a[148:151], v[32:35], v[144:159]
    ds_read_b128 v[28:31], v2 offset:33024
    v_cvt_pk_bf16_f32 v103, v103, v119
    buffer_store_dwordx4 v[100:103], v11, s[12:15], s37 offen offset:512 sc1
    v_mul_f32 v104, s36, v104
    v_mul_f32 v105, s36, v105
    v_mfma_f32_32x32x16_bf16 v[160:175], a[20:23], v[36:39], v[160:175]
    v_mul_f32 v106, s36, v106
    v_mul_f32 v107, s36, v107
    v_mul_f32 v120, s36, v120
    v_mul_f32 v121, s36, v121
    v_mul_f32 v122, s36, v122
    v_mfma_f32_32x32x16_bf16 v[176:191], a[148:151], v[36:39], v[176:191]
    v_mul_f32 v123, s36, v123
    v_cvt_pk_bf16_f32 v104, v104, v120
    v_cvt_pk_bf16_f32 v105, v105, v121
    v_cvt_pk_bf16_f32 v106, v106, v122
    v_cvt_pk_bf16_f32 v107, v107, v123
    s_waitcnt lgkmcnt(4)
    v_mfma_f32_32x32x16_bf16 v[128:143], a[24:27], v[40:43], v[128:143]
    ds_read_b128 v[32:35], v3 offset:256
    buffer_store_dwordx4 v[104:107], v11, s[12:15], s37 offen offset:1024 sc1
    v_mul_f32 v108, s36, v108
    v_mul_f32 v109, s36, v109
    v_mul_f32 v110, s36, v110
    v_mfma_f32_32x32x16_bf16 v[144:159], a[152:155], v[40:43], v[144:159]
    ds_read_b128 v[36:39], v3 offset:33024
    v_mul_f32 v111, s36, v111
    v_mul_f32 v124, s36, v124
    v_mul_f32 v125, s36, v125
    v_mul_f32 v126, s36, v126
    v_mfma_f32_32x32x16_bf16 v[160:175], a[24:27], v[44:47], v[160:175]
    v_mul_f32 v127, s36, v127
    v_cvt_pk_bf16_f32 v108, v108, v124
    v_cvt_pk_bf16_f32 v109, v109, v125
    v_cvt_pk_bf16_f32 v110, v110, v126
    v_cvt_pk_bf16_f32 v111, v111, v127
    v_mfma_f32_32x32x16_bf16 v[176:191], a[152:155], v[44:47], v[176:191]
    buffer_store_dwordx4 v[108:111], v11, s[12:15], s37 offen offset:1536 sc1
    s_waitcnt lgkmcnt(4)
    v_mfma_f32_32x32x16_bf16 v[128:143], a[28:31], v[48:51], v[128:143]
    ds_read_b128 v[40:43], v4 offset:256
    v_mfma_f32_32x32x16_bf16 v[144:159], a[156:159], v[48:51], v[144:159]
    ds_read_b128 v[44:47], v4 offset:33024
    v_mfma_f32_32x32x16_bf16 v[160:175], a[28:31], v[52:55], v[160:175]
    s_add_u32 m0, s32, 0
    s_add_u32 s31, s34, 0
    v_xor_b32 v21, 0, v10
    buffer_load_dwordx4 v21, s[8:11], s31 offen offset:0 lds
    v_xor_b32 v22, 16, v10
    buffer_load_dwordx4 v22, s[8:11], s31 offen offset:1024 lds
    v_mfma_f32_32x32x16_bf16 v[176:191], a[156:159], v[52:55], v[176:191]
    s_waitcnt lgkmcnt(4)
    v_mfma_f32_32x32x16_bf16 v[128:143], a[32:35], v[24:27], v[128:143]
    ds_read_b128 v[48:51], v5 offset:256
    v_mfma_f32_32x32x16_bf16 v[144:159], a[160:163], v[24:27], v[144:159]
    ds_read_b128 v[52:55], v5 offset:33024
    v_mfma_f32_32x32x16_bf16 v[160:175], a[32:35], v[28:31], v[160:175]
    v_xor_b32 v21, 32, v10
    buffer_load_dwordx4 v21, s[8:11], s31 offen offset:2048 lds
    v_xor_b32 v22, 48, v10
    buffer_load_dwordx4 v22, s[8:11], s31 offen offset:3072 lds
    v_mfma_f32_32x32x16_bf16 v[176:191], a[160:163], v[28:31], v[176:191]
    s_waitcnt lgkmcnt(4)
    v_mfma_f32_32x32x16_bf16 v[128:143], a[36:39], v[32:35], v[128:143]
    ds_read_b128 v[24:27], v6 offset:256
    v_mfma_f32_32x32x16_bf16 v[144:159], a[164:167], v[32:35], v[144:159]
    ds_read_b128 v[28:31], v6 offset:33024
    v_mfma_f32_32x32x16_bf16 v[160:175], a[36:39], v[36:39], v[160:175]
    s_add_u32 m0, s32, 4096
    s_add_u32 s31, s34, 4096
    v_xor_b32 v21, 64, v10
    buffer_load_dwordx4 v21, s[8:11], s31 offen offset:0 lds
    v_xor_b32 v22, 80, v10
    buffer_load_dwordx4 v22, s[8:11], s31 offen offset:1024 lds
    v_mfma_f32_32x32x16_bf16 v[176:191], a[164:167], v[36:39], v[176:191]
    s_waitcnt lgkmcnt(4)
    v_mfma_f32_32x32x16_bf16 v[128:143], a[40:43], v[40:43], v[128:143]
    ds_read_b128 v[32:35], v7 offset:256
    v_mfma_f32_32x32x16_bf16 v[144:159], a[168:171], v[40:43], v[144:159]
    ds_read_b128 v[36:39], v7 offset:33024
    v_mfma_f32_32x32x16_bf16 v[160:175], a[40:43], v[44:47], v[160:175]
    v_xor_b32 v21, 96, v10
    buffer_load_dwordx4 v21, s[8:11], s31 offen offset:2048 lds
    v_xor_b32 v22, 112, v10
    buffer_load_dwordx4 v22, s[8:11], s31 offen offset:3072 lds
    v_mfma_f32_32x32x16_bf16 v[176:191], a[168:171], v[44:47], v[176:191]
    s_waitcnt lgkmcnt(4)
    v_mfma_f32_32x32x16_bf16 v[128:143], a[44:47], v[48:51], v[128:143]
    ds_read_b128 v[40:43], v8 offset:256
    v_mfma_f32_32x32x16_bf16 v[144:159], a[172:175], v[48:51], v[144:159]
    ds_read_b128 v[44:47], v8 offset:33024
    v_mfma_f32_32x32x16_bf16 v[160:175], a[44:47], v[52:55], v[160:175]
    s_add_u32 m0, s32, 8192
    s_add_u32 s31, s34, 8192
    v_xor_b32 v21, 128, v10
    buffer_load_dwordx4 v21, s[8:11], s31 offen offset:0 lds
    v_xor_b32 v22, 144, v10
    buffer_load_dwordx4 v22, s[8:11], s31 offen offset:1024 lds
    v_mfma_f32_32x32x16_bf16 v[176:191], a[172:175], v[52:55], v[176:191]
    s_waitcnt lgkmcnt(4)
    v_mfma_f32_32x32x16_bf16 v[128:143], a[48:51], v[24:27], v[128:143]
    ds_read_b128 v[48:51], v9 offset:256
    v_mfma_f32_32x32x16_bf16 v[144:159], a[176:179], v[24:27], v[144:159]
    ds_read_b128 v[52:55], v9 offset:33024
    v_mfma_f32_32x32x16_bf16 v[160:175], a[48:51], v[28:31], v[160:175]
    v_xor_b32 v21, 160, v10
    buffer_load_dwordx4 v21, s[8:11], s31 offen offset:2048 lds
    v_xor_b32 v22, 176, v10
    buffer_load_dwordx4 v22, s[8:11], s31 offen offset:3072 lds
    v_mfma_f32_32x32x16_bf16 v[176:191], a[176:179], v[28:31], v[176:191]
    s_waitcnt lgkmcnt(4)
    v_mfma_f32_32x32x16_bf16 v[128:143], a[52:55], v[32:35], v[128:143]
    ds_read_b128 v[24:27], v2 offset:512
    v_mfma_f32_32x32x16_bf16 v[144:159], a[180:183], v[32:35], v[144:159]
    ds_read_b128 v[28:31], v2 offset:33280
    v_mfma_f32_32x32x16_bf16 v[160:175], a[52:55], v[36:39], v[160:175]
    s_add_u32 m0, s32, 12288
    s_add_u32 s31, s34, 12288
    v_xor_b32 v21, 192, v10
    buffer_load_dwordx4 v21, s[8:11], s31 offen offset:0 lds
    v_xor_b32 v22, 208, v10
    buffer_load_dwordx4 v22, s[8:11], s31 offen offset:1024 lds
    v_mfma_f32_32x32x16_bf16 v[176:191], a[180:183], v[36:39], v[176:191]
    s_waitcnt lgkmcnt(4)
    v_mfma_f32_32x32x16_bf16 v[128:143], a[56:59], v[40:43], v[128:143]
    ds_read_b128 v[32:35], v3 offset:512
    v_mfma_f32_32x32x16_bf16 v[144:159], a[184:187], v[40:43], v[144:159]
    ds_read_b128 v[36:39], v3 offset:33280
    v_mfma_f32_32x32x16_bf16 v[160:175], a[56:59], v[44:47], v[160:175]
    v_xor_b32 v21, 224, v10
    buffer_load_dwordx4 v21, s[8:11], s31 offen offset:2048 lds
    v_xor_b32 v22, 240, v10
    buffer_load_dwordx4 v22, s[8:11], s31 offen offset:3072 lds
    v_mfma_f32_32x32x16_bf16 v[176:191], a[184:187], v[44:47], v[176:191]
    s_waitcnt lgkmcnt(4)
    v_mfma_f32_32x32x16_bf16 v[128:143], a[60:63], v[48:51], v[128:143]
    ds_read_b128 v[40:43], v4 offset:512
    v_mfma_f32_32x32x16_bf16 v[144:159], a[188:191], v[48:51], v[144:159]
    ds_read_b128 v[44:47], v4 offset:33280
    v_mfma_f32_32x32x16_bf16 v[160:175], a[60:63], v[52:55], v[160:175]
    v_mfma_f32_32x32x16_bf16 v[176:191], a[188:191], v[52:55], v[176:191]
    s_waitcnt lgkmcnt(4)
    v_mfma_f32_32x32x16_bf16 v[128:143], a[64:67], v[24:27], v[128:143]
    ds_read_b128 v[48:51], v5 offset:512
    v_mfma_f32_32x32x16_bf16 v[144:159], a[192:195], v[24:27], v[144:159]
    ds_read_b128 v[52:55], v5 offset:33280
    v_mfma_f32_32x32x16_bf16 v[160:175], a[64:67], v[28:31], v[160:175]
    v_mfma_f32_32x32x16_bf16 v[176:191], a[192:195], v[28:31], v[176:191]
    v_mov_b32 v23, s33
    s_waitcnt vmcnt(16)
    buffer_store_dword v23, v240, s[12:15], 0 offen sc1
    s_waitcnt lgkmcnt(4)
    v_mfma_f32_32x32x16_bf16 v[128:143], a[68:71], v[32:35], v[128:143]
    ds_read_b128 v[24:27], v6 offset:512
    v_mfma_f32_32x32x16_bf16 v[144:159], a[196:199], v[32:35], v[144:159]
    ds_read_b128 v[28:31], v6 offset:33280
    v_mfma_f32_32x32x16_bf16 v[160:175], a[68:71], v[36:39], v[160:175]
    v_mfma_f32_32x32x16_bf16 v[176:191], a[196:199], v[36:39], v[176:191]
    s_waitcnt lgkmcnt(4)
    v_mfma_f32_32x32x16_bf16 v[128:143], a[72:75], v[40:43], v[128:143]
    ds_read_b128 v[32:35], v7 offset:512
    v_mfma_f32_32x32x16_bf16 v[144:159], a[200:203], v[40:43], v[144:159]
    ds_read_b128 v[36:39], v7 offset:33280
    v_mfma_f32_32x32x16_bf16 v[160:175], a[72:75], v[44:47], v[160:175]
    v_mfma_f32_32x32x16_bf16 v[176:191], a[200:203], v[44:47], v[176:191]
    s_waitcnt lgkmcnt(4)
    v_mfma_f32_32x32x16_bf16 v[128:143], a[76:79], v[48:51], v[128:143]
    ds_read_b128 v[40:43], v8 offset:512
    v_mfma_f32_32x32x16_bf16 v[144:159], a[204:207], v[48:51], v[144:159]
    ds_read_b128 v[44:47], v8 offset:33280
    v_mfma_f32_32x32x16_bf16 v[160:175], a[76:79], v[52:55], v[160:175]
    v_mfma_f32_32x32x16_bf16 v[176:191], a[204:207], v[52:55], v[176:191]
    s_waitcnt lgkmcnt(4)
    v_mfma_f32_32x32x16_bf16 v[128:143], a[80:83], v[24:27], v[128:143]
    ds_read_b128 v[48:51], v9 offset:512
    v_mfma_f32_32x32x16_bf16 v[144:159], a[208:211], v[24:27], v[144:159]
    ds_read_b128 v[52:55], v9 offset:33280
    v_mfma_f32_32x32x16_bf16 v[160:175], a[80:83], v[28:31], v[160:175]
    v_mfma_f32_32x32x16_bf16 v[176:191], a[208:211], v[28:31], v[176:191]
    s_waitcnt lgkmcnt(4)
    v_mfma_f32_32x32x16_bf16 v[128:143], a[84:87], v[32:35], v[128:143]
    ds_read_b128 v[24:27], v2 offset:768
    v_mfma_f32_32x32x16_bf16 v[144:159], a[212:215], v[32:35], v[144:159]
    ds_read_b128 v[28:31], v2 offset:33536
    v_mfma_f32_32x32x16_bf16 v[160:175], a[84:87], v[36:39], v[160:175]
    v_mfma_f32_32x32x16_bf16 v[176:191], a[212:215], v[36:39], v[176:191]
    s_waitcnt lgkmcnt(4)
    v_mfma_f32_32x32x16_bf16 v[128:143], a[88:91], v[40:43], v[128:143]
    ds_read_b128 v[32:35], v3 offset:768
    v_mfma_f32_32x32x16_bf16 v[144:159], a[216:219], v[40:43], v[144:159]
    ds_read_b128 v[36:39], v3 offset:33536
    v_mfma_f32_32x32x16_bf16 v[160:175], a[88:91], v[44:47], v[160:175]
    v_mfma_f32_32x32x16_bf16 v[176:191], a[216:219], v[44:47], v[176:191]
    s_waitcnt lgkmcnt(4)
    v_mfma_f32_32x32x16_bf16 v[128:143], a[92:95], v[48:51], v[128:143]
    ds_read_b128 v[40:43], v4 offset:768
    v_mfma_f32_32x32x16_bf16 v[144:159], a[220:223], v[48:51], v[144:159]
    ds_read_b128 v[44:47], v4 offset:33536
    v_mfma_f32_32x32x16_bf16 v[160:175], a[92:95], v[52:55], v[160:175]
    v_mfma_f32_32x32x16_bf16 v[176:191], a[220:223], v[52:55], v[176:191]
    s_waitcnt lgkmcnt(4)
    v_mfma_f32_32x32x16_bf16 v[128:143], a[96:99], v[24:27], v[128:143]
    ds_read_b128 v[48:51], v5 offset:768
    v_mfma_f32_32x32x16_bf16 v[144:159], a[224:227], v[24:27], v[144:159]
    ds_read_b128 v[52:55], v5 offset:33536
    v_mfma_f32_32x32x16_bf16 v[160:175], a[96:99], v[28:31], v[160:175]
    v_mfma_f32_32x32x16_bf16 v[176:191], a[224:227], v[28:31], v[176:191]
    s_waitcnt lgkmcnt(4)
    v_mfma_f32_32x32x16_bf16 v[128:143], a[100:103], v[32:35], v[128:143]
    ds_read_b128 v[24:27], v6 offset:768
    v_mfma_f32_32x32x16_bf16 v[144:159], a[228:231], v[32:35], v[144:159]
    ds_read_b128 v[28:31], v6 offset:33536
    v_mfma_f32_32x32x16_bf16 v[160:175], a[100:103], v[36:39], v[160:175]
    v_mfma_f32_32x32x16_bf16 v[176:191], a[228:231], v[36:39], v[176:191]
    s_waitcnt lgkmcnt(4)
    v_mfma_f32_32x32x16_bf16 v[128:143], a[104:107], v[40:43], v[128:143]
    ds_read_b128 v[32:35], v7 offset:768
    v_mfma_f32_32x32x16_bf16 v[144:159], a[232:235], v[40:43], v[144:159]
    ds_read_b128 v[36:39], v7 offset:33536
    v_mfma_f32_32x32x16_bf16 v[160:175], a[104:107], v[44:47], v[160:175]
    v_mfma_f32_32x32x16_bf16 v[176:191], a[232:235], v[44:47], v[176:191]
    s_waitcnt lgkmcnt(4)
    v_mfma_f32_32x32x16_bf16 v[128:143], a[108:111], v[48:51], v[128:143]
    ds_read_b128 v[40:43], v8 offset:768
    v_mfma_f32_32x32x16_bf16 v[144:159], a[236:239], v[48:51], v[144:159]
    ds_read_b128 v[44:47], v8 offset:33536
    v_mfma_f32_32x32x16_bf16 v[160:175], a[108:111], v[52:55], v[160:175]
    v_mfma_f32_32x32x16_bf16 v[176:191], a[236:239], v[52:55], v[176:191]
    s_waitcnt lgkmcnt(4)
    v_mfma_f32_32x32x16_bf16 v[128:143], a[112:115], v[24:27], v[128:143]
    ds_read_b128 v[48:51], v9 offset:768
    v_mfma_f32_32x32x16_bf16 v[144:159], a[240:243], v[24:27], v[144:159]
    ds_read_b128 v[52:55], v9 offset:33536
    v_mfma_f32_32x32x16_bf16 v[160:175], a[112:115], v[28:31], v[160:175]
    v_mfma_f32_32x32x16_bf16 v[176:191], a[240:243], v[28:31], v[176:191]
    s_waitcnt lgkmcnt(4)
    v_mfma_f32_32x32x16_bf16 v[128:143], a[116:119], v[32:35], v[128:143]
    v_mfma_f32_32x32x16_bf16 v[144:159], a[244:247], v[32:35], v[144:159]
    v_xor_b32 v2, 0x10000, v2
    v_mfma_f32_32x32x16_bf16 v[160:175], a[116:119], v[36:39], v[160:175]
    v_xor_b32 v3, 0x10000, v3
    v_mfma_f32_32x32x16_bf16 v[176:191], a[244:247], v[36:39], v[176:191]
    v_xor_b32 v4, 0x10000, v4
    s_waitcnt lgkmcnt(2)
    v_mfma_f32_32x32x16_bf16 v[128:143], a[120:123], v[40:43], v[128:143]
    v_mfma_f32_32x32x16_bf16 v[144:159], a[248:251], v[40:43], v[144:159]
    v_xor_b32 v5, 0x10000, v5
    v_mfma_f32_32x32x16_bf16 v[160:175], a[120:123], v[44:47], v[160:175]
    v_xor_b32 v6, 0x10000, v6
    v_mfma_f32_32x32x16_bf16 v[176:191], a[248:251], v[44:47], v[176:191]
    v_xor_b32 v7, 0x10000, v7
    s_waitcnt lgkmcnt(0)
    v_mfma_f32_32x32x16_bf16 v[128:143], a[124:127], v[48:51], v[128:143]
    v_mfma_f32_32x32x16_bf16 v[144:159], a[252:255], v[48:51], v[144:159]
    v_xor_b32 v8, 0x10000, v8
    v_mfma_f32_32x32x16_bf16 v[160:175], a[124:127], v[52:55], v[160:175]
    v_xor_b32 v9, 0x10000, v9
    v_mfma_f32_32x32x16_bf16 v[176:191], a[252:255], v[52:55], v[176:191]
    s_mov_b32 s28, s38
    s_add_u32 s37, s28, s29
    s_lshl_b32 s30, s29, 3
    s_add_u32 s38, s38, s30
    s_add_u32 s33, s33, 1
    s_cmp_lt_u32 s33, 8
    s_cbranch_scc1 P1L_76
    v_mul_f32 v128, s36, v128
    v_mul_f32 v129, s36, v129
    v_mul_f32 v130, s36, v130
    v_mul_f32 v131, s36, v131
    v_mul_f32 v144, s36, v144
    v_mul_f32 v145, s36, v145
    v_mul_f32 v146, s36, v146
    v_mul_f32 v147, s36, v147
    v_cvt_pk_bf16_f32 v128, v128, v144
    v_cvt_pk_bf16_f32 v129, v129, v145
    v_cvt_pk_bf16_f32 v130, v130, v146
    v_cvt_pk_bf16_f32 v131, v131, v147
    buffer_store_dwordx4 v[128:131], v11, s[12:15], s28 offen offset:0 sc1
    v_mul_f32 v132, s36, v132
    v_mul_f32 v133, s36, v133
    v_mul_f32 v134, s36, v134
    v_mul_f32 v135, s36, v135
    v_mul_f32 v148, s36, v148
    v_mul_f32 v149, s36, v149
    v_mul_f32 v150, s36, v150
    v_mul_f32 v151, s36, v151
    v_cvt_pk_bf16_f32 v132, v132, v148
    v_cvt_pk_bf16_f32 v133, v133, v149
    v_cvt_pk_bf16_f32 v134, v134, v150
    v_cvt_pk_bf16_f32 v135, v135, v151
    buffer_store_dwordx4 v[132:135], v11, s[12:15], s28 offen offset:512 sc1
    v_mul_f32 v136, s36, v136
    v_mul_f32 v137, s36, v137
    v_mul_f32 v138, s36, v138
    v_mul_f32 v139, s36, v139
    v_mul_f32 v152, s36, v152
    v_mul_f32 v153, s36, v153
    v_mul_f32 v154, s36, v154
    v_mul_f32 v155, s36, v155
    v_cvt_pk_bf16_f32 v136, v136, v152
    v_cvt_pk_bf16_f32 v137, v137, v153
    v_cvt_pk_bf16_f32 v138, v138, v154
    v_cvt_pk_bf16_f32 v139, v139, v155
    buffer_store_dwordx4 v[136:139], v11, s[12:15], s28 offen offset:1024 sc1
    v_mul_f32 v140, s36, v140
    v_mul_f32 v141, s36, v141
    v_mul_f32 v142, s36, v142
    v_mul_f32 v143, s36, v143
    v_mul_f32 v156, s36, v156
    v_mul_f32 v157, s36, v157
    v_mul_f32 v158, s36, v158
    v_mul_f32 v159, s36, v159
    v_cvt_pk_bf16_f32 v140, v140, v156
    v_cvt_pk_bf16_f32 v141, v141, v157
    v_cvt_pk_bf16_f32 v142, v142, v158
    v_cvt_pk_bf16_f32 v143, v143, v159
    buffer_store_dwordx4 v[140:143], v11, s[12:15], s28 offen offset:1536 sc1
    v_mul_f32 v160, s36, v160
    v_mul_f32 v161, s36, v161
    v_mul_f32 v162, s36, v162
    v_mul_f32 v163, s36, v163
    v_mul_f32 v176, s36, v176
    v_mul_f32 v177, s36, v177
    v_mul_f32 v178, s36, v178
    v_mul_f32 v179, s36, v179
    v_cvt_pk_bf16_f32 v160, v160, v176
    v_cvt_pk_bf16_f32 v161, v161, v177
    v_cvt_pk_bf16_f32 v162, v162, v178
    v_cvt_pk_bf16_f32 v163, v163, v179
    buffer_store_dwordx4 v[160:163], v11, s[12:15], s37 offen offset:0 sc1
    v_mul_f32 v164, s36, v164
    v_mul_f32 v165, s36, v165
    v_mul_f32 v166, s36, v166
    v_mul_f32 v167, s36, v167
    v_mul_f32 v180, s36, v180
    v_mul_f32 v181, s36, v181
    v_mul_f32 v182, s36, v182
    v_mul_f32 v183, s36, v183
    v_cvt_pk_bf16_f32 v164, v164, v180
    v_cvt_pk_bf16_f32 v165, v165, v181
    v_cvt_pk_bf16_f32 v166, v166, v182
    v_cvt_pk_bf16_f32 v167, v167, v183
    buffer_store_dwordx4 v[164:167], v11, s[12:15], s37 offen offset:512 sc1
    v_mul_f32 v168, s36, v168
    v_mul_f32 v169, s36, v169
    v_mul_f32 v170, s36, v170
    v_mul_f32 v171, s36, v171
    v_mul_f32 v184, s36, v184
    v_mul_f32 v185, s36, v185
    v_mul_f32 v186, s36, v186
    v_mul_f32 v187, s36, v187
    v_cvt_pk_bf16_f32 v168, v168, v184
    v_cvt_pk_bf16_f32 v169, v169, v185
    v_cvt_pk_bf16_f32 v170, v170, v186
    v_cvt_pk_bf16_f32 v171, v171, v187
    buffer_store_dwordx4 v[168:171], v11, s[12:15], s37 offen offset:1024 sc1
    v_mul_f32 v172, s36, v172
    v_mul_f32 v173, s36, v173
    v_mul_f32 v174, s36, v174
    v_mul_f32 v175, s36, v175
    v_mul_f32 v188, s36, v188
    v_mul_f32 v189, s36, v189
    v_mul_f32 v190, s36, v190
    v_mul_f32 v191, s36, v191
    v_cvt_pk_bf16_f32 v172, v172, v188
    v_cvt_pk_bf16_f32 v173, v173, v189
    v_cvt_pk_bf16_f32 v174, v174, v190
    v_cvt_pk_bf16_f32 v175, v175, v191
    buffer_store_dwordx4 v[172:175], v11, s[12:15], s37 offen offset:1536 sc1
    v_mov_b32 v23, 8
    s_waitcnt vmcnt(0)
    buffer_store_dword v23, v240, s[12:15], 0 offen sc1
    s_branch P1END
P1V_74:
    s_mov_b32 s33, 0
    s_mov_b32 s38, s28
    s_mov_b32 s28, 0x40000000
    s_mov_b32 s37, 0x40000000
P1L_77:
    s_waitcnt vmcnt(1)
    s_barrier
    s_add_u32 s34, s34, 0x40000
    s_xor_b32 s32, s32, 0x10000
    ds_read_b128 v[24:27], v2 offset:0
    ds_read_b128 v[28:31], v2 offset:32768
    ds_read_b128 v[32:35], v3 offset:0
    ds_read_b128 v[36:39], v3 offset:32768
    ds_read_b128 v[40:43], v4 offset:0
    ds_read_b128 v[44:47], v4 offset:32768
    s_waitcnt lgkmcnt(4)
    v_mfma_f32_32x32x16_bf16 v[64:79], v[24:27], a[0:3], 0
    ds_read_b128 v[48:51], v5 offset:0
    v_mfma_f32_32x32x16_bf16 v[80:95], v[24:27], a[128:131], 0
    ds_read_b128 v[52:55], v5 offset:32768
    v_mfma_f32_32x32x16_bf16 v[96:111], v[28:31], a[0:3], 0
    v_mfma_f32_32x32x16_bf16 v[112:127], v[28:31], a[128:131], 0
    s_waitcnt lgkmcnt(4)
    v_mfma_f32_32x32x16_bf16 v[64:79], v[32:35], a[4:7], v[64:79]
    ds_read_b128 v[24:27], v6 offset:0
    v_cvt_pk_bf16_f32 v128, v128, v129
    v_cvt_pk_bf16_f32 v129, v130, v131
    v_mfma_f32_32x32x16_bf16 v[80:95], v[32:35], a[132:135], v[80:95]
    ds_read_b128 v[28:31], v6 offset:32768
    v_cvt_pk_bf16_f32 v130, v132, v133
    v_cvt_pk_bf16_f32 v131, v134, v135
    v_mfma_f32_32x32x16_bf16 v[96:111], v[36:39], a[4:7], v[96:111]
    buffer_store_dwordx4 v[128:131], v11, s[12:15], s28 offen offset:0 sc1
    v_cvt_pk_bf16_f32 v136, v136, v137
    v_cvt_pk_bf16_f32 v137, v138, v139
    v_mfma_f32_32x32x16_bf16 v[112:127], v[36:39], a[132:135], v[112:127]
    v_cvt_pk_bf16_f32 v138, v140, v141
    v_cvt_pk_bf16_f32 v139, v142, v143
    buffer_store_dwordx4 v[136:139], v11, s[12:15], s28 offen offset:512 sc1
    s_waitcnt lgkmcnt(4)
    v_mfma_f32_32x32x16_bf16 v[64:79], v[40:43], a[8:11], v[64:79]
    ds_read_b128 v[32:35], v7 offset:0
    v_cvt_pk_bf16_f32 v144, v144, v145
    v_cvt_pk_bf16_f32 v145, v146, v147
    v_mfma_f32_32x32x16_bf16 v[80:95], v[40:43], a[136:139], v[80:95]
    ds_read_b128 v[36:39], v7 offset:32768
    v_cvt_pk_bf16_f32 v146, v148, v149
    v_cvt_pk_bf16_f32 v147, v150, v151
    v_mfma_f32_32x32x16_bf16 v[96:111], v[44:47], a[8:11], v[96:111]
    buffer_store_dwordx4 v[144:147], v11, s[12:15], s28 offen offset:1024 sc1
    v_cvt_pk_bf16_f32 v152, v152, v153
    v_cvt_pk_bf16_f32 v153, v154, v155
    v_mfma_f32_32x32x16_bf16 v[112:127], v[44:47], a[136:139], v[112:127]
    v_cvt_pk_bf16_f32 v154, v156, v157
    v_cvt_pk_bf16_f32 v155, v158, v159
    buffer_store_dwordx4 v[152:155], v11, s[12:15], s28 offen offset:1536 sc1
    s_waitcnt lgkmcnt(4)
    v_mfma_f32_32x32x16_bf16 v[64:79], v[48:51], a[12:15], v[64:79]
    ds_read_b128 v[40:43], v8 offset:0
    v_cvt_pk_bf16_f32 v160, v160, v161
    v_cvt_pk_bf16_f32 v161, v162, v163
    v_mfma_f32_32x32x16_bf16 v[80:95], v[48:51], a[140:143], v[80:95]
    ds_read_b128 v[44:47], v8 offset:32768
    v_cvt_pk_bf16_f32 v162, v164, v165
    v_cvt_pk_bf16_f32 v163, v166, v167
    v_mfma_f32_32x32x16_bf16 v[96:111], v[52:55], a[12:15], v[96:111]
    buffer_store_dwordx4 v[160:163], v11, s[12:15], s37 offen offset:0 sc1
    v_cvt_pk_bf16_f32 v168, v168, v169
    v_cvt_pk_bf16_f32 v169, v170, v171
    v_mfma_f32_32x32x16_bf16 v[112:127], v[52:55], a[140:143], v[112:127]
    v_cvt_pk_bf16_f32 v170, v172, v173
    v_cvt_pk_bf16_f32 v171, v174, v175
    buffer_store_dwordx4 v[168:171], v11, s[12:15], s37 offen offset:512 sc1
    s_waitcnt lgkmcnt(4)
    v_mfma_f32_32x32x16_bf16 v[64:79], v[24:27], a[16:19], v[64:79]
    ds_read_b128 v[48:51], v9 offset:0
    v_cvt_pk_bf16_f32 v176, v176, v177
    v_cvt_pk_bf16_f32 v177, v178, v179
    v_mfma_f32_32x32x16_bf16 v[80:95], v[24:27], a[144:147], v[80:95]
    ds_read_b128 v[52:55], v9 offset:32768
    v_cvt_pk_bf16_f32 v178, v180, v181
    v_cvt_pk_bf16_f32 v179, v182, v183
    v_mfma_f32_32x32x16_bf16 v[96:111], v[28:31], a[16:19], v[96:111]
    buffer_store_dwordx4 v[176:179], v11, s[12:15], s37 offen offset:1024 sc1
    v_cvt_pk_bf16_f32 v184, v184, v185
    v_cvt_pk_bf16_f32 v185, v186, v187
    v_mfma_f32_32x32x16_bf16 v[112:127], v[28:31], a[144:147], v[112:127]
    v_cvt_pk_bf16_f32 v186, v188, v189
    v_cvt_pk_bf16_f32 v187, v190, v191
    buffer_store_dwordx4 v[184:187], v11, s[12:15], s37 offen offset:1536 sc1
    s_waitcnt lgkmcnt(4)
    v_mfma_f32_32x32x16_bf16 v[64:79], v[32:35], a[20:23], v[64:79]
    ds_read_b128 v[24:27], v2 offset:256
    v_mfma_f32_32x32x16_bf16 v[80:95], v[32:35], a[148:151], v[80:95]
    ds_read_b128 v[28:31], v2 offset:33024
    v_mfma_f32_32x32x16_bf16 v[96:111], v[36:39], a[20:23], v[96:111]
    s_add_u32 m0, s32, 0
    s_add_u32 s31, s34, 0
    v_xor_b32 v21, 0, v10
    buffer_load_dwordx4 v21, s[8:11], s31 offen offset:0 lds
    v_xor_b32 v22, 16, v10
    buffer_load_dwordx4 v22, s[8:11], s31 offen offset:1024 lds
    v_mfma_f32_32x32x16_bf16 v[112:127], v[36:39], a[148:151], v[112:127]
    s_waitcnt lgkmcnt(4)
    v_mfma_f32_32x32x16_bf16 v[64:79], v[40:43], a[24:27], v[64:79]
    ds_read_b128 v[32:35], v3 offset:256
    v_mfma_f32_32x32x16_bf16 v[80:95], v[40:43], a[152:155], v[80:95]
    ds_read_b128 v[36:39], v3 offset:33024
    v_mfma_f32_32x32x16_bf16 v[96:111], v[44:47], a[24:27], v[96:111]
    v_xor_b32 v21, 32, v10
    buffer_load_dwordx4 v21, s[8:11], s31 offen offset:2048 lds
    v_xor_b32 v22, 48, v10
    buffer_load_dwordx4 v22, s[8:11], s31 offen offset:3072 lds
    v_mfma_f32_32x32x16_bf16 v[112:127], v[44:47], a[152:155], v[112:127]
    s_waitcnt lgkmcnt(4)
    v_mfma_f32_32x32x16_bf16 v[64:79], v[48:51], a[28:31], v[64:79]
    ds_read_b128 v[40:43], v4 offset:256
    v_mfma_f32_32x32x16_bf16 v[80:95], v[48:51], a[156:159], v[80:95]
    ds_read_b128 v[44:47], v4 offset:33024
    v_mfma_f32_32x32x16_bf16 v[96:111], v[52:55], a[28:31], v[96:111]
    s_add_u32 m0, s32, 4096
    s_add_u32 s31, s34, 4096
    v_xor_b32 v21, 64, v10
    buffer_load_dwordx4 v21, s[8:11], s31 offen offset:0 lds
    v_xor_b32 v22, 80, v10
    buffer_load_dwordx4 v22, s[8:11], s31 offen offset:1024 lds
    v_mfma_f32_32x32x16_bf16 v[112:127], v[52:55], a[156:159], v[112:127]
    s_waitcnt lgkmcnt(4)
    v_mfma_f32_32x32x16_bf16 v[64:79], v[24:27], a[32:35], v[64:79]
    ds_read_b128 v[48:51], v5 offset:256
    v_mfma_f32_32x32x16_bf16 v[80:95], v[24:27], a[160:163], v[80:95]
    ds_read_b128 v[52:55], v5 offset:33024
    v_mfma_f32_32x32x16_bf16 v[96:111], v[28:31], a[32:35], v[96:111]
    v_xor_b32 v21, 96, v10
    buffer_load_dwordx4 v21, s[8:11], s31 offen offset:2048 lds
    v_xor_b32 v22, 112, v10
    buffer_load_dwordx4 v22, s[8:11], s31 offen offset:3072 lds
    v_mfma_f32_32x32x16_bf16 v[112:127], v[28:31], a[160:163], v[112:127]
    s_waitcnt lgkmcnt(4)
    v_mfma_f32_32x32x16_bf16 v[64:79], v[32:35], a[36:39], v[64:79]
    ds_read_b128 v[24:27], v6 offset:256
    v_mfma_f32_32x32x16_bf16 v[80:95], v[32:35], a[164:167], v[80:95]
    ds_read_b128 v[28:31], v6 offset:33024
    v_mfma_f32_32x32x16_bf16 v[96:111], v[36:39], a[36:39], v[96:111]
    s_add_u32 m0, s32, 8192
    s_add_u32 s31, s34, 8192
    v_xor_b32 v21, 128, v10
    buffer_load_dwordx4 v21, s[8:11], s31 offen offset:0 lds
    v_xor_b32 v22, 144, v10
    buffer_load_dwordx4 v22, s[8:11], s31 offen offset:1024 lds
    v_mfma_f32_32x32x16_bf16 v[112:127], v[36:39], a[164:167], v[112:127]
    s_waitcnt lgkmcnt(4)
    v_mfma_f32_32x32x16_bf16 v[64:79], v[40:43], a[40:43], v[64:79]
    ds_read_b128 v[32:35], v7 offset:256
    v_mfma_f32_32x32x16_bf16 v[80:95], v[40:43], a[168:171], v[80:95]
    ds_read_b128 v[36:39], v7 offset:33024
    v_mfma_f32_32x32x16_bf16 v[96:111], v[44:47], a[40:43], v[96:111]
    v_xor_b32 v21, 160, v10
    buffer_load_dwordx4 v21, s[8:11], s31 offen offset:2048 lds
    v_xor_b32 v22, 176, v10
    buffer_load_dwordx4 v22, s[8:11], s31 offen offset:3072 lds
    v_mfma_f32_32x32x16_bf16 v[112:127], v[44:47], a[168:171], v[112:127]
    s_waitcnt lgkmcnt(4)
    v_mfma_f32_32x32x16_bf16 v[64:79], v[48:51], a[44:47], v[64:79]
    ds_read_b128 v[40:43], v8 offset:256
    v_mfma_f32_32x32x16_bf16 v[80:95], v[48:51], a[172:175], v[80:95]
    ds_read_b128 v[44:47], v8 offset:33024
    v_mfma_f32_32x32x16_bf16 v[96:111], v[52:55], a[44:47], v[96:111]
    s_add_u32 m0, s32, 12288
    s_add_u32 s31, s34, 12288
    v_xor_b32 v21, 192, v10
    buffer_load_dwordx4 v21, s[8:11], s31 offen offset:0 lds
    v_xor_b32 v22, 208, v10
    buffer_load_dwordx4 v22, s[8:11], s31 offen offset:1024 lds
    v_mfma_f32_32x32x16_bf16 v[112:127], v[52:55], a[172:175], v[112:127]
    s_waitcnt lgkmcnt(4)
    v_mfma_f32_32x32x16_bf16 v[64:79], v[24:27], a[48:51], v[64:79]
    ds_read_b128 v[48:51], v9 offset:256
    v_mfma_f32_32x32x16_bf16 v[80:95], v[24:27], a[176:179], v[80:95]
    ds_read_b128 v[52:55], v9 offset:33024
    v_mfma_f32_32x32x16_bf16 v[96:111], v[28:31], a[48:51], v[96:111]
    v_xor_b32 v21, 224, v10
    buffer_load_dwordx4 v21, s[8:11], s31 offen offset:2048 lds
    v_xor_b32 v22, 240, v10
    buffer_load_dwordx4 v22, s[8:11], s31 offen offset:3072 lds
    v_mfma_f32_32x32x16_bf16 v[112:127], v[28:31], a[176:179], v[112:127]
    s_waitcnt lgkmcnt(4)
    v_mfma_f32_32x32x16_bf16 v[64:79], v[32:35], a[52:55], v[64:79]
    ds_read_b128 v[24:27], v2 offset:512
    v_mfma_f32_32x32x16_bf16 v[80:95], v[32:35], a[180:183], v[80:95]
    ds_read_b128 v[28:31], v2 offset:33280
    v_mfma_f32_32x32x16_bf16 v[96:111], v[36:39], a[52:55], v[96:111]
    v_mfma_f32_32x32x16_bf16 v[112:127], v[36:39], a[180:183], v[112:127]
    s_waitcnt lgkmcnt(4)
    v_mfma_f32_32x32x16_bf16 v[64:79], v[40:43], a[56:59], v[64:79]
    ds_read_b128 v[32:35], v3 offset:512
    v_mfma_f32_32x32x16_bf16 v[80:95], v[40:43], a[184:187], v[80:95]
    ds_read_b128 v[36:39], v3 offset:33280
    v_mfma_f32_32x32x16_bf16 v[96:111], v[44:47], a[56:59], v[96:111]
    v_mfma_f32_32x32x16_bf16 v[112:127], v[44:47], a[184:187], v[112:127]
    s_waitcnt lgkmcnt(4)
    v_mfma_f32_32x32x16_bf16 v[64:79], v[48:51], a[60:63], v[64:79]
    ds_read_b128 v[40:43], v4 offset:512
    v_mfma_f32_32x32x16_bf16 v[80:95], v[48:51], a[188:191], v[80:95]
    ds_read_b128 v[44:47], v4 offset:33280
    v_mfma_f32_32x32x16_bf16 v[96:111], v[52:55], a[60:63], v[96:111]
    v_mfma_f32_32x32x16_bf16 v[112:127], v[52:55], a[188:191], v[112:127]
    s_waitcnt lgkmcnt(4)
    v_mfma_f32_32x32x16_bf16 v[64:79], v[24:27], a[64:67], v[64:79]
    ds_read_b128 v[48:51], v5 offset:512
    v_mfma_f32_32x32x16_bf16 v[80:95], v[24:27], a[192:195], v[80:95]
    ds_read_b128 v[52:55], v5 offset:33280
    v_mfma_f32_32x32x16_bf16 v[96:111], v[28:31], a[64:67], v[96:111]
    v_mfma_f32_32x32x16_bf16 v[112:127], v[28:31], a[192:195], v[112:127]
    s_waitcnt lgkmcnt(4)
    v_mfma_f32_32x32x16_bf16 v[64:79], v[32:35], a[68:71], v[64:79]
    ds_read_b128 v[24:27], v6 offset:512
    v_mfma_f32_32x32x16_bf16 v[80:95], v[32:35], a[196:199], v[80:95]
    ds_read_b128 v[28:31], v6 offset:33280
    v_mfma_f32_32x32x16_bf16 v[96:111], v[36:39], a[68:71], v[96:111]
    v_mfma_f32_32x32x16_bf16 v[112:127], v[36:39], a[196:199], v[112:127]
    s_waitcnt lgkmcnt(4)
    v_mfma_f32_32x32x16_bf16 v[64:79], v[40:43], a[72:75], v[64:79]
    ds_read_b128 v[32:35], v7 offset:512
    v_mfma_f32_32x32x16_bf16 v[80:95], v[40:43], a[200:203], v[80:95]
    ds_read_b128 v[36:39], v7 offset:33280
    v_mfma_f32_32x32x16_bf16 v[96:111], v[44:47], a[72:75], v[96:111]
    v_mfma_f32_32x32x16_bf16 v[112:127], v[44:47], a[200:203], v[112:127]
    s_waitcnt lgkmcnt(4)
    v_mfma_f32_32x32x16_bf16 v[64:79], v[48:51], a[76:79], v[64:79]
    ds_read_b128 v[40:43], v8 offset:512
    v_mfma_f32_32x32x16_bf16 v[80:95], v[48:51], a[204:207], v[80:95]
    ds_read_b128 v[44:47], v8 offset:33280
    v_mfma_f32_32x32x16_bf16 v[96:111], v[52:55], a[76:79], v[96:111]
    v_mfma_f32_32x32x16_bf16 v[112:127], v[52:55], a[204:207], v[112:127]
    s_waitcnt lgkmcnt(4)
    v_mfma_f32_32x32x16_bf16 v[64:79], v[24:27], a[80:83], v[64:79]
    ds_read_b128 v[48:51], v9 offset:512
    v_mfma_f32_32x32x16_bf16 v[80:95], v[24:27], a[208:211], v[80:95]
    ds_read_b128 v[52:55], v9 offset:33280
    v_mfma_f32_32x32x16_bf16 v[96:111], v[28:31], a[80:83], v[96:111]
    v_mfma_f32_32x32x16_bf16 v[112:127], v[28:31], a[208:211], v[112:127]
    s_waitcnt lgkmcnt(4)
    v_mfma_f32_32x32x16_bf16 v[64:79], v[32:35], a[84:87], v[64:79]
    ds_read_b128 v[24:27], v2 offset:768
    v_mfma_f32_32x32x16_bf16 v[80:95], v[32:35], a[212:215], v[80:95]
    ds_read_b128 v[28:31], v2 offset:33536
    v_mfma_f32_32x32x16_bf16 v[96:111], v[36:39], a[84:87], v[96:111]
    v_mfma_f32_32x32x16_bf16 v[112:127], v[36:39], a[212:215], v[112:127]
    s_waitcnt lgkmcnt(4)
    v_mfma_f32_32x32x16_bf16 v[64:79], v[40:43], a[88:91], v[64:79]
    ds_read_b128 v[32:35], v3 offset:768
    v_mfma_f32_32x32x16_bf16 v[80:95], v[40:43], a[216:219], v[80:95]
    ds_read_b128 v[36:39], v3 offset:33536
    v_mfma_f32_32x32x16_bf16 v[96:111], v[44:47], a[88:91], v[96:111]
    v_mfma_f32_32x32x16_bf16 v[112:127], v[44:47], a[216:219], v[112:127]
    s_waitcnt lgkmcnt(4)
    v_mfma_f32_32x32x16_bf16 v[64:79], v[48:51], a[92:95], v[64:79]
    ds_read_b128 v[40:43], v4 offset:768
    v_mfma_f32_32x32x16_bf16 v[80:95], v[48:51], a[220:223], v[80:95]
    ds_read_b128 v[44:47], v4 offset:33536
    v_mfma_f32_32x32x16_bf16 v[96:111], v[52:55], a[92:95], v[96:111]
    v_mfma_f32_32x32x16_bf16 v[112:127], v[52:55], a[220:223], v[112:127]
    s_waitcnt lgkmcnt(4)
    v_mfma_f32_32x32x16_bf16 v[64:79], v[24:27], a[96:99], v[64:79]
    ds_read_b128 v[48:51], v5 offset:768
    v_mfma_f32_32x32x16_bf16 v[80:95], v[24:27], a[224:227], v[80:95]
    ds_read_b128 v[52:55], v5 offset:33536
    v_mfma_f32_32x32x16_bf16 v[96:111], v[28:31], a[96:99], v[96:111]
    v_mfma_f32_32x32x16_bf16 v[112:127], v[28:31], a[224:227], v[112:127]
    s_waitcnt lgkmcnt(4)
    v_mfma_f32_32x32x16_bf16 v[64:79], v[32:35], a[100:103], v[64:79]
    ds_read_b128 v[24:27], v6 offset:768
    v_mfma_f32_32x32x16_bf16 v[80:95], v[32:35], a[228:231], v[80:95]
    ds_read_b128 v[28:31], v6 offset:33536
    v_mfma_f32_32x32x16_bf16 v[96:111], v[36:39], a[100:103], v[96:111]
    v_mfma_f32_32x32x16_bf16 v[112:127], v[36:39], a[228:231], v[112:127]
    s_waitcnt lgkmcnt(4)
    v_mfma_f32_32x32x16_bf16 v[64:79], v[40:43], a[104:107], v[64:79]
    ds_read_b128 v[32:35], v7 offset:768
    v_mfma_f32_32x32x16_bf16 v[80:95], v[40:43], a[232:235], v[80:95]
    ds_read_b128 v[36:39], v7 offset:33536
    v_mfma_f32_32x32x16_bf16 v[96:111], v[44:47], a[104:107], v[96:111]
    v_mfma_f32_32x32x16_bf16 v[112:127], v[44:47], a[232:235], v[112:127]
    s_waitcnt lgkmcnt(4)
    v_mfma_f32_32x32x16_bf16 v[64:79], v[48:51], a[108:111], v[64:79]
    ds_read_b128 v[40:43], v8 offset:768
    v_mfma_f32_32x32x16_bf16 v[80:95], v[48:51], a[236:239], v[80:95]
    ds_read_b128 v[44:47], v8 offset:33536
    v_mfma_f32_32x32x16_bf16 v[96:111], v[52:55], a[108:111], v[96:111]
    v_mfma_f32_32x32x16_bf16 v[112:127], v[52:55], a[236:239], v[112:127]
    s_waitcnt lgkmcnt(4)
    v_mfma_f32_32x32x16_bf16 v[64:79], v[24:27], a[112:115], v[64:79]
    ds_read_b128 v[48:51], v9 offset:768
    v_mfma_f32_32x32x16_bf16 v[80:95], v[24:27], a[240:243], v[80:95]
    ds_read_b128 v[52:55], v9 offset:33536
    v_mfma_f32_32x32x16_bf16 v[96:111], v[28:31], a[112:115], v[96:111]
    v_mfma_f32_32x32x16_bf16 v[112:127], v[28:31], a[240:243], v[112:127]
    s_waitcnt lgkmcnt(4)
    v_mfma_f32_32x32x16_bf16 v[64:79], v[32:35], a[116:119], v[64:79]
    v_mfma_f32_32x32x16_bf16 v[80:95], v[32:35], a[244:247], v[80:95]
    v_xor_b32 v2, 0x10000, v2
    v_mfma_f32_32x32x16_bf16 v[96:111], v[36:39], a[116:119], v[96:111]
    v_xor_b32 v3, 0x10000, v3
    v_mfma_f32_32x32x16_bf16 v[112:127], v[36:39], a[244:247], v[112:127]
    v_xor_b32 v4, 0x10000, v4
    v_mov_b32 v23, s33
    s_waitcnt vmcnt(16)
    buffer_store_dword v23, v240, s[12:15], 0 offen sc1
    s_waitcnt lgkmcnt(2)
    v_mfma_f32_32x32x16_bf16 v[64:79], v[40:43], a[120:123], v[64:79]
    v_mfma_f32_32x32x16_bf16 v[80:95], v[40:43], a[248:251], v[80:95]
    v_xor_b32 v5, 0x10000, v5
    v_mfma_f32_32x32x16_bf16 v[96:111], v[44:47], a[120:123], v[96:111]
    v_xor_b32 v6, 0x10000, v6
    v_mfma_f32_32x32x16_bf16 v[112:127], v[44:47], a[248:251], v[112:127]
    v_xor_b32 v7, 0x10000, v7
    s_waitcnt lgkmcnt(0)
    v_mfma_f32_32x32x16_bf16 v[64:79], v[48:51], a[124:127], v[64:79]
    v_mfma_f32_32x32x16_bf16 v[80:95], v[48:51], a[252:255], v[80:95]
    v_xor_b32 v8, 0x10000, v8
    v_mfma_f32_32x32x16_bf16 v[96:111], v[52:55], a[124:127], v[96:111]
    v_xor_b32 v9, 0x10000, v9
    v_mfma_f32_32x32x16_bf16 v[112:127], v[52:55], a[252:255], v[112:127]
    s_mov_b32 s28, s38
    s_add_u32 s37, s28, s29
    s_lshl_b32 s30, s29, 3
    s_add_u32 s38, s38, s30
    s_add_u32 s33, s33, 1
    s_waitcnt vmcnt(1)
    s_barrier
    s_add_u32 s34, s34, 0x40000
    s_xor_b32 s32, s32, 0x10000
    ds_read_b128 v[24:27], v2 offset:0
    ds_read_b128 v[28:31], v2 offset:32768
    ds_read_b128 v[32:35], v3 offset:0
    ds_read_b128 v[36:39], v3 offset:32768
    ds_read_b128 v[40:43], v4 offset:0
    ds_read_b128 v[44:47], v4 offset:32768
    s_waitcnt lgkmcnt(4)
    v_mfma_f32_32x32x16_bf16 v[128:143], v[24:27], a[0:3], 0
    ds_read_b128 v[48:51], v5 offset:0
    v_mfma_f32_32x32x16_bf16 v[144:159], v[24:27], a[128:131], 0
    ds_read_b128 v[52:55], v5 offset:32768
    v_mfma_f32_32x32x16_bf16 v[160:175], v[28:31], a[0:3], 0
    v_mfma_f32_32x32x16_bf16 v[176:191], v[28:31], a[128:131], 0
    s_waitcnt lgkmcnt(4)
    v_mfma_f32_32x32x16_bf16 v[128:143], v[32:35], a[4:7], v[128:143]
    ds_read_b128 v[24:27], v6 offset:0
    v_cvt_pk_bf16_f32 v64, v64, v65
    v_cvt_pk_bf16_f32 v65, v66, v67
    v_cvt_pk_bf16_f32 v66, v68, v69
    v_cvt_pk_bf16_f32 v67, v70, v71
    v_mfma_f32_32x32x16_bf16 v[144:159], v[32:35], a[132:135], v[144:159]
    ds_read_b128 v[28:31], v6 offset:32768
    buffer_store_dwordx4 v[64:67], v11, s[12:15], s28 offen offset:0 sc1
    v_cvt_pk_bf16_f32 v72, v72, v73
    v_cvt_pk_bf16_f32 v73, v74, v75
    v_cvt_pk_bf16_f32 v74, v76, v77
    v_mfma_f32_32x32x16_bf16 v[160:175], v[36:39], a[4:7], v[160:175]
    v_cvt_pk_bf16_f32 v75, v78, v79
    buffer_store_dwordx4 v[72:75], v11, s[12:15], s28 offen offset:512 sc1
    v_cvt_pk_bf16_f32 v80, v80, v81
    v_cvt_pk_bf16_f32 v81, v82, v83
    v_cvt_pk_bf16_f32 v82, v84, v85
    v_mfma_f32_32x32x16_bf16 v[176:191], v[36:39], a[132:135], v[176:191]
    v_cvt_pk_bf16_f32 v83, v86, v87
    buffer_store_dwordx4 v[80:83], v11, s[12:15], s28 offen offset:1024 sc1
    v_cvt_pk_bf16_f32 v88, v88, v89
    v_cvt_pk_bf16_f32 v89, v90, v91
    v_cvt_pk_bf16_f32 v90, v92, v93
    s_waitcnt lgkmcnt(4)
    v_mfma_f32_32x32x16_bf16 v[128:143], v[40:43], a[8:11], v[128:143]
    ds_read_b128 v[32:35], v7 offset:0
    v_cvt_pk_bf16_f32 v91, v94, v95
    buffer_store_dwordx4 v[88:91], v11, s[12:15], s28 offen offset:1536 sc1
    v_cvt_pk_bf16_f32 v96, v96, v97
    v_cvt_pk_bf16_f32 v97, v98, v99
    v_mfma_f32_32x32x16_bf16 v[144:159], v[40:43], a[136:139], v[144:159]
    ds_read_b128 v[36:39], v7 offset:32768
    v_cvt_pk_bf16_f32 v98, v100, v101
    v_cvt_pk_bf16_f32 v99, v102, v103
    buffer_store_dwordx4 v[96:99], v11, s[12:15], s37 offen offset:0 sc1
    v_cvt_pk_bf16_f32 v104, v104, v105
    v_mfma_f32_32x32x16_bf16 v[160:175], v[44:47], a[8:11], v[160:175]
    v_cvt_pk_bf16_f32 v105, v106, v107
    v_cvt_pk_bf16_f32 v106, v108, v109
    v_cvt_pk_bf16_f32 v107, v110, v111
    buffer_store_dwordx4 v[104:107], v11, s[12:15], s37 offen offset:512 sc1
    v_cvt_pk_bf16_f32 v112, v112, v113
    v_mfma_f32_32x32x16_bf16 v[176:191], v[44:47], a[136:139], v[176:191]
    v_cvt_pk_bf16_f32 v113, v114, v115
    v_cvt_pk_bf16_f32 v114, v116, v117
    v_cvt_pk_bf16_f32 v115, v118, v119
    buffer_store_dwordx4 v[112:115], v11, s[12:15], s37 offen offset:1024 sc1
    v_cvt_pk_bf16_f32 v120, v120, v121
    s_waitcnt lgkmcnt(4)
    v_mfma_f32_32x32x16_bf16 v[128:143], v[48:51], a[12:15], v[128:143]
    ds_read_b128 v[40:43], v8 offset:0
    v_cvt_pk_bf16_f32 v121, v122, v123
    v_cvt_pk_bf16_f32 v122, v124, v125
    v_cvt_pk_bf16_f32 v123, v126, v127
    buffer_store_dwordx4 v[120:123], v11, s[12:15], s37 offen offset:1536 sc1
    v_mfma_f32_32x32x16_bf16 v[144:159], v[48:51], a[140:143], v[144:159]
    ds_read_b128 v[44:47], v8 offset:32768
    v_mfma_f32_32x32x16_bf16 v[160:175], v[52:55], a[12:15], v[160:175]
    s_add_u32 m0, s32, 0
    s_add_u32 s31, s34, 0
    v_xor_b32 v21, 0, v10
    buffer_load_dwordx4 v21, s[8:11], s31 offen offset:0 lds
    v_xor_b32 v22, 16, v10
    buffer_load_dwordx4 v22, s[8:11], s31 offen offset:1024 lds
    v_mfma_f32_32x32x16_bf16 v[176:191], v[52:55], a[140:143], v[176:191]
    s_waitcnt lgkmcnt(4)
    v_mfma_f32_32x32x16_bf16 v[128:143], v[24:27], a[16:19], v[128:143]
    ds_read_b128 v[48:51], v9 offset:0
    v_mfma_f32_32x32x16_bf16 v[144:159], v[24:27], a[144:147], v[144:159]
    ds_read_b128 v[52:55], v9 offset:32768
    v_mfma_f32_32x32x16_bf16 v[160:175], v[28:31], a[16:19], v[160:175]
    v_xor_b32 v21, 32, v10
    buffer_load_dwordx4 v21, s[8:11], s31 offen offset:2048 lds
    v_xor_b32 v22, 48, v10
    buffer_load_dwordx4 v22, s[8:11], s31 offen offset:3072 lds
    v_mfma_f32_32x32x16_bf16 v[176:191], v[28:31], a[144:147], v[176:191]
    s_waitcnt lgkmcnt(4)
    v_mfma_f32_32x32x16_bf16 v[128:143], v[32:35], a[20:23], v[128:143]
    ds_read_b128 v[24:27], v2 offset:256
    v_mfma_f32_32x32x16_bf16 v[144:159], v[32:35], a[148:151], v[144:159]
    ds_read_b128 v[28:31], v2 offset:33024
    v_mfma_f32_32x32x16_bf16 v[160:175], v[36:39], a[20:23], v[160:175]
    s_add_u32 m0, s32, 4096
    s_add_u32 s31, s34, 4096
    v_xor_b32 v21, 64, v10
    buffer_load_dwordx4 v21, s[8:11], s31 offen offset:0 lds
    v_xor_b32 v22, 80, v10
    buffer_load_dwordx4 v22, s[8:11], s31 offen offset:1024 lds
    v_mfma_f32_32x32x16_bf16 v[176:191], v[36:39], a[148:151], v[176:191]
    s_waitcnt lgkmcnt(4)
    v_mfma_f32_32x32x16_bf16 v[128:143], v[40:43], a[24:27], v[128:143]
    ds_read_b128 v[32:35], v3 offset:256
    v_mfma_f32_32x32x16_bf16 v[144:159], v[40:43], a[152:155], v[144:159]
    ds_read_b128 v[36:39], v3 offset:33024
    v_mfma_f32_32x32x16_bf16 v[160:175], v[44:47], a[24:27], v[160:175]
    v_xor_b32 v21, 96, v10
    buffer_load_dwordx4 v21, s[8:11], s31 offen offset:2048 lds
    v_xor_b32 v22, 112, v10
    buffer_load_dwordx4 v22, s[8:11], s31 offen offset:3072 lds
    v_mfma_f32_32x32x16_bf16 v[176:191], v[44:47], a[152:155], v[176:191]
    s_waitcnt lgkmcnt(4)
    v_mfma_f32_32x32x16_bf16 v[128:143], v[48:51], a[28:31], v[128:143]
    ds_read_b128 v[40:43], v4 offset:256
    v_mfma_f32_32x32x16_bf16 v[144:159], v[48:51], a[156:159], v[144:159]
    ds_read_b128 v[44:47], v4 offset:33024
    v_mfma_f32_32x32x16_bf16 v[160:175], v[52:55], a[28:31], v[160:175]
    s_add_u32 m0, s32, 8192
    s_add_u32 s31, s34, 8192
    v_xor_b32 v21, 128, v10
    buffer_load_dwordx4 v21, s[8:11], s31 offen offset:0 lds
    v_xor_b32 v22, 144, v10
    buffer_load_dwordx4 v22, s[8:11], s31 offen offset:1024 lds
    v_mfma_f32_32x32x16_bf16 v[176:191], v[52:55], a[156:159], v[176:191]
    s_waitcnt lgkmcnt(4)
    v_mfma_f32_32x32x16_bf16 v[128:143], v[24:27], a[32:35], v[128:143]
    ds_read_b128 v[48:51], v5 offset:256
    v_mfma_f32_32x32x16_bf16 v[144:159], v[24:27], a[160:163], v[144:159]
    ds_read_b128 v[52:55], v5 offset:33024
    v_mfma_f32_32x32x16_bf16 v[160:175], v[28:31], a[32:35], v[160:175]
    v_xor_b32 v21, 160, v10
    buffer_load_dwordx4 v21, s[8:11], s31 offen offset:2048 lds
    v_xor_b32 v22, 176, v10
    buffer_load_dwordx4 v22, s[8:11], s31 offen offset:3072 lds
    v_mfma_f32_32x32x16_bf16 v[176:191], v[28:31], a[160:163], v[176:191]
    s_waitcnt lgkmcnt(4)
    v_mfma_f32_32x32x16_bf16 v[128:143], v[32:35], a[36:39], v[128:143]
    ds_read_b128 v[24:27], v6 offset:256
    v_mfma_f32_32x32x16_bf16 v[144:159], v[32:35], a[164:167], v[144:159]
    ds_read_b128 v[28:31], v6 offset:33024
    v_mfma_f32_32x32x16_bf16 v[160:175], v[36:39], a[36:39], v[160:175]
    s_add_u32 m0, s32, 12288
    s_add_u32 s31, s34, 12288
    v_xor_b32 v21, 192, v10
    buffer_load_dwordx4 v21, s[8:11], s31 offen offset:0 lds
    v_xor_b32 v22, 208, v10
    buffer_load_dwordx4 v22, s[8:11], s31 offen offset:1024 lds
    v_mfma_f32_32x32x16_bf16 v[176:191], v[36:39], a[164:167], v[176:191]
    s_waitcnt lgkmcnt(4)
    v_mfma_f32_32x32x16_bf16 v[128:143], v[40:43], a[40:43], v[128:143]
    ds_read_b128 v[32:35], v7 offset:256
    v_mfma_f32_32x32x16_bf16 v[144:159], v[40:43], a[168:171], v[144:159]
    ds_read_b128 v[36:39], v7 offset:33024
    v_mfma_f32_32x32x16_bf16 v[160:175], v[44:47], a[40:43], v[160:175]
    v_xor_b32 v21, 224, v10
    buffer_load_dwordx4 v21, s[8:11], s31 offen offset:2048 lds
    v_xor_b32 v22, 240, v10
    buffer_load_dwordx4 v22, s[8:11], s31 offen offset:3072 lds
    v_mfma_f32_32x32x16_bf16 v[176:191], v[44:47], a[168:171], v[176:191]
    s_waitcnt lgkmcnt(4)
    v_mfma_f32_32x32x16_bf16 v[128:143], v[48:51], a[44:47], v[128:143]
    ds_read_b128 v[40:43], v8 offset:256
    v_mfma_f32_32x32x16_bf16 v[144:159], v[48:51], a[172:175], v[144:159]
    ds_read_b128 v[44:47], v8 offset:33024
    v_mfma_f32_32x32x16_bf16 v[160:175], v[52:55], a[44:47], v[160:175]
    v_mfma_f32_32x32x16_bf16 v[176:191], v[52:55], a[172:175], v[176:191]
    s_waitcnt lgkmcnt(4)
    v_mfma_f32_32x32x16_bf16 v[128:143], v[24:27], a[48:51], v[128:143]
    ds_read_b128 v[48:51], v9 offset:256
    v_mfma_f32_32x32x16_bf16 v[144:159], v[24:27], a[176:179], v[144:159]
    ds_read_b128 v[52:55], v9 offset:33024
    v_mfma_f32_32x32x16_bf16 v[160:175], v[28:31], a[48:51], v[160:175]
    v_mfma_f32_32x32x16_bf16 v[176:191], v[28:31], a[176:179], v[176:191]
    s_waitcnt lgkmcnt(4)
    v_mfma_f32_32x32x16_bf16 v[128:143], v[32:35], a[52:55], v[128:143]
    ds_read_b128 v[24:27], v2 offset:512
    v_mfma_f32_32x32x16_bf16 v[144:159], v[32:35], a[180:183], v[144:159]
    ds_read_b128 v[28:31], v2 offset:33280
    v_mfma_f32_32x32x16_bf16 v[160:175], v[36:39], a[52:55], v[160:175]
    v_mfma_f32_32x32x16_bf16 v[176:191], v[36:39], a[180:183], v[176:191]
    s_waitcnt lgkmcnt(4)
    v_mfma_f32_32x32x16_bf16 v[128:143], v[40:43], a[56:59], v[128:143]
    ds_read_b128 v[32:35], v3 offset:512
    v_mfma_f32_32x32x16_bf16 v[144:159], v[40:43], a[184:187], v[144:159]
    ds_read_b128 v[36:39], v3 offset:33280
    v_mfma_f32_32x32x16_bf16 v[160:175], v[44:47], a[56:59], v[160:175]
    v_mfma_f32_32x32x16_bf16 v[176:191], v[44:47], a[184:187], v[176:191]
    s_waitcnt lgkmcnt(4)
    v_mfma_f32_32x32x16_bf16 v[128:143], v[48:51], a[60:63], v[128:143]
    ds_read_b128 v[40:43], v4 offset:512
    v_mfma_f32_32x32x16_bf16 v[144:159], v[48:51], a[188:191], v[144:159]
    ds_read_b128 v[44:47], v4 offset:33280
    v_mfma_f32_32x32x16_bf16 v[160:175], v[52:55], a[60:63], v[160:175]
    v_mfma_f32_32x32x16_bf16 v[176:191], v[52:55], a[188:191], v[176:191]
    s_waitcnt lgkmcnt(4)
    v_mfma_f32_32x32x16_bf16 v[128:143], v[24:27], a[64:67], v[128:143]
    ds_read_b128 v[48:51], v5 offset:512
    v_mfma_f32_32x32x16_bf16 v[144:159], v[24:27], a[192:195], v[144:159]
    ds_read_b128 v[52:55], v5 offset:33280
    v_mfma_f32_32x32x16_bf16 v[160:175], v[28:31], a[64:67], v[160:175]
    v_mfma_f32_32x32x16_bf16 v[176:191], v[28:31], a[192:195], v[176:191]
    v_mov_b32 v23, s33
    s_waitcnt vmcnt(16)
    buffer_store_dword v23, v240, s[12:15], 0 offen sc1
    s_waitcnt lgkmcnt(4)
    v_mfma_f32_32x32x16_bf16 v[128:143], v[32:35], a[68:71], v[128:143]
    ds_read_b128 v[24:27], v6 offset:512
    v_mfma_f32_32x32x16_bf16 v[144:159], v[32:35], a[196:199], v[144:159]
    ds_read_b128 v[28:31], v6 offset:33280
    v_mfma_f32_32x32x16_bf16 v[160:175], v[36:39], a[68:71], v[160:175]
    v_mfma_f32_32x32x16_bf16 v[176:191], v[36:39], a[196:199], v[176:191]
    s_waitcnt lgkmcnt(4)
    v_mfma_f32_32x32x16_bf16 v[128:143], v[40:43], a[72:75], v[128:143]
    ds_read_b128 v[32:35], v7 offset:512
    v_mfma_f32_32x32x16_bf16 v[144:159], v[40:43], a[200:203], v[144:159]
    ds_read_b128 v[36:39], v7 offset:33280
    v_mfma_f32_32x32x16_bf16 v[160:175], v[44:47], a[72:75], v[160:175]
    v_mfma_f32_32x32x16_bf16 v[176:191], v[44:47], a[200:203], v[176:191]
    s_waitcnt lgkmcnt(4)
    v_mfma_f32_32x32x16_bf16 v[128:143], v[48:51], a[76:79], v[128:143]
    ds_read_b128 v[40:43], v8 offset:512
    v_mfma_f32_32x32x16_bf16 v[144:159], v[48:51], a[204:207], v[144:159]
    ds_read_b128 v[44:47], v8 offset:33280
    v_mfma_f32_32x32x16_bf16 v[160:175], v[52:55], a[76:79], v[160:175]
    v_mfma_f32_32x32x16_bf16 v[176:191], v[52:55], a[204:207], v[176:191]
    s_waitcnt lgkmcnt(4)
    v_mfma_f32_32x32x16_bf16 v[128:143], v[24:27], a[80:83], v[128:143]
    ds_read_b128 v[48:51], v9 offset:512
    v_mfma_f32_32x32x16_bf16 v[144:159], v[24:27], a[208:211], v[144:159]
    ds_read_b128 v[52:55], v9 offset:33280
    v_mfma_f32_32x32x16_bf16 v[160:175], v[28:31], a[80:83], v[160:175]
    v_mfma_f32_32x32x16_bf16 v[176:191], v[28:31], a[208:211], v[176:191]
    s_waitcnt lgkmcnt(4)
    v_mfma_f32_32x32x16_bf16 v[128:143], v[32:35], a[84:87], v[128:143]
    ds_read_b128 v[24:27], v2 offset:768
    v_mfma_f32_32x32x16_bf16 v[144:159], v[32:35], a[212:215], v[144:159]
    ds_read_b128 v[28:31], v2 offset:33536
    v_mfma_f32_32x32x16_bf16 v[160:175], v[36:39], a[84:87], v[160:175]
    v_mfma_f32_32x32x16_bf16 v[176:191], v[36:39], a[212:215], v[176:191]
    s_waitcnt lgkmcnt(4)
    v_mfma_f32_32x32x16_bf16 v[128:143], v[40:43], a[88:91], v[128:143]
    ds_read_b128 v[32:35], v3 offset:768
    v_mfma_f32_32x32x16_bf16 v[144:159], v[40:43], a[216:219], v[144:159]
    ds_read_b128 v[36:39], v3 offset:33536
    v_mfma_f32_32x32x16_bf16 v[160:175], v[44:47], a[88:91], v[160:175]
    v_mfma_f32_32x32x16_bf16 v[176:191], v[44:47], a[216:219], v[176:191]
    s_waitcnt lgkmcnt(4)
    v_mfma_f32_32x32x16_bf16 v[128:143], v[48:51], a[92:95], v[128:143]
    ds_read_b128 v[40:43], v4 offset:768
    v_mfma_f32_32x32x16_bf16 v[144:159], v[48:51], a[220:223], v[144:159]
    ds_read_b128 v[44:47], v4 offset:33536
    v_mfma_f32_32x32x16_bf16 v[160:175], v[52:55], a[92:95], v[160:175]
    v_mfma_f32_32x32x16_bf16 v[176:191], v[52:55], a[220:223], v[176:191]
    s_waitcnt lgkmcnt(4)
    v_mfma_f32_32x32x16_bf16 v[128:143], v[24:27], a[96:99], v[128:143]
    ds_read_b128 v[48:51], v5 offset:768
    v_mfma_f32_32x32x16_bf16 v[144:159], v[24:27], a[224:227], v[144:159]
    ds_read_b128 v[52:55], v5 offset:33536
    v_mfma_f32_32x32x16_bf16 v[160:175], v[28:31], a[96:99], v[160:175]
    v_mfma_f32_32x32x16_bf16 v[176:191], v[28:31], a[224:227], v[176:191]
    s_waitcnt lgkmcnt(4)
    v_mfma_f32_32x32x16_bf16 v[128:143], v[32:35], a[100:103], v[128:143]
    ds_read_b128 v[24:27], v6 offset:768
    v_mfma_f32_32x32x16_bf16 v[144:159], v[32:35], a[228:231], v[144:159]
    ds_read_b128 v[28:31], v6 offset:33536
    v_mfma_f32_32x32x16_bf16 v[160:175], v[36:39], a[100:103], v[160:175]
    v_mfma_f32_32x32x16_bf16 v[176:191], v[36:39], a[228:231], v[176:191]
    s_waitcnt lgkmcnt(4)
    v_mfma_f32_32x32x16_bf16 v[128:143], v[40:43], a[104:107], v[128:143]
    ds_read_b128 v[32:35], v7 offset:768
    v_mfma_f32_32x32x16_bf16 v[144:159], v[40:43], a[232:235], v[144:159]
    ds_read_b128 v[36:39], v7 offset:33536
    v_mfma_f32_32x32x16_bf16 v[160:175], v[44:47], a[104:107], v[160:175]
    v_mfma_f32_32x32x16_bf16 v[176:191], v[44:47], a[232:235], v[176:191]
    s_waitcnt lgkmcnt(4)
    v_mfma_f32_32x32x16_bf16 v[128:143], v[48:51], a[108:111], v[128:143]
    ds_read_b128 v[40:43], v8 offset:768
    v_mfma_f32_32x32x16_bf16 v[144:159], v[48:51], a[236:239], v[144:159]
    ds_read_b128 v[44:47], v8 offset:33536
    v_mfma_f32_32x32x16_bf16 v[160:175], v[52:55], a[108:111], v[160:175]
    v_mfma_f32_32x32x16_bf16 v[176:191], v[52:55], a[236:239], v[176:191]
    s_waitcnt lgkmcnt(4)
    v_mfma_f32_32x32x16_bf16 v[128:143], v[24:27], a[112:115], v[128:143]
    ds_read_b128 v[48:51], v9 offset:768
    v_mfma_f32_32x32x16_bf16 v[144:159], v[24:27], a[240:243], v[144:159]
    ds_read_b128 v[52:55], v9 offset:33536
    v_mfma_f32_32x32x16_bf16 v[160:175], v[28:31], a[112:115], v[160:175]
    v_mfma_f32_32x32x16_bf16 v[176:191], v[28:31], a[240:243], v[176:191]
    s_waitcnt lgkmcnt(4)
    v_mfma_f32_32x32x16_bf16 v[128:143], v[32:35], a[116:119], v[128:143]
    v_mfma_f32_32x32x16_bf16 v[144:159], v[32:35], a[244:247], v[144:159]
    v_xor_b32 v2, 0x10000, v2
    v_mfma_f32_32x32x16_bf16 v[160:175], v[36:39], a[116:119], v[160:175]
    v_xor_b32 v3, 0x10000, v3
    v_mfma_f32_32x32x16_bf16 v[176:191], v[36:39], a[244:247], v[176:191]
    v_xor_b32 v4, 0x10000, v4
    s_waitcnt lgkmcnt(2)
    v_mfma_f32_32x32x16_bf16 v[128:143], v[40:43], a[120:123], v[128:143]
    v_mfma_f32_32x32x16_bf16 v[144:159], v[40:43], a[248:251], v[144:159]
    v_xor_b32 v5, 0x10000, v5
    v_mfma_f32_32x32x16_bf16 v[160:175], v[44:47], a[120:123], v[160:175]
    v_xor_b32 v6, 0x10000, v6
    v_mfma_f32_32x32x16_bf16 v[176:191], v[44:47], a[248:251], v[176:191]
    v_xor_b32 v7, 0x10000, v7
    s_waitcnt lgkmcnt(0)
    v_mfma_f32_32x32x16_bf16 v[128:143], v[48:51], a[124:127], v[128:143]
    v_mfma_f32_32x32x16_bf16 v[144:159], v[48:51], a[252:255], v[144:159]
    v_xor_b32 v8, 0x10000, v8
    v_mfma_f32_32x32x16_bf16 v[160:175], v[52:55], a[124:127], v[160:175]
    v_xor_b32 v9, 0x10000, v9
    v_mfma_f32_32x32x16_bf16 v[176:191], v[52:55], a[252:255], v[176:191]
    s_mov_b32 s28, s38
    s_add_u32 s37, s28, s29
    s_lshl_b32 s30, s29, 3
    s_add_u32 s38, s38, s30
    s_add_u32 s33, s33, 1
    s_cmp_lt_u32 s33, 8
    s_cbranch_scc1 P1L_77
    v_cvt_pk_bf16_f32 v128, v128, v129
    v_cvt_pk_bf16_f32 v129, v130, v131
    v_cvt_pk_bf16_f32 v130, v132, v133
    v_cvt_pk_bf16_f32 v131, v134, v135
    buffer_store_dwordx4 v[128:131], v11, s[12:15], s28 offen offset:0 sc1
    v_cvt_pk_bf16_f32 v136, v136, v137
    v_cvt_pk_bf16_f32 v137, v138, v139
    v_cvt_pk_bf16_f32 v138, v140, v141
    v_cvt_pk_bf16_f32 v139, v142, v143
    buffer_store_dwordx4 v[136:139], v11, s[12:15], s28 offen offset:512 sc1
    v_cvt_pk_bf16_f32 v144, v144, v145
    v_cvt_pk_bf16_f32 v145, v146, v147
    v_cvt_pk_bf16_f32 v146, v148, v149
    v_cvt_pk_bf16_f32 v147, v150, v151
    buffer_store_dwordx4 v[144:147], v11, s[12:15], s28 offen offset:1024 sc1
    v_cvt_pk_bf16_f32 v152, v152, v153
    v_cvt_pk_bf16_f32 v153, v154, v155
    v_cvt_pk_bf16_f32 v154, v156, v157
    v_cvt_pk_bf16_f32 v155, v158, v159
    buffer_store_dwordx4 v[152:155], v11, s[12:15], s28 offen offset:1536 sc1
    v_cvt_pk_bf16_f32 v160, v160, v161
    v_cvt_pk_bf16_f32 v161, v162, v163
    v_cvt_pk_bf16_f32 v162, v164, v165
    v_cvt_pk_bf16_f32 v163, v166, v167
    buffer_store_dwordx4 v[160:163], v11, s[12:15], s37 offen offset:0 sc1
    v_cvt_pk_bf16_f32 v168, v168, v169
    v_cvt_pk_bf16_f32 v169, v170, v171
    v_cvt_pk_bf16_f32 v170, v172, v173
    v_cvt_pk_bf16_f32 v171, v174, v175
    buffer_store_dwordx4 v[168:171], v11, s[12:15], s37 offen offset:512 sc1
    v_cvt_pk_bf16_f32 v176, v176, v177
    v_cvt_pk_bf16_f32 v177, v178, v179
    v_cvt_pk_bf16_f32 v178, v180, v181
    v_cvt_pk_bf16_f32 v179, v182, v183
    buffer_store_dwordx4 v[176:179], v11, s[12:15], s37 offen offset:1024 sc1
    v_cvt_pk_bf16_f32 v184, v184, v185
    v_cvt_pk_bf16_f32 v185, v186, v187
    v_cvt_pk_bf16_f32 v186, v188, v189
    v_cvt_pk_bf16_f32 v187, v190, v191
    buffer_store_dwordx4 v[184:187], v11, s[12:15], s37 offen offset:1536 sc1
    v_mov_b32 v23, 8
    s_waitcnt vmcnt(0)
    buffer_store_dword v23, v240, s[12:15], 0 offen sc1
    s_branch P1END
P1H_75:
    v_lshlrev_b32 v61, 4, v57
    s_lshl_b32 s30, s24, 1
    buffer_load_dwordx4 v[224:227], v61, s[16:19], s30 offen offset:0
    buffer_load_dwordx4 v[228:231], v61, s[16:19], s30 offen offset:32
    buffer_load_dwordx4 v[232:235], v61, s[16:19], s30 offen offset:64
    buffer_load_dwordx4 v[236:239], v61, s[16:19], s30 offen offset:96
    s_mov_b32 s36, 0x3dd2d3e3
    s_mov_b32 s36, 0x3dd2d3e8
    v_mov_b32 v244, 0x40135761
    s_waitcnt vmcnt(0)
    v_lshlrev_b32 v192, 16, v224
    v_and_b32 v208, 0xffff0000, v224
    v_lshlrev_b32 v193, 16, v225
    v_and_b32 v209, 0xffff0000, v225
    v_lshlrev_b32 v194, 16, v226
    v_and_b32 v210, 0xffff0000, v226
    v_lshlrev_b32 v195, 16, v227
    v_and_b32 v211, 0xffff0000, v227
    v_lshlrev_b32 v196, 16, v228
    v_and_b32 v212, 0xffff0000, v228
    v_lshlrev_b32 v197, 16, v229
    v_and_b32 v213, 0xffff0000, v229
    v_lshlrev_b32 v198, 16, v230
    v_and_b32 v214, 0xffff0000, v230
    v_lshlrev_b32 v199, 16, v231
    v_and_b32 v215, 0xffff0000, v231
    v_lshlrev_b32 v200, 16, v232
    v_and_b32 v216, 0xffff0000, v232
    v_lshlrev_b32 v201, 16, v233
    v_and_b32 v217, 0xffff0000, v233
    v_lshlrev_b32 v202, 16, v234
    v_and_b32 v218, 0xffff0000, v234
    v_lshlrev_b32 v203, 16, v235
    v_and_b32 v219, 0xffff0000, v235
    v_lshlrev_b32 v204, 16, v236
    v_and_b32 v220, 0xffff0000, v236
    v_lshlrev_b32 v205, 16, v237
    v_and_b32 v221, 0xffff0000, v237
    v_lshlrev_b32 v206, 16, v238
    v_and_b32 v222, 0xffff0000, v238
    v_lshlrev_b32 v207, 16, v239
    v_and_b32 v223, 0xffff0000, v239
    s_mov_b32 s33, 0
    s_mov_b32 s38, s28
    s_mov_b32 s28, 0x40000000
    s_mov_b32 s37, 0x40000000
P1L_78:
    s_waitcnt vmcnt(5)
    s_barrier
    s_add_u32 s34, s34, 0x40000
    s_xor_b32 s32, s32, 0x10000
    ds_read_b128 v[24:27], v2 offset:0
    ds_read_b128 v[28:31], v2 offset:32768
    ds_read_b128 v[32:35], v3 offset:0
    ds_read_b128 v[36:39], v3 offset:32768
    ds_read_b128 v[40:43], v4 offset:0
    ds_read_b128 v[44:47], v4 offset:32768
    s_waitcnt lgkmcnt(4)
    v_mfma_f32_32x32x16_bf16 v[64:79], a[0:3], v[24:27], v[192:207]
    ds_read_b128 v[48:51], v5 offset:0
    v_mfma_f32_32x32x16_bf16 v[80:95], a[128:131], v[24:27], v[208:223]
    ds_read_b128 v[52:55], v5 offset:32768
    v_mfma_f32_32x32x16_bf16 v[96:111], a[0:3], v[28:31], v[192:207]
    s_add_u32 m0, s32, 0
    s_add_u32 s31, s34, 0
    v_xor_b32 v21, 0, v10
    buffer_load_dwordx4 v21, s[8:11], s31 offen offset:0 lds
    v_mfma_f32_32x32x16_bf16 v[112:127], a[128:131], v[28:31], v[208:223]
    s_waitcnt lgkmcnt(4)
    v_mfma_f32_32x32x16_bf16 v[64:79], a[4:7], v[32:35], v[64:79]
    ds_read_b128 v[24:27], v6 offset:0
    v_mul_f32 v224, v128, v128
    v_mul_f32 v225, v129, v129
    v_mul_f32 v226, v130, v130
    v_mul_f32 v227, v131, v131
    v_mul_f32 v228, v144, v144
    v_mfma_f32_32x32x16_bf16 v[80:95], a[132:135], v[32:35], v[80:95]
    ds_read_b128 v[28:31], v6 offset:32768
    v_mul_f32 v229, v145, v145
    v_mul_f32 v230, v146, v146
    v_mul_f32 v231, v147, v147
    v_fma_f32 v224, v224, s36, v244
    v_fma_f32 v225, v225, s36, v244
    v_mfma_f32_32x32x16_bf16 v[96:111], a[4:7], v[36:39], v[96:111]
    v_xor_b32 v22, 16, v10
    buffer_load_dwordx4 v22, s[8:11], s31 offen offset:1024 lds
    v_mfma_f32_32x32x16_bf16 v[112:127], a[132:135], v[36:39], v[112:127]
    v_fma_f32 v226, v226, s36, v244
    v_fma_f32 v227, v227, s36, v244
    v_fma_f32 v228, v228, s36, v244
    v_fma_f32 v229, v229, s36, v244
    v_fma_f32 v230, v230, s36, v244
    v_fma_f32 v231, v231, s36, v244
    s_waitcnt lgkmcnt(4)
    v_mfma_f32_32x32x16_bf16 v[64:79], a[8:11], v[40:43], v[64:79]
    ds_read_b128 v[32:35], v7 offset:0
    v_mul_f32 v224, v224, v128
    v_mul_f32 v225, v225, v129
    v_mul_f32 v226, v226, v130
    v_mul_f32 v227, v227, v131
    v_mul_f32 v228, v228, v144
    v_mfma_f32_32x32x16_bf16 v[80:95], a[136:139], v[40:43], v[80:95]
    ds_read_b128 v[36:39], v7 offset:32768
    v_mul_f32 v229, v229, v145
    v_mul_f32 v230, v230, v146
    v_mul_f32 v231, v231, v147
    v_exp_f32 v224, -v224
    v_exp_f32 v225, -v225
    v_mfma_f32_32x32x16_bf16 v[96:111], a[8:11], v[44:47], v[96:111]
    v_xor_b32 v21, 32, v10
    buffer_load_dwordx4 v21, s[8:11], s31 offen offset:2048 lds
    v_mfma_f32_32x32x16_bf16 v[112:127], a[136:139], v[44:47], v[112:127]
    v_exp_f32 v226, -v226
    v_exp_f32 v227, -v227
    v_exp_f32 v228, -v228
    v_exp_f32 v229, -v229
    v_exp_f32 v230, -v230
    v_exp_f32 v231, -v231
    s_waitcnt lgkmcnt(4)
    v_mfma_f32_32x32x16_bf16 v[64:79], a[12:15], v[48:51], v[64:79]
    ds_read_b128 v[40:43], v8 offset:0
    v_add_f32 v224, 1.0, v224
    v_add_f32 v225, 1.0, v225
    v_add_f32 v226, 1.0, v226
    v_add_f32 v227, 1.0, v227
    v_add_f32 v228, 1.0, v228
    v_mfma_f32_32x32x16_bf16 v[80:95], a[140:143], v[48:51], v[80:95]
    ds_read_b128 v[44:47], v8 offset:32768
    v_add_f32 v229, 1.0, v229
    v_add_f32 v230, 1.0, v230
    v_add_f32 v231, 1.0, v231
    v_rcp_f32 v224, v224
    v_rcp_f32 v225, v225
    v_mfma_f32_32x32x16_bf16 v[96:111], a[12:15], v[52:55], v[96:111]
    v_xor_b32 v22, 48, v10
    buffer_load_dwordx4 v22, s[8:11], s31 offen offset:3072 lds
    v_mfma_f32_32x32x16_bf16 v[112:127], a[140:143], v[52:55], v[112:127]
    v_rcp_f32 v226, v226
    v_rcp_f32 v227, v227
    v_rcp_f32 v228, v228
    v_rcp_f32 v229, v229
    v_rcp_f32 v230, v230
    v_rcp_f32 v231, v231
    s_waitcnt lgkmcnt(4)
    v_mfma_f32_32x32x16_bf16 v[64:79], a[16:19], v[24:27], v[64:79]
    ds_read_b128 v[48:51], v9 offset:0
    v_mul_f32 v128, v128, v224
    v_mul_f32 v129, v129, v225
    v_mul_f32 v130, v130, v226
    v_mul_f32 v131, v131, v227
    v_mul_f32 v144, v144, v228
    v_mfma_f32_32x32x16_bf16 v[80:95], a[144:147], v[24:27], v[80:95]
    ds_read_b128 v[52:55], v9 offset:32768
    v_mul_f32 v145, v145, v229
    v_mul_f32 v146, v146, v230
    v_mul_f32 v147, v147, v231
    v_cvt_pk_bf16_f32 v128, v128, v144
    v_cvt_pk_bf16_f32 v129, v129, v145
    v_mfma_f32_32x32x16_bf16 v[96:111], a[16:19], v[28:31], v[96:111]
    s_add_u32 m0, s32, 4096
    s_add_u32 s31, s34, 4096
    v_xor_b32 v21, 64, v10
    buffer_load_dwordx4 v21, s[8:11], s31 offen offset:0 lds
    v_mfma_f32_32x32x16_bf16 v[112:127], a[144:147], v[28:31], v[112:127]
    v_cvt_pk_bf16_f32 v130, v130, v146
    v_cvt_pk_bf16_f32 v131, v131, v147
    buffer_store_dwordx4 v[128:131], v11, s[12:15], s28 offen offset:0 sc1
    v_mul_f32 v224, v132, v132
    v_mul_f32 v225, v133, v133
    v_mul_f32 v226, v134, v134
    s_waitcnt lgkmcnt(4)
    v_mfma_f32_32x32x16_bf16 v[64:79], a[20:23], v[32:35], v[64:79]
    ds_read_b128 v[24:27], v2 offset:256
    v_mul_f32 v227, v135, v135
    v_mul_f32 v228, v148, v148
    v_mul_f32 v229, v149, v149
    v_mul_f32 v230, v150, v150
    v_mul_f32 v231, v151, v151
    v_mfma_f32_32x32x16_bf16 v[80:95], a[148:151], v[32:35], v[80:95]
    ds_read_b128 v[28:31], v2 offset:33024
    v_fma_f32 v224, v224, s36, v244
    v_fma_f32 v225, v225, s36, v244
    v_fma_f32 v226, v226, s36, v244
    v_fma_f32 v227, v227, s36, v244
    v_fma_f32 v228, v228, s36, v244
    v_mfma_f32_32x32x16_bf16 v[96:111], a[20:23], v[36:39], v[96:111]
    v_xor_b32 v22, 80, v10
    buffer_load_dwordx4 v22, s[8:11], s31 offen offset:1024 lds
    v_mfma_f32_32x32x16_bf16 v[112:127], a[148:151], v[36:39], v[112:127]
    v_fma_f32 v229, v229, s36, v244
    v_fma_f32 v230, v230, s36, v244
    v_fma_f32 v231, v231, s36, v244
    v_mul_f32 v224, v224, v132
    v_mul_f32 v225, v225, v133
    v_mul_f32 v226, v226, v134
    s_waitcnt lgkmcnt(4)
    v_mfma_f32_32x32x16_bf16 v[64:79], a[24:27], v[40:43], v[64:79]
    ds_read_b128 v[32:35], v3 offset:256
    v_mul_f32 v227, v227, v135
    v_mul_f32 v228, v228, v148
    v_mul_f32 v229, v229, v149
    v_mul_f32 v230, v230, v150
    v_mul_f32 v231, v231, v151
    v_mfma_f32_32x32x16_bf16 v[80:95], a[152:155], v[40:43], v[80:95]
    ds_read_b128 v[36:39], v3 offset:33024
    v_exp_f32 v224, -v224
    v_exp_f32 v225, -v225
    v_exp_f32 v226, -v226
    v_exp_f32 v227, -v227
    v_exp_f32 v228, -v228
    v_mfma_f32_32x32x16_bf16 v[96:111], a[24:27], v[44:47], v[96:111]
    v_xor_b32 v21, 96, v10
    buffer_load_dwordx4 v21, s[8:11], s31 offen offset:2048 lds
    v_mfma_f32_32x32x16_bf16 v[112:127], a[152:155], v[44:47], v[112:127]
    v_exp_f32 v229, -v229
    v_exp_f32 v230, -v230
    v_exp_f32 v231, -v231
    v_add_f32 v224, 1.0, v224
    v_add_f32 v225, 1.0, v225
    v_add_f32 v226, 1.0, v226
    s_waitcnt lgkmcnt(4)
    v_mfma_f32_32x32x16_bf16 v[64:79], a[28:31], v[48:51], v[64:79]
    ds_read_b128 v[40:43], v4 offset:256
    v_add_f32 v227, 1.0, v227
    v_add_f32 v228, 1.0, v228
    v_add_f32 v229, 1.0, v229
    v_add_f32 v230, 1.0, v230
    v_add_f32 v231, 1.0, v231
    v_mfma_f32_32x32x16_bf16 v[80:95], a[156:159], v[48:51], v[80:95]
    ds_read_b128 v[44:47], v4 offset:33024
    v_rcp_f32 v224, v224
    v_rcp_f32 v225, v225
    v_rcp_f32 v226, v226
    v_rcp_f32 v227, v227
    v_rcp_f32 v228, v228
    v_mfma_f32_32x32x16_bf16 v[96:111], a[28:31], v[52:55], v[96:111]
    v_xor_b32 v22, 112, v10
    buffer_load_dwordx4 v22, s[8:11], s31 offen offset:3072 lds
    v_mfma_f32_32x32x16_bf16 v[112:127], a[156:159], v[52:55], v[112:127]
    v_rcp_f32 v229, v229
    v_rcp_f32 v230, v230
    v_rcp_f32 v231, v231
    v_mul_f32 v132, v132, v224
    v_mul_f32 v133, v133, v225
    v_mul_f32 v134, v134, v226
    s_waitcnt lgkmcnt(4)
    v_mfma_f32_32x32x16_bf16 v[64:79], a[32:35], v[24:27], v[64:79]
    ds_read_b128 v[48:51], v5 offset:256
    v_mul_f32 v135, v135, v227
    v_mul_f32 v148, v148, v228
    v_mul_f32 v149, v149, v229
    v_mul_f32 v150, v150, v230
    v_mul_f32 v151, v151, v231
    v_mfma_f32_32x32x16_bf16 v[80:95], a[160:163], v[24:27], v[80:95]
    ds_read_b128 v[52:55], v5 offset:33024
    v_cvt_pk_bf16_f32 v132, v132, v148
    v_cvt_pk_bf16_f32 v133, v133, v149
    v_cvt_pk_bf16_f32 v134, v134, v150
    v_cvt_pk_bf16_f32 v135, v135, v151
    buffer_store_dwordx4 v[132:135], v11, s[12:15], s28 offen offset:1024 sc1
    v_mfma_f32_32x32x16_bf16 v[96:111], a[32:35], v[28:31], v[96:111]
    s_add_u32 m0, s32, 8192
    s_add_u32 s31, s34, 8192
    v_xor_b32 v21, 128, v10
    buffer_load_dwordx4 v21, s[8:11], s31 offen offset:0 lds
    v_mfma_f32_32x32x16_bf16 v[112:127], a[160:163], v[28:31], v[112:127]
    v_mul_f32 v224, v136, v136
    v_mul_f32 v225, v137, v137
    v_mul_f32 v226, v138, v138
    v_mul_f32 v227, v139, v139
    v_mul_f32 v228, v152, v152
    v_mul_f32 v229, v153, v153
    s_waitcnt lgkmcnt(4)
    v_mfma_f32_32x32x16_bf16 v[64:79], a[36:39], v[32:35], v[64:79]
    ds_read_b128 v[24:27], v6 offset:256
    v_mul_f32 v230, v154, v154
    v_mul_f32 v231, v155, v155
    v_fma_f32 v224, v224, s36, v244
    v_fma_f32 v225, v225, s36, v244
    v_fma_f32 v226, v226, s36, v244
    v_mfma_f32_32x32x16_bf16 v[80:95], a[164:167], v[32:35], v[80:95]
    ds_read_b128 v[28:31], v6 offset:33024
    v_fma_f32 v227, v227, s36, v244
    v_fma_f32 v228, v228, s36, v244
    v_fma_f32 v229, v229, s36, v244
    v_fma_f32 v230, v230, s36, v244
    v_fma_f32 v231, v231, s36, v244
    v_mfma_f32_32x32x16_bf16 v[96:111], a[36:39], v[36:39], v[96:111]
    v_xor_b32 v22, 144, v10
    buffer_load_dwordx4 v22, s[8:11], s31 offen offset:1024 lds
    v_mfma_f32_32x32x16_bf16 v[112:127], a[164:167], v[36:39], v[112:127]
    v_mul_f32 v224, v224, v136
    v_mul_f32 v225, v225, v137
    v_mul_f32 v226, v226, v138
    v_mul_f32 v227, v227, v139
    v_mul_f32 v228, v228, v152
    v_mul_f32 v229, v229, v153
    s_waitcnt lgkmcnt(4)
    v_mfma_f32_32x32x16_bf16 v[64:79], a[40:43], v[40:43], v[64:79]
    ds_read_b128 v[32:35], v7 offset:256
    v_mul_f32 v230, v230, v154
    v_mul_f32 v231, v231, v155
    v_exp_f32 v224, -v224
    v_exp_f32 v225, -v225
    v_exp_f32 v226, -v226
    v_mfma_f32_32x32x16_bf16 v[80:95], a[168:171], v[40:43], v[80:95]
    ds_read_b128 v[36:39], v7 offset:33024
    v_exp_f32 v227, -v227
    v_exp_f32 v228, -v228
    v_exp_f32 v229, -v229
    v_exp_f32 v230, -v230
    v_exp_f32 v231, -v231
    v_mfma_f32_32x32x16_bf16 v[96:111], a[40:43], v[44:47], v[96:111]
    v_xor_b32 v21, 160, v10
    buffer_load_dwordx4 v21, s[8:11], s31 offen offset:2048 lds
    v_mfma_f32_32x32x16_bf16 v[112:127], a[168:171], v[44:47], v[112:127]
    v_add_f32 v224, 1.0, v224
    v_add_f32 v225, 1.0, v225
    v_add_f32 v226, 1.0, v226
    v_add_f32 v227, 1.0, v227
    v_add_f32 v228, 1.0, v228
    v_add_f32 v229, 1.0, v229
    s_waitcnt lgkmcnt(4)
    v_mfma_f32_32x32x16_bf16 v[64:79], a[44:47], v[48:51], v[64:79]
    ds_read_b128 v[40:43], v8 offset:256
    v_add_f32 v230, 1.0, v230
    v_add_f32 v231, 1.0, v231
    v_rcp_f32 v224, v224
    v_rcp_f32 v225, v225
    v_rcp_f32 v226, v226
    v_mfma_f32_32x32x16_bf16 v[80:95], a[172:175], v[48:51], v[80:95]
    ds_read_b128 v[44:47], v8 offset:33024
    v_rcp_f32 v227, v227
    v_rcp_f32 v228, v228
    v_rcp_f32 v229, v229
    v_rcp_f32 v230, v230
    v_rcp_f32 v231, v231
    v_mfma_f32_32x32x16_bf16 v[96:111], a[44:47], v[52:55], v[96:111]
    v_xor_b32 v22, 176, v10
    buffer_load_dwordx4 v22, s[8:11], s31 offen offset:3072 lds
    v_mfma_f32_32x32x16_bf16 v[112:127], a[172:175], v[52:55], v[112:127]
    v_mul_f32 v136, v136, v224
    v_mul_f32 v137, v137, v225
    v_mul_f32 v138, v138, v226
    v_mul_f32 v139, v139, v227
    v_mul_f32 v152, v152, v228
    v_mul_f32 v153, v153, v229
    s_waitcnt lgkmcnt(4)
    v_mfma_f32_32x32x16_bf16 v[64:79], a[48:51], v[24:27], v[64:79]
    ds_read_b128 v[48:51], v9 offset:256
    v_mul_f32 v154, v154, v230
    v_mul_f32 v155, v155, v231
    v_cvt_pk_bf16_f32 v136, v136, v152
    v_cvt_pk_bf16_f32 v137, v137, v153
    v_cvt_pk_bf16_f32 v138, v138, v154
    v_mfma_f32_32x32x16_bf16 v[80:95], a[176:179], v[24:27], v[80:95]
    ds_read_b128 v[52:55], v9 offset:33024
    v_cvt_pk_bf16_f32 v139, v139, v155
    buffer_store_dwordx4 v[136:139], v11, s[12:15], s28 offen offset:2048 sc1
    v_mul_f32 v224, v140, v140
    v_mul_f32 v225, v141, v141
    v_mul_f32 v226, v142, v142
    v_mfma_f32_32x32x16_bf16 v[96:111], a[48:51], v[28:31], v[96:111]
    s_add_u32 m0, s32, 12288
    s_add_u32 s31, s34, 12288
    v_xor_b32 v21, 192, v10
    buffer_load_dwordx4 v21, s[8:11], s31 offen offset:0 lds
    v_mfma_f32_32x32x16_bf16 v[112:127], a[176:179], v[28:31], v[112:127]
    v_mul_f32 v227, v143, v143
    v_mul_f32 v228, v156, v156
    v_mul_f32 v229, v157, v157
    v_mul_f32 v230, v158, v158
    v_mul_f32 v231, v159, v159
    v_fma_f32 v224, v224, s36, v244
    s_waitcnt lgkmcnt(4)
    v_mfma_f32_32x32x16_bf16 v[64:79], a[52:55], v[32:35], v[64:79]
    ds_read_b128 v[24:27], v2 offset:512
    v_fma_f32 v225, v225, s36, v244
    v_fma_f32 v226, v226, s36, v244
    v_fma_f32 v227, v227, s36, v244
    v_fma_f32 v228, v228, s36, v244
    v_fma_f32 v229, v229, s36, v244
    v_mfma_f32_32x32x16_bf16 v[80:95], a[180:183], v[32:35], v[80:95]
    ds_read_b128 v[28:31], v2 offset:33280
    v_fma_f32 v230, v230, s36, v244
    v_fma_f32 v231, v231, s36, v244
    v_mul_f32 v224, v224, v140
    v_mul_f32 v225, v225, v141
    v_mul_f32 v226, v226, v142
    v_mfma_f32_32x32x16_bf16 v[96:111], a[52:55], v[36:39], v[96:111]
    v_xor_b32 v22, 208, v10
    buffer_load_dwordx4 v22, s[8:11], s31 offen offset:1024 lds
    v_mfma_f32_32x32x16_bf16 v[112:127], a[180:183], v[36:39], v[112:127]
    v_mul_f32 v227, v227, v143
    v_mul_f32 v228, v228, v156
    v_mul_f32 v229, v229, v157
    v_mul_f32 v230, v230, v158
    v_mul_f32 v231, v231, v159
    v_exp_f32 v224, -v224
    s_waitcnt lgkmcnt(4)
    v_mfma_f32_32x32x16_bf16 v[64:79], a[56:59], v[40:43], v[64:79]
    ds_read_b128 v[32:35], v3 offset:512
    v_exp_f32 v225, -v225
    v_exp_f32 v226, -v226
    v_exp_f32 v227, -v227
    v_exp_f32 v228, -v228
    v_exp_f32 v229, -v229
    v_mfma_f32_32x32x16_bf16 v[80:95], a[184:187], v[40:43], v[80:95]
    ds_read_b128 v[36:39], v3 offset:33280
    v_exp_f32 v230, -v230
    v_exp_f32 v231, -v231
    v_add_f32 v224, 1.0, v224
    v_add_f32 v225, 1.0, v225
    v_add_f32 v226, 1.0, v226
    v_mfma_f32_32x32x16_bf16 v[96:111], a[56:59], v[44:47], v[96:111]
    v_xor_b32 v21, 224, v10
    buffer_load_dwordx4 v21, s[8:11], s31 offen offset:2048 lds
    v_mfma_f32_32x32x16_bf16 v[112:127], a[184:187], v[44:47], v[112:127]
    v_add_f32 v227, 1.0, v227
    v_add_f32 v228, 1.0, v228
    v_add_f32 v229, 1.0, v229
    v_add_f32 v230, 1.0, v230
    v_add_f32 v231, 1.0, v231
    v_rcp_f32 v224, v224
    s_waitcnt lgkmcnt(4)
    v_mfma_f32_32x32x16_bf16 v[64:79], a[60:63], v[48:51], v[64:79]
    ds_read_b128 v[40:43], v4 offset:512
    v_rcp_f32 v225, v225
    v_rcp_f32 v226, v226
    v_rcp_f32 v227, v227
    v_rcp_f32 v228, v228
    v_rcp_f32 v229, v229
    v_mfma_f32_32x32x16_bf16 v[80:95], a[188:191], v[48:51], v[80:95]
    ds_read_b128 v[44:47], v4 offset:33280
    v_rcp_f32 v230, v230
    v_rcp_f32 v231, v231
    v_mul_f32 v140, v140, v224
    v_mul_f32 v141, v141, v225
    v_mul_f32 v142, v142, v226
    v_mfma_f32_32x32x16_bf16 v[96:111], a[60:63], v[52:55], v[96:111]
    v_xor_b32 v22, 240, v10
    buffer_load_dwordx4 v22, s[8:11], s31 offen offset:3072 lds
    v_mfma_f32_32x32x16_bf16 v[112:127], a[188:191], v[52:55], v[112:127]
    v_mul_f32 v143, v143, v227
    v_mul_f32 v156, v156, v228
    v_mul_f32 v157, v157, v229
    v_mul_f32 v158, v158, v230
    v_mul_f32 v159, v159, v231
    v_cvt_pk_bf16_f32 v140, v140, v156
    s_waitcnt lgkmcnt(4)
    v_mfma_f32_32x32x16_bf16 v[64:79], a[64:67], v[24:27], v[64:79]
    ds_read_b128 v[48:51], v5 offset:512
    v_cvt_pk_bf16_f32 v141, v141, v157
    v_cvt_pk_bf16_f32 v142, v142, v158
    v_cvt_pk_bf16_f32 v143, v143, v159
    buffer_store_dwordx4 v[140:143], v11, s[12:15], s28 offen offset:3072 sc1
    v_mul_f32 v224, v160, v160
    v_mfma_f32_32x32x16_bf16 v[80:95], a[192:195], v[24:27], v[80:95]
    ds_read_b128 v[52:55], v5 offset:33280
    v_mul_f32 v225, v161, v161
    v_mul_f32 v226, v162, v162
    v_mul_f32 v227, v163, v163
    v_mul_f32 v228, v176, v176
    v_mul_f32 v229, v177, v177
    v_mfma_f32_32x32x16_bf16 v[96:111], a[64:67], v[28:31], v[96:111]
    v_mul_f32 v230, v178, v178
    v_mul_f32 v231, v179, v179
    v_fma_f32 v224, v224, s36, v244
    v_fma_f32 v225, v225, s36, v244
    v_fma_f32 v226, v226, s36, v244
    v_fma_f32 v227, v227, s36, v244
    v_mfma_f32_32x32x16_bf16 v[112:127], a[192:195], v[28:31], v[112:127]
    v_fma_f32 v228, v228, s36, v244
    v_fma_f32 v229, v229, s36, v244
    v_fma_f32 v230, v230, s36, v244
    v_fma_f32 v231, v231, s36, v244
    v_mul_f32 v224, v224, v160
    v_mul_f32 v225, v225, v161
    s_waitcnt lgkmcnt(4)
    v_mfma_f32_32x32x16_bf16 v[64:79], a[68:71], v[32:35], v[64:79]
    ds_read_b128 v[24:27], v6 offset:512
    v_mul_f32 v226, v226, v162
    v_mul_f32 v227, v227, v163
    v_mul_f32 v228, v228, v176
    v_mul_f32 v229, v229, v177
    v_mul_f32 v230, v230, v178
    v_mfma_f32_32x32x16_bf16 v[80:95], a[196:199], v[32:35], v[80:95]
    ds_read_b128 v[28:31], v6 offset:33280
    v_mul_f32 v231, v231, v179
    v_exp_f32 v224, -v224
    v_exp_f32 v225, -v225
    v_exp_f32 v226, -v226
    v_exp_f32 v227, -v227
    v_mfma_f32_32x32x16_bf16 v[96:111], a[68:71], v[36:39], v[96:111]
    v_exp_f32 v228, -v228
    v_exp_f32 v229, -v229
    v_exp_f32 v230, -v230
    v_exp_f32 v231, -v231
    v_add_f32 v224, 1.0, v224
    v_add_f32 v225, 1.0, v225
    v_mfma_f32_32x32x16_bf16 v[112:127], a[196:199], v[36:39], v[112:127]
    v_add_f32 v226, 1.0, v226
    v_add_f32 v227, 1.0, v227
    v_add_f32 v228, 1.0, v228
    v_add_f32 v229, 1.0, v229
    v_add_f32 v230, 1.0, v230
    v_add_f32 v231, 1.0, v231
    s_waitcnt lgkmcnt(4)
    v_mfma_f32_32x32x16_bf16 v[64:79], a[72:75], v[40:43], v[64:79]
    ds_read_b128 v[32:35], v7 offset:512
    v_rcp_f32 v224, v224
    v_rcp_f32 v225, v225
    v_rcp_f32 v226, v226
    v_rcp_f32 v227, v227
    v_rcp_f32 v228, v228
    v_mfma_f32_32x32x16_bf16 v[80:95], a[200:203], v[40:43], v[80:95]
    ds_read_b128 v[36:39], v7 offset:33280
    v_rcp_f32 v229, v229
    v_rcp_f32 v230, v230
    v_rcp_f32 v231, v231
    v_mul_f32 v160, v160, v224
    v_mul_f32 v161, v161, v225
    v_mfma_f32_32x32x16_bf16 v[96:111], a[72:75], v[44:47], v[96:111]
    v_mul_f32 v162, v162, v226
    v_mul_f32 v163, v163, v227
    v_mul_f32 v176, v176, v228
    v_mul_f32 v177, v177, v229
    v_mul_f32 v178, v178, v230
    v_mul_f32 v179, v179, v231
    v_mfma_f32_32x32x16_bf16 v[112:127], a[200:203], v[44:47], v[112:127]
    v_cvt_pk_bf16_f32 v160, v160, v176
    v_cvt_pk_bf16_f32 v161, v161, v177
    v_cvt_pk_bf16_f32 v162, v162, v178
    v_cvt_pk_bf16_f32 v163, v163, v179
    buffer_store_dwordx4 v[160:163], v11, s[12:15], s37 offen offset:0 sc1
    v_mul_f32 v224, v164, v164
    s_waitcnt lgkmcnt(4)
    v_mfma_f32_32x32x16_bf16 v[64:79], a[76:79], v[48:51], v[64:79]
    ds_read_b128 v[40:43], v8 offset:512
    v_mul_f32 v225, v165, v165
    v_mul_f32 v226, v166, v166
    v_mul_f32 v227, v167, v167
    v_mul_f32 v228, v180, v180
    v_mul_f32 v229, v181, v181
    v_mfma_f32_32x32x16_bf16 v[80:95], a[204:207], v[48:51], v[80:95]
    ds_read_b128 v[44:47], v8 offset:33280
    v_mul_f32 v230, v182, v182
    v_mul_f32 v231, v183, v183
    v_fma_f32 v224, v224, s36, v244
    v_fma_f32 v225, v225, s36, v244
    v_fma_f32 v226, v226, s36, v244
    v_mfma_f32_32x32x16_bf16 v[96:111], a[76:79], v[52:55], v[96:111]
    v_fma_f32 v227, v227, s36, v244
    v_fma_f32 v228, v228, s36, v244
    v_fma_f32 v229, v229, s36, v244
    v_fma_f32 v230, v230, s36, v244
    v_fma_f32 v231, v231, s36, v244
    v_mul_f32 v224, v224, v164
    v_mfma_f32_32x32x16_bf16 v[112:127], a[204:207], v[52:55], v[112:127]
    v_mul_f32 v225, v225, v165
    v_mul_f32 v226, v226, v166
    v_mul_f32 v227, v227, v167
    v_mul_f32 v228, v228, v180
    v_mul_f32 v229, v229, v181
    v_mul_f32 v230, v230, v182
    s_waitcnt lgkmcnt(4)
    v_mfma_f32_32x32x16_bf16 v[64:79], a[80:83], v[24:27], v[64:79]
    ds_read_b128 v[48:51], v9 offset:512
    v_mul_f32 v231, v231, v183
    v_exp_f32 v224, -v224
    v_exp_f32 v225, -v225
    v_exp_f32 v226, -v226
    v_exp_f32 v227, -v227
    v_mfma_f32_32x32x16_bf16 v[80:95], a[208:211], v[24:27], v[80:95]
    ds_read_b128 v[52:55], v9 offset:33280
    v_exp_f32 v228, -v228
    v_exp_f32 v229, -v229
    v_exp_f32 v230, -v230
    v_exp_f32 v231, -v231
    v_add_f32 v224, 1.0, v224
    v_mfma_f32_32x32x16_bf16 v[96:111], a[80:83], v[28:31], v[96:111]
    v_add_f32 v225, 1.0, v225
    v_add_f32 v226, 1.0, v226
    v_add_f32 v227, 1.0, v227
    v_add_f32 v228, 1.0, v228
    v_add_f32 v229, 1.0, v229
    v_add_f32 v230, 1.0, v230
    v_mfma_f32_32x32x16_bf16 v[112:127], a[208:211], v[28:31], v[112:127]
    v_add_f32 v231, 1.0, v231
    v_rcp_f32 v224, v224
    v_rcp_f32 v225, v225
    v_rcp_f32 v226, v226
    v_rcp_f32 v227, v227
    v_rcp_f32 v228, v228
    s_waitcnt lgkmcnt(4)
    v_mfma_f32_32x32x16_bf16 v[64:79], a[84:87], v[32:35], v[64:79]
    ds_read_b128 v[24:27], v2 offset:768
    v_rcp_f32 v229, v229
    v_rcp_f32 v230, v230
    v_rcp_f32 v231, v231
    v_mul_f32 v164, v164, v224
    v_mul_f32 v165, v165, v225
    v_mfma_f32_32x32x16_bf16 v[80:95], a[212:215], v[32:35], v[80:95]
    ds_read_b128 v[28:31], v2 offset:33536
    v_mul_f32 v166, v166, v226
    v_mul_f32 v167, v167, v227
    v_mul_f32 v180, v180, v228
    v_mul_f32 v181, v181, v229
    v_mul_f32 v182, v182, v230
    v_mfma_f32_32x32x16_bf16 v[96:111], a[84:87], v[36:39], v[96:111]
    v_mul_f32 v183, v183, v231
    v_cvt_pk_bf16_f32 v164, v164, v180
    v_cvt_pk_bf16_f32 v165, v165, v181
    v_cvt_pk_bf16_f32 v166, v166, v182
    v_cvt_pk_bf16_f32 v167, v167, v183
    buffer_store_dwordx4 v[164:167], v11, s[12:15], s37 offen offset:1024 sc1
    v_mfma_f32_32x32x16_bf16 v[112:127], a[212:215], v[36:39], v[112:127]
    v_mul_f32 v224, v168, v168
    v_mul_f32 v225, v169, v169
    v_mul_f32 v226, v170, v170
    v_mul_f32 v227, v171, v171
    v_mul_f32 v228, v184, v184
    v_mul_f32 v229, v185, v185
    s_waitcnt lgkmcnt(4)
    v_mfma_f32_32x32x16_bf16 v[64:79], a[88:91], v[40:43], v[64:79]
    ds_read_b128 v[32:35], v3 offset:768
    v_mul_f32 v230, v186, v186
    v_mul_f32 v231, v187, v187
    v_fma_f32 v224, v224, s36, v244
    v_fma_f32 v225, v225, s36, v244
    v_fma_f32 v226, v226, s36, v244
    v_mfma_f32_32x32x16_bf16 v[80:95], a[216:219], v[40:43], v[80:95]
    ds_read_b128 v[36:39], v3 offset:33536
    v_fma_f32 v227, v227, s36, v244
    v_fma_f32 v228, v228, s36, v244
    v_fma_f32 v229, v229, s36, v244
    v_fma_f32 v230, v230, s36, v244
    v_fma_f32 v231, v231, s36, v244
    v_mfma_f32_32x32x16_bf16 v[96:111], a[88:91], v[44:47], v[96:111]
    v_mul_f32 v224, v224, v168
    v_mul_f32 v225, v225, v169
    v_mul_f32 v226, v226, v170
    v_mul_f32 v227, v227, v171
    v_mul_f32 v228, v228, v184
    v_mul_f32 v229, v229, v185
    v_mfma_f32_32x32x16_bf16 v[112:127], a[216:219], v[44:47], v[112:127]
    v_mul_f32 v230, v230, v186
    v_mul_f32 v231, v231, v187
    v_exp_f32 v224, -v224
    v_exp_f32 v225, -v225
    v_exp_f32 v226, -v226
    v_exp_f32 v227, -v227
    s_waitcnt lgkmcnt(4)
    v_mfma_f32_32x32x16_bf16 v[64:79], a[92:95], v[48:51], v[64:79]
    ds_read_b128 v[40:43], v4 offset:768
    v_exp_f32 v228, -v228
    v_exp_f32 v229, -v229
    v_exp_f32 v230, -v230
    v_exp_f32 v231, -v231
    v_add_f32 v224, 1.0, v224
    v_mfma_f32_32x32x16_bf16 v[80:95], a[220:223], v[48:51], v[80:95]
    ds_read_b128 v[44:47], v4 offset:33536
    v_add_f32 v225, 1.0, v225
    v_add_f32 v226, 1.0, v226
    v_add_f32 v227, 1.0, v227
    v_add_f32 v228, 1.0, v228
    v_add_f32 v229, 1.0, v229
    v_mfma_f32_32x32x16_bf16 v[96:111], a[92:95], v[52:55], v[96:111]
    v_add_f32 v230, 1.0, v230
    v_add_f32 v231, 1.0, v231
    v_rcp_f32 v224, v224
    v_rcp_f32 v225, v225
    v_rcp_f32 v226, v226
    v_rcp_f32 v227, v227
    v_mfma_f32_32x32x16_bf16 v[112:127], a[220:223], v[52:55], v[112:127]
    v_rcp_f32 v228, v228
    v_rcp_f32 v229, v229
    v_rcp_f32 v230, v230
    v_rcp_f32 v231, v231
    v_mul_f32 v168, v168, v224
    v_mul_f32 v169, v169, v225
    s_waitcnt lgkmcnt(4)
    v_mfma_f32_32x32x16_bf16 v[64:79], a[96:99], v[24:27], v[64:79]
    ds_read_b128 v[48:51], v5 offset:768
    v_mul_f32 v170, v170, v226
    v_mul_f32 v171, v171, v227
    v_mul_f32 v184, v184, v228
    v_mul_f32 v185, v185, v229
    v_mul_f32 v186, v186, v230
    v_mfma_f32_32x32x16_bf16 v[80:95], a[224:227], v[24:27], v[80:95]
    ds_read_b128 v[52:55], v5 offset:33536
    v_mul_f32 v187, v187, v231
    v_cvt_pk_bf16_f32 v168, v168, v184
    v_cvt_pk_bf16_f32 v169, v169, v185
    v_cvt_pk_bf16_f32 v170, v170, v186
    v_cvt_pk_bf16_f32 v171, v171, v187
    v_mfma_f32_32x32x16_bf16 v[96:111], a[96:99], v[28:31], v[96:111]
    buffer_store_dwordx4 v[168:171], v11, s[12:15], s37 offen offset:2048 sc1
    v_mul_f32 v224, v172, v172
    v_mul_f32 v225, v173, v173
    v_mul_f32 v226, v174, v174
    v_mul_f32 v227, v175, v175
    v_mul_f32 v228, v188, v188
    v_mfma_f32_32x32x16_bf16 v[112:127], a[224:227], v[28:31], v[112:127]
    v_mul_f32 v229, v189, v189
    v_mul_f32 v230, v190, v190
    v_mul_f32 v231, v191, v191
    v_fma_f32 v224, v224, s36, v244
    v_fma_f32 v225, v225, s36, v244
    v_fma_f32 v226, v226, s36, v244
    s_waitcnt lgkmcnt(4)
    v_mfma_f32_32x32x16_bf16 v[64:79], a[100:103], v[32:35], v[64:79]
    ds_read_b128 v[24:27], v6 offset:768
    v_fma_f32 v227, v227, s36, v244
    v_fma_f32 v228, v228, s36, v244
    v_fma_f32 v229, v229, s36, v244
    v_fma_f32 v230, v230, s36, v244
    v_fma_f32 v231, v231, s36, v244
    v_mfma_f32_32x32x16_bf16 v[80:95], a[228:231], v[32:35], v[80:95]
    ds_read_b128 v[28:31], v6 offset:33536
    v_mul_f32 v224, v224, v172
    v_mul_f32 v225, v225, v173
    v_mul_f32 v226, v226, v174
    v_mul_f32 v227, v227, v175
    v_mul_f32 v228, v228, v188
    v_mfma_f32_32x32x16_bf16 v[96:111], a[100:103], v[36:39], v[96:111]
    v_mul_f32 v229, v229, v189
    v_mul_f32 v230, v230, v190
    v_mul_f32 v231, v231, v191
    v_exp_f32 v224, -v224
    v_exp_f32 v225, -v225
    v_exp_f32 v226, -v226
    v_mfma_f32_32x32x16_bf16 v[112:127], a[228:231], v[36:39], v[112:127]
    v_exp_f32 v227, -v227
    v_exp_f32 v228, -v228
    v_exp_f32 v229, -v229
    v_exp_f32 v230, -v230
    v_exp_f32 v231, -v231
    v_add_f32 v224, 1.0, v224
    s_waitcnt lgkmcnt(4)
    v_mfma_f32_32x32x16_bf16 v[64:79], a[104:107], v[40:43], v[64:79]
    ds_read_b128 v[32:35], v7 offset:768
    v_add_f32 v225, 1.0, v225
    v_add_f32 v226, 1.0, v226
    v_add_f32 v227, 1.0, v227
    v_add_f32 v228, 1.0, v228
    v_add_f32 v229, 1.0, v229
    v_mfma_f32_32x32x16_bf16 v[80:95], a[232:235], v[40:43], v[80:95]
    ds_read_b128 v[36:39], v7 offset:33536
    v_add_f32 v230, 1.0, v230
    v_add_f32 v231, 1.0, v231
    v_rcp_f32 v224, v224
    v_rcp_f32 v225, v225
    v_rcp_f32 v226, v226
    v_mfma_f32_32x32x16_bf16 v[96:111], a[104:107], v[44:47], v[96:111]
    v_rcp_f32 v227, v227
    v_rcp_f32 v228, v228
    v_rcp_f32 v229, v229
    v_rcp_f32 v230, v230
    v_rcp_f32 v231, v231
    v_mul_f32 v172, v172, v224
    v_mfma_f32_32x32x16_bf16 v[112:127], a[232:235], v[44:47], v[112:127]
    v_mul_f32 v173, v173, v225
    v_mul_f32 v174, v174, v226
    v_mul_f32 v175, v175, v227
    v_mul_f32 v188, v188, v228
    v_mul_f32 v189, v189, v229
    v_mul_f32 v190, v190, v230
    s_waitcnt lgkmcnt(4)
    v_mfma_f32_32x32x16_bf16 v[64:79], a[108:111], v[48:51], v[64:79]
    ds_read_b128 v[40:43], v8 offset:768
    v_mul_f32 v191, v191, v231
    v_cvt_pk_bf16_f32 v172, v172, v188
    v_cvt_pk_bf16_f32 v173, v173, v189
    v_cvt_pk_bf16_f32 v174, v174, v190
    v_cvt_pk_bf16_f32 v175, v175, v191
    v_mfma_f32_32x32x16_bf16 v[80:95], a[236:239], v[48:51], v[80:95]
    ds_read_b128 v[44:47], v8 offset:33536
    buffer_store_dwordx4 v[172:175], v11, s[12:15], s37 offen offset:3072 sc1
    v_mfma_f32_32x32x16_bf16 v[96:111], a[108:111], v[52:55], v[96:111]
    v_mfma_f32_32x32x16_bf16 v[112:127], a[236:239], v[52:55], v[112:127]
    s_waitcnt lgkmcnt(4)
    v_mfma_f32_32x32x16_bf16 v[64:79], a[112:115], v[24:27], v[64:79]
    ds_read_b128 v[48:51], v9 offset:768
    v_mfma_f32_32x32x16_bf16 v[80:95], a[240:243], v[24:27], v[80:95]
    ds_read_b128 v[52:55], v9 offset:33536
    v_mfma_f32_32x32x16_bf16 v[96:111], a[112:115], v[28:31], v[96:111]
    v_mfma_f32_32x32x16_bf16 v[112:127], a[240:243], v[28:31], v[112:127]
    s_waitcnt lgkmcnt(4)
    v_mfma_f32_32x32x16_bf16 v[64:79], a[116:119], v[32:35], v[64:79]
    v_mfma_f32_32x32x16_bf16 v[80:95], a[244:247], v[32:35], v[80:95]
    v_xor_b32 v2, 0x10000, v2
    v_mfma_f32_32x32x16_bf16 v[96:111], a[116:119], v[36:39], v[96:111]
    v_xor_b32 v3, 0x10000, v3
    v_mfma_f32_32x32x16_bf16 v[112:127], a[244:247], v[36:39], v[112:127]
    v_xor_b32 v4, 0x10000, v4
    s_waitcnt lgkmcnt(2)
    v_mfma_f32_32x32x16_bf16 v[64:79], a[120:123], v[40:43], v[64:79]
    v_mfma_f32_32x32x16_bf16 v[80:95], a[248:251], v[40:43], v[80:95]
    v_xor_b32 v5, 0x10000, v5
    v_mfma_f32_32x32x16_bf16 v[96:111], a[120:123], v[44:47], v[96:111]
    v_xor_b32 v6, 0x10000, v6
    v_mfma_f32_32x32x16_bf16 v[112:127], a[248:251], v[44:47], v[112:127]
    v_xor_b32 v7, 0x10000, v7
    s_waitcnt lgkmcnt(0)
    v_mfma_f32_32x32x16_bf16 v[64:79], a[124:127], v[48:51], v[64:79]
    v_mfma_f32_32x32x16_bf16 v[80:95], a[252:255], v[48:51], v[80:95]
    v_xor_b32 v8, 0x10000, v8
    v_mfma_f32_32x32x16_bf16 v[96:111], a[124:127], v[52:55], v[96:111]
    v_xor_b32 v9, 0x10000, v9
    v_mfma_f32_32x32x16_bf16 v[112:127], a[252:255], v[52:55], v[112:127]
    s_mov_b32 s28, s38
    s_add_u32 s37, s28, s29
    s_lshl_b32 s30, s29, 3
    s_add_u32 s38, s38, s30
    s_add_u32 s33, s33, 1
    s_waitcnt vmcnt(5)
    s_barrier
    s_add_u32 s34, s34, 0x40000
    s_xor_b32 s32, s32, 0x10000
    ds_read_b128 v[24:27], v2 offset:0
    ds_read_b128 v[28:31], v2 offset:32768
    ds_read_b128 v[32:35], v3 offset:0
    ds_read_b128 v[36:39], v3 offset:32768
    ds_read_b128 v[40:43], v4 offset:0
    ds_read_b128 v[44:47], v4 offset:32768
    s_waitcnt lgkmcnt(4)
    v_mfma_f32_32x32x16_bf16 v[128:143], a[0:3], v[24:27], v[192:207]
    ds_read_b128 v[48:51], v5 offset:0
    v_mfma_f32_32x32x16_bf16 v[144:159], a[128:131], v[24:27], v[208:223]
    ds_read_b128 v[52:55], v5 offset:32768
    v_mfma_f32_32x32x16_bf16 v[160:175], a[0:3], v[28:31], v[192:207]
    s_add_u32 m0, s32, 0
    s_add_u32 s31, s34, 0
    v_xor_b32 v21, 0, v10
    buffer_load_dwordx4 v21, s[8:11], s31 offen offset:0 lds
    v_mfma_f32_32x32x16_bf16 v[176:191], a[128:131], v[28:31], v[208:223]
    s_waitcnt lgkmcnt(4)
    v_mfma_f32_32x32x16_bf16 v[128:143], a[4:7], v[32:35], v[128:143]
    ds_read_b128 v[24:27], v6 offset:0
    v_mul_f32 v224, v64, v64
    v_mul_f32 v225, v65, v65
    v_mul_f32 v226, v66, v66
    v_mul_f32 v227, v67, v67
    v_mul_f32 v228, v80, v80
    v_mfma_f32_32x32x16_bf16 v[144:159], a[132:135], v[32:35], v[144:159]
    ds_read_b128 v[28:31], v6 offset:32768
    v_mul_f32 v229, v81, v81
    v_mul_f32 v230, v82, v82
    v_mul_f32 v231, v83, v83
    v_fma_f32 v224, v224, s36, v244
    v_fma_f32 v225, v225, s36, v244
    v_mfma_f32_32x32x16_bf16 v[160:175], a[4:7], v[36:39], v[160:175]
    v_xor_b32 v22, 16, v10
    buffer_load_dwordx4 v22, s[8:11], s31 offen offset:1024 lds
    v_mfma_f32_32x32x16_bf16 v[176:191], a[132:135], v[36:39], v[176:191]
    v_fma_f32 v226, v226, s36, v244
    v_fma_f32 v227, v227, s36, v244
    v_fma_f32 v228, v228, s36, v244
    v_fma_f32 v229, v229, s36, v244
    v_fma_f32 v230, v230, s36, v244
    v_fma_f32 v231, v231, s36, v244
    s_waitcnt lgkmcnt(4)
    v_mfma_f32_32x32x16_bf16 v[128:143], a[8:11], v[40:43], v[128:143]
    ds_read_b128 v[32:35], v7 offset:0
    v_mul_f32 v224, v224, v64
    v_mul_f32 v225, v225, v65
    v_mul_f32 v226, v226, v66
    v_mul_f32 v227, v227, v67
    v_mul_f32 v228, v228, v80
    v_mfma_f32_32x32x16_bf16 v[144:159], a[136:139], v[40:43], v[144:159]
    ds_read_b128 v[36:39], v7 offset:32768
    v_mul_f32 v229, v229, v81
    v_mul_f32 v230, v230, v82
    v_mul_f32 v231, v231, v83
    v_exp_f32 v224, -v224
    v_exp_f32 v225, -v225
    v_mfma_f32_32x32x16_bf16 v[160:175], a[8:11], v[44:47], v[160:175]
    v_xor_b32 v21, 32, v10
    buffer_load_dwordx4 v21, s[8:11], s31 offen offset:2048 lds
    v_mfma_f32_32x32x16_bf16 v[176:191], a[136:139], v[44:47], v[176:191]
    v_exp_f32 v226, -v226
    v_exp_f32 v227, -v227
    v_exp_f32 v228, -v228
    v_exp_f32 v229, -v229
    v_exp_f32 v230, -v230
    v_exp_f32 v231, -v231
    s_waitcnt lgkmcnt(4)
    v_mfma_f32_32x32x16_bf16 v[128:143], a[12:15], v[48:51], v[128:143]
    ds_read_b128 v[40:43], v8 offset:0
    v_add_f32 v224, 1.0, v224
    v_add_f32 v225, 1.0, v225
    v_add_f32 v226, 1.0, v226
    v_add_f32 v227, 1.0, v227
    v_add_f32 v228, 1.0, v228
    v_mfma_f32_32x32x16_bf16 v[144:159], a[140:143], v[48:51], v[144:159]
    ds_read_b128 v[44:47], v8 offset:32768
    v_add_f32 v229, 1.0, v229
    v_add_f32 v230, 1.0, v230
    v_add_f32 v231, 1.0, v231
    v_rcp_f32 v224, v224
    v_rcp_f32 v225, v225
    v_mfma_f32_32x32x16_bf16 v[160:175], a[12:15], v[52:55], v[160:175]
    v_xor_b32 v22, 48, v10
    buffer_load_dwordx4 v22, s[8:11], s31 offen offset:3072 lds
    v_mfma_f32_32x32x16_bf16 v[176:191], a[140:143], v[52:55], v[176:191]
    v_rcp_f32 v226, v226
    v_rcp_f32 v227, v227
    v_rcp_f32 v228, v228
    v_rcp_f32 v229, v229
    v_rcp_f32 v230, v230
    v_rcp_f32 v231, v231
    s_waitcnt lgkmcnt(4)
    v_mfma_f32_32x32x16_bf16 v[128:143], a[16:19], v[24:27], v[128:143]
    ds_read_b128 v[48:51], v9 offset:0
    v_mul_f32 v64, v64, v224
    v_mul_f32 v65, v65, v225
    v_mul_f32 v66, v66, v226
    v_mul_f32 v67, v67, v227
    v_mul_f32 v80, v80, v228
    v_mfma_f32_32x32x16_bf16 v[144:159], a[144:147], v[24:27], v[144:159]
    ds_read_b128 v[52:55], v9 offset:32768
    v_mul_f32 v81, v81, v229
    v_mul_f32 v82, v82, v230
    v_mul_f32 v83, v83, v231
    v_cvt_pk_bf16_f32 v64, v64, v80
    v_cvt_pk_bf16_f32 v65, v65, v81
    v_mfma_f32_32x32x16_bf16 v[160:175], a[16:19], v[28:31], v[160:175]
    s_add_u32 m0, s32, 4096
    s_add_u32 s31, s34, 4096
    v_xor_b32 v21, 64, v10
    buffer_load_dwordx4 v21, s[8:11], s31 offen offset:0 lds
    v_mfma_f32_32x32x16_bf16 v[176:191], a[144:147], v[28:31], v[176:191]
    v_cvt_pk_bf16_f32 v66, v66, v82
    v_cvt_pk_bf16_f32 v67, v67, v83
    buffer_store_dwordx4 v[64:67], v11, s[12:15], s28 offen offset:0 sc1
    v_mul_f32 v224, v68, v68
    v_mul_f32 v225, v69, v69
    v_mul_f32 v226, v70, v70
    s_waitcnt lgkmcnt(4)
    v_mfma_f32_32x32x16_bf16 v[128:143], a[20:23], v[32:35], v[128:143]
    ds_read_b128 v[24:27], v2 offset:256
    v_mul_f32 v227, v71, v71
    v_mul_f32 v228, v84, v84
    v_mul_f32 v229, v85, v85
    v_mul_f32 v230, v86, v86
    v_mul_f32 v231, v87, v87
    v_mfma_f32_32x32x16_bf16 v[144:159], a[148:151], v[32:35], v[144:159]
    ds_read_b128 v[28:31], v2 offset:33024
    v_fma_f32 v224, v224, s36, v244
    v_fma_f32 v225, v225, s36, v244
    v_fma_f32 v226, v226, s36, v244
    v_fma_f32 v227, v227, s36, v244
    v_fma_f32 v228, v228, s36, v244
    v_mfma_f32_32x32x16_bf16 v[160:175], a[20:23], v[36:39], v[160:175]
    v_xor_b32 v22, 80, v10
    buffer_load_dwordx4 v22, s[8:11], s31 offen offset:1024 lds
    v_mfma_f32_32x32x16_bf16 v[176:191], a[148:151], v[36:39], v[176:191]
    v_fma_f32 v229, v229, s36, v244
    v_fma_f32 v230, v230, s36, v244
    v_fma_f32 v231, v231, s36, v244
    v_mul_f32 v224, v224, v68
    v_mul_f32 v225, v225, v69
    v_mul_f32 v226, v226, v70
    s_waitcnt lgkmcnt(4)
    v_mfma_f32_32x32x16_bf16 v[128:143], a[24:27], v[40:43], v[128:143]
    ds_read_b128 v[32:35], v3 offset:256
    v_mul_f32 v227, v227, v71
    v_mul_f32 v228, v228, v84
    v_mul_f32 v229, v229, v85
    v_mul_f32 v230, v230, v86
    v_mul_f32 v231, v231, v87
    v_mfma_f32_32x32x16_bf16 v[144:159], a[152:155], v[40:43], v[144:159]
    ds_read_b128 v[36:39], v3 offset:33024
    v_exp_f32 v224, -v224
    v_exp_f32 v225, -v225
    v_exp_f32 v226, -v226
    v_exp_f32 v227, -v227
    v_exp_f32 v228, -v228
    v_mfma_f32_32x32x16_bf16 v[160:175], a[24:27], v[44:47], v[160:175]
    v_xor_b32 v21, 96, v10
    buffer_load_dwordx4 v21, s[8:11], s31 offen offset:2048 lds
    v_mfma_f32_32x32x16_bf16 v[176:191], a[152:155], v[44:47], v[176:191]
    v_exp_f32 v229, -v229
    v_exp_f32 v230, -v230
    v_exp_f32 v231, -v231
    v_add_f32 v224, 1.0, v224
    v_add_f32 v225, 1.0, v225
    v_add_f32 v226, 1.0, v226
    s_waitcnt lgkmcnt(4)
    v_mfma_f32_32x32x16_bf16 v[128:143], a[28:31], v[48:51], v[128:143]
    ds_read_b128 v[40:43], v4 offset:256
    v_add_f32 v227, 1.0, v227
    v_add_f32 v228, 1.0, v228
    v_add_f32 v229, 1.0, v229
    v_add_f32 v230, 1.0, v230
    v_add_f32 v231, 1.0, v231
    v_mfma_f32_32x32x16_bf16 v[144:159], a[156:159], v[48:51], v[144:159]
    ds_read_b128 v[44:47], v4 offset:33024
    v_rcp_f32 v224, v224
    v_rcp_f32 v225, v225
    v_rcp_f32 v226, v226
    v_rcp_f32 v227, v227
    v_rcp_f32 v228, v228
    v_mfma_f32_32x32x16_bf16 v[160:175], a[28:31], v[52:55], v[160:175]
    v_xor_b32 v22, 112, v10
    buffer_load_dwordx4 v22, s[8:11], s31 offen offset:3072 lds
    v_mfma_f32_32x32x16_bf16 v[176:191], a[156:159], v[52:55], v[176:191]
    v_rcp_f32 v229, v229
    v_rcp_f32 v230, v230
    v_rcp_f32 v231, v231
    v_mul_f32 v68, v68, v224
    v_mul_f32 v69, v69, v225
    v_mul_f32 v70, v70, v226
    s_waitcnt lgkmcnt(4)
    v_mfma_f32_32x32x16_bf16 v[128:143], a[32:35], v[24:27], v[128:143]
    ds_read_b128 v[48:51], v5 offset:256
    v_mul_f32 v71, v71, v227
    v_mul_f32 v84, v84, v228
    v_mul_f32 v85, v85, v229
    v_mul_f32 v86, v86, v230
    v_mul_f32 v87, v87, v231
    v_mfma_f32_32x32x16_bf16 v[144:159], a[160:163], v[24:27], v[144:159]
    ds_read_b128 v[52:55], v5 offset:33024
    v_cvt_pk_bf16_f32 v68, v68, v84
    v_cvt_pk_bf16_f32 v69, v69, v85
    v_cvt_pk_bf16_f32 v70, v70, v86
    v_cvt_pk_bf16_f32 v71, v71, v87
    buffer_store_dwordx4 v[68:71], v11, s[12:15], s28 offen offset:1024 sc1
    v_mfma_f32_32x32x16_bf16 v[160:175], a[32:35], v[28:31], v[160:175]
    s_add_u32 m0, s32, 8192
    s_add_u32 s31, s34, 8192
    v_xor_b32 v21, 128, v10
    buffer_load_dwordx4 v21, s[8:11], s31 offen offset:0 lds
    v_mfma_f32_32x32x16_bf16 v[176:191], a[160:163], v[28:31], v[176:191]
    v_mul_f32 v224, v72, v72
    v_mul_f32 v225, v73, v73
    v_mul_f32 v226, v74, v74
    v_mul_f32 v227, v75, v75
    v_mul_f32 v228, v88, v88
    v_mul_f32 v229, v89, v89
    s_waitcnt lgkmcnt(4)
    v_mfma_f32_32x32x16_bf16 v[128:143], a[36:39], v[32:35], v[128:143]
    ds_read_b128 v[24:27], v6 offset:256
    v_mul_f32 v230, v90, v90
    v_mul_f32 v231, v91, v91
    v_fma_f32 v224, v224, s36, v244
    v_fma_f32 v225, v225, s36, v244
    v_fma_f32 v226, v226, s36, v244
    v_mfma_f32_32x32x16_bf16 v[144:159], a[164:167], v[32:35], v[144:159]
    ds_read_b128 v[28:31], v6 offset:33024
    v_fma_f32 v227, v227, s36, v244
    v_fma_f32 v228, v228, s36, v244
    v_fma_f32 v229, v229, s36, v244
    v_fma_f32 v230, v230, s36, v244
    v_fma_f32 v231, v231, s36, v244
    v_mfma_f32_32x32x16_bf16 v[160:175], a[36:39], v[36:39], v[160:175]
    v_xor_b32 v22, 144, v10
    buffer_load_dwordx4 v22, s[8:11], s31 offen offset:1024 lds
    v_mfma_f32_32x32x16_bf16 v[176:191], a[164:167], v[36:39], v[176:191]
    v_mul_f32 v224, v224, v72
    v_mul_f32 v225, v225, v73
    v_mul_f32 v226, v226, v74
    v_mul_f32 v227, v227, v75
    v_mul_f32 v228, v228, v88
    v_mul_f32 v229, v229, v89
    s_waitcnt lgkmcnt(4)
    v_mfma_f32_32x32x16_bf16 v[128:143], a[40:43], v[40:43], v[128:143]
    ds_read_b128 v[32:35], v7 offset:256
    v_mul_f32 v230, v230, v90
    v_mul_f32 v231, v231, v91
    v_exp_f32 v224, -v224
    v_exp_f32 v225, -v225
    v_exp_f32 v226, -v226
    v_mfma_f32_32x32x16_bf16 v[144:159], a[168:171], v[40:43], v[144:159]
    ds_read_b128 v[36:39], v7 offset:33024
    v_exp_f32 v227, -v227
    v_exp_f32 v228, -v228
    v_exp_f32 v229, -v229
    v_exp_f32 v230, -v230
    v_exp_f32 v231, -v231
    v_mfma_f32_32x32x16_bf16 v[160:175], a[40:43], v[44:47], v[160:175]
    v_xor_b32 v21, 160, v10
    buffer_load_dwordx4 v21, s[8:11], s31 offen offset:2048 lds
    v_mfma_f32_32x32x16_bf16 v[176:191], a[168:171], v[44:47], v[176:191]
    v_add_f32 v224, 1.0, v224
    v_add_f32 v225, 1.0, v225
    v_add_f32 v226, 1.0, v226
    v_add_f32 v227, 1.0, v227
    v_add_f32 v228, 1.0, v228
    v_add_f32 v229, 1.0, v229
    s_waitcnt lgkmcnt(4)
    v_mfma_f32_32x32x16_bf16 v[128:143], a[44:47], v[48:51], v[128:143]
    ds_read_b128 v[40:43], v8 offset:256
    v_add_f32 v230, 1.0, v230
    v_add_f32 v231, 1.0, v231
    v_rcp_f32 v224, v224
    v_rcp_f32 v225, v225
    v_rcp_f32 v226, v226
    v_mfma_f32_32x32x16_bf16 v[144:159], a[172:175], v[48:51], v[144:159]
    ds_read_b128 v[44:47], v8 offset:33024
    v_rcp_f32 v227, v227
    v_rcp_f32 v228, v228
    v_rcp_f32 v229, v229
    v_rcp_f32 v230, v230
    v_rcp_f32 v231, v231
    v_mfma_f32_32x32x16_bf16 v[160:175], a[44:47], v[52:55], v[160:175]
    v_xor_b32 v22, 176, v10
    buffer_load_dwordx4 v22, s[8:11], s31 offen offset:3072 lds
    v_mfma_f32_32x32x16_bf16 v[176:191], a[172:175], v[52:55], v[176:191]
    v_mul_f32 v72, v72, v224
    v_mul_f32 v73, v73, v225
    v_mul_f32 v74, v74, v226
    v_mul_f32 v75, v75, v227
    v_mul_f32 v88, v88, v228
    v_mul_f32 v89, v89, v229
    s_waitcnt lgkmcnt(4)
    v_mfma_f32_32x32x16_bf16 v[128:143], a[48:51], v[24:27], v[128:143]
    ds_read_b128 v[48:51], v9 offset:256
    v_mul_f32 v90, v90, v230
    v_mul_f32 v91, v91, v231
    v_cvt_pk_bf16_f32 v72, v72, v88
    v_cvt_pk_bf16_f32 v73, v73, v89
    v_cvt_pk_bf16_f32 v74, v74, v90
    v_mfma_f32_32x32x16_bf16 v[144:159], a[176:179], v[24:27], v[144:159]
    ds_read_b128 v[52:55], v9 offset:33024
    v_cvt_pk_bf16_f32 v75, v75, v91
    buffer_store_dwordx4 v[72:75], v11, s[12:15], s28 offen offset:2048 sc1
    v_mul_f32 v224, v76, v76
    v_mul_f32 v225, v77, v77
    v_mul_f32 v226, v78, v78
    v_mfma_f32_32x32x16_bf16 v[160:175], a[48:51], v[28:31], v[160:175]
    s_add_u32 m0, s32, 12288
    s_add_u32 s31, s34, 12288
    v_xor_b32 v21, 192, v10
    buffer_load_dwordx4 v21, s[8:11], s31 offen offset:0 lds
    v_mfma_f32_32x32x16_bf16 v[176:191], a[176:179], v[28:31], v[176:191]
    v_mul_f32 v227, v79, v79
    v_mul_f32 v228, v92, v92
    v_mul_f32 v229, v93, v93
    v_mul_f32 v230, v94, v94
    v_mul_f32 v231, v95, v95
    v_fma_f32 v224, v224, s36, v244
    s_waitcnt lgkmcnt(4)
    v_mfma_f32_32x32x16_bf16 v[128:143], a[52:55], v[32:35], v[128:143]
    ds_read_b128 v[24:27], v2 offset:512
    v_fma_f32 v225, v225, s36, v244
    v_fma_f32 v226, v226, s36, v244
    v_fma_f32 v227, v227, s36, v244
    v_fma_f32 v228, v228, s36, v244
    v_fma_f32 v229, v229, s36, v244
    v_mfma_f32_32x32x16_bf16 v[144:159], a[180:183], v[32:35], v[144:159]
    ds_read_b128 v[28:31], v2 offset:33280
    v_fma_f32 v230, v230, s36, v244
    v_fma_f32 v231, v231, s36, v244
    v_mul_f32 v224, v224, v76
    v_mul_f32 v225, v225, v77
    v_mul_f32 v226, v226, v78
    v_mfma_f32_32x32x16_bf16 v[160:175], a[52:55], v[36:39], v[160:175]
    v_xor_b32 v22, 208, v10
    buffer_load_dwordx4 v22, s[8:11], s31 offen offset:1024 lds
    v_mfma_f32_32x32x16_bf16 v[176:191], a[180:183], v[36:39], v[176:191]
    v_mul_f32 v227, v227, v79
    v_mul_f32 v228, v228, v92
    v_mul_f32 v229, v229, v93
    v_mul_f32 v230, v230, v94
    v_mul_f32 v231, v231, v95
    v_exp_f32 v224, -v224
    s_waitcnt lgkmcnt(4)
    v_mfma_f32_32x32x16_bf16 v[128:143], a[56:59], v[40:43], v[128:143]
    ds_read_b128 v[32:35], v3 offset:512
    v_exp_f32 v225, -v225
    v_exp_f32 v226, -v226
    v_exp_f32 v227, -v227
    v_exp_f32 v228, -v228
    v_exp_f32 v229, -v229
    v_mfma_f32_32x32x16_bf16 v[144:159], a[184:187], v[40:43], v[144:159]
    ds_read_b128 v[36:39], v3 offset:33280
    v_exp_f32 v230, -v230
    v_exp_f32 v231, -v231
    v_add_f32 v224, 1.0, v224
    v_add_f32 v225, 1.0, v225
    v_add_f32 v226, 1.0, v226
    v_mfma_f32_32x32x16_bf16 v[160:175], a[56:59], v[44:47], v[160:175]
    v_xor_b32 v21, 224, v10
    buffer_load_dwordx4 v21, s[8:11], s31 offen offset:2048 lds
    v_mfma_f32_32x32x16_bf16 v[176:191], a[184:187], v[44:47], v[176:191]
    v_add_f32 v227, 1.0, v227
    v_add_f32 v228, 1.0, v228
    v_add_f32 v229, 1.0, v229
    v_add_f32 v230, 1.0, v230
    v_add_f32 v231, 1.0, v231
    v_rcp_f32 v224, v224
    s_waitcnt lgkmcnt(4)
    v_mfma_f32_32x32x16_bf16 v[128:143], a[60:63], v[48:51], v[128:143]
    ds_read_b128 v[40:43], v4 offset:512
    v_rcp_f32 v225, v225
    v_rcp_f32 v226, v226
    v_rcp_f32 v227, v227
    v_rcp_f32 v228, v228
    v_rcp_f32 v229, v229
    v_mfma_f32_32x32x16_bf16 v[144:159], a[188:191], v[48:51], v[144:159]
    ds_read_b128 v[44:47], v4 offset:33280
    v_rcp_f32 v230, v230
    v_rcp_f32 v231, v231
    v_mul_f32 v76, v76, v224
    v_mul_f32 v77, v77, v225
    v_mul_f32 v78, v78, v226
    v_mfma_f32_32x32x16_bf16 v[160:175], a[60:63], v[52:55], v[160:175]
    v_xor_b32 v22, 240, v10
    buffer_load_dwordx4 v22, s[8:11], s31 offen offset:3072 lds
    v_mfma_f32_32x32x16_bf16 v[176:191], a[188:191], v[52:55], v[176:191]
    v_mul_f32 v79, v79, v227
    v_mul_f32 v92, v92, v228
    v_mul_f32 v93, v93, v229
    v_mul_f32 v94, v94, v230
    v_mul_f32 v95, v95, v231
    v_cvt_pk_bf16_f32 v76, v76, v92
    s_waitcnt lgkmcnt(4)
    v_mfma_f32_32x32x16_bf16 v[128:143], a[64:67], v[24:27], v[128:143]
    ds_read_b128 v[48:51], v5 offset:512
    v_cvt_pk_bf16_f32 v77, v77, v93
    v_cvt_pk_bf16_f32 v78, v78, v94
    v_cvt_pk_bf16_f32 v79, v79, v95
    buffer_store_dwordx4 v[76:79], v11, s[12:15], s28 offen offset:3072 sc1
    v_mul_f32 v224, v96, v96
    v_mfma_f32_32x32x16_bf16 v[144:159], a[192:195], v[24:27], v[144:159]
    ds_read_b128 v[52:55], v5 offset:33280
    v_mul_f32 v225, v97, v97
    v_mul_f32 v226, v98, v98
    v_mul_f32 v227, v99, v99
    v_mul_f32 v228, v112, v112
    v_mul_f32 v229, v113, v113
    v_mfma_f32_32x32x16_bf16 v[160:175], a[64:67], v[28:31], v[160:175]
    v_mul_f32 v230, v114, v114
    v_mul_f32 v231, v115, v115
    v_fma_f32 v224, v224, s36, v244
    v_fma_f32 v225, v225, s36, v244
    v_fma_f32 v226, v226, s36, v244
    v_fma_f32 v227, v227, s36, v244
    v_mfma_f32_32x32x16_bf16 v[176:191], a[192:195], v[28:31], v[176:191]
    v_fma_f32 v228, v228, s36, v244
    v_fma_f32 v229, v229, s36, v244
    v_fma_f32 v230, v230, s36, v244
    v_fma_f32 v231, v231, s36, v244
    v_mul_f32 v224, v224, v96
    v_mul_f32 v225, v225, v97
    s_waitcnt lgkmcnt(4)
    v_mfma_f32_32x32x16_bf16 v[128:143], a[68:71], v[32:35], v[128:143]
    ds_read_b128 v[24:27], v6 offset:512
    v_mul_f32 v226, v226, v98
    v_mul_f32 v227, v227, v99
    v_mul_f32 v228, v228, v112
    v_mul_f32 v229, v229, v113
    v_mul_f32 v230, v230, v114
    v_mfma_f32_32x32x16_bf16 v[144:159], a[196:199], v[32:35], v[144:159]
    ds_read_b128 v[28:31], v6 offset:33280
    v_mul_f32 v231, v231, v115
    v_exp_f32 v224, -v224
    v_exp_f32 v225, -v225
    v_exp_f32 v226, -v226
    v_exp_f32 v227, -v227
    v_mfma_f32_32x32x16_bf16 v[160:175], a[68:71], v[36:39], v[160:175]
    v_exp_f32 v228, -v228
    v_exp_f32 v229, -v229
    v_exp_f32 v230, -v230
    v_exp_f32 v231, -v231
    v_add_f32 v224, 1.0, v224
    v_add_f32 v225, 1.0, v225
    v_mfma_f32_32x32x16_bf16 v[176:191], a[196:199], v[36:39], v[176:191]
    v_add_f32 v226, 1.0, v226
    v_add_f32 v227, 1.0, v227
    v_add_f32 v228, 1.0, v228
    v_add_f32 v229, 1.0, v229
    v_add_f32 v230, 1.0, v230
    v_add_f32 v231, 1.0, v231
    s_waitcnt lgkmcnt(4)
    v_mfma_f32_32x32x16_bf16 v[128:143], a[72:75], v[40:43], v[128:143]
    ds_read_b128 v[32:35], v7 offset:512
    v_rcp_f32 v224, v224
    v_rcp_f32 v225, v225
    v_rcp_f32 v226, v226
    v_rcp_f32 v227, v227
    v_rcp_f32 v228, v228
    v_mfma_f32_32x32x16_bf16 v[144:159], a[200:203], v[40:43], v[144:159]
    ds_read_b128 v[36:39], v7 offset:33280
    v_rcp_f32 v229, v229
    v_rcp_f32 v230, v230
    v_rcp_f32 v231, v231
    v_mul_f32 v96, v96, v224
    v_mul_f32 v97, v97, v225
    v_mfma_f32_32x32x16_bf16 v[160:175], a[72:75], v[44:47], v[160:175]
    v_mul_f32 v98, v98, v226
    v_mul_f32 v99, v99, v227
    v_mul_f32 v112, v112, v228
    v_mul_f32 v113, v113, v229
    v_mul_f32 v114, v114, v230
    v_mul_f32 v115, v115, v231
    v_mfma_f32_32x32x16_bf16 v[176:191], a[200:203], v[44:47], v[176:191]
    v_cvt_pk_bf16_f32 v96, v96, v112
    v_cvt_pk_bf16_f32 v97, v97, v113
    v_cvt_pk_bf16_f32 v98, v98, v114
    v_cvt_pk_bf16_f32 v99, v99, v115
    buffer_store_dwordx4 v[96:99], v11, s[12:15], s37 offen offset:0 sc1
    v_mul_f32 v224, v100, v100
    s_waitcnt lgkmcnt(4)
    v_mfma_f32_32x32x16_bf16 v[128:143], a[76:79], v[48:51], v[128:143]
    ds_read_b128 v[40:43], v8 offset:512
    v_mul_f32 v225, v101, v101
    v_mul_f32 v226, v102, v102
    v_mul_f32 v227, v103, v103
    v_mul_f32 v228, v116, v116
    v_mul_f32 v229, v117, v117
    v_mfma_f32_32x32x16_bf16 v[144:159], a[204:207], v[48:51], v[144:159]
    ds_read_b128 v[44:47], v8 offset:33280
    v_mul_f32 v230, v118, v118
    v_mul_f32 v231, v119, v119
    v_fma_f32 v224, v224, s36, v244
    v_fma_f32 v225, v225, s36, v244
    v_fma_f32 v226, v226, s36, v244
    v_mfma_f32_32x32x16_bf16 v[160:175], a[76:79], v[52:55], v[160:175]
    v_fma_f32 v227, v227, s36, v244
    v_fma_f32 v228, v228, s36, v244
    v_fma_f32 v229, v229, s36, v244
    v_fma_f32 v230, v230, s36, v244
    v_fma_f32 v231, v231, s36, v244
    v_mul_f32 v224, v224, v100
    v_mfma_f32_32x32x16_bf16 v[176:191], a[204:207], v[52:55], v[176:191]
    v_mul_f32 v225, v225, v101
    v_mul_f32 v226, v226, v102
    v_mul_f32 v227, v227, v103
    v_mul_f32 v228, v228, v116
    v_mul_f32 v229, v229, v117
    v_mul_f32 v230, v230, v118
    s_waitcnt lgkmcnt(4)
    v_mfma_f32_32x32x16_bf16 v[128:143], a[80:83], v[24:27], v[128:143]
    ds_read_b128 v[48:51], v9 offset:512
    v_mul_f32 v231, v231, v119
    v_exp_f32 v224, -v224
    v_exp_f32 v225, -v225
    v_exp_f32 v226, -v226
    v_exp_f32 v227, -v227
    v_mfma_f32_32x32x16_bf16 v[144:159], a[208:211], v[24:27], v[144:159]
    ds_read_b128 v[52:55], v9 offset:33280
    v_exp_f32 v228, -v228
    v_exp_f32 v229, -v229
    v_exp_f32 v230, -v230
    v_exp_f32 v231, -v231
    v_add_f32 v224, 1.0, v224
    v_mfma_f32_32x32x16_bf16 v[160:175], a[80:83], v[28:31], v[160:175]
    v_add_f32 v225, 1.0, v225
    v_add_f32 v226, 1.0, v226
    v_add_f32 v227, 1.0, v227
    v_add_f32 v228, 1.0, v228
    v_add_f32 v229, 1.0, v229
    v_add_f32 v230, 1.0, v230
    v_mfma_f32_32x32x16_bf16 v[176:191], a[208:211], v[28:31], v[176:191]
    v_add_f32 v231, 1.0, v231
    v_rcp_f32 v224, v224
    v_rcp_f32 v225, v225
    v_rcp_f32 v226, v226
    v_rcp_f32 v227, v227
    v_rcp_f32 v228, v228
    s_waitcnt lgkmcnt(4)
    v_mfma_f32_32x32x16_bf16 v[128:143], a[84:87], v[32:35], v[128:143]
    ds_read_b128 v[24:27], v2 offset:768
    v_rcp_f32 v229, v229
    v_rcp_f32 v230, v230
    v_rcp_f32 v231, v231
    v_mul_f32 v100, v100, v224
    v_mul_f32 v101, v101, v225
    v_mfma_f32_32x32x16_bf16 v[144:159], a[212:215], v[32:35], v[144:159]
    ds_read_b128 v[28:31], v2 offset:33536
    v_mul_f32 v102, v102, v226
    v_mul_f32 v103, v103, v227
    v_mul_f32 v116, v116, v228
    v_mul_f32 v117, v117, v229
    v_mul_f32 v118, v118, v230
    v_mfma_f32_32x32x16_bf16 v[160:175], a[84:87], v[36:39], v[160:175]
    v_mul_f32 v119, v119, v231
    v_cvt_pk_bf16_f32 v100, v100, v116
    v_cvt_pk_bf16_f32 v101, v101, v117
    v_cvt_pk_bf16_f32 v102, v102, v118
    v_cvt_pk_bf16_f32 v103, v103, v119
    buffer_store_dwordx4 v[100:103], v11, s[12:15], s37 offen offset:1024 sc1
    v_mfma_f32_32x32x16_bf16 v[176:191], a[212:215], v[36:39], v[176:191]
    v_mul_f32 v224, v104, v104
    v_mul_f32 v225, v105, v105
    v_mul_f32 v226, v106, v106
    v_mul_f32 v227, v107, v107
    v_mul_f32 v228, v120, v120
    v_mul_f32 v229, v121, v121
    s_waitcnt lgkmcnt(4)
    v_mfma_f32_32x32x16_bf16 v[128:143], a[88:91], v[40:43], v[128:143]
    ds_read_b128 v[32:35], v3 offset:768
    v_mul_f32 v230, v122, v122
    v_mul_f32 v231, v123, v123
    v_fma_f32 v224, v224, s36, v244
    v_fma_f32 v225, v225, s36, v244
    v_fma_f32 v226, v226, s36, v244
    v_mfma_f32_32x32x16_bf16 v[144:159], a[216:219], v[40:43], v[144:159]
    ds_read_b128 v[36:39], v3 offset:33536
    v_fma_f32 v227, v227, s36, v244
    v_fma_f32 v228, v228, s36, v244
    v_fma_f32 v229, v229, s36, v244
    v_fma_f32 v230, v230, s36, v244
    v_fma_f32 v231, v231, s36, v244
    v_mfma_f32_32x32x16_bf16 v[160:175], a[88:91], v[44:47], v[160:175]
    v_mul_f32 v224, v224, v104
    v_mul_f32 v225, v225, v105
    v_mul_f32 v226, v226, v106
    v_mul_f32 v227, v227, v107
    v_mul_f32 v228, v228, v120
    v_mul_f32 v229, v229, v121
    v_mfma_f32_32x32x16_bf16 v[176:191], a[216:219], v[44:47], v[176:191]
    v_mul_f32 v230, v230, v122
    v_mul_f32 v231, v231, v123
    v_exp_f32 v224, -v224
    v_exp_f32 v225, -v225
    v_exp_f32 v226, -v226
    v_exp_f32 v227, -v227
    s_waitcnt lgkmcnt(4)
    v_mfma_f32_32x32x16_bf16 v[128:143], a[92:95], v[48:51], v[128:143]
    ds_read_b128 v[40:43], v4 offset:768
    v_exp_f32 v228, -v228
    v_exp_f32 v229, -v229
    v_exp_f32 v230, -v230
    v_exp_f32 v231, -v231
    v_add_f32 v224, 1.0, v224
    v_mfma_f32_32x32x16_bf16 v[144:159], a[220:223], v[48:51], v[144:159]
    ds_read_b128 v[44:47], v4 offset:33536
    v_add_f32 v225, 1.0, v225
    v_add_f32 v226, 1.0, v226
    v_add_f32 v227, 1.0, v227
    v_add_f32 v228, 1.0, v228
    v_add_f32 v229, 1.0, v229
    v_mfma_f32_32x32x16_bf16 v[160:175], a[92:95], v[52:55], v[160:175]
    v_add_f32 v230, 1.0, v230
    v_add_f32 v231, 1.0, v231
    v_rcp_f32 v224, v224
    v_rcp_f32 v225, v225
    v_rcp_f32 v226, v226
    v_rcp_f32 v227, v227
    v_mfma_f32_32x32x16_bf16 v[176:191], a[220:223], v[52:55], v[176:191]
    v_rcp_f32 v228, v228
    v_rcp_f32 v229, v229
    v_rcp_f32 v230, v230
    v_rcp_f32 v231, v231
    v_mul_f32 v104, v104, v224
    v_mul_f32 v105, v105, v225
    s_waitcnt lgkmcnt(4)
    v_mfma_f32_32x32x16_bf16 v[128:143], a[96:99], v[24:27], v[128:143]
    ds_read_b128 v[48:51], v5 offset:768
    v_mul_f32 v106, v106, v226
    v_mul_f32 v107, v107, v227
    v_mul_f32 v120, v120, v228
    v_mul_f32 v121, v121, v229
    v_mul_f32 v122, v122, v230
    v_mfma_f32_32x32x16_bf16 v[144:159], a[224:227], v[24:27], v[144:159]
    ds_read_b128 v[52:55], v5 offset:33536
    v_mul_f32 v123, v123, v231
    v_cvt_pk_bf16_f32 v104, v104, v120
    v_cvt_pk_bf16_f32 v105, v105, v121
    v_cvt_pk_bf16_f32 v106, v106, v122
    v_cvt_pk_bf16_f32 v107, v107, v123
    v_mfma_f32_32x32x16_bf16 v[160:175], a[96:99], v[28:31], v[160:175]
    buffer_store_dwordx4 v[104:107], v11, s[12:15], s37 offen offset:2048 sc1
    v_mul_f32 v224, v108, v108
    v_mul_f32 v225, v109, v109
    v_mul_f32 v226, v110, v110
    v_mul_f32 v227, v111, v111
    v_mul_f32 v228, v124, v124
    v_mfma_f32_32x32x16_bf16 v[176:191], a[224:227], v[28:31], v[176:191]
    v_mul_f32 v229, v125, v125
    v_mul_f32 v230, v126, v126
    v_mul_f32 v231, v127, v127
    v_fma_f32 v224, v224, s36, v244
    v_fma_f32 v225, v225, s36, v244
    v_fma_f32 v226, v226, s36, v244
    s_waitcnt lgkmcnt(4)
    v_mfma_f32_32x32x16_bf16 v[128:143], a[100:103], v[32:35], v[128:143]
    ds_read_b128 v[24:27], v6 offset:768
    v_fma_f32 v227, v227, s36, v244
    v_fma_f32 v228, v228, s36, v244
    v_fma_f32 v229, v229, s36, v244
    v_fma_f32 v230, v230, s36, v244
    v_fma_f32 v231, v231, s36, v244
    v_mfma_f32_32x32x16_bf16 v[144:159], a[228:231], v[32:35], v[144:159]
    ds_read_b128 v[28:31], v6 offset:33536
    v_mul_f32 v224, v224, v108
    v_mul_f32 v225, v225, v109
    v_mul_f32 v226, v226, v110
    v_mul_f32 v227, v227, v111
    v_mul_f32 v228, v228, v124
    v_mfma_f32_32x32x16_bf16 v[160:175], a[100:103], v[36:39], v[160:175]
    v_mul_f32 v229, v229, v125
    v_mul_f32 v230, v230, v126
    v_mul_f32 v231, v231, v127
    v_exp_f32 v224, -v224
    v_exp_f32 v225, -v225
    v_exp_f32 v226, -v226
    v_mfma_f32_32x32x16_bf16 v[176:191], a[228:231], v[36:39], v[176:191]
    v_exp_f32 v227, -v227
    v_exp_f32 v228, -v228
    v_exp_f32 v229, -v229
    v_exp_f32 v230, -v230
    v_exp_f32 v231, -v231
    v_add_f32 v224, 1.0, v224
    s_waitcnt lgkmcnt(4)
    v_mfma_f32_32x32x16_bf16 v[128:143], a[104:107], v[40:43], v[128:143]
    ds_read_b128 v[32:35], v7 offset:768
    v_add_f32 v225, 1.0, v225
    v_add_f32 v226, 1.0, v226
    v_add_f32 v227, 1.0, v227
    v_add_f32 v228, 1.0, v228
    v_add_f32 v229, 1.0, v229
    v_mfma_f32_32x32x16_bf16 v[144:159], a[232:235], v[40:43], v[144:159]
    ds_read_b128 v[36:39], v7 offset:33536
    v_add_f32 v230, 1.0, v230
    v_add_f32 v231, 1.0, v231
    v_rcp_f32 v224, v224
    v_rcp_f32 v225, v225
    v_rcp_f32 v226, v226
    v_mfma_f32_32x32x16_bf16 v[160:175], a[104:107], v[44:47], v[160:175]
    v_rcp_f32 v227, v227
    v_rcp_f32 v228, v228
    v_rcp_f32 v229, v229
    v_rcp_f32 v230, v230
    v_rcp_f32 v231, v231
    v_mul_f32 v108, v108, v224
    v_mfma_f32_32x32x16_bf16 v[176:191], a[232:235], v[44:47], v[176:191]
    v_mul_f32 v109, v109, v225
    v_mul_f32 v110, v110, v226
    v_mul_f32 v111, v111, v227
    v_mul_f32 v124, v124, v228
    v_mul_f32 v125, v125, v229
    v_mul_f32 v126, v126, v230
    s_waitcnt lgkmcnt(4)
    v_mfma_f32_32x32x16_bf16 v[128:143], a[108:111], v[48:51], v[128:143]
    ds_read_b128 v[40:43], v8 offset:768
    v_mul_f32 v127, v127, v231
    v_cvt_pk_bf16_f32 v108, v108, v124
    v_cvt_pk_bf16_f32 v109, v109, v125
    v_cvt_pk_bf16_f32 v110, v110, v126
    v_cvt_pk_bf16_f32 v111, v111, v127
    v_mfma_f32_32x32x16_bf16 v[144:159], a[236:239], v[48:51], v[144:159]
    ds_read_b128 v[44:47], v8 offset:33536
    buffer_store_dwordx4 v[108:111], v11, s[12:15], s37 offen offset:3072 sc1
    v_mfma_f32_32x32x16_bf16 v[160:175], a[108:111], v[52:55], v[160:175]
    v_mfma_f32_32x32x16_bf16 v[176:191], a[236:239], v[52:55], v[176:191]
    s_waitcnt lgkmcnt(4)
    v_mfma_f32_32x32x16_bf16 v[128:143], a[112:115], v[24:27], v[128:143]
    ds_read_b128 v[48:51], v9 offset:768
    v_mfma_f32_32x32x16_bf16 v[144:159], a[240:243], v[24:27], v[144:159]
    ds_read_b128 v[52:55], v9 offset:33536
    v_mfma_f32_32x32x16_bf16 v[160:175], a[112:115], v[28:31], v[160:175]
    v_mfma_f32_32x32x16_bf16 v[176:191], a[240:243], v[28:31], v[176:191]
    s_waitcnt lgkmcnt(4)
    v_mfma_f32_32x32x16_bf16 v[128:143], a[116:119], v[32:35], v[128:143]
    v_mfma_f32_32x32x16_bf16 v[144:159], a[244:247], v[32:35], v[144:159]
    v_xor_b32 v2, 0x10000, v2
    v_mfma_f32_32x32x16_bf16 v[160:175], a[116:119], v[36:39], v[160:175]
    v_xor_b32 v3, 0x10000, v3
    v_mfma_f32_32x32x16_bf16 v[176:191], a[244:247], v[36:39], v[176:191]
    v_xor_b32 v4, 0x10000, v4
    s_waitcnt lgkmcnt(2)
    v_mfma_f32_32x32x16_bf16 v[128:143], a[120:123], v[40:43], v[128:143]
    v_mfma_f32_32x32x16_bf16 v[144:159], a[248:251], v[40:43], v[144:159]
    v_xor_b32 v5, 0x10000, v5
    v_mfma_f32_32x32x16_bf16 v[160:175], a[120:123], v[44:47], v[160:175]
    v_xor_b32 v6, 0x10000, v6
    v_mfma_f32_32x32x16_bf16 v[176:191], a[248:251], v[44:47], v[176:191]
    v_xor_b32 v7, 0x10000, v7
    s_waitcnt lgkmcnt(0)
    v_mfma_f32_32x32x16_bf16 v[128:143], a[124:127], v[48:51], v[128:143]
    v_mfma_f32_32x32x16_bf16 v[144:159], a[252:255], v[48:51], v[144:159]
    v_xor_b32 v8, 0x10000, v8
    v_mfma_f32_32x32x16_bf16 v[160:175], a[124:127], v[52:55], v[160:175]
    v_xor_b32 v9, 0x10000, v9
    v_mfma_f32_32x32x16_bf16 v[176:191], a[252:255], v[52:55], v[176:191]
    s_mov_b32 s28, s38
    s_add_u32 s37, s28, s29
    s_lshl_b32 s30, s29, 3
    s_add_u32 s38, s38, s30
    s_add_u32 s33, s33, 1
    s_cmp_lt_u32 s33, 8
    s_cbranch_scc1 P1L_78
    v_mul_f32 v224, v128, v128
    v_mul_f32 v225, v129, v129
    v_mul_f32 v226, v130, v130
    v_mul_f32 v227, v131, v131
    v_mul_f32 v228, v144, v144
    v_mul_f32 v229, v145, v145
    v_mul_f32 v230, v146, v146
    v_mul_f32 v231, v147, v147
    v_fma_f32 v224, v224, s36, v244
    v_fma_f32 v225, v225, s36, v244
    v_fma_f32 v226, v226, s36, v244
    v_fma_f32 v227, v227, s36, v244
    v_fma_f32 v228, v228, s36, v244
    v_fma_f32 v229, v229, s36, v244
    v_fma_f32 v230, v230, s36, v244
    v_fma_f32 v231, v231, s36, v244
    v_mul_f32 v224, v224, v128
    v_mul_f32 v225, v225, v129
    v_mul_f32 v226, v226, v130
    v_mul_f32 v227, v227, v131
    v_mul_f32 v228, v228, v144
    v_mul_f32 v229, v229, v145
    v_mul_f32 v230, v230, v146
    v_mul_f32 v231, v231, v147
    v_exp_f32 v224, -v224
    v_exp_f32 v225, -v225
    v_exp_f32 v226, -v226
    v_exp_f32 v227, -v227
    v_exp_f32 v228, -v228
    v_exp_f32 v229, -v229
    v_exp_f32 v230, -v230
    v_exp_f32 v231, -v231
    v_add_f32 v224, 1.0, v224
    v_add_f32 v225, 1.0, v225
    v_add_f32 v226, 1.0, v226
    v_add_f32 v227, 1.0, v227
    v_add_f32 v228, 1.0, v228
    v_add_f32 v229, 1.0, v229
    v_add_f32 v230, 1.0, v230
    v_add_f32 v231, 1.0, v231
    v_rcp_f32 v224, v224
    v_rcp_f32 v225, v225
    v_rcp_f32 v226, v226
    v_rcp_f32 v227, v227
    v_rcp_f32 v228, v228
    v_rcp_f32 v229, v229
    v_rcp_f32 v230, v230
    v_rcp_f32 v231, v231
    v_mul_f32 v128, v128, v224
    v_mul_f32 v129, v129, v225
    v_mul_f32 v130, v130, v226
    v_mul_f32 v131, v131, v227
    v_mul_f32 v144, v144, v228
    v_mul_f32 v145, v145, v229
    v_mul_f32 v146, v146, v230
    v_mul_f32 v147, v147, v231
    v_cvt_pk_bf16_f32 v128, v128, v144
    v_cvt_pk_bf16_f32 v129, v129, v145
    v_cvt_pk_bf16_f32 v130, v130, v146
    v_cvt_pk_bf16_f32 v131, v131, v147
    buffer_store_dwordx4 v[128:131], v11, s[12:15], s28 offen offset:0 sc1
    v_mul_f32 v224, v132, v132
    v_mul_f32 v225, v133, v133
    v_mul_f32 v226, v134, v134
    v_mul_f32 v227, v135, v135
    v_mul_f32 v228, v148, v148
    v_mul_f32 v229, v149, v149
    v_mul_f32 v230, v150, v150
    v_mul_f32 v231, v151, v151
    v_fma_f32 v224, v224, s36, v244
    v_fma_f32 v225, v225, s36, v244
    v_fma_f32 v226, v226, s36, v244
    v_fma_f32 v227, v227, s36, v244
    v_fma_f32 v228, v228, s36, v244
    v_fma_f32 v229, v229, s36, v244
    v_fma_f32 v230, v230, s36, v244
    v_fma_f32 v231, v231, s36, v244
    v_mul_f32 v224, v224, v132
    v_mul_f32 v225, v225, v133
    v_mul_f32 v226, v226, v134
    v_mul_f32 v227, v227, v135
    v_mul_f32 v228, v228, v148
    v_mul_f32 v229, v229, v149
    v_mul_f32 v230, v230, v150
    v_mul_f32 v231, v231, v151
    v_exp_f32 v224, -v224
    v_exp_f32 v225, -v225
    v_exp_f32 v226, -v226
    v_exp_f32 v227, -v227
    v_exp_f32 v228, -v228
    v_exp_f32 v229, -v229
    v_exp_f32 v230, -v230
    v_exp_f32 v231, -v231
    v_add_f32 v224, 1.0, v224
    v_add_f32 v225, 1.0, v225
    v_add_f32 v226, 1.0, v226
    v_add_f32 v227, 1.0, v227
    v_add_f32 v228, 1.0, v228
    v_add_f32 v229, 1.0, v229
    v_add_f32 v230, 1.0, v230
    v_add_f32 v231, 1.0, v231
    v_rcp_f32 v224, v224
    v_rcp_f32 v225, v225
    v_rcp_f32 v226, v226
    v_rcp_f32 v227, v227
    v_rcp_f32 v228, v228
    v_rcp_f32 v229, v229
    v_rcp_f32 v230, v230
    v_rcp_f32 v231, v231
    v_mul_f32 v132, v132, v224
    v_mul_f32 v133, v133, v225
    v_mul_f32 v134, v134, v226
    v_mul_f32 v135, v135, v227
    v_mul_f32 v148, v148, v228
    v_mul_f32 v149, v149, v229
    v_mul_f32 v150, v150, v230
    v_mul_f32 v151, v151, v231
    v_cvt_pk_bf16_f32 v132, v132, v148
    v_cvt_pk_bf16_f32 v133, v133, v149
    v_cvt_pk_bf16_f32 v134, v134, v150
    v_cvt_pk_bf16_f32 v135, v135, v151
    buffer_store_dwordx4 v[132:135], v11, s[12:15], s28 offen offset:1024 sc1
    v_mul_f32 v224, v136, v136
    v_mul_f32 v225, v137, v137
    v_mul_f32 v226, v138, v138
    v_mul_f32 v227, v139, v139
    v_mul_f32 v228, v152, v152
    v_mul_f32 v229, v153, v153
    v_mul_f32 v230, v154, v154
    v_mul_f32 v231, v155, v155
    v_fma_f32 v224, v224, s36, v244
    v_fma_f32 v225, v225, s36, v244
    v_fma_f32 v226, v226, s36, v244
    v_fma_f32 v227, v227, s36, v244
    v_fma_f32 v228, v228, s36, v244
    v_fma_f32 v229, v229, s36, v244
    v_fma_f32 v230, v230, s36, v244
    v_fma_f32 v231, v231, s36, v244
    v_mul_f32 v224, v224, v136
    v_mul_f32 v225, v225, v137
    v_mul_f32 v226, v226, v138
    v_mul_f32 v227, v227, v139
    v_mul_f32 v228, v228, v152
    v_mul_f32 v229, v229, v153
    v_mul_f32 v230, v230, v154
    v_mul_f32 v231, v231, v155
    v_exp_f32 v224, -v224
    v_exp_f32 v225, -v225
    v_exp_f32 v226, -v226
    v_exp_f32 v227, -v227
    v_exp_f32 v228, -v228
    v_exp_f32 v229, -v229
    v_exp_f32 v230, -v230
    v_exp_f32 v231, -v231
    v_add_f32 v224, 1.0, v224
    v_add_f32 v225, 1.0, v225
    v_add_f32 v226, 1.0, v226
    v_add_f32 v227, 1.0, v227
    v_add_f32 v228, 1.0, v228
    v_add_f32 v229, 1.0, v229
    v_add_f32 v230, 1.0, v230
    v_add_f32 v231, 1.0, v231
    v_rcp_f32 v224, v224
    v_rcp_f32 v225, v225
    v_rcp_f32 v226, v226
    v_rcp_f32 v227, v227
    v_rcp_f32 v228, v228
    v_rcp_f32 v229, v229
    v_rcp_f32 v230, v230
    v_rcp_f32 v231, v231
    v_mul_f32 v136, v136, v224
    v_mul_f32 v137, v137, v225
    v_mul_f32 v138, v138, v226
    v_mul_f32 v139, v139, v227
    v_mul_f32 v152, v152, v228
    v_mul_f32 v153, v153, v229
    v_mul_f32 v154, v154, v230
    v_mul_f32 v155, v155, v231
    v_cvt_pk_bf16_f32 v136, v136, v152
    v_cvt_pk_bf16_f32 v137, v137, v153
    v_cvt_pk_bf16_f32 v138, v138, v154
    v_cvt_pk_bf16_f32 v139, v139, v155
    buffer_store_dwordx4 v[136:139], v11, s[12:15], s28 offen offset:2048 sc1
    v_mul_f32 v224, v140, v140
    v_mul_f32 v225, v141, v141
    v_mul_f32 v226, v142, v142
    v_mul_f32 v227, v143, v143
    v_mul_f32 v228, v156, v156
    v_mul_f32 v229, v157, v157
    v_mul_f32 v230, v158, v158
    v_mul_f32 v231, v159, v159
    v_fma_f32 v224, v224, s36, v244
    v_fma_f32 v225, v225, s36, v244
    v_fma_f32 v226, v226, s36, v244
    v_fma_f32 v227, v227, s36, v244
    v_fma_f32 v228, v228, s36, v244
    v_fma_f32 v229, v229, s36, v244
    v_fma_f32 v230, v230, s36, v244
    v_fma_f32 v231, v231, s36, v244
    v_mul_f32 v224, v224, v140
    v_mul_f32 v225, v225, v141
    v_mul_f32 v226, v226, v142
    v_mul_f32 v227, v227, v143
    v_mul_f32 v228, v228, v156
    v_mul_f32 v229, v229, v157
    v_mul_f32 v230, v230, v158
    v_mul_f32 v231, v231, v159
    v_exp_f32 v224, -v224
    v_exp_f32 v225, -v225
    v_exp_f32 v226, -v226
    v_exp_f32 v227, -v227
    v_exp_f32 v228, -v228
    v_exp_f32 v229, -v229
    v_exp_f32 v230, -v230
    v_exp_f32 v231, -v231
    v_add_f32 v224, 1.0, v224
    v_add_f32 v225, 1.0, v225
    v_add_f32 v226, 1.0, v226
    v_add_f32 v227, 1.0, v227
    v_add_f32 v228, 1.0, v228
    v_add_f32 v229, 1.0, v229
    v_add_f32 v230, 1.0, v230
    v_add_f32 v231, 1.0, v231
    v_rcp_f32 v224, v224
    v_rcp_f32 v225, v225
    v_rcp_f32 v226, v226
    v_rcp_f32 v227, v227
    v_rcp_f32 v228, v228
    v_rcp_f32 v229, v229
    v_rcp_f32 v230, v230
    v_rcp_f32 v231, v231
    v_mul_f32 v140, v140, v224
    v_mul_f32 v141, v141, v225
    v_mul_f32 v142, v142, v226
    v_mul_f32 v143, v143, v227
    v_mul_f32 v156, v156, v228
    v_mul_f32 v157, v157, v229
    v_mul_f32 v158, v158, v230
    v_mul_f32 v159, v159, v231
    v_cvt_pk_bf16_f32 v140, v140, v156
    v_cvt_pk_bf16_f32 v141, v141, v157
    v_cvt_pk_bf16_f32 v142, v142, v158
    v_cvt_pk_bf16_f32 v143, v143, v159
    buffer_store_dwordx4 v[140:143], v11, s[12:15], s28 offen offset:3072 sc1
    v_mul_f32 v224, v160, v160
    v_mul_f32 v225, v161, v161
    v_mul_f32 v226, v162, v162
    v_mul_f32 v227, v163, v163
    v_mul_f32 v228, v176, v176
    v_mul_f32 v229, v177, v177
    v_mul_f32 v230, v178, v178
    v_mul_f32 v231, v179, v179
    v_fma_f32 v224, v224, s36, v244
    v_fma_f32 v225, v225, s36, v244
    v_fma_f32 v226, v226, s36, v244
    v_fma_f32 v227, v227, s36, v244
    v_fma_f32 v228, v228, s36, v244
    v_fma_f32 v229, v229, s36, v244
    v_fma_f32 v230, v230, s36, v244
    v_fma_f32 v231, v231, s36, v244
    v_mul_f32 v224, v224, v160
    v_mul_f32 v225, v225, v161
    v_mul_f32 v226, v226, v162
    v_mul_f32 v227, v227, v163
    v_mul_f32 v228, v228, v176
    v_mul_f32 v229, v229, v177
    v_mul_f32 v230, v230, v178
    v_mul_f32 v231, v231, v179
    v_exp_f32 v224, -v224
    v_exp_f32 v225, -v225
    v_exp_f32 v226, -v226
    v_exp_f32 v227, -v227
    v_exp_f32 v228, -v228
    v_exp_f32 v229, -v229
    v_exp_f32 v230, -v230
    v_exp_f32 v231, -v231
    v_add_f32 v224, 1.0, v224
    v_add_f32 v225, 1.0, v225
    v_add_f32 v226, 1.0, v226
    v_add_f32 v227, 1.0, v227
    v_add_f32 v228, 1.0, v228
    v_add_f32 v229, 1.0, v229
    v_add_f32 v230, 1.0, v230
    v_add_f32 v231, 1.0, v231
    v_rcp_f32 v224, v224
    v_rcp_f32 v225, v225
    v_rcp_f32 v226, v226
    v_rcp_f32 v227, v227
    v_rcp_f32 v228, v228
    v_rcp_f32 v229, v229
    v_rcp_f32 v230, v230
    v_rcp_f32 v231, v231
    v_mul_f32 v160, v160, v224
    v_mul_f32 v161, v161, v225
    v_mul_f32 v162, v162, v226
    v_mul_f32 v163, v163, v227
    v_mul_f32 v176, v176, v228
    v_mul_f32 v177, v177, v229
    v_mul_f32 v178, v178, v230
    v_mul_f32 v179, v179, v231
    v_cvt_pk_bf16_f32 v160, v160, v176
    v_cvt_pk_bf16_f32 v161, v161, v177
    v_cvt_pk_bf16_f32 v162, v162, v178
    v_cvt_pk_bf16_f32 v163, v163, v179
    buffer_store_dwordx4 v[160:163], v11, s[12:15], s37 offen offset:0 sc1
    v_mul_f32 v224, v164, v164
    v_mul_f32 v225, v165, v165
    v_mul_f32 v226, v166, v166
    v_mul_f32 v227, v167, v167
    v_mul_f32 v228, v180, v180
    v_mul_f32 v229, v181, v181
    v_mul_f32 v230, v182, v182
    v_mul_f32 v231, v183, v183
    v_fma_f32 v224, v224, s36, v244
    v_fma_f32 v225, v225, s36, v244
    v_fma_f32 v226, v226, s36, v244
    v_fma_f32 v227, v227, s36, v244
    v_fma_f32 v228, v228, s36, v244
    v_fma_f32 v229, v229, s36, v244
    v_fma_f32 v230, v230, s36, v244
    v_fma_f32 v231, v231, s36, v244
    v_mul_f32 v224, v224, v164
    v_mul_f32 v225, v225, v165
    v_mul_f32 v226, v226, v166
    v_mul_f32 v227, v227, v167
    v_mul_f32 v228, v228, v180
    v_mul_f32 v229, v229, v181
    v_mul_f32 v230, v230, v182
    v_mul_f32 v231, v231, v183
    v_exp_f32 v224, -v224
    v_exp_f32 v225, -v225
    v_exp_f32 v226, -v226
    v_exp_f32 v227, -v227
    v_exp_f32 v228, -v228
    v_exp_f32 v229, -v229
    v_exp_f32 v230, -v230
    v_exp_f32 v231, -v231
    v_add_f32 v224, 1.0, v224
    v_add_f32 v225, 1.0, v225
    v_add_f32 v226, 1.0, v226
    v_add_f32 v227, 1.0, v227
    v_add_f32 v228, 1.0, v228
    v_add_f32 v229, 1.0, v229
    v_add_f32 v230, 1.0, v230
    v_add_f32 v231, 1.0, v231
    v_rcp_f32 v224, v224
    v_rcp_f32 v225, v225
    v_rcp_f32 v226, v226
    v_rcp_f32 v227, v227
    v_rcp_f32 v228, v228
    v_rcp_f32 v229, v229
    v_rcp_f32 v230, v230
    v_rcp_f32 v231, v231
    v_mul_f32 v164, v164, v224
    v_mul_f32 v165, v165, v225
    v_mul_f32 v166, v166, v226
    v_mul_f32 v167, v167, v227
    v_mul_f32 v180, v180, v228
    v_mul_f32 v181, v181, v229
    v_mul_f32 v182, v182, v230
    v_mul_f32 v183, v183, v231
    v_cvt_pk_bf16_f32 v164, v164, v180
    v_cvt_pk_bf16_f32 v165, v165, v181
    v_cvt_pk_bf16_f32 v166, v166, v182
    v_cvt_pk_bf16_f32 v167, v167, v183
    buffer_store_dwordx4 v[164:167], v11, s[12:15], s37 offen offset:1024 sc1
    v_mul_f32 v224, v168, v168
    v_mul_f32 v225, v169, v169
    v_mul_f32 v226, v170, v170
    v_mul_f32 v227, v171, v171
    v_mul_f32 v228, v184, v184
    v_mul_f32 v229, v185, v185
    v_mul_f32 v230, v186, v186
    v_mul_f32 v231, v187, v187
    v_fma_f32 v224, v224, s36, v244
    v_fma_f32 v225, v225, s36, v244
    v_fma_f32 v226, v226, s36, v244
    v_fma_f32 v227, v227, s36, v244
    v_fma_f32 v228, v228, s36, v244
    v_fma_f32 v229, v229, s36, v244
    v_fma_f32 v230, v230, s36, v244
    v_fma_f32 v231, v231, s36, v244
    v_mul_f32 v224, v224, v168
    v_mul_f32 v225, v225, v169
    v_mul_f32 v226, v226, v170
    v_mul_f32 v227, v227, v171
    v_mul_f32 v228, v228, v184
    v_mul_f32 v229, v229, v185
    v_mul_f32 v230, v230, v186
    v_mul_f32 v231, v231, v187
    v_exp_f32 v224, -v224
    v_exp_f32 v225, -v225
    v_exp_f32 v226, -v226
    v_exp_f32 v227, -v227
    v_exp_f32 v228, -v228
    v_exp_f32 v229, -v229
    v_exp_f32 v230, -v230
    v_exp_f32 v231, -v231
    v_add_f32 v224, 1.0, v224
    v_add_f32 v225, 1.0, v225
    v_add_f32 v226, 1.0, v226
    v_add_f32 v227, 1.0, v227
    v_add_f32 v228, 1.0, v228
    v_add_f32 v229, 1.0, v229
    v_add_f32 v230, 1.0, v230
    v_add_f32 v231, 1.0, v231
    v_rcp_f32 v224, v224
    v_rcp_f32 v225, v225
    v_rcp_f32 v226, v226
    v_rcp_f32 v227, v227
    v_rcp_f32 v228, v228
    v_rcp_f32 v229, v229
    v_rcp_f32 v230, v230
    v_rcp_f32 v231, v231
    v_mul_f32 v168, v168, v224
    v_mul_f32 v169, v169, v225
    v_mul_f32 v170, v170, v226
    v_mul_f32 v171, v171, v227
    v_mul_f32 v184, v184, v228
    v_mul_f32 v185, v185, v229
    v_mul_f32 v186, v186, v230
    v_mul_f32 v187, v187, v231
    v_cvt_pk_bf16_f32 v168, v168, v184
    v_cvt_pk_bf16_f32 v169, v169, v185
    v_cvt_pk_bf16_f32 v170, v170, v186
    v_cvt_pk_bf16_f32 v171, v171, v187
    buffer_store_dwordx4 v[168:171], v11, s[12:15], s37 offen offset:2048 sc1
    v_mul_f32 v224, v172, v172
    v_mul_f32 v225, v173, v173
    v_mul_f32 v226, v174, v174
    v_mul_f32 v227, v175, v175
    v_mul_f32 v228, v188, v188
    v_mul_f32 v229, v189, v189
    v_mul_f32 v230, v190, v190
    v_mul_f32 v231, v191, v191
    v_fma_f32 v224, v224, s36, v244
    v_fma_f32 v225, v225, s36, v244
    v_fma_f32 v226, v226, s36, v244
    v_fma_f32 v227, v227, s36, v244
    v_fma_f32 v228, v228, s36, v244
    v_fma_f32 v229, v229, s36, v244
    v_fma_f32 v230, v230, s36, v244
    v_fma_f32 v231, v231, s36, v244
    v_mul_f32 v224, v224, v172
    v_mul_f32 v225, v225, v173
    v_mul_f32 v226, v226, v174
    v_mul_f32 v227, v227, v175
    v_mul_f32 v228, v228, v188
    v_mul_f32 v229, v229, v189
    v_mul_f32 v230, v230, v190
    v_mul_f32 v231, v231, v191
    v_exp_f32 v224, -v224
    v_exp_f32 v225, -v225
    v_exp_f32 v226, -v226
    v_exp_f32 v227, -v227
    v_exp_f32 v228, -v228
    v_exp_f32 v229, -v229
    v_exp_f32 v230, -v230
    v_exp_f32 v231, -v231
    v_add_f32 v224, 1.0, v224
    v_add_f32 v225, 1.0, v225
    v_add_f32 v226, 1.0, v226
    v_add_f32 v227, 1.0, v227
    v_add_f32 v228, 1.0, v228
    v_add_f32 v229, 1.0, v229
    v_add_f32 v230, 1.0, v230
    v_add_f32 v231, 1.0, v231
    v_rcp_f32 v224, v224
    v_rcp_f32 v225, v225
    v_rcp_f32 v226, v226
    v_rcp_f32 v227, v227
    v_rcp_f32 v228, v228
    v_rcp_f32 v229, v229
    v_rcp_f32 v230, v230
    v_rcp_f32 v231, v231
    v_mul_f32 v172, v172, v224
    v_mul_f32 v173, v173, v225
    v_mul_f32 v174, v174, v226
    v_mul_f32 v175, v175, v227
    v_mul_f32 v188, v188, v228
    v_mul_f32 v189, v189, v229
    v_mul_f32 v190, v190, v230
    v_mul_f32 v191, v191, v231
    v_cvt_pk_bf16_f32 v172, v172, v188
    v_cvt_pk_bf16_f32 v173, v173, v189
    v_cvt_pk_bf16_f32 v174, v174, v190
    v_cvt_pk_bf16_f32 v175, v175, v191
    buffer_store_dwordx4 v[172:175], v11, s[12:15], s37 offen offset:3072 sc1
    v_mov_b32 v23, 8
    s_waitcnt vmcnt(0)
    buffer_store_dword v23, v240, s[12:15], 0 offen sc1
    s_branch P1END
P1END:
    s_load_dwordx2 s[4:5], s[0:1], 40
    s_load_dwordx2 s[8:9], s[0:1], 80
    s_load_dwordx2 s[12:13], s[0:1], 120
    s_load_dwordx2 s[16:17], s[0:1], 104
    s_load_dwordx2 s[20:21], s[0:1], 88
    s_sub_u32 s24, s64, 1
    s_and_b32 s25, s65, 15
    s_lshr_b32 s33, s65, 4
    s_mov_b32 s34, s65
    v_lshrrev_b32 v16, 6, v0
    v_and_b32 v1, 63, v0
    v_readfirstlane_b32 s26, v16
    s_mov_b32 s27, 0x5040100
    s_mov_b32 s28, 0x7060302
    v_and_b32 v17, 15, v1
    v_lshrrev_b32 v18, 4, v1
    s_waitcnt lgkmcnt(0)
    s_and_b32 s5, s5, 0xffff
    s_mov_b32 s6, 0x400000
    s_mov_b32 s7, 0x20000
    s_and_b32 s9, s9, 0xffff
    s_mov_b32 s10, 0x158000
    s_mov_b32 s11, 0x20000
    s_and_b32 s13, s13, 0xffff
    s_mov_b32 s14, 0x10000000
    s_mov_b32 s15, 0x20000
    s_and_b32 s17, s17, 0xffff
    s_mov_b32 s18, 0x200000
    s_mov_b32 s19, 0x20000
    s_and_b32 s21, s21, 0xffff
    s_mov_b32 s22, 0x400
    s_mov_b32 s23, 0x20000
    s_lshr_b32 s35, s26, 1
    s_and_b32 s56, s26, 1
    v_lshlrev_b32 v2, 4, v1
    v_lshlrev_b32 v19, 4, v17
    v_and_b32 v3, 0x3d0, v2
    v_lshl_add_u32 v19, v18, 9, v19
    s_lshl_b32 s29, s33, 8
    v_add_u32 v5, s29, v19
    s_lshl_b32 s29, s35, 8
    v_add_u32 v4, s29, v19
    v_lshrrev_b32 v20, 3, v17
    v_and_b32 v21, 7, v17
    v_lshl_add_u32 v20, v20, 4, v21
    s_lshl_b32 s29, s35, 3
    v_add_u32 v21, s29, v20
    v_lshrrev_b32 v22, 1, v18
    v_and_b32 v23, 1, v18
    v_lshlrev_b32 v23, 2, v23
    v_lshl_add_u32 v22, v22, 4, v23
    v_sub_u32 v21, v21, v22
    v_cmp_le_i32 s[40:41], 0, v21
    v_cmp_le_i32 s[42:43], 1, v21
    v_cmp_le_i32 s[44:45], 2, v21
    v_cmp_le_i32 s[46:47], 3, v21
    v_cmp_le_i32 s[48:49], 8, v21
    v_cmp_le_i32 s[50:51], 9, v21
    v_cmp_le_i32 s[52:53], 10, v21
    v_cmp_le_i32 s[54:55], 11, v21
    s_lshl_b32 s30, s33, 3
    v_add_u32 v20, s30, v20
    v_lshlrev_b32 v7, 2, v20
    v_lshlrev_b32 v20, 10, v20
    v_lshl_add_u32 v20, v18, 4, v20
    s_lshl_b32 s30, s25, 6
    v_add_u32 v8, s30, v20
    s_lshl_b32 s29, s26, 12
    v_add_u32 v9, s29, v2
    v_lshlrev_b32 v20, 4, v18
    buffer_load_dwordx4 v[24:27], v20, s[20:23], s30 offen
    v_lshlrev_b32 v21, 2, v17
    v_lshl_add_u32 v21, v18, 13, v21
    v_add_u32 v21, s30, v21
    v_add_u32 v22, 4096, v21
    s_lshl_b32 s37, s26, 20
    s_mul_i32 s38, s26, 360448
    s_lshl_b32 s29, s25, 16
    s_xor_b32 s29, s29, 0
    s_add_u32 s29, s29, s37
    buffer_load_dword v32, v21, s[4:7], s29 offen offset:0
    buffer_load_dword v33, v21, s[4:7], s29 offen offset:1024
    buffer_load_dword v34, v21, s[4:7], s29 offen offset:2048
    buffer_load_dword v35, v21, s[4:7], s29 offen offset:3072
    buffer_load_dword v36, v22, s[4:7], s29 offen offset:0
    buffer_load_dword v37, v22, s[4:7], s29 offen offset:1024
    buffer_load_dword v38, v22, s[4:7], s29 offen offset:2048
    buffer_load_dword v39, v22, s[4:7], s29 offen offset:3072
    s_lshl_b32 s29, s25, 16
    s_xor_b32 s29, s29, 32768
    s_add_u32 s29, s29, s37
    buffer_load_dword v40, v21, s[4:7], s29 offen offset:0
    buffer_load_dword v41, v21, s[4:7], s29 offen offset:1024
    buffer_load_dword v42, v21, s[4:7], s29 offen offset:2048
    buffer_load_dword v43, v21, s[4:7], s29 offen offset:3072
    buffer_load_dword v44, v22, s[4:7], s29 offen offset:0
    buffer_load_dword v45, v22, s[4:7], s29 offen offset:1024
    buffer_load_dword v46, v22, s[4:7], s29 offen offset:2048
    buffer_load_dword v47, v22, s[4:7], s29 offen offset:3072
    s_lshl_b32 s29, s25, 16
    s_xor_b32 s29, s29, 65536
    s_add_u32 s29, s29, s37
    buffer_load_dword v48, v21, s[4:7], s29 offen offset:0
    buffer_load_dword v49, v21, s[4:7], s29 offen offset:1024
    buffer_load_dword v50, v21, s[4:7], s29 offen offset:2048
    buffer_load_dword v51, v21, s[4:7], s29 offen offset:3072
    buffer_load_dword v52, v22, s[4:7], s29 offen offset:0
    buffer_load_dword v53, v22, s[4:7], s29 offen offset:1024
    buffer_load_dword v54, v22, s[4:7], s29 offen offset:2048
    buffer_load_dword v55, v22, s[4:7], s29 offen offset:3072
    s_lshl_b32 s29, s25, 16
    s_xor_b32 s29, s29, 98304
    s_add_u32 s29, s29, s37
    buffer_load_dword v56, v21, s[4:7], s29 offen offset:0
    buffer_load_dword v57, v21, s[4:7], s29 offen offset:1024
    buffer_load_dword v58, v21, s[4:7], s29 offen offset:2048
    buffer_load_dword v59, v21, s[4:7], s29 offen offset:3072
    buffer_load_dword v60, v22, s[4:7], s29 offen offset:0
    buffer_load_dword v61, v22, s[4:7], s29 offen offset:1024
    buffer_load_dword v62, v22, s[4:7], s29 offen offset:2048
    s_waitcnt vmcnt(62)
    buffer_load_dword v63, v22, s[4:7], s29 offen offset:3072
    s_waitcnt vmcnt(31)
    v_lshlrev_b32 v148, 16, v24
    v_and_b32 v149, 0xffff0000, v24
    v_lshlrev_b32 v150, 16, v25
    v_and_b32 v151, 0xffff0000, v25
    v_lshlrev_b32 v152, 16, v26
    v_and_b32 v153, 0xffff0000, v26
    v_lshlrev_b32 v154, 16, v27
    v_and_b32 v155, 0xffff0000, v27
    s_lshl_b32 s29, s25, 16
    s_xor_b32 s29, s29, 131072
    s_add_u32 s29, s29, s37
    buffer_load_dword v64, v21, s[4:7], s29 offen offset:0
    buffer_load_dword v65, v21, s[4:7], s29 offen offset:1024
    buffer_load_dword v66, v21, s[4:7], s29 offen offset:2048
    buffer_load_dword v67, v21, s[4:7], s29 offen offset:3072
    buffer_load_dword v68, v22, s[4:7], s29 offen offset:0
    buffer_load_dword v69, v22, s[4:7], s29 offen offset:1024
    buffer_load_dword v70, v22, s[4:7], s29 offen offset:2048
    buffer_load_dword v71, v22, s[4:7], s29 offen offset:3072
    s_lshl_b32 s29, s25, 16
    s_xor_b32 s29, s29, 163840
    s_add_u32 s29, s29, s37
    buffer_load_dword v72, v21, s[4:7], s29 offen offset:0
    buffer_load_dword v73, v21, s[4:7], s29 offen offset:1024
    buffer_load_dword v74, v21, s[4:7], s29 offen offset:2048
    buffer_load_dword v75, v21, s[4:7], s29 offen offset:3072
    buffer_load_dword v76, v22, s[4:7], s29 offen offset:0
    buffer_load_dword v77, v22, s[4:7], s29 offen offset:1024
    buffer_load_dword v78, v22, s[4:7], s29 offen offset:2048
    buffer_load_dword v79, v22, s[4:7], s29 offen offset:3072
    s_lshl_b32 s29, s25, 16
    s_xor_b32 s29, s29, 196608
    s_add_u32 s29, s29, s37
    buffer_load_dword v80, v21, s[4:7], s29 offen offset:0
    buffer_load_dword v81, v21, s[4:7], s29 offen offset:1024
    buffer_load_dword v82, v21, s[4:7], s29 offen offset:2048
    buffer_load_dword v83, v21, s[4:7], s29 offen offset:3072
    buffer_load_dword v84, v22, s[4:7], s29 offen offset:0
    buffer_load_dword v85, v22, s[4:7], s29 offen offset:1024
    buffer_load_dword v86, v22, s[4:7], s29 offen offset:2048
    buffer_load_dword v87, v22, s[4:7], s29 offen offset:3072
    s_lshl_b32 s29, s25, 16
    s_xor_b32 s29, s29, 229376
    s_add_u32 s29, s29, s37
    buffer_load_dword v88, v21, s[4:7], s29 offen offset:0
    buffer_load_dword v89, v21, s[4:7], s29 offen offset:1024
    buffer_load_dword v90, v21, s[4:7], s29 offen offset:2048
    buffer_load_dword v91, v21, s[4:7], s29 offen offset:3072
    buffer_load_dword v92, v22, s[4:7], s29 offen offset:0
    buffer_load_dword v93, v22, s[4:7], s29 offen offset:1024
    buffer_load_dword v94, v22, s[4:7], s29 offen offset:2048
    s_waitcnt vmcnt(62)
    buffer_load_dword v95, v22, s[4:7], s29 offen offset:3072
    s_waitcnt vmcnt(32)
    v_perm_b32 v96, v33, v32, s27
    v_perm_b32 v97, v35, v34, s27
    v_perm_b32 v98, v37, v36, s27
    v_perm_b32 v99, v39, v38, s27
    v_perm_b32 v100, v33, v32, s28
    v_perm_b32 v101, v35, v34, s28
    v_perm_b32 v102, v37, v36, s28
    v_perm_b32 v103, v39, v38, s28
    v_accvgpr_write_b32 a0, v96
    v_accvgpr_write_b32 a1, v97
    v_accvgpr_write_b32 a2, v98
    v_accvgpr_write_b32 a3, v99
    v_accvgpr_write_b32 a4, v100
    v_accvgpr_write_b32 a5, v101
    v_accvgpr_write_b32 a6, v102
    v_accvgpr_write_b32 a7, v103
    v_perm_b32 v96, v41, v40, s27
    v_perm_b32 v97, v43, v42, s27
    v_perm_b32 v98, v45, v44, s27
    v_perm_b32 v99, v47, v46, s27
    v_perm_b32 v100, v41, v40, s28
    v_perm_b32 v101, v43, v42, s28
    v_perm_b32 v102, v45, v44, s28
    v_perm_b32 v103, v47, v46, s28
    v_accvgpr_write_b32 a8, v96
    v_accvgpr_write_b32 a9, v97
    v_accvgpr_write_b32 a10, v98
    v_accvgpr_write_b32 a11, v99
    v_accvgpr_write_b32 a12, v100
    v_accvgpr_write_b32 a13, v101
    v_accvgpr_write_b32 a14, v102
    v_accvgpr_write_b32 a15, v103
    v_perm_b32 v96, v49, v48, s27
    v_perm_b32 v97, v51, v50, s27
    v_perm_b32 v98, v53, v52, s27
    v_perm_b32 v99, v55, v54, s27
    v_perm_b32 v100, v49, v48, s28
    v_perm_b32 v101, v51, v50, s28
    v_perm_b32 v102, v53, v52, s28
    v_perm_b32 v103, v55, v54, s28
    v_accvgpr_write_b32 a16, v96
    v_accvgpr_write_b32 a17, v97
    v_accvgpr_write_b32 a18, v98
    v_accvgpr_write_b32 a19, v99
    v_accvgpr_write_b32 a20, v100
    v_accvgpr_write_b32 a21, v101
    v_accvgpr_write_b32 a22, v102
    v_accvgpr_write_b32 a23, v103
    v_perm_b32 v96, v57, v56, s27
    v_perm_b32 v97, v59, v58, s27
    v_perm_b32 v98, v61, v60, s27
    v_perm_b32 v99, v63, v62, s27
    v_perm_b32 v100, v57, v56, s28
    v_perm_b32 v101, v59, v58, s28
    v_perm_b32 v102, v61, v60, s28
    v_perm_b32 v103, v63, v62, s28
    v_accvgpr_write_b32 a24, v96
    v_accvgpr_write_b32 a25, v97
    v_accvgpr_write_b32 a26, v98
    v_accvgpr_write_b32 a27, v99
    v_accvgpr_write_b32 a28, v100
    v_accvgpr_write_b32 a29, v101
    v_accvgpr_write_b32 a30, v102
    v_accvgpr_write_b32 a31, v103
    s_lshl_b32 s29, s25, 16
    s_xor_b32 s29, s29, 262144
    s_add_u32 s29, s29, s37
    buffer_load_dword v32, v21, s[4:7], s29 offen offset:0
    buffer_load_dword v33, v21, s[4:7], s29 offen offset:1024
    buffer_load_dword v34, v21, s[4:7], s29 offen offset:2048
    buffer_load_dword v35, v21, s[4:7], s29 offen offset:3072
    buffer_load_dword v36, v22, s[4:7], s29 offen offset:0
    buffer_load_dword v37, v22, s[4:7], s29 offen offset:1024
    buffer_load_dword v38, v22, s[4:7], s29 offen offset:2048
    buffer_load_dword v39, v22, s[4:7], s29 offen offset:3072
    s_lshl_b32 s29, s25, 16
    s_xor_b32 s29, s29, 294912
    s_add_u32 s29, s29, s37
    buffer_load_dword v40, v21, s[4:7], s29 offen offset:0
    buffer_load_dword v41, v21, s[4:7], s29 offen offset:1024
    buffer_load_dword v42, v21, s[4:7], s29 offen offset:2048
    buffer_load_dword v43, v21, s[4:7], s29 offen offset:3072
    buffer_load_dword v44, v22, s[4:7], s29 offen offset:0
    buffer_load_dword v45, v22, s[4:7], s29 offen offset:1024
    buffer_load_dword v46, v22, s[4:7], s29 offen offset:2048
    buffer_load_dword v47, v22, s[4:7], s29 offen offset:3072
    s_lshl_b32 s29, s25, 16
    s_xor_b32 s29, s29, 327680
    s_add_u32 s29, s29, s37
    buffer_load_dword v48, v21, s[4:7], s29 offen offset:0
    buffer_load_dword v49, v21, s[4:7], s29 offen offset:1024
    buffer_load_dword v50, v21, s[4:7], s29 offen offset:2048
    buffer_load_dword v51, v21, s[4:7], s29 offen offset:3072
    buffer_load_dword v52, v22, s[4:7], s29 offen offset:0
    buffer_load_dword v53, v22, s[4:7], s29 offen offset:1024
    buffer_load_dword v54, v22, s[4:7], s29 offen offset:2048
    buffer_load_dword v55, v22, s[4:7], s29 offen offset:3072
    s_lshl_b32 s29, s25, 16
    s_xor_b32 s29, s29, 360448
    s_add_u32 s29, s29, s37
    buffer_load_dword v56, v21, s[4:7], s29 offen offset:0
    buffer_load_dword v57, v21, s[4:7], s29 offen offset:1024
    buffer_load_dword v58, v21, s[4:7], s29 offen offset:2048
    buffer_load_dword v59, v21, s[4:7], s29 offen offset:3072
    buffer_load_dword v60, v22, s[4:7], s29 offen offset:0
    buffer_load_dword v61, v22, s[4:7], s29 offen offset:1024
    buffer_load_dword v62, v22, s[4:7], s29 offen offset:2048
    s_waitcnt vmcnt(62)
    buffer_load_dword v63, v22, s[4:7], s29 offen offset:3072
    s_waitcnt vmcnt(32)
    v_perm_b32 v96, v65, v64, s27
    v_perm_b32 v97, v67, v66, s27
    v_perm_b32 v98, v69, v68, s27
    v_perm_b32 v99, v71, v70, s27
    v_perm_b32 v100, v65, v64, s28
    v_perm_b32 v101, v67, v66, s28
    v_perm_b32 v102, v69, v68, s28
    v_perm_b32 v103, v71, v70, s28
    v_accvgpr_write_b32 a32, v96
    v_accvgpr_write_b32 a33, v97
    v_accvgpr_write_b32 a34, v98
    v_accvgpr_write_b32 a35, v99
    v_accvgpr_write_b32 a36, v100
    v_accvgpr_write_b32 a37, v101
    v_accvgpr_write_b32 a38, v102
    v_accvgpr_write_b32 a39, v103
    v_perm_b32 v96, v73, v72, s27
    v_perm_b32 v97, v75, v74, s27
    v_perm_b32 v98, v77, v76, s27
    v_perm_b32 v99, v79, v78, s27
    v_perm_b32 v100, v73, v72, s28
    v_perm_b32 v101, v75, v74, s28
    v_perm_b32 v102, v77, v76, s28
    v_perm_b32 v103, v79, v78, s28
    v_accvgpr_write_b32 a40, v96
    v_accvgpr_write_b32 a41, v97
    v_accvgpr_write_b32 a42, v98
    v_accvgpr_write_b32 a43, v99
    v_accvgpr_write_b32 a44, v100
    v_accvgpr_write_b32 a45, v101
    v_accvgpr_write_b32 a46, v102
    v_accvgpr_write_b32 a47, v103
    v_perm_b32 v96, v81, v80, s27
    v_perm_b32 v97, v83, v82, s27
    v_perm_b32 v98, v85, v84, s27
    v_perm_b32 v99, v87, v86, s27
    v_perm_b32 v100, v81, v80, s28
    v_perm_b32 v101, v83, v82, s28
    v_perm_b32 v102, v85, v84, s28
    v_perm_b32 v103, v87, v86, s28
    v_accvgpr_write_b32 a48, v96
    v_accvgpr_write_b32 a49, v97
    v_accvgpr_write_b32 a50, v98
    v_accvgpr_write_b32 a51, v99
    v_accvgpr_write_b32 a52, v100
    v_accvgpr_write_b32 a53, v101
    v_accvgpr_write_b32 a54, v102
    v_accvgpr_write_b32 a55, v103
    v_perm_b32 v96, v89, v88, s27
    v_perm_b32 v97, v91, v90, s27
    v_perm_b32 v98, v93, v92, s27
    v_perm_b32 v99, v95, v94, s27
    v_perm_b32 v100, v89, v88, s28
    v_perm_b32 v101, v91, v90, s28
    v_perm_b32 v102, v93, v92, s28
    v_perm_b32 v103, v95, v94, s28
    v_accvgpr_write_b32 a56, v96
    v_accvgpr_write_b32 a57, v97
    v_accvgpr_write_b32 a58, v98
    v_accvgpr_write_b32 a59, v99
    v_accvgpr_write_b32 a60, v100
    v_accvgpr_write_b32 a61, v101
    v_accvgpr_write_b32 a62, v102
    v_accvgpr_write_b32 a63, v103
    s_lshl_b32 s29, s25, 16
    s_xor_b32 s29, s29, 393216
    s_add_u32 s29, s29, s37
    buffer_load_dword v64, v21, s[4:7], s29 offen offset:0
    buffer_load_dword v65, v21, s[4:7], s29 offen offset:1024
    buffer_load_dword v66, v21, s[4:7], s29 offen offset:2048
    buffer_load_dword v67, v21, s[4:7], s29 offen offset:3072
    buffer_load_dword v68, v22, s[4:7], s29 offen offset:0
    buffer_load_dword v69, v22, s[4:7], s29 offen offset:1024
    buffer_load_dword v70, v22, s[4:7], s29 offen offset:2048
    buffer_load_dword v71, v22, s[4:7], s29 offen offset:3072
    s_lshl_b32 s29, s25, 16
    s_xor_b32 s29, s29, 425984
    s_add_u32 s29, s29, s37
    buffer_load_dword v72, v21, s[4:7], s29 offen offset:0
    buffer_load_dword v73, v21, s[4:7], s29 offen offset:1024
    buffer_load_dword v74, v21, s[4:7], s29 offen offset:2048
    buffer_load_dword v75, v21, s[4:7], s29 offen offset:3072
    buffer_load_dword v76, v22, s[4:7], s29 offen offset:0
    buffer_load_dword v77, v22, s[4:7], s29 offen offset:1024
    buffer_load_dword v78, v22, s[4:7], s29 offen offset:2048
    buffer_load_dword v79, v22, s[4:7], s29 offen offset:3072
    s_lshl_b32 s29, s25, 16
    s_xor_b32 s29, s29, 458752
    s_add_u32 s29, s29, s37
    buffer_load_dword v80, v21, s[4:7], s29 offen offset:0
    buffer_load_dword v81, v21, s[4:7], s29 offen offset:1024
    buffer_load_dword v82, v21, s[4:7], s29 offen offset:2048
    buffer_load_dword v83, v21, s[4:7], s29 offen offset:3072
    buffer_load_dword v84, v22, s[4:7], s29 offen offset:0
    buffer_load_dword v85, v22, s[4:7], s29 offen offset:1024
    buffer_load_dword v86, v22, s[4:7], s29 offen offset:2048
    buffer_load_dword v87, v22, s[4:7], s29 offen offset:3072
    s_lshl_b32 s29, s25, 16
    s_xor_b32 s29, s29, 491520
    s_add_u32 s29, s29, s37
    buffer_load_dword v88, v21, s[4:7], s29 offen offset:0
    buffer_load_dword v89, v21, s[4:7], s29 offen offset:1024
    buffer_load_dword v90, v21, s[4:7], s29 offen offset:2048
    buffer_load_dword v91, v21, s[4:7], s29 offen offset:3072
    buffer_load_dword v92, v22, s[4:7], s29 offen offset:0
    buffer_load_dword v93, v22, s[4:7], s29 offen offset:1024
    buffer_load_dword v94, v22, s[4:7], s29 offen offset:2048
    s_waitcnt vmcnt(62)
    buffer_load_dword v95, v22, s[4:7], s29 offen offset:3072
    s_waitcnt vmcnt(32)
    v_perm_b32 v96, v33, v32, s27
    v_perm_b32 v97, v35, v34, s27
    v_perm_b32 v98, v37, v36, s27
    v_perm_b32 v99, v39, v38, s27
    v_perm_b32 v100, v33, v32, s28
    v_perm_b32 v101, v35, v34, s28
    v_perm_b32 v102, v37, v36, s28
    v_perm_b32 v103, v39, v38, s28
    v_accvgpr_write_b32 a64, v96
    v_accvgpr_write_b32 a65, v97
    v_accvgpr_write_b32 a66, v98
    v_accvgpr_write_b32 a67, v99
    v_accvgpr_write_b32 a68, v100
    v_accvgpr_write_b32 a69, v101
    v_accvgpr_write_b32 a70, v102
    v_accvgpr_write_b32 a71, v103
    v_perm_b32 v96, v41, v40, s27
    v_perm_b32 v97, v43, v42, s27
    v_perm_b32 v98, v45, v44, s27
    v_perm_b32 v99, v47, v46, s27
    v_perm_b32 v100, v41, v40, s28
    v_perm_b32 v101, v43, v42, s28
    v_perm_b32 v102, v45, v44, s28
    v_perm_b32 v103, v47, v46, s28
    v_accvgpr_write_b32 a72, v96
    v_accvgpr_write_b32 a73, v97
    v_accvgpr_write_b32 a74, v98
    v_accvgpr_write_b32 a75, v99
    v_accvgpr_write_b32 a76, v100
    v_accvgpr_write_b32 a77, v101
    v_accvgpr_write_b32 a78, v102
    v_accvgpr_write_b32 a79, v103
    v_perm_b32 v96, v49, v48, s27
    v_perm_b32 v97, v51, v50, s27
    v_perm_b32 v98, v53, v52, s27
    v_perm_b32 v99, v55, v54, s27
    v_perm_b32 v100, v49, v48, s28
    v_perm_b32 v101, v51, v50, s28
    v_perm_b32 v102, v53, v52, s28
    v_perm_b32 v103, v55, v54, s28
    v_accvgpr_write_b32 a80, v96
    v_accvgpr_write_b32 a81, v97
    v_accvgpr_write_b32 a82, v98
    v_accvgpr_write_b32 a83, v99
    v_accvgpr_write_b32 a84, v100
    v_accvgpr_write_b32 a85, v101
    v_accvgpr_write_b32 a86, v102
    v_accvgpr_write_b32 a87, v103
    v_perm_b32 v96, v57, v56, s27
    v_perm_b32 v97, v59, v58, s27
    v_perm_b32 v98, v61, v60, s27
    v_perm_b32 v99, v63, v62, s27
    v_perm_b32 v100, v57, v56, s28
    v_perm_b32 v101, v59, v58, s28
    v_perm_b32 v102, v61, v60, s28
    v_perm_b32 v103, v63, v62, s28
    v_accvgpr_write_b32 a88, v96
    v_accvgpr_write_b32 a89, v97
    v_accvgpr_write_b32 a90, v98
    v_accvgpr_write_b32 a91, v99
    v_accvgpr_write_b32 a92, v100
    v_accvgpr_write_b32 a93, v101
    v_accvgpr_write_b32 a94, v102
    v_accvgpr_write_b32 a95, v103
    s_lshl_b32 s29, s25, 16
    s_xor_b32 s29, s29, 524288
    s_add_u32 s29, s29, s37
    buffer_load_dword v32, v21, s[4:7], s29 offen offset:0
    buffer_load_dword v33, v21, s[4:7], s29 offen offset:1024
    buffer_load_dword v34, v21, s[4:7], s29 offen offset:2048
    buffer_load_dword v35, v21, s[4:7], s29 offen offset:3072
    buffer_load_dword v36, v22, s[4:7], s29 offen offset:0
    buffer_load_dword v37, v22, s[4:7], s29 offen offset:1024
    buffer_load_dword v38, v22, s[4:7], s29 offen offset:2048
    buffer_load_dword v39, v22, s[4:7], s29 offen offset:3072
    s_lshl_b32 s29, s25, 16
    s_xor_b32 s29, s29, 557056
    s_add_u32 s29, s29, s37
    buffer_load_dword v40, v21, s[4:7], s29 offen offset:0
    buffer_load_dword v41, v21, s[4:7], s29 offen offset:1024
    buffer_load_dword v42, v21, s[4:7], s29 offen offset:2048
    buffer_load_dword v43, v21, s[4:7], s29 offen offset:3072
    buffer_load_dword v44, v22, s[4:7], s29 offen offset:0
    buffer_load_dword v45, v22, s[4:7], s29 offen offset:1024
    buffer_load_dword v46, v22, s[4:7], s29 offen offset:2048
    buffer_load_dword v47, v22, s[4:7], s29 offen offset:3072
    s_lshl_b32 s29, s25, 16
    s_xor_b32 s29, s29, 589824
    s_add_u32 s29, s29, s37
    buffer_load_dword v48, v21, s[4:7], s29 offen offset:0
    buffer_load_dword v49, v21, s[4:7], s29 offen offset:1024
    buffer_load_dword v50, v21, s[4:7], s29 offen offset:2048
    buffer_load_dword v51, v21, s[4:7], s29 offen offset:3072
    buffer_load_dword v52, v22, s[4:7], s29 offen offset:0
    buffer_load_dword v53, v22, s[4:7], s29 offen offset:1024
    buffer_load_dword v54, v22, s[4:7], s29 offen offset:2048
    buffer_load_dword v55, v22, s[4:7], s29 offen offset:3072
    s_lshl_b32 s29, s25, 16
    s_xor_b32 s29, s29, 622592
    s_add_u32 s29, s29, s37
    buffer_load_dword v56, v21, s[4:7], s29 offen offset:0
    buffer_load_dword v57, v21, s[4:7], s29 offen offset:1024
    buffer_load_dword v58, v21, s[4:7], s29 offen offset:2048
    buffer_load_dword v59, v21, s[4:7], s29 offen offset:3072
    buffer_load_dword v60, v22, s[4:7], s29 offen offset:0
    buffer_load_dword v61, v22, s[4:7], s29 offen offset:1024
    buffer_load_dword v62, v22, s[4:7], s29 offen offset:2048
    s_waitcnt vmcnt(62)
    buffer_load_dword v63, v22, s[4:7], s29 offen offset:3072
    s_waitcnt vmcnt(32)
    v_perm_b32 v96, v65, v64, s27
    v_perm_b32 v97, v67, v66, s27
    v_perm_b32 v98, v69, v68, s27
    v_perm_b32 v99, v71, v70, s27
    v_perm_b32 v100, v65, v64, s28
    v_perm_b32 v101, v67, v66, s28
    v_perm_b32 v102, v69, v68, s28
    v_perm_b32 v103, v71, v70, s28
    v_accvgpr_write_b32 a96, v96
    v_accvgpr_write_b32 a97, v97
    v_accvgpr_write_b32 a98, v98
    v_accvgpr_write_b32 a99, v99
    v_accvgpr_write_b32 a100, v100
    v_accvgpr_write_b32 a101, v101
    v_accvgpr_write_b32 a102, v102
    v_accvgpr_write_b32 a103, v103
    v_perm_b32 v96, v73, v72, s27
    v_perm_b32 v97, v75, v74, s27
    v_perm_b32 v98, v77, v76, s27
    v_perm_b32 v99, v79, v78, s27
    v_perm_b32 v100, v73, v72, s28
    v_perm_b32 v101, v75, v74, s28
    v_perm_b32 v102, v77, v76, s28
    v_perm_b32 v103, v79, v78, s28
    v_accvgpr_write_b32 a104, v96
    v_accvgpr_write_b32 a105, v97
    v_accvgpr_write_b32 a106, v98
    v_accvgpr_write_b32 a107, v99
    v_accvgpr_write_b32 a108, v100
    v_accvgpr_write_b32 a109, v101
    v_accvgpr_write_b32 a110, v102
    v_accvgpr_write_b32 a111, v103
    v_perm_b32 v96, v81, v80, s27
    v_perm_b32 v97, v83, v82, s27
    v_perm_b32 v98, v85, v84, s27
    v_perm_b32 v99, v87, v86, s27
    v_perm_b32 v100, v81, v80, s28
    v_perm_b32 v101, v83, v82, s28
    v_perm_b32 v102, v85, v84, s28
    v_perm_b32 v103, v87, v86, s28
    v_accvgpr_write_b32 a112, v96
    v_accvgpr_write_b32 a113, v97
    v_accvgpr_write_b32 a114, v98
    v_accvgpr_write_b32 a115, v99
    v_accvgpr_write_b32 a116, v100
    v_accvgpr_write_b32 a117, v101
    v_accvgpr_write_b32 a118, v102
    v_accvgpr_write_b32 a119, v103
    v_perm_b32 v96, v89, v88, s27
    v_perm_b32 v97, v91, v90, s27
    v_perm_b32 v98, v93, v92, s27
    v_perm_b32 v99, v95, v94, s27
    v_perm_b32 v100, v89, v88, s28
    v_perm_b32 v101, v91, v90, s28
    v_perm_b32 v102, v93, v92, s28
    v_perm_b32 v103, v95, v94, s28
    v_accvgpr_write_b32 a120, v96
    v_accvgpr_write_b32 a121, v97
    v_accvgpr_write_b32 a122, v98
    v_accvgpr_write_b32 a123, v99
    v_accvgpr_write_b32 a124, v100
    v_accvgpr_write_b32 a125, v101
    v_accvgpr_write_b32 a126, v102
    v_accvgpr_write_b32 a127, v103
    s_lshl_b32 s29, s25, 16
    s_xor_b32 s29, s29, 655360
    s_add_u32 s29, s29, s37
    buffer_load_dword v64, v21, s[4:7], s29 offen offset:0
    buffer_load_dword v65, v21, s[4:7], s29 offen offset:1024
    buffer_load_dword v66, v21, s[4:7], s29 offen offset:2048
    buffer_load_dword v67, v21, s[4:7], s29 offen offset:3072
    buffer_load_dword v68, v22, s[4:7], s29 offen offset:0
    buffer_load_dword v69, v22, s[4:7], s29 offen offset:1024
    buffer_load_dword v70, v22, s[4:7], s29 offen offset:2048
    buffer_load_dword v71, v22, s[4:7], s29 offen offset:3072
    s_lshl_b32 s29, s25, 16
    s_xor_b32 s29, s29, 688128
    s_add_u32 s29, s29, s37
    buffer_load_dword v72, v21, s[4:7], s29 offen offset:0
    buffer_load_dword v73, v21, s[4:7], s29 offen offset:1024
    buffer_load_dword v74, v21, s[4:7], s29 offen offset:2048
    buffer_load_dword v75, v21, s[4:7], s29 offen offset:3072
    buffer_load_dword v76, v22, s[4:7], s29 offen offset:0
    buffer_load_dword v77, v22, s[4:7], s29 offen offset:1024
    buffer_load_dword v78, v22, s[4:7], s29 offen offset:2048
    buffer_load_dword v79, v22, s[4:7], s29 offen offset:3072
    s_lshl_b32 s29, s25, 16
    s_xor_b32 s29, s29, 720896
    s_add_u32 s29, s29, s37
    buffer_load_dword v80, v21, s[4:7], s29 offen offset:0
    buffer_load_dword v81, v21, s[4:7], s29 offen offset:1024
    buffer_load_dword v82, v21, s[4:7], s29 offen offset:2048
    buffer_load_dword v83, v21, s[4:7], s29 offen offset:3072
    buffer_load_dword v84, v22, s[4:7], s29 offen offset:0
    buffer_load_dword v85, v22, s[4:7], s29 offen offset:1024
    buffer_load_dword v86, v22, s[4:7], s29 offen offset:2048
    buffer_load_dword v87, v22, s[4:7], s29 offen offset:3072
    s_lshl_b32 s29, s25, 16
    s_xor_b32 s29, s29, 753664
    s_add_u32 s29, s29, s37
    buffer_load_dword v88, v21, s[4:7], s29 offen offset:0
    buffer_load_dword v89, v21, s[4:7], s29 offen offset:1024
    buffer_load_dword v90, v21, s[4:7], s29 offen offset:2048
    buffer_load_dword v91, v21, s[4:7], s29 offen offset:3072
    buffer_load_dword v92, v22, s[4:7], s29 offen offset:0
    buffer_load_dword v93, v22, s[4:7], s29 offen offset:1024
    buffer_load_dword v94, v22, s[4:7], s29 offen offset:2048
    s_waitcnt vmcnt(62)
    buffer_load_dword v95, v22, s[4:7], s29 offen offset:3072
    s_waitcnt vmcnt(32)
    v_perm_b32 v96, v33, v32, s27
    v_perm_b32 v97, v35, v34, s27
    v_perm_b32 v98, v37, v36, s27
    v_perm_b32 v99, v39, v38, s27
    v_perm_b32 v100, v33, v32, s28
    v_perm_b32 v101, v35, v34, s28
    v_perm_b32 v102, v37, v36, s28
    v_perm_b32 v103, v39, v38, s28
    v_accvgpr_write_b32 a128, v96
    v_accvgpr_write_b32 a129, v97
    v_accvgpr_write_b32 a130, v98
    v_accvgpr_write_b32 a131, v99
    v_accvgpr_write_b32 a132, v100
    v_accvgpr_write_b32 a133, v101
    v_accvgpr_write_b32 a134, v102
    v_accvgpr_write_b32 a135, v103
    v_perm_b32 v96, v41, v40, s27
    v_perm_b32 v97, v43, v42, s27
    v_perm_b32 v98, v45, v44, s27
    v_perm_b32 v99, v47, v46, s27
    v_perm_b32 v100, v41, v40, s28
    v_perm_b32 v101, v43, v42, s28
    v_perm_b32 v102, v45, v44, s28
    v_perm_b32 v103, v47, v46, s28
    v_accvgpr_write_b32 a136, v96
    v_accvgpr_write_b32 a137, v97
    v_accvgpr_write_b32 a138, v98
    v_accvgpr_write_b32 a139, v99
    v_accvgpr_write_b32 a140, v100
    v_accvgpr_write_b32 a141, v101
    v_accvgpr_write_b32 a142, v102
    v_accvgpr_write_b32 a143, v103
    v_perm_b32 v96, v49, v48, s27
    v_perm_b32 v97, v51, v50, s27
    v_perm_b32 v98, v53, v52, s27
    v_perm_b32 v99, v55, v54, s27
    v_perm_b32 v100, v49, v48, s28
    v_perm_b32 v101, v51, v50, s28
    v_perm_b32 v102, v53, v52, s28
    v_perm_b32 v103, v55, v54, s28
    v_accvgpr_write_b32 a144, v96
    v_accvgpr_write_b32 a145, v97
    v_accvgpr_write_b32 a146, v98
    v_accvgpr_write_b32 a147, v99
    v_accvgpr_write_b32 a148, v100
    v_accvgpr_write_b32 a149, v101
    v_accvgpr_write_b32 a150, v102
    v_accvgpr_write_b32 a151, v103
    v_perm_b32 v96, v57, v56, s27
    v_perm_b32 v97, v59, v58, s27
    v_perm_b32 v98, v61, v60, s27
    v_perm_b32 v99, v63, v62, s27
    v_perm_b32 v100, v57, v56, s28
    v_perm_b32 v101, v59, v58, s28
    v_perm_b32 v102, v61, v60, s28
    v_perm_b32 v103, v63, v62, s28
    v_accvgpr_write_b32 a152, v96
    v_accvgpr_write_b32 a153, v97
    v_accvgpr_write_b32 a154, v98
    v_accvgpr_write_b32 a155, v99
    v_accvgpr_write_b32 a156, v100
    v_accvgpr_write_b32 a157, v101
    v_accvgpr_write_b32 a158, v102
    v_accvgpr_write_b32 a159, v103
    s_lshl_b32 s29, s25, 16
    s_xor_b32 s29, s29, 786432
    s_add_u32 s29, s29, s37
    buffer_load_dword v32, v21, s[4:7], s29 offen offset:0
    buffer_load_dword v33, v21, s[4:7], s29 offen offset:1024
    buffer_load_dword v34, v21, s[4:7], s29 offen offset:2048
    buffer_load_dword v35, v21, s[4:7], s29 offen offset:3072
    buffer_load_dword v36, v22, s[4:7], s29 offen offset:0
    buffer_load_dword v37, v22, s[4:7], s29 offen offset:1024
    buffer_load_dword v38, v22, s[4:7], s29 offen offset:2048
    buffer_load_dword v39, v22, s[4:7], s29 offen offset:3072
    s_lshl_b32 s29, s25, 16
    s_xor_b32 s29, s29, 819200
    s_add_u32 s29, s29, s37
    buffer_load_dword v40, v21, s[4:7], s29 offen offset:0
    buffer_load_dword v41, v21, s[4:7], s29 offen offset:1024
    buffer_load_dword v42, v21, s[4:7], s29 offen offset:2048
    buffer_load_dword v43, v21, s[4:7], s29 offen offset:3072
    buffer_load_dword v44, v22, s[4:7], s29 offen offset:0
    buffer_load_dword v45, v22, s[4:7], s29 offen offset:1024
    buffer_load_dword v46, v22, s[4:7], s29 offen offset:2048
    buffer_load_dword v47, v22, s[4:7], s29 offen offset:3072
    s_lshl_b32 s29, s25, 16
    s_xor_b32 s29, s29, 851968
    s_add_u32 s29, s29, s37
    buffer_load_dword v48, v21, s[4:7], s29 offen offset:0
    buffer_load_dword v49, v21, s[4:7], s29 offen offset:1024
    buffer_load_dword v50, v21, s[4:7], s29 offen offset:2048
    buffer_load_dword v51, v21, s[4:7], s29 offen offset:3072
    buffer_load_dword v52, v22, s[4:7], s29 offen offset:0
    buffer_load_dword v53, v22, s[4:7], s29 offen offset:1024
    buffer_load_dword v54, v22, s[4:7], s29 offen offset:2048
    buffer_load_dword v55, v22, s[4:7], s29 offen offset:3072
    s_lshl_b32 s29, s25, 16
    s_xor_b32 s29, s29, 884736
    s_add_u32 s29, s29, s37
    buffer_load_dword v56, v21, s[4:7], s29 offen offset:0
    buffer_load_dword v57, v21, s[4:7], s29 offen offset:1024
    buffer_load_dword v58, v21, s[4:7], s29 offen offset:2048
    buffer_load_dword v59, v21, s[4:7], s29 offen offset:3072
    buffer_load_dword v60, v22, s[4:7], s29 offen offset:0
    buffer_load_dword v61, v22, s[4:7], s29 offen offset:1024
    buffer_load_dword v62, v22, s[4:7], s29 offen offset:2048
    s_waitcnt vmcnt(62)
    buffer_load_dword v63, v22, s[4:7], s29 offen offset:3072
    s_waitcnt vmcnt(32)
    v_perm_b32 v96, v65, v64, s27
    v_perm_b32 v97, v67, v66, s27
    v_perm_b32 v98, v69, v68, s27
    v_perm_b32 v99, v71, v70, s27
    v_perm_b32 v100, v65, v64, s28
    v_perm_b32 v101, v67, v66, s28
    v_perm_b32 v102, v69, v68, s28
    v_perm_b32 v103, v71, v70, s28
    v_accvgpr_write_b32 a160, v96
    v_accvgpr_write_b32 a161, v97
    v_accvgpr_write_b32 a162, v98
    v_accvgpr_write_b32 a163, v99
    v_accvgpr_write_b32 a164, v100
    v_accvgpr_write_b32 a165, v101
    v_accvgpr_write_b32 a166, v102
    v_accvgpr_write_b32 a167, v103
    v_perm_b32 v96, v73, v72, s27
    v_perm_b32 v97, v75, v74, s27
    v_perm_b32 v98, v77, v76, s27
    v_perm_b32 v99, v79, v78, s27
    v_perm_b32 v100, v73, v72, s28
    v_perm_b32 v101, v75, v74, s28
    v_perm_b32 v102, v77, v76, s28
    v_perm_b32 v103, v79, v78, s28
    v_accvgpr_write_b32 a168, v96
    v_accvgpr_write_b32 a169, v97
    v_accvgpr_write_b32 a170, v98
    v_accvgpr_write_b32 a171, v99
    v_accvgpr_write_b32 a172, v100
    v_accvgpr_write_b32 a173, v101
    v_accvgpr_write_b32 a174, v102
    v_accvgpr_write_b32 a175, v103
    v_perm_b32 v96, v81, v80, s27
    v_perm_b32 v97, v83, v82, s27
    v_perm_b32 v98, v85, v84, s27
    v_perm_b32 v99, v87, v86, s27
    v_perm_b32 v100, v81, v80, s28
    v_perm_b32 v101, v83, v82, s28
    v_perm_b32 v102, v85, v84, s28
    v_perm_b32 v103, v87, v86, s28
    v_accvgpr_write_b32 a176, v96
    v_accvgpr_write_b32 a177, v97
    v_accvgpr_write_b32 a178, v98
    v_accvgpr_write_b32 a179, v99
    v_accvgpr_write_b32 a180, v100
    v_accvgpr_write_b32 a181, v101
    v_accvgpr_write_b32 a182, v102
    v_accvgpr_write_b32 a183, v103
    v_perm_b32 v96, v89, v88, s27
    v_perm_b32 v97, v91, v90, s27
    v_perm_b32 v98, v93, v92, s27
    v_perm_b32 v99, v95, v94, s27
    v_perm_b32 v100, v89, v88, s28
    v_perm_b32 v101, v91, v90, s28
    v_perm_b32 v102, v93, v92, s28
    v_perm_b32 v103, v95, v94, s28
    v_accvgpr_write_b32 a184, v96
    v_accvgpr_write_b32 a185, v97
    v_accvgpr_write_b32 a186, v98
    v_accvgpr_write_b32 a187, v99
    v_accvgpr_write_b32 a188, v100
    v_accvgpr_write_b32 a189, v101
    v_accvgpr_write_b32 a190, v102
    v_accvgpr_write_b32 a191, v103
    s_lshl_b32 s29, s25, 16
    s_xor_b32 s29, s29, 917504
    s_add_u32 s29, s29, s37
    buffer_load_dword v64, v21, s[4:7], s29 offen offset:0
    buffer_load_dword v65, v21, s[4:7], s29 offen offset:1024
    buffer_load_dword v66, v21, s[4:7], s29 offen offset:2048
    buffer_load_dword v67, v21, s[4:7], s29 offen offset:3072
    buffer_load_dword v68, v22, s[4:7], s29 offen offset:0
    buffer_load_dword v69, v22, s[4:7], s29 offen offset:1024
    buffer_load_dword v70, v22, s[4:7], s29 offen offset:2048
    buffer_load_dword v71, v22, s[4:7], s29 offen offset:3072
    s_lshl_b32 s29, s25, 16
    s_xor_b32 s29, s29, 950272
    s_add_u32 s29, s29, s37
    buffer_load_dword v72, v21, s[4:7], s29 offen offset:0
    buffer_load_dword v73, v21, s[4:7], s29 offen offset:1024
    buffer_load_dword v74, v21, s[4:7], s29 offen offset:2048
    buffer_load_dword v75, v21, s[4:7], s29 offen offset:3072
    buffer_load_dword v76, v22, s[4:7], s29 offen offset:0
    buffer_load_dword v77, v22, s[4:7], s29 offen offset:1024
    buffer_load_dword v78, v22, s[4:7], s29 offen offset:2048
    buffer_load_dword v79, v22, s[4:7], s29 offen offset:3072
    s_lshl_b32 s29, s25, 16
    s_xor_b32 s29, s29, 983040
    s_add_u32 s29, s29, s37
    buffer_load_dword v80, v21, s[4:7], s29 offen offset:0
    buffer_load_dword v81, v21, s[4:7], s29 offen offset:1024
    buffer_load_dword v82, v21, s[4:7], s29 offen offset:2048
    buffer_load_dword v83, v21, s[4:7], s29 offen offset:3072
    buffer_load_dword v84, v22, s[4:7], s29 offen offset:0
    buffer_load_dword v85, v22, s[4:7], s29 offen offset:1024
    buffer_load_dword v86, v22, s[4:7], s29 offen offset:2048
    buffer_load_dword v87, v22, s[4:7], s29 offen offset:3072
    s_lshl_b32 s29, s25, 16
    s_xor_b32 s29, s29, 1015808
    s_add_u32 s29, s29, s37
    buffer_load_dword v88, v21, s[4:7], s29 offen offset:0
    buffer_load_dword v89, v21, s[4:7], s29 offen offset:1024
    buffer_load_dword v90, v21, s[4:7], s29 offen offset:2048
    buffer_load_dword v91, v21, s[4:7], s29 offen offset:3072
    buffer_load_dword v92, v22, s[4:7], s29 offen offset:0
    buffer_load_dword v93, v22, s[4:7], s29 offen offset:1024
    buffer_load_dword v94, v22, s[4:7], s29 offen offset:2048
    s_waitcnt vmcnt(62)
    buffer_load_dword v95, v22, s[4:7], s29 offen offset:3072
    s_waitcnt vmcnt(32)
    v_perm_b32 v96, v33, v32, s27
    v_perm_b32 v97, v35, v34, s27
    v_perm_b32 v98, v37, v36, s27
    v_perm_b32 v99, v39, v38, s27
    v_perm_b32 v100, v33, v32, s28
    v_perm_b32 v101, v35, v34, s28
    v_perm_b32 v102, v37, v36, s28
    v_perm_b32 v103, v39, v38, s28
    v_accvgpr_write_b32 a192, v96
    v_accvgpr_write_b32 a193, v97
    v_accvgpr_write_b32 a194, v98
    v_accvgpr_write_b32 a195, v99
    v_accvgpr_write_b32 a196, v100
    v_accvgpr_write_b32 a197, v101
    v_accvgpr_write_b32 a198, v102
    v_accvgpr_write_b32 a199, v103
    v_perm_b32 v96, v41, v40, s27
    v_perm_b32 v97, v43, v42, s27
    v_perm_b32 v98, v45, v44, s27
    v_perm_b32 v99, v47, v46, s27
    v_perm_b32 v100, v41, v40, s28
    v_perm_b32 v101, v43, v42, s28
    v_perm_b32 v102, v45, v44, s28
    v_perm_b32 v103, v47, v46, s28
    v_accvgpr_write_b32 a200, v96
    v_accvgpr_write_b32 a201, v97
    v_accvgpr_write_b32 a202, v98
    v_accvgpr_write_b32 a203, v99
    v_accvgpr_write_b32 a204, v100
    v_accvgpr_write_b32 a205, v101
    v_accvgpr_write_b32 a206, v102
    v_accvgpr_write_b32 a207, v103
    v_perm_b32 v96, v49, v48, s27
    v_perm_b32 v97, v51, v50, s27
    v_perm_b32 v98, v53, v52, s27
    v_perm_b32 v99, v55, v54, s27
    v_perm_b32 v100, v49, v48, s28
    v_perm_b32 v101, v51, v50, s28
    v_perm_b32 v102, v53, v52, s28
    v_perm_b32 v103, v55, v54, s28
    v_accvgpr_write_b32 a208, v96
    v_accvgpr_write_b32 a209, v97
    v_accvgpr_write_b32 a210, v98
    v_accvgpr_write_b32 a211, v99
    v_accvgpr_write_b32 a212, v100
    v_accvgpr_write_b32 a213, v101
    v_accvgpr_write_b32 a214, v102
    v_accvgpr_write_b32 a215, v103
    v_perm_b32 v96, v57, v56, s27
    v_perm_b32 v97, v59, v58, s27
    v_perm_b32 v98, v61, v60, s27
    v_perm_b32 v99, v63, v62, s27
    v_perm_b32 v100, v57, v56, s28
    v_perm_b32 v101, v59, v58, s28
    v_perm_b32 v102, v61, v60, s28
    v_perm_b32 v103, v63, v62, s28
    v_accvgpr_write_b32 a216, v96
    v_accvgpr_write_b32 a217, v97
    v_accvgpr_write_b32 a218, v98
    v_accvgpr_write_b32 a219, v99
    v_accvgpr_write_b32 a220, v100
    v_accvgpr_write_b32 a221, v101
    v_accvgpr_write_b32 a222, v102
    v_accvgpr_write_b32 a223, v103
    s_add_u32 s29, s38, 0
    buffer_load_dword v32, v21, s[8:11], s29 offen offset:0
    buffer_load_dword v33, v21, s[8:11], s29 offen offset:1024
    buffer_load_dword v34, v21, s[8:11], s29 offen offset:2048
    buffer_load_dword v35, v21, s[8:11], s29 offen offset:3072
    buffer_load_dword v36, v22, s[8:11], s29 offen offset:0
    buffer_load_dword v37, v22, s[8:11], s29 offen offset:1024
    buffer_load_dword v38, v22, s[8:11], s29 offen offset:2048
    buffer_load_dword v39, v22, s[8:11], s29 offen offset:3072
    s_add_u32 s29, s38, 32768
    buffer_load_dword v40, v21, s[8:11], s29 offen offset:0
    buffer_load_dword v41, v21, s[8:11], s29 offen offset:1024
    buffer_load_dword v42, v21, s[8:11], s29 offen offset:2048
    buffer_load_dword v43, v21, s[8:11], s29 offen offset:3072
    buffer_load_dword v44, v22, s[8:11], s29 offen offset:0
    buffer_load_dword v45, v22, s[8:11], s29 offen offset:1024
    buffer_load_dword v46, v22, s[8:11], s29 offen offset:2048
    buffer_load_dword v47, v22, s[8:11], s29 offen offset:3072
    s_add_u32 s29, s38, 65536
    buffer_load_dword v48, v21, s[8:11], s29 offen offset:0
    buffer_load_dword v49, v21, s[8:11], s29 offen offset:1024
    buffer_load_dword v50, v21, s[8:11], s29 offen offset:2048
    buffer_load_dword v51, v21, s[8:11], s29 offen offset:3072
    buffer_load_dword v52, v22, s[8:11], s29 offen offset:0
    buffer_load_dword v53, v22, s[8:11], s29 offen offset:1024
    buffer_load_dword v54, v22, s[8:11], s29 offen offset:2048
    buffer_load_dword v55, v22, s[8:11], s29 offen offset:3072
    s_add_u32 s29, s38, 98304
    buffer_load_dword v56, v21, s[8:11], s29 offen offset:0
    buffer_load_dword v57, v21, s[8:11], s29 offen offset:1024
    buffer_load_dword v58, v21, s[8:11], s29 offen offset:2048
    buffer_load_dword v59, v21, s[8:11], s29 offen offset:3072
    buffer_load_dword v60, v22, s[8:11], s29 offen offset:0
    buffer_load_dword v61, v22, s[8:11], s29 offen offset:1024
    buffer_load_dword v62, v22, s[8:11], s29 offen offset:2048
    s_waitcnt vmcnt(62)
    buffer_load_dword v63, v22, s[8:11], s29 offen offset:3072
    s_waitcnt vmcnt(32)
    v_perm_b32 v96, v65, v64, s27
    v_perm_b32 v97, v67, v66, s27
    v_perm_b32 v98, v69, v68, s27
    v_perm_b32 v99, v71, v70, s27
    v_perm_b32 v100, v65, v64, s28
    v_perm_b32 v101, v67, v66, s28
    v_perm_b32 v102, v69, v68, s28
    v_perm_b32 v103, v71, v70, s28
    v_accvgpr_write_b32 a224, v96
    v_accvgpr_write_b32 a225, v97
    v_accvgpr_write_b32 a226, v98
    v_accvgpr_write_b32 a227, v99
    v_accvgpr_write_b32 a228, v100
    v_accvgpr_write_b32 a229, v101
    v_accvgpr_write_b32 a230, v102
    v_accvgpr_write_b32 a231, v103
    v_perm_b32 v96, v73, v72, s27
    v_perm_b32 v97, v75, v74, s27
    v_perm_b32 v98, v77, v76, s27
    v_perm_b32 v99, v79, v78, s27
    v_perm_b32 v100, v73, v72, s28
    v_perm_b32 v101, v75, v74, s28
    v_perm_b32 v102, v77, v76, s28
    v_perm_b32 v103, v79, v78, s28
    v_accvgpr_write_b32 a232, v96
    v_accvgpr_write_b32 a233, v97
    v_accvgpr_write_b32 a234, v98
    v_accvgpr_write_b32 a235, v99
    v_accvgpr_write_b32 a236, v100
    v_accvgpr_write_b32 a237, v101
    v_accvgpr_write_b32 a238, v102
    v_accvgpr_write_b32 a239, v103
    v_perm_b32 v96, v81, v80, s27
    v_perm_b32 v97, v83, v82, s27
    v_perm_b32 v98, v85, v84, s27
    v_perm_b32 v99, v87, v86, s27
    v_perm_b32 v100, v81, v80, s28
    v_perm_b32 v101, v83, v82, s28
    v_perm_b32 v102, v85, v84, s28
    v_perm_b32 v103, v87, v86, s28
    v_accvgpr_write_b32 a240, v96
    v_accvgpr_write_b32 a241, v97
    v_accvgpr_write_b32 a242, v98
    v_accvgpr_write_b32 a243, v99
    v_accvgpr_write_b32 a244, v100
    v_accvgpr_write_b32 a245, v101
    v_accvgpr_write_b32 a246, v102
    v_accvgpr_write_b32 a247, v103
    v_perm_b32 v96, v89, v88, s27
    v_perm_b32 v97, v91, v90, s27
    v_perm_b32 v98, v93, v92, s27
    v_perm_b32 v99, v95, v94, s27
    v_perm_b32 v100, v89, v88, s28
    v_perm_b32 v101, v91, v90, s28
    v_perm_b32 v102, v93, v92, s28
    v_perm_b32 v103, v95, v94, s28
    v_accvgpr_write_b32 a248, v96
    v_accvgpr_write_b32 a249, v97
    v_accvgpr_write_b32 a250, v98
    v_accvgpr_write_b32 a251, v99
    v_accvgpr_write_b32 a252, v100
    v_accvgpr_write_b32 a253, v101
    v_accvgpr_write_b32 a254, v102
    v_accvgpr_write_b32 a255, v103
    s_add_u32 s29, s38, 131072
    buffer_load_dword v64, v21, s[8:11], s29 offen offset:0
    buffer_load_dword v65, v21, s[8:11], s29 offen offset:1024
    buffer_load_dword v66, v21, s[8:11], s29 offen offset:2048
    buffer_load_dword v67, v21, s[8:11], s29 offen offset:3072
    buffer_load_dword v68, v22, s[8:11], s29 offen offset:0
    buffer_load_dword v69, v22, s[8:11], s29 offen offset:1024
    buffer_load_dword v70, v22, s[8:11], s29 offen offset:2048
    buffer_load_dword v71, v22, s[8:11], s29 offen offset:3072
    s_add_u32 s29, s38, 163840
    buffer_load_dword v72, v21, s[8:11], s29 offen offset:0
    buffer_load_dword v73, v21, s[8:11], s29 offen offset:1024
    buffer_load_dword v74, v21, s[8:11], s29 offen offset:2048
    buffer_load_dword v75, v21, s[8:11], s29 offen offset:3072
    buffer_load_dword v76, v22, s[8:11], s29 offen offset:0
    buffer_load_dword v77, v22, s[8:11], s29 offen offset:1024
    buffer_load_dword v78, v22, s[8:11], s29 offen offset:2048
    buffer_load_dword v79, v22, s[8:11], s29 offen offset:3072
    s_add_u32 s29, s38, 196608
    buffer_load_dword v80, v21, s[8:11], s29 offen offset:0
    buffer_load_dword v81, v21, s[8:11], s29 offen offset:1024
    buffer_load_dword v82, v21, s[8:11], s29 offen offset:2048
    buffer_load_dword v83, v21, s[8:11], s29 offen offset:3072
    buffer_load_dword v84, v22, s[8:11], s29 offen offset:0
    buffer_load_dword v85, v22, s[8:11], s29 offen offset:1024
    buffer_load_dword v86, v22, s[8:11], s29 offen offset:2048
    buffer_load_dword v87, v22, s[8:11], s29 offen offset:3072
    s_add_u32 s29, s38, 229376
    buffer_load_dword v88, v21, s[8:11], s29 offen offset:0
    buffer_load_dword v89, v21, s[8:11], s29 offen offset:1024
    buffer_load_dword v90, v21, s[8:11], s29 offen offset:2048
    buffer_load_dword v91, v21, s[8:11], s29 offen offset:3072
    buffer_load_dword v92, v22, s[8:11], s29 offen offset:0
    buffer_load_dword v93, v22, s[8:11], s29 offen offset:1024
    buffer_load_dword v94, v22, s[8:11], s29 offen offset:2048
    s_waitcnt vmcnt(62)
    buffer_load_dword v95, v22, s[8:11], s29 offen offset:3072
    s_waitcnt vmcnt(32)
    v_perm_b32 v168, v33, v32, s27
    v_perm_b32 v169, v35, v34, s27
    v_perm_b32 v170, v37, v36, s27
    v_perm_b32 v171, v39, v38, s27
    v_perm_b32 v172, v33, v32, s28
    v_perm_b32 v173, v35, v34, s28
    v_perm_b32 v174, v37, v36, s28
    v_perm_b32 v175, v39, v38, s28
    v_perm_b32 v176, v41, v40, s27
    v_perm_b32 v177, v43, v42, s27
    v_perm_b32 v178, v45, v44, s27
    v_perm_b32 v179, v47, v46, s27
    v_perm_b32 v180, v41, v40, s28
    v_perm_b32 v181, v43, v42, s28
    v_perm_b32 v182, v45, v44, s28
    v_perm_b32 v183, v47, v46, s28
    v_perm_b32 v184, v49, v48, s27
    v_perm_b32 v185, v51, v50, s27
    v_perm_b32 v186, v53, v52, s27
    v_perm_b32 v187, v55, v54, s27
    v_perm_b32 v188, v49, v48, s28
    v_perm_b32 v189, v51, v50, s28
    v_perm_b32 v190, v53, v52, s28
    v_perm_b32 v191, v55, v54, s28
    v_perm_b32 v192, v57, v56, s27
    v_perm_b32 v193, v59, v58, s27
    v_perm_b32 v194, v61, v60, s27
    v_perm_b32 v195, v63, v62, s27
    v_perm_b32 v196, v57, v56, s28
    v_perm_b32 v197, v59, v58, s28
    v_perm_b32 v198, v61, v60, s28
    v_perm_b32 v199, v63, v62, s28
    s_add_u32 s29, s38, 262144
    buffer_load_dword v32, v21, s[8:11], s29 offen offset:0
    buffer_load_dword v33, v21, s[8:11], s29 offen offset:1024
    buffer_load_dword v34, v21, s[8:11], s29 offen offset:2048
    buffer_load_dword v35, v21, s[8:11], s29 offen offset:3072
    buffer_load_dword v36, v22, s[8:11], s29 offen offset:0
    buffer_load_dword v37, v22, s[8:11], s29 offen offset:1024
    buffer_load_dword v38, v22, s[8:11], s29 offen offset:2048
    buffer_load_dword v39, v22, s[8:11], s29 offen offset:3072
    s_add_u32 s29, s38, 294912
    buffer_load_dword v40, v21, s[8:11], s29 offen offset:0
    buffer_load_dword v41, v21, s[8:11], s29 offen offset:1024
    buffer_load_dword v42, v21, s[8:11], s29 offen offset:2048
    buffer_load_dword v43, v21, s[8:11], s29 offen offset:3072
    buffer_load_dword v44, v22, s[8:11], s29 offen offset:0
    buffer_load_dword v45, v22, s[8:11], s29 offen offset:1024
    buffer_load_dword v46, v22, s[8:11], s29 offen offset:2048
    buffer_load_dword v47, v22, s[8:11], s29 offen offset:3072
    s_add_u32 s29, s38, 327680
    buffer_load_dword v48, v21, s[8:11], s29 offen offset:0
    buffer_load_dword v49, v21, s[8:11], s29 offen offset:1024
    buffer_load_dword v50, v21, s[8:11], s29 offen offset:2048
    buffer_load_dword v51, v21, s[8:11], s29 offen offset:3072
    buffer_load_dword v52, v22, s[8:11], s29 offen offset:0
    buffer_load_dword v53, v22, s[8:11], s29 offen offset:1024
    buffer_load_dword v54, v22, s[8:11], s29 offen offset:2048
    buffer_load_dword v55, v22, s[8:11], s29 offen offset:3072
    s_waitcnt vmcnt(24)
    v_perm_b32 v200, v65, v64, s27
    v_perm_b32 v201, v67, v66, s27
    v_perm_b32 v202, v69, v68, s27
    v_perm_b32 v203, v71, v70, s27
    v_perm_b32 v204, v65, v64, s28
    v_perm_b32 v205, v67, v66, s28
    v_perm_b32 v206, v69, v68, s28
    v_perm_b32 v207, v71, v70, s28
    v_perm_b32 v208, v73, v72, s27
    v_perm_b32 v209, v75, v74, s27
    v_perm_b32 v210, v77, v76, s27
    v_perm_b32 v211, v79, v78, s27
    v_perm_b32 v212, v73, v72, s28
    v_perm_b32 v213, v75, v74, s28
    v_perm_b32 v214, v77, v76, s28
    v_perm_b32 v215, v79, v78, s28
    v_perm_b32 v216, v81, v80, s27
    v_perm_b32 v217, v83, v82, s27
    v_perm_b32 v218, v85, v84, s27
    v_perm_b32 v219, v87, v86, s27
    v_perm_b32 v220, v81, v80, s28
    v_perm_b32 v221, v83, v82, s28
    v_perm_b32 v222, v85, v84, s28
    v_perm_b32 v223, v87, v86, s28
    v_perm_b32 v224, v89, v88, s27
    v_perm_b32 v225, v91, v90, s27
    v_perm_b32 v226, v93, v92, s27
    v_perm_b32 v227, v95, v94, s27
    v_perm_b32 v228, v89, v88, s28
    v_perm_b32 v229, v91, v90, s28
    v_perm_b32 v230, v93, v92, s28
    v_perm_b32 v231, v95, v94, s28
    s_waitcnt vmcnt(0)
    v_perm_b32 v232, v33, v32, s27
    v_perm_b32 v233, v35, v34, s27
    v_perm_b32 v234, v37, v36, s27
    v_perm_b32 v235, v39, v38, s27
    v_perm_b32 v236, v33, v32, s28
    v_perm_b32 v237, v35, v34, s28
    v_perm_b32 v238, v37, v36, s28
    v_perm_b32 v239, v39, v38, s28
    v_perm_b32 v240, v41, v40, s27
    v_perm_b32 v241, v43, v42, s27
    v_perm_b32 v242, v45, v44, s27
    v_perm_b32 v243, v47, v46, s27
    v_perm_b32 v244, v41, v40, s28
    v_perm_b32 v245, v43, v42, s28
    v_perm_b32 v246, v45, v44, s28
    v_perm_b32 v247, v47, v46, s28
    v_perm_b32 v248, v49, v48, s27
    v_perm_b32 v249, v51, v50, s27
    v_perm_b32 v250, v53, v52, s27
    v_perm_b32 v251, v55, v54, s27
    v_perm_b32 v252, v49, v48, s28
    v_perm_b32 v253, v51, v50, s28
    v_perm_b32 v254, v53, v52, s28
    v_perm_b32 v255, v55, v54, s28
    s_lshl_b32 s29, s64, 5
    s_add_u32 s29, s29, s65
    s_lshl_b32 s29, s29, 5
    s_add_u32 s29, s29, s26
    s_lshl_b32 s29, s29, 2
    s_add_u32 s29, s29, 16
    v_cmp_eq_u32 vcc, 0, v1
    v_mov_b32 v160, 0x40000000
    v_mov_b32 v161, s29
    v_cndmask_b32 v160, v160, v161, vcc
    v_and_b32 v162, 3, v1
    v_lshlrev_b32 v162, 2, v162
    s_lshl_b32 s29, s34, 7
    s_add_u32 s29, s29, 0
    v_add_u32 v162, s29, v162
    v_lshrrev_b32 v163, 1, v1
    v_lshlrev_b32 v163, 7, v163
    v_and_b32 v16, 1, v1
    v_lshl_add_u32 v163, v16, 2, v163
    s_lshl_b32 s29, s64, 12
    s_lshl_b32 s30, s33, 3
    s_add_u32 s29, s29, s30
    s_add_u32 s29, s29, 16
    v_add_u32 v163, s29, v163
    v_lshlrev_b32 v16, 7, v1
    v_add_u32 v16, 4096, v16
    s_cmp_lg_u32 s26, 0
    s_cbranch_scc1 P1W_79
    s_mov_b32 s36, 0
WP1_80:
    s_mov_b32 s29, 0
    buffer_load_dwordx4 v[20:23], v16, s[12:15], s29 offen sc1
    s_mov_b32 s29, 8192
    buffer_load_dwordx4 v[24:27], v16, s[12:15], s29 offen sc1
    s_mov_b32 s29, 16384
    buffer_load_dwordx4 v[28:31], v16, s[12:15], s29 offen sc1
    s_mov_b32 s29, 20480
    buffer_load_dwordx4 v[32:35], v16, s[12:15], s29 offen sc1
    s_waitcnt vmcnt(0)
    v_and_b32 v20, v20, v21
    v_bitop3_b32 v20, v20, v22, v23 bitop3:0x80
    v_bitop3_b32 v20, v20, v24, v25 bitop3:0x80
    v_bitop3_b32 v20, v20, v26, v27 bitop3:0x80
    v_bitop3_b32 v20, v20, v28, v29 bitop3:0x80
    v_bitop3_b32 v20, v20, v30, v31 bitop3:0x80
    v_bitop3_b32 v20, v20, v32, v33 bitop3:0x80
    v_bitop3_b32 v20, v20, v34, v35 bitop3:0x80
    v_cmp_ne_u32 vcc, 8, v20
    s_cbranch_vccz WP1OK_81
    s_sleep 32
    s_add_u32 s36, s36, 1
    s_cmp_lt_u32 s36, 0x10000
    s_cbranch_scc1 WP1_80
    s_branch KEND3
WP1OK_81:
P1W_79:
    s_barrier
    s_mov_b32 s32, s24
    s_mov_b32 s58, 0
P34L_82:
    s_sub_u32 s29, s32, 0
    s_cmp_ge_u32 s29, 57
    s_cselect_b32 s59, 1, 0
    s_andn2_b32 s59, s59, s90
    s_mul_i32 s39, s32, 98304
    s_mul_i32 s29, s26, 22528
    s_add_u32 s39, s39, s29
    s_add_u32 s39, s39, 0x4100000
    s_add_u32 s29, s39, 0
    buffer_load_dwordx4 v[96:99], v5, s[12:15], s29 offen offset:0 sc1
    buffer_load_dwordx4 v[100:103], v5, s[12:15], s29 offen offset:2048 sc1
    s_add_u32 s29, s39, 4096
    buffer_load_dwordx4 v[104:107], v5, s[12:15], s29 offen offset:0 sc1
    buffer_load_dwordx4 v[108:111], v5, s[12:15], s29 offen offset:2048 sc1
    s_add_u32 s29, s39, 8192
    buffer_load_dwordx4 v[112:115], v5, s[12:15], s29 offen offset:0 sc1
    buffer_load_dwordx4 v[116:119], v5, s[12:15], s29 offen offset:2048 sc1
    s_add_u32 s29, s39, 12288
    buffer_load_dwordx4 v[120:123], v5, s[12:15], s29 offen offset:0 sc1
    buffer_load_dwordx4 v[124:127], v5, s[12:15], s29 offen offset:2048 sc1
    s_add_u32 s29, s39, 16384
    buffer_load_dwordx4 v[128:131], v5, s[12:15], s29 offen offset:0 sc1
    buffer_load_dwordx4 v[132:135], v5, s[12:15], s29 offen offset:2048 sc1
    s_add_u32 s29, s39, 20480
    buffer_load_dwordx4 v[136:139], v5, s[12:15], s29 offen offset:0 sc1
    s_lshl_b32 s29, s32, 7
    s_add_u32 s29, s29, 0xc0000
    buffer_load_dword v164, v7, s[12:15], s29 offen sc1
    s_lshl_b32 s37, s32, 18
    s_lshl_b32 s29, s34, 13
    s_add_u32 s37, s37, s29
    s_lshl_b32 s29, s35, 12
    s_add_u32 s29, s29, s37
    s_add_u32 s29, s29, 0x2100000
    buffer_load_dwordx4 v[16:19], v2, s[12:15], s29 offen offset:0 sc1
    buffer_load_dwordx4 v[20:23], v2, s[12:15], s29 offen offset:1024 sc1
    buffer_load_dwordx4 v[24:27], v2, s[12:15], s29 offen offset:2048 sc1
    buffer_load_dwordx4 v[28:31], v2, s[12:15], s29 offen offset:3072 sc1
    s_add_u32 s29, s37, 0x100000
    buffer_load_dwordx4 v[32:35], v2, s[12:15], s29 offen offset:0 sc1
    buffer_load_dwordx4 v[36:39], v2, s[12:15], s29 offen offset:1024 sc1
    buffer_load_dwordx4 v[40:43], v2, s[12:15], s29 offen offset:2048 sc1
    buffer_load_dwordx4 v[44:47], v2, s[12:15], s29 offen offset:3072 sc1
    s_add_u32 s29, s37, 0x101000
    buffer_load_dwordx4 v[48:51], v2, s[12:15], s29 offen offset:0 sc1
    buffer_load_dwordx4 v[52:55], v2, s[12:15], s29 offen offset:1024 sc1
    buffer_load_dwordx4 v[56:59], v2, s[12:15], s29 offen offset:2048 sc1
    buffer_load_dwordx4 v[60:63], v2, s[12:15], s29 offen offset:3072 sc1
    s_lshl_b32 s29, s56, 12
    s_add_u32 s29, s29, s37
    s_add_u32 s29, s29, 0x1100000
    buffer_load_dwordx4 v[64:67], v2, s[12:15], s29 offen offset:0 sc1
    buffer_load_dwordx4 v[68:71], v2, s[12:15], s29 offen offset:1024 sc1
    buffer_load_dwordx4 v[72:75], v2, s[12:15], s29 offen offset:2048 sc1
    buffer_load_dwordx4 v[76:79], v2, s[12:15], s29 offen offset:3072 sc1
    buffer_load_dword v156, v162, s[12:15], 0 offen sc1
    s_lshl_b32 s38, s32, 17
    s_lshl_b32 s29, s34, 12
    s_add_u32 s38, s38, s29
    s_add_u32 s38, s38, 0x4900000
    s_waitcnt vmcnt(28)
    v_mfma_f32_16x16x32_bf16 v[144:147], v[168:171], v[96:99], 0
    v_mfma_f32_16x16x32_bf16 v[10:13], v[172:175], v[96:99], 0
    s_waitcnt vmcnt(27)
    v_mfma_f32_16x16x32_bf16 v[144:147], v[176:179], v[100:103], v[144:147]
    v_mfma_f32_16x16x32_bf16 v[10:13], v[180:183], v[100:103], v[10:13]
    s_waitcnt vmcnt(26)
    v_mfma_f32_16x16x32_bf16 v[144:147], v[184:187], v[104:107], v[144:147]
    v_mfma_f32_16x16x32_bf16 v[10:13], v[188:191], v[104:107], v[10:13]
    s_waitcnt vmcnt(25)
    v_mfma_f32_16x16x32_bf16 v[144:147], v[192:195], v[108:111], v[144:147]
    v_mfma_f32_16x16x32_bf16 v[10:13], v[196:199], v[108:111], v[10:13]
    s_waitcnt vmcnt(24)
    v_mfma_f32_16x16x32_bf16 v[144:147], v[200:203], v[112:115], v[144:147]
    v_mfma_f32_16x16x32_bf16 v[10:13], v[204:207], v[112:115], v[10:13]
    s_waitcnt vmcnt(23)
    v_mfma_f32_16x16x32_bf16 v[144:147], v[208:211], v[116:119], v[144:147]
    v_mfma_f32_16x16x32_bf16 v[10:13], v[212:215], v[116:119], v[10:13]
    s_waitcnt vmcnt(22)
    v_mfma_f32_16x16x32_bf16 v[144:147], v[216:219], v[120:123], v[144:147]
    v_mfma_f32_16x16x32_bf16 v[10:13], v[220:223], v[120:123], v[10:13]
    s_waitcnt vmcnt(21)
    v_mfma_f32_16x16x32_bf16 v[144:147], v[224:227], v[124:127], v[144:147]
    v_mfma_f32_16x16x32_bf16 v[10:13], v[228:231], v[124:127], v[10:13]
    s_waitcnt vmcnt(20)
    v_mfma_f32_16x16x32_bf16 v[144:147], v[232:235], v[128:131], v[144:147]
    v_mfma_f32_16x16x32_bf16 v[10:13], v[236:239], v[128:131], v[10:13]
    s_waitcnt vmcnt(19)
    v_mfma_f32_16x16x32_bf16 v[144:147], v[240:243], v[132:135], v[144:147]
    v_mfma_f32_16x16x32_bf16 v[10:13], v[244:247], v[132:135], v[10:13]
    s_waitcnt vmcnt(18)
    v_mfma_f32_16x16x32_bf16 v[144:147], v[248:251], v[136:139], v[144:147]
    v_mfma_f32_16x16x32_bf16 v[10:13], v[252:255], v[136:139], v[10:13]
    v_mov_b32 v159, 0xff7fffff
    s_waitcnt vmcnt(17)
    v_sub_f32 v165, 1.0, v164
    v_cvt_pk_bf16_f32 v165, v165, v165
    v_lshlrev_b32 v165, 16, v165
    ds_write_b128 v9, v[144:147] offset:2048
    s_nop 1
    ds_write_b128 v9, v[10:13] offset:3072
    s_waitcnt lgkmcnt(0)
    s_barrier
    s_cmp_lg_u32 s26, 0
    s_cbranch_scc1 FFSK_83
    ds_read_b128 v[96:99], v2 offset:2048
    ds_read_b128 v[100:103], v2 offset:3072
    ds_read_b128 v[104:107], v2 offset:6144
    ds_read_b128 v[108:111], v2 offset:7168
    ds_read_b128 v[112:115], v2 offset:10240
    ds_read_b128 v[116:119], v2 offset:11264
    ds_read_b128 v[120:123], v2 offset:14336
    ds_read_b128 v[124:127], v2 offset:15360
    s_waitcnt lgkmcnt(0)
    v_pk_add_f32 v[96:97], v[96:97], v[104:105]
    v_pk_add_f32 v[112:113], v[112:113], v[120:121]
    v_pk_add_f32 v[98:99], v[98:99], v[106:107]
    v_pk_add_f32 v[114:115], v[114:115], v[122:123]
    v_pk_add_f32 v[100:101], v[100:101], v[108:109]
    v_pk_add_f32 v[116:117], v[116:117], v[124:125]
    v_pk_add_f32 v[102:103], v[102:103], v[110:111]
    v_pk_add_f32 v[118:119], v[118:119], v[126:127]
    v_pk_add_f32 v[96:97], v[96:97], v[112:113]
    v_pk_add_f32 v[98:99], v[98:99], v[114:115]
    v_pk_add_f32 v[100:101], v[100:101], v[116:117]
    v_pk_add_f32 v[102:103], v[102:103], v[118:119]
    v_cvt_pk_bf16_f32 v104, v96, v100
    v_lshlrev_b32 v96, 16, v104
    v_and_b32 v100, 0xffff0000, v104
    v_add_f32 v96, v96, v148
    v_add_f32 v100, v100, v149
    v_cvt_pk_bf16_f32 v104, v96, v100
    v_lshlrev_b32 v96, 16, v104
    v_and_b32 v100, 0xffff0000, v104
    v_mul_f32 v96, v165, v96
    v_mul_f32 v100, v165, v100
    v_cvt_pk_bf16_f32 v104, v96, v100
    v_lshlrev_b32 v96, 16, v104
    v_and_b32 v100, 0xffff0000, v104
    v_cvt_pk_bf16_f32 v104, v97, v101
    v_lshlrev_b32 v97, 16, v104
    v_and_b32 v101, 0xffff0000, v104
    v_add_f32 v97, v97, v150
    v_add_f32 v101, v101, v151
    v_cvt_pk_bf16_f32 v104, v97, v101
    v_lshlrev_b32 v97, 16, v104
    v_and_b32 v101, 0xffff0000, v104
    v_mul_f32 v97, v165, v97
    v_mul_f32 v101, v165, v101
    v_cvt_pk_bf16_f32 v104, v97, v101
    v_lshlrev_b32 v97, 16, v104
    v_and_b32 v101, 0xffff0000, v104
    v_cvt_pk_bf16_f32 v104, v98, v102
    v_lshlrev_b32 v98, 16, v104
    v_and_b32 v102, 0xffff0000, v104
    v_add_f32 v98, v98, v152
    v_add_f32 v102, v102, v153
    v_cvt_pk_bf16_f32 v104, v98, v102
    v_lshlrev_b32 v98, 16, v104
    v_and_b32 v102, 0xffff0000, v104
    v_mul_f32 v98, v165, v98
    v_mul_f32 v102, v165, v102
    v_cvt_pk_bf16_f32 v104, v98, v102
    v_lshlrev_b32 v98, 16, v104
    v_and_b32 v102, 0xffff0000, v104
    v_cvt_pk_bf16_f32 v104, v99, v103
    v_lshlrev_b32 v99, 16, v104
    v_and_b32 v103, 0xffff0000, v104
    v_add_f32 v99, v99, v154
    v_add_f32 v103, v103, v155
    v_cvt_pk_bf16_f32 v104, v99, v103
    v_lshlrev_b32 v99, 16, v104
    v_and_b32 v103, 0xffff0000, v104
    v_mul_f32 v99, v165, v99
    v_mul_f32 v103, v165, v103
    v_cvt_pk_bf16_f32 v104, v99, v103
    v_lshlrev_b32 v99, 16, v104
    v_and_b32 v103, 0xffff0000, v104
    ds_write_b128 v2, v[96:99] offset:2048
    ds_write_b128 v2, v[100:103] offset:3072
    s_waitcnt lgkmcnt(0)
FFSK_83:
    s_waitcnt vmcnt(5)
    v_mfma_f32_16x16x32_bf16 v[128:131], v[32:35], v[16:19], 0
    v_mfma_f32_16x16x32_bf16 v[132:135], v[48:51], v[16:19], 0
    v_mfma_f32_16x16x32_bf16 v[128:131], v[36:39], v[20:23], v[128:131]
    v_mfma_f32_16x16x32_bf16 v[132:135], v[52:55], v[20:23], v[132:135]
    v_mfma_f32_16x16x32_bf16 v[128:131], v[40:43], v[24:27], v[128:131]
    v_mfma_f32_16x16x32_bf16 v[132:135], v[56:59], v[24:27], v[132:135]
    v_mfma_f32_16x16x32_bf16 v[128:131], v[44:47], v[28:31], v[128:131]
    v_mfma_f32_16x16x32_bf16 v[132:135], v[60:63], v[28:31], v[132:135]
    s_nop 3
    v_cndmask_b32 v128, v159, v128, s[40:41]
    v_cndmask_b32 v129, v159, v129, s[42:43]
    v_cndmask_b32 v130, v159, v130, s[44:45]
    v_cndmask_b32 v131, v159, v131, s[46:47]
    v_cndmask_b32 v132, v159, v132, s[48:49]
    v_cndmask_b32 v133, v159, v133, s[50:51]
    v_cndmask_b32 v134, v159, v134, s[52:53]
    v_cndmask_b32 v135, v159, v135, s[54:55]
    v_max3_f32 v157, v128, v129, v130
    v_max3_f32 v157, v157, v131, v132
    v_max3_f32 v157, v157, v133, v134
    v_max_f32 v157, v157, v135
    v_mov_b32 v85, 0
    v_mov_b32 v86, 0
    s_waitcnt vmcnt(0)
    v_cmp_ge_u32 vcc, s32, v156
    s_cbranch_vccz CHOK_84
    s_cmp_ge_u32 s32, 57
    s_cbranch_scc1 QUICK_85
    s_mov_b32 s36, 0
WCS_86:
    buffer_load_dword v158, v162, s[12:15], 0 offen sc1
    s_waitcnt vmcnt(0)
    v_cmp_ge_u32 vcc, s32, v158
    s_cbranch_vccz WCSOK_87
    s_sleep 16
    s_add_u32 s36, s36, 1
    s_cmp_lt_u32 s36, 0x10000
    s_cbranch_scc1 WCS_86
    s_branch KEND3
WCSOK_87:
QUICK_85:
    s_mov_b32 s36, 0
WCH_88:
    buffer_load_dword v158, v162, s[12:15], 0 offen sc1
    s_waitcnt vmcnt(0)
    v_cmp_ge_u32 vcc, s32, v158
    s_cbranch_vccz WCHOK_89
    s_sleep 1
    s_add_u32 s36, s36, 1
    s_cmp_lt_u32 s36, 0x40000
    s_cbranch_scc1 WCH_88
    s_branch KEND3
WCHOK_89:
CHOK_84:
    buffer_load_dwordx2 v[96:97], v3, s[12:15], s38 offen offset:8 sc1
    buffer_load_dwordx2 v[98:99], v3, s[12:15], s38 offen offset:40 sc1
    buffer_load_dwordx2 v[100:101], v3, s[12:15], s38 offen offset:1032 sc1
    buffer_load_dwordx2 v[102:103], v3, s[12:15], s38 offen offset:1064 sc1
    buffer_load_dwordx2 v[104:105], v3, s[12:15], s38 offen offset:2056 sc1
    buffer_load_dwordx2 v[106:107], v3, s[12:15], s38 offen offset:2088 sc1
    buffer_load_dwordx2 v[108:109], v3, s[12:15], s38 offen offset:3080 sc1
    buffer_load_dwordx2 v[110:111], v3, s[12:15], s38 offen offset:3112 sc1
    s_lshl_b32 s29, s56, 11
    s_add_u32 s29, s29, s38
    buffer_load_dwordx2 v[112:113], v2, s[12:15], s29 offen offset:0 sc1
    buffer_load_dwordx2 v[114:115], v2, s[12:15], s29 offen offset:1024 sc1
    s_waitcnt vmcnt(8)
    v_mfma_f32_16x16x32_bf16 v[136:139], v[96:99], v[16:19], 0
    s_waitcnt vmcnt(6)
    v_mfma_f32_16x16x32_bf16 v[136:139], v[100:103], v[20:23], v[136:139]
    s_waitcnt vmcnt(4)
    v_mfma_f32_16x16x32_bf16 v[136:139], v[104:107], v[24:27], v[136:139]
    s_waitcnt vmcnt(2)
    v_mfma_f32_16x16x32_bf16 v[136:139], v[108:111], v[28:31], v[136:139]
    s_lshl_b32 s29, s56, 12
    s_add_u32 s29, s29, s37
    s_add_u32 s29, s29, 0x3100000
    s_nop 4
    v_mul_f32 v136, 0x3e0293ee, v136
    v_mul_f32 v137, 0x3e0293ee, v137
    v_max3_f32 v158, v157, v136, v137
    v_mov_b32 v159, v158
    s_nop 1
    v_permlane32_swap_b32 v158, v159
    v_max_f32 v158, v158, v159
    v_mov_b32 v159, v158
    s_nop 1
    v_permlane16_swap_b32 v158, v159
    v_max_f32 v158, v158, v159
    v_sub_f32 v128, v128, v158
    v_sub_f32 v129, v129, v158
    v_sub_f32 v130, v130, v158
    v_sub_f32 v131, v131, v158
    v_sub_f32 v132, v132, v158
    v_sub_f32 v133, v133, v158
    v_sub_f32 v134, v134, v158
    v_sub_f32 v135, v135, v158
    v_sub_f32 v136, v136, v158
    v_sub_f32 v137, v137, v158
    v_exp_f32 v128, v128
    v_exp_f32 v129, v129
    v_exp_f32 v130, v130
    v_exp_f32 v131, v131
    v_exp_f32 v132, v132
    v_exp_f32 v133, v133
    v_exp_f32 v134, v134
    v_exp_f32 v135, v135
    v_exp_f32 v136, v136
    v_exp_f32 v137, v137
    v_cvt_pk_bf16_f32 v80, v128, v129
    v_cvt_pk_bf16_f32 v81, v130, v131
    v_cvt_pk_bf16_f32 v82, v132, v133
    v_cvt_pk_bf16_f32 v83, v134, v135
    v_cvt_pk_bf16_f32 v84, v136, v137
    v_cvt_pk_bf16_f32 v87, v136, v137
    s_waitcnt vmcnt(0)
    v_mfma_f32_16x16x32_bf16 v[32:35], v[64:67], v[80:83], 0
    v_add_f32 v157, v136, v137
    v_add_f32 v157, v157, v128
    v_mfma_f32_16x16x32_bf16 v[36:39], v[68:71], v[80:83], 0
    v_add_f32 v157, v157, v129
    v_add_f32 v157, v157, v130
    v_mfma_f32_16x16x32_bf16 v[40:43], v[72:75], v[80:83], 0
    v_add_f32 v157, v157, v131
    v_add_f32 v157, v157, v132
    v_mfma_f32_16x16x32_bf16 v[44:47], v[76:79], v[80:83], 0
    v_add_f32 v157, v157, v133
    v_add_f32 v157, v157, v134
    v_add_f32 v157, v157, v135
    v_mfma_f32_16x16x16_bf16 v[32:35], v[112:113], v[84:85], v[32:35]
    v_mov_b32 v159, v157
    s_nop 1
    v_permlane32_swap_b32 v157, v159
    v_add_f32 v157, v157, v159
    v_mfma_f32_16x16x16_bf16 v[36:39], v[112:113], v[86:87], v[36:39]
    v_mov_b32 v159, v157
    s_nop 1
    v_permlane16_swap_b32 v157, v159
    v_add_f32 v157, v157, v159
    v_mfma_f32_16x16x16_bf16 v[40:43], v[114:115], v[84:85], v[40:43]
    v_mfma_f32_16x16x16_bf16 v[44:47], v[114:115], v[86:87], v[44:47]
    v_rcp_f32 v157, v157
    s_nop 0
    v_mul_f32 v32, v32, v157
    v_mul_f32 v33, v33, v157
    v_mul_f32 v34, v34, v157
    v_mul_f32 v35, v35, v157
    v_mul_f32 v36, v36, v157
    v_mul_f32 v37, v37, v157
    v_mul_f32 v38, v38, v157
    v_mul_f32 v39, v39, v157
    v_cvt_pk_bf16_f32 v16, v32, v36
    v_cvt_pk_bf16_f32 v17, v33, v37
    v_cvt_pk_bf16_f32 v18, v34, v38
    v_cvt_pk_bf16_f32 v19, v35, v39
    v_mul_f32 v40, v40, v157
    v_mul_f32 v41, v41, v157
    v_mul_f32 v42, v42, v157
    v_mul_f32 v43, v43, v157
    v_mul_f32 v44, v44, v157
    v_mul_f32 v45, v45, v157
    v_mul_f32 v46, v46, v157
    v_mul_f32 v47, v47, v157
    v_cvt_pk_bf16_f32 v20, v40, v44
    v_cvt_pk_bf16_f32 v21, v41, v45
    v_cvt_pk_bf16_f32 v22, v42, v46
    v_cvt_pk_bf16_f32 v23, v43, v47
    s_add_u32 s58, s58, 1
    v_mov_b32 v158, s58
    s_cmp_eq_u32 s59, 0
    s_cbranch_scc1 FAR_90
    buffer_store_dwordx4 v[16:19], v4, s[12:15], s29 offen offset:0
    buffer_store_dwordx4 v[20:23], v4, s[12:15], s29 offen offset:2048
    s_waitcnt vmcnt(0)
    buffer_store_dword v158, v160, s[12:15], 0 offen
    s_branch NJ_91
FAR_90:
    buffer_store_dwordx4 v[16:19], v4, s[12:15], s29 offen offset:0 sc1
    buffer_store_dwordx4 v[20:23], v4, s[12:15], s29 offen offset:2048 sc1
    s_waitcnt vmcnt(0)
    buffer_store_dword v158, v160, s[12:15], 0 offen sc1
NJ_91:
    s_mov_b32 s36, 0
WGR_92:
    buffer_load_dword v159, v163, s[12:15], 0 offen sc1
    s_waitcnt vmcnt(0)
    v_cmp_gt_u32 vcc, s58, v159
    s_cbranch_vccz WGROK_93
    s_sleep 2
    s_add_u32 s36, s36, 1
    s_cmp_lt_u32 s36, 0x40000
    s_cbranch_scc1 WGR_92
    s_branch KEND3
WGROK_93:
    s_lshl_b32 s39, s32, 18
    s_lshl_b32 s29, s26, 16
    s_add_u32 s39, s39, s29
    s_add_u32 s39, s39, 0x3100000
    s_lshl_b32 s30, s25, 12
    s_xor_b32 s29, s30, 0
    s_add_u32 s29, s29, s39
    buffer_load_dwordx4 v[16:19], v5, s[12:15], s29 offen offset:0 sc1
    buffer_load_dwordx4 v[20:23], v5, s[12:15], s29 offen offset:2048 sc1
    s_xor_b32 s29, s30, 4096
    s_add_u32 s29, s29, s39
    buffer_load_dwordx4 v[24:27], v5, s[12:15], s29 offen offset:0 sc1
    buffer_load_dwordx4 v[28:31], v5, s[12:15], s29 offen offset:2048 sc1
    s_xor_b32 s29, s30, 8192
    s_add_u32 s29, s29, s39
    buffer_load_dwordx4 v[32:35], v5, s[12:15], s29 offen offset:0 sc1
    buffer_load_dwordx4 v[36:39], v5, s[12:15], s29 offen offset:2048 sc1
    s_xor_b32 s29, s30, 12288
    s_add_u32 s29, s29, s39
    buffer_load_dwordx4 v[40:43], v5, s[12:15], s29 offen offset:0 sc1
    buffer_load_dwordx4 v[44:47], v5, s[12:15], s29 offen offset:2048 sc1
    s_xor_b32 s29, s30, 16384
    s_add_u32 s29, s29, s39
    buffer_load_dwordx4 v[48:51], v5, s[12:15], s29 offen offset:0 sc1
    buffer_load_dwordx4 v[52:55], v5, s[12:15], s29 offen offset:2048 sc1
    s_xor_b32 s29, s30, 20480
    s_add_u32 s29, s29, s39
    buffer_load_dwordx4 v[56:59], v5, s[12:15], s29 offen offset:0 sc1
    buffer_load_dwordx4 v[60:63], v5, s[12:15], s29 offen offset:2048 sc1
    s_xor_b32 s29, s30, 24576
    s_add_u32 s29, s29, s39
    buffer_load_dwordx4 v[64:67], v5, s[12:15], s29 offen offset:0 sc1
    buffer_load_dwordx4 v[68:71], v5, s[12:15], s29 offen offset:2048 sc1
    s_xor_b32 s29, s30, 28672
    s_add_u32 s29, s29, s39
    buffer_load_dwordx4 v[72:75], v5, s[12:15], s29 offen offset:0 sc1
    buffer_load_dwordx4 v[76:79], v5, s[12:15], s29 offen offset:2048 sc1
    s_xor_b32 s29, s30, 32768
    s_add_u32 s29, s29, s39
    buffer_load_dwordx4 v[80:83], v5, s[12:15], s29 offen offset:0 sc1
    buffer_load_dwordx4 v[84:87], v5, s[12:15], s29 offen offset:2048 sc1
    s_xor_b32 s29, s30, 36864
    s_add_u32 s29, s29, s39
    buffer_load_dwordx4 v[88:91], v5, s[12:15], s29 offen offset:0 sc1
    buffer_load_dwordx4 v[92:95], v5, s[12:15], s29 offen offset:2048 sc1
    s_xor_b32 s29, s30, 40960
    s_add_u32 s29, s29, s39
    buffer_load_dwordx4 v[96:99], v5, s[12:15], s29 offen offset:0 sc1
    buffer_load_dwordx4 v[100:103], v5, s[12:15], s29 offen offset:2048 sc1
    s_xor_b32 s29, s30, 45056
    s_add_u32 s29, s29, s39
    buffer_load_dwordx4 v[104:107], v5, s[12:15], s29 offen offset:0 sc1
    buffer_load_dwordx4 v[108:111], v5, s[12:15], s29 offen offset:2048 sc1
    s_xor_b32 s29, s30, 49152
    s_add_u32 s29, s29, s39
    buffer_load_dwordx4 v[112:115], v5, s[12:15], s29 offen offset:0 sc1
    buffer_load_dwordx4 v[116:119], v5, s[12:15], s29 offen offset:2048 sc1
    s_xor_b32 s29, s30, 53248
    s_add_u32 s29, s29, s39
    buffer_load_dwordx4 v[120:123], v5, s[12:15], s29 offen offset:0 sc1
    buffer_load_dwordx4 v[124:127], v5, s[12:15], s29 offen offset:2048 sc1
    s_xor_b32 s29, s30, 57344
    s_add_u32 s29, s29, s39
    buffer_load_dwordx4 v[128:131], v5, s[12:15], s29 offen offset:0 sc1
    buffer_load_dwordx4 v[132:135], v5, s[12:15], s29 offen offset:2048 sc1
    s_xor_b32 s29, s30, 61440
    s_add_u32 s29, s29, s39
    buffer_load_dwordx4 v[136:139], v5, s[12:15], s29 offen offset:0 sc1
    buffer_load_dwordx4 v[140:143], v5, s[12:15], s29 offen offset:2048 sc1
    s_waitcnt vmcnt(31)
    v_mfma_f32_16x16x32_bf16 v[144:147], a[0:3], v[16:19], 0
    v_mfma_f32_16x16x32_bf16 v[10:13], a[4:7], v[16:19], 0
    s_waitcnt vmcnt(30)
    v_mfma_f32_16x16x32_bf16 v[144:147], a[8:11], v[20:23], v[144:147]
    v_mfma_f32_16x16x32_bf16 v[10:13], a[12:15], v[20:23], v[10:13]
    s_waitcnt vmcnt(29)
    v_mfma_f32_16x16x32_bf16 v[144:147], a[16:19], v[24:27], v[144:147]
    v_mfma_f32_16x16x32_bf16 v[10:13], a[20:23], v[24:27], v[10:13]
    s_waitcnt vmcnt(28)
    v_mfma_f32_16x16x32_bf16 v[144:147], a[24:27], v[28:31], v[144:147]
    v_mfma_f32_16x16x32_bf16 v[10:13], a[28:31], v[28:31], v[10:13]
    s_waitcnt vmcnt(27)
    v_mfma_f32_16x16x32_bf16 v[144:147], a[32:35], v[32:35], v[144:147]
    v_mfma_f32_16x16x32_bf16 v[10:13], a[36:39], v[32:35], v[10:13]
    s_waitcnt vmcnt(26)
    v_mfma_f32_16x16x32_bf16 v[144:147], a[40:43], v[36:39], v[144:147]
    v_mfma_f32_16x16x32_bf16 v[10:13], a[44:47], v[36:39], v[10:13]
    s_waitcnt vmcnt(25)
    v_mfma_f32_16x16x32_bf16 v[144:147], a[48:51], v[40:43], v[144:147]
    v_mfma_f32_16x16x32_bf16 v[10:13], a[52:55], v[40:43], v[10:13]
    s_waitcnt vmcnt(24)
    v_mfma_f32_16x16x32_bf16 v[144:147], a[56:59], v[44:47], v[144:147]
    v_mfma_f32_16x16x32_bf16 v[10:13], a[60:63], v[44:47], v[10:13]
    s_waitcnt vmcnt(23)
    v_mfma_f32_16x16x32_bf16 v[144:147], a[64:67], v[48:51], v[144:147]
    v_mfma_f32_16x16x32_bf16 v[10:13], a[68:71], v[48:51], v[10:13]
    s_waitcnt vmcnt(22)
    v_mfma_f32_16x16x32_bf16 v[144:147], a[72:75], v[52:55], v[144:147]
    v_mfma_f32_16x16x32_bf16 v[10:13], a[76:79], v[52:55], v[10:13]
    s_waitcnt vmcnt(21)
    v_mfma_f32_16x16x32_bf16 v[144:147], a[80:83], v[56:59], v[144:147]
    v_mfma_f32_16x16x32_bf16 v[10:13], a[84:87], v[56:59], v[10:13]
    s_waitcnt vmcnt(20)
    v_mfma_f32_16x16x32_bf16 v[144:147], a[88:91], v[60:63], v[144:147]
    v_mfma_f32_16x16x32_bf16 v[10:13], a[92:95], v[60:63], v[10:13]
    s_waitcnt vmcnt(19)
    v_mfma_f32_16x16x32_bf16 v[144:147], a[96:99], v[64:67], v[144:147]
    v_mfma_f32_16x16x32_bf16 v[10:13], a[100:103], v[64:67], v[10:13]
    s_waitcnt vmcnt(18)
    v_mfma_f32_16x16x32_bf16 v[144:147], a[104:107], v[68:71], v[144:147]
    v_mfma_f32_16x16x32_bf16 v[10:13], a[108:111], v[68:71], v[10:13]
    s_waitcnt vmcnt(17)
    v_mfma_f32_16x16x32_bf16 v[144:147], a[112:115], v[72:75], v[144:147]
    v_mfma_f32_16x16x32_bf16 v[10:13], a[116:119], v[72:75], v[10:13]
    s_waitcnt vmcnt(16)
    v_mfma_f32_16x16x32_bf16 v[144:147], a[120:123], v[76:79], v[144:147]
    v_mfma_f32_16x16x32_bf16 v[10:13], a[124:127], v[76:79], v[10:13]
    s_waitcnt vmcnt(15)
    v_mfma_f32_16x16x32_bf16 v[144:147], a[128:131], v[80:83], v[144:147]
    v_mfma_f32_16x16x32_bf16 v[10:13], a[132:135], v[80:83], v[10:13]
    s_waitcnt vmcnt(14)
    v_mfma_f32_16x16x32_bf16 v[144:147], a[136:139], v[84:87], v[144:147]
    v_mfma_f32_16x16x32_bf16 v[10:13], a[140:143], v[84:87], v[10:13]
    s_waitcnt vmcnt(13)
    v_mfma_f32_16x16x32_bf16 v[144:147], a[144:147], v[88:91], v[144:147]
    v_mfma_f32_16x16x32_bf16 v[10:13], a[148:151], v[88:91], v[10:13]
    s_waitcnt vmcnt(12)
    v_mfma_f32_16x16x32_bf16 v[144:147], a[152:155], v[92:95], v[144:147]
    v_mfma_f32_16x16x32_bf16 v[10:13], a[156:159], v[92:95], v[10:13]
    s_waitcnt vmcnt(11)
    v_mfma_f32_16x16x32_bf16 v[144:147], a[160:163], v[96:99], v[144:147]
    v_mfma_f32_16x16x32_bf16 v[10:13], a[164:167], v[96:99], v[10:13]
    s_waitcnt vmcnt(10)
    v_mfma_f32_16x16x32_bf16 v[144:147], a[168:171], v[100:103], v[144:147]
    v_mfma_f32_16x16x32_bf16 v[10:13], a[172:175], v[100:103], v[10:13]
    s_waitcnt vmcnt(9)
    v_mfma_f32_16x16x32_bf16 v[144:147], a[176:179], v[104:107], v[144:147]
    v_mfma_f32_16x16x32_bf16 v[10:13], a[180:183], v[104:107], v[10:13]
    s_waitcnt vmcnt(8)
    v_mfma_f32_16x16x32_bf16 v[144:147], a[184:187], v[108:111], v[144:147]
    v_mfma_f32_16x16x32_bf16 v[10:13], a[188:191], v[108:111], v[10:13]
    s_waitcnt vmcnt(7)
    v_mfma_f32_16x16x32_bf16 v[144:147], a[192:195], v[112:115], v[144:147]
    v_mfma_f32_16x16x32_bf16 v[10:13], a[196:199], v[112:115], v[10:13]
    s_waitcnt vmcnt(6)
    v_mfma_f32_16x16x32_bf16 v[144:147], a[200:203], v[116:119], v[144:147]
    v_mfma_f32_16x16x32_bf16 v[10:13], a[204:207], v[116:119], v[10:13]
    s_waitcnt vmcnt(5)
    v_mfma_f32_16x16x32_bf16 v[144:147], a[208:211], v[120:123], v[144:147]
    v_mfma_f32_16x16x32_bf16 v[10:13], a[212:215], v[120:123], v[10:13]
    s_waitcnt vmcnt(4)
    v_mfma_f32_16x16x32_bf16 v[144:147], a[216:219], v[124:127], v[144:147]
    v_mfma_f32_16x16x32_bf16 v[10:13], a[220:223], v[124:127], v[10:13]
    s_waitcnt vmcnt(3)
    v_mfma_f32_16x16x32_bf16 v[144:147], a[224:227], v[128:131], v[144:147]
    v_mfma_f32_16x16x32_bf16 v[10:13], a[228:231], v[128:131], v[10:13]
    s_waitcnt vmcnt(2)
    v_mfma_f32_16x16x32_bf16 v[144:147], a[232:235], v[132:135], v[144:147]
    v_mfma_f32_16x16x32_bf16 v[10:13], a[236:239], v[132:135], v[10:13]
    s_waitcnt vmcnt(1)
    v_mfma_f32_16x16x32_bf16 v[144:147], a[240:243], v[136:139], v[144:147]
    v_mfma_f32_16x16x32_bf16 v[10:13], a[244:247], v[136:139], v[10:13]
    s_waitcnt vmcnt(0)
    v_mfma_f32_16x16x32_bf16 v[144:147], a[248:251], v[140:143], v[144:147]
    v_mfma_f32_16x16x32_bf16 v[10:13], a[252:255], v[140:143], v[10:13]
    s_nop 3
    ds_write_b128 v9, v[144:147] offset:0
    s_nop 2
    ds_write_b128 v9, v[10:13] offset:1024
    s_waitcnt lgkmcnt(0)
    s_barrier
    s_cmp_lg_u32 s26, 0
    s_cbranch_scc1 FINSK_94
    ds_read_b128 v[16:19], v2 offset:0
    ds_read_b128 v[20:23], v2 offset:1024
    ds_read_b128 v[24:27], v2 offset:4096
    ds_read_b128 v[28:31], v2 offset:5120
    ds_read_b128 v[32:35], v2 offset:8192
    ds_read_b128 v[36:39], v2 offset:9216
    ds_read_b128 v[40:43], v2 offset:12288
    ds_read_b128 v[44:47], v2 offset:13312
    ds_read_b128 v[48:51], v2 offset:2048
    ds_read_b128 v[52:55], v2 offset:3072
    s_waitcnt lgkmcnt(2)
    v_pk_add_f32 v[16:17], v[16:17], v[24:25]
    v_pk_add_f32 v[32:33], v[32:33], v[40:41]
    v_pk_add_f32 v[18:19], v[18:19], v[26:27]
    v_pk_add_f32 v[34:35], v[34:35], v[42:43]
    v_pk_add_f32 v[20:21], v[20:21], v[28:29]
    v_pk_add_f32 v[36:37], v[36:37], v[44:45]
    v_pk_add_f32 v[22:23], v[22:23], v[30:31]
    v_pk_add_f32 v[38:39], v[38:39], v[46:47]
    v_pk_add_f32 v[16:17], v[16:17], v[32:33]
    v_pk_add_f32 v[18:19], v[18:19], v[34:35]
    v_pk_add_f32 v[20:21], v[20:21], v[36:37]
    v_pk_add_f32 v[22:23], v[22:23], v[38:39]
    s_waitcnt lgkmcnt(0)
    v_cvt_pk_bf16_f32 v24, v16, v20
    v_lshlrev_b32 v16, 16, v24
    v_and_b32 v20, 0xffff0000, v24
    v_mul_f32 v16, v164, v16
    v_mul_f32 v20, v164, v20
    v_cvt_pk_bf16_f32 v24, v16, v20
    v_lshlrev_b32 v16, 16, v24
    v_and_b32 v20, 0xffff0000, v24
    v_add_f32 v16, v16, v48
    v_add_f32 v20, v20, v52
    v_cvt_pk_bf16_f32 v28, v16, v20
    v_cvt_pk_bf16_f32 v24, v17, v21
    v_lshlrev_b32 v17, 16, v24
    v_and_b32 v21, 0xffff0000, v24
    v_mul_f32 v17, v164, v17
    v_mul_f32 v21, v164, v21
    v_cvt_pk_bf16_f32 v24, v17, v21
    v_lshlrev_b32 v17, 16, v24
    v_and_b32 v21, 0xffff0000, v24
    v_add_f32 v17, v17, v49
    v_add_f32 v21, v21, v53
    v_cvt_pk_bf16_f32 v29, v17, v21
    v_cvt_pk_bf16_f32 v24, v18, v22
    v_lshlrev_b32 v18, 16, v24
    v_and_b32 v22, 0xffff0000, v24
    v_mul_f32 v18, v164, v18
    v_mul_f32 v22, v164, v22
    v_cvt_pk_bf16_f32 v24, v18, v22
    v_lshlrev_b32 v18, 16, v24
    v_and_b32 v22, 0xffff0000, v24
    v_add_f32 v18, v18, v50
    v_add_f32 v22, v22, v54
    v_cvt_pk_bf16_f32 v30, v18, v22
    v_cvt_pk_bf16_f32 v24, v19, v23
    v_lshlrev_b32 v19, 16, v24
    v_and_b32 v23, 0xffff0000, v24
    v_mul_f32 v19, v164, v19
    v_mul_f32 v23, v164, v23
    v_cvt_pk_bf16_f32 v24, v19, v23
    v_lshlrev_b32 v19, 16, v24
    v_and_b32 v23, 0xffff0000, v24
    v_add_f32 v19, v19, v51
    v_add_f32 v23, v23, v55
    v_cvt_pk_bf16_f32 v31, v19, v23
    s_lshl_b32 s29, s32, 15
    buffer_store_dwordx4 v[28:31], v8, s[16:19], s29 offen sc1
FINSK_94:
    s_barrier
    s_add_u32 s32, s32, 7
    s_cmp_lt_u32 s32, 64
    s_cbranch_scc1 P34L_82
KEND3:
    s_endpgm
.section .rodata,"a"
.p2align 6
.amdhsa_kernel gated_mix__memory_aug_recurrent_mem_tr__dense_activation_gelu__prompt_kernel
  .amdhsa_next_free_vgpr 512
  .amdhsa_next_free_sgpr 102
  .amdhsa_accum_offset 256
  .amdhsa_group_segment_fixed_size 0
  .amdhsa_kernarg_size 128
  .amdhsa_user_sgpr_count 2
  .amdhsa_user_sgpr_kernarg_segment_ptr 1
  .amdhsa_system_sgpr_workgroup_id_x 1
.end_amdhsa_kernel
```
